```python
import torch

def _softmax(x, axis=-1):
    return torch.softmax(x, dim=axis)

def _gelu(x):
    return torch.nn.functional.gelu(x, approximate='tanh')

def _silu(x):
    return torch.nn.functional.silu(x)

def _sigmoid(x):
    return torch.sigmoid(x)

def _layernorm(x, axis=-1, eps=1e-05):
    m = x.mean(dim=axis, keepdim=True)
    v = x.var(dim=axis, keepdim=True, unbiased=False)
    return (x - m) / torch.sqrt(v + eps)

def _scatter_add(tgt, idx, src, axis=0):
    return tgt.clone().index_add_(axis, idx, src)

def _segment_sum(src, seg, n):
    out = torch.zeros((n,) + src.shape[1:], dtype=src.dtype)
    return out.index_add_(0, seg, src)

def _pad(x, pw):
    flat = tuple((v for pair in reversed(pw) for v in pair))
    return torch.nn.functional.pad(x, flat)
kernel_name = 'adaLN_cond__gqa_block_cached__swiglu_ffn__prompt'

def setup_inputs():

    _w = lambda a: (lambda t: t.to(torch.bfloat16) if t.is_floating_point() else t)(torch.as_tensor(a))

    def _A_setup():
        B, Sq, D = (1, 2048, 576)
        Hq, Hkv, Sk, Dh = (32, 16, 2048, 128)
        assert Hq % Hkv == 0, (Hq, Hkv)
        return {'x': _w((lambda *s: torch.randn(*s, dtype=torch.bfloat16) * 0.05)(B, Sq, D)), 'k_cache': _w((lambda *s: torch.randn(*s, dtype=torch.bfloat16) * 3.2)(B, Hkv, Sk, Dh)), 'v_cache': _w((lambda *s: torch.randn(*s, dtype=torch.bfloat16) * 0.4)(B, Hkv, Sk, Dh)), 'wq': _w((lambda *s: torch.randn(*s, dtype=torch.bfloat16) * 3.2)(D, Hq * Dh) * D ** (-0.5)), 'wo': _w((lambda *s: torch.randn(*s, dtype=torch.bfloat16) * 0.4)(Hq * Dh, D) * (Hq * Dh) ** (-0.5))}
    _A_in = _A_setup()

    def _B_setup():
        B, S, D, F = (1, 2048, 576, 4608)
        return {'x': _w((lambda *s: torch.randn(*s, dtype=torch.bfloat16) * 0.05)(B, S, D)), 'w_gate': _w((lambda *s: torch.randn(*s, dtype=torch.bfloat16) * 0.05)(D, F)), 'w_up': _w((lambda *s: torch.randn(*s, dtype=torch.bfloat16) * 0.05)(D, F)), 'w_down': _w((lambda *s: torch.randn(*s, dtype=torch.bfloat16) * 0.05)(F, D))}
    _B_in = _B_setup()
    return {'A_x': _A_in['x'], 'A_k_cache': _A_in['k_cache'], 'A_v_cache': _A_in['v_cache'], 'A_wq': _A_in['wq'], 'A_wo': _A_in['wo'], 'B_x': _B_in['x'], 'B_w_gate': _B_in['w_gate'], 'B_w_up': _B_in['w_up'], 'B_w_down': _B_in['w_down'], 'c': _w((lambda *s: torch.randn(*s, dtype=torch.bfloat16) * 0.1)(1, 576) * 8.0), 'w_mod': _w((lambda *s: torch.randn(*s, dtype=torch.bfloat16) * 0.1)(576, 6 * 576) * 576 ** (-0.5) * 8.0)}

def reference(A_x, A_k_cache, A_v_cache, A_wq, A_wo, B_x, B_w_gate, B_w_up, B_w_down, c, w_mod):

    def _A_ref(x, k_cache, v_cache, wq, wo):
        B, Sq, D = x.shape
        Hq, Dh = (32, 128)
        Hkv = k_cache.shape[1]
        rep = Hq // Hkv
        q = (lambda x, *d: x.permute(*d))((x @ wq).reshape(B, Sq, Hq, Dh), 0, 2, 1, 3)
        k = (lambda x, n, axis: torch.repeat_interleave(x, n, dim=axis))(k_cache, rep, axis=1)
        v = (lambda x, n, axis: torch.repeat_interleave(x, n, dim=axis))(v_cache, rep, axis=1)
        scores = torch.einsum('bhqd,bhkd->bhqk', q, k) * Dh ** (-0.5)
        p = _softmax(scores, axis=-1)
        o = torch.einsum('bhqk,bhkd->bhqd', p, v)
        return (lambda x, *d: x.permute(*d))(o, 0, 2, 1, 3).reshape(B, Sq, Hq * Dh) @ wo

    def _B_ref(x, w_gate, w_up, w_down):
        g = _silu(x @ w_gate)
        u = x @ w_up
        return g * u @ w_down
    x = A_x
    mod = (_silu(c) @ w_mod).reshape(c.shape[0], 6, 1, -1)
    sa, ca, ga, sb, cb, gb = (mod[:, 0].clone(), mod[:, 1].clone(), mod[:, 2].clone(), mod[:, 3].clone(), mod[:, 4].clone(), mod[:, 5].clone())
    h = _layernorm(x, axis=-1) * (1 + ca) + sa
    x = x + ga * _A_ref(h, A_k_cache, A_v_cache, A_wq, A_wo)
    h = _layernorm(x, axis=-1) * (1 + cb) + sb
    x = x + gb * _B_ref(h, B_w_gate, B_w_up, B_w_down)
    return x
```

```asm
; @launch kernel=k0_mod_kernel grid=(108,1,1) block=(256,1,1) lds=9216
; @launch kernel=k1_ln_kernel grid=(256,1,1) block=(576,1,1) lds=8192
; @launch kernel=k2_attn_kernel grid=(256,1,1) block=(256,1,1) lds=131072
; @launch kernel=k3_oproj_kernel grid=(256,1,1) block=(256,1,1) lds=147456
; @launch kernel=k4_red_kernel grid=(256,1,1) block=(576,1,1) lds=8192
; @launch kernel=k5_gateup_kernel grid=(256,1,1) block=(256,1,1) lds=148480
; @launch kernel=k6_down_kernel grid=(256,1,1) block=(256,1,1) lds=147456
; @launch kernel=k7_red_kernel grid=(256,1,1) block=(576,1,1) lds=8192
.amdgcn_target "amdgcn-amd-amdhsa--gfx950"
.text
.globl k0_mod_kernel
.p2align 8
.type k0_mod_kernel,@function
k0_mod_kernel:
  s_cmp_ge_u32 s2, 108
  s_cbranch_scc1 L_k0_mod_kernel_end
  s_load_dwordx2 s[4:5], s[0:1], 80
  s_mov_b32 s6, 3981312
  s_mov_b32 s7, 0x00020000
  s_load_dwordx2 s[8:9], s[0:1], 72
  s_mov_b32 s10, 1152
  s_mov_b32 s11, 0x00020000
  s_load_dwordx2 s[12:13], s[0:1], 104
  s_mov_b32 s14, 13824
  s_mov_b32 s15, 0x00020000
  s_and_b32 s20, s2, 7
  s_lshl_b32 s20, s20, 1
  s_bfe_u32 s21, s2, 0x10003
  s_add_u32 s20, s20, s21
  s_and_b32 s21, s2, 0xfffffff0
  s_add_u32 s20, s20, s21
  s_cmp_ge_u32 s2, 96
  s_cselect_b32 s20, s2, s20
  s_mov_b32 s16, 0xffff0000
  s_lshl_b32 s17, s20, 6
  v_and_b32 v1, 3, v0
  v_lshrrev_b32 v2, 2, v0
  v_mul_u32_u24 v4, 62208, v2
  v_lshl_add_u32 v4, v1, 4, v4
  v_mul_u32_u24 v5, 18, v2
  s_waitcnt lgkmcnt(0)
  buffer_load_ushort v10, v5, s[8:11], 0 offen offset:0
  buffer_load_ushort v11, v5, s[8:11], 0 offen offset:2
  buffer_load_ushort v12, v5, s[8:11], 0 offen offset:4
  buffer_load_ushort v13, v5, s[8:11], 0 offen offset:6
  buffer_load_ushort v14, v5, s[8:11], 0 offen offset:8
  buffer_load_ushort v15, v5, s[8:11], 0 offen offset:10
  buffer_load_ushort v16, v5, s[8:11], 0 offen offset:12
  buffer_load_ushort v17, v5, s[8:11], 0 offen offset:14
  buffer_load_ushort v18, v5, s[8:11], 0 offen offset:16
  buffer_load_dwordx4 v[20:23], v4, s[4:7], s17 offen
  v_add_u32 v4, 6912, v4
  buffer_load_dwordx4 v[24:27], v4, s[4:7], s17 offen
  v_add_u32 v4, 6912, v4
  buffer_load_dwordx4 v[28:31], v4, s[4:7], s17 offen
  v_add_u32 v4, 6912, v4
  buffer_load_dwordx4 v[32:35], v4, s[4:7], s17 offen
  v_add_u32 v4, 6912, v4
  buffer_load_dwordx4 v[36:39], v4, s[4:7], s17 offen
  v_add_u32 v4, 6912, v4
  buffer_load_dwordx4 v[40:43], v4, s[4:7], s17 offen
  v_add_u32 v4, 6912, v4
  buffer_load_dwordx4 v[44:47], v4, s[4:7], s17 offen
  v_add_u32 v4, 6912, v4
  buffer_load_dwordx4 v[48:51], v4, s[4:7], s17 offen
  v_add_u32 v4, 6912, v4
  buffer_load_dwordx4 v[52:55], v4, s[4:7], s17 offen
  s_waitcnt vmcnt(9)
  v_lshlrev_b32 v10, 16, v10
  v_mul_f32 v6, 0xbfb8aa3b, v10
  v_exp_f32 v6, v6
  s_nop 0
  v_add_f32 v6, 1.0, v6
  v_rcp_f32 v6, v6
  s_nop 0
  v_mul_f32 v6, v10, v6
  v_cvt_pk_bf16_f32 v6, v6, v6
  v_lshlrev_b32 v10, 16, v6
  v_lshlrev_b32 v11, 16, v11
  v_mul_f32 v6, 0xbfb8aa3b, v11
  v_exp_f32 v6, v6
  s_nop 0
  v_add_f32 v6, 1.0, v6
  v_rcp_f32 v6, v6
  s_nop 0
  v_mul_f32 v6, v11, v6
  v_cvt_pk_bf16_f32 v6, v6, v6
  v_lshlrev_b32 v11, 16, v6
  v_lshlrev_b32 v12, 16, v12
  v_mul_f32 v6, 0xbfb8aa3b, v12
  v_exp_f32 v6, v6
  s_nop 0
  v_add_f32 v6, 1.0, v6
  v_rcp_f32 v6, v6
  s_nop 0
  v_mul_f32 v6, v12, v6
  v_cvt_pk_bf16_f32 v6, v6, v6
  v_lshlrev_b32 v12, 16, v6
  v_lshlrev_b32 v13, 16, v13
  v_mul_f32 v6, 0xbfb8aa3b, v13
  v_exp_f32 v6, v6
  s_nop 0
  v_add_f32 v6, 1.0, v6
  v_rcp_f32 v6, v6
  s_nop 0
  v_mul_f32 v6, v13, v6
  v_cvt_pk_bf16_f32 v6, v6, v6
  v_lshlrev_b32 v13, 16, v6
  v_lshlrev_b32 v14, 16, v14
  v_mul_f32 v6, 0xbfb8aa3b, v14
  v_exp_f32 v6, v6
  s_nop 0
  v_add_f32 v6, 1.0, v6
  v_rcp_f32 v6, v6
  s_nop 0
  v_mul_f32 v6, v14, v6
  v_cvt_pk_bf16_f32 v6, v6, v6
  v_lshlrev_b32 v14, 16, v6
  v_lshlrev_b32 v15, 16, v15
  v_mul_f32 v6, 0xbfb8aa3b, v15
  v_exp_f32 v6, v6
  s_nop 0
  v_add_f32 v6, 1.0, v6
  v_rcp_f32 v6, v6
  s_nop 0
  v_mul_f32 v6, v15, v6
  v_cvt_pk_bf16_f32 v6, v6, v6
  v_lshlrev_b32 v15, 16, v6
  v_lshlrev_b32 v16, 16, v16
  v_mul_f32 v6, 0xbfb8aa3b, v16
  v_exp_f32 v6, v6
  s_nop 0
  v_add_f32 v6, 1.0, v6
  v_rcp_f32 v6, v6
  s_nop 0
  v_mul_f32 v6, v16, v6
  v_cvt_pk_bf16_f32 v6, v6, v6
  v_lshlrev_b32 v16, 16, v6
  v_lshlrev_b32 v17, 16, v17
  v_mul_f32 v6, 0xbfb8aa3b, v17
  v_exp_f32 v6, v6
  s_nop 0
  v_add_f32 v6, 1.0, v6
  v_rcp_f32 v6, v6
  s_nop 0
  v_mul_f32 v6, v17, v6
  v_cvt_pk_bf16_f32 v6, v6, v6
  v_lshlrev_b32 v17, 16, v6
  v_lshlrev_b32 v18, 16, v18
  v_mul_f32 v6, 0xbfb8aa3b, v18
  v_exp_f32 v6, v6
  s_nop 0
  v_add_f32 v6, 1.0, v6
  v_rcp_f32 v6, v6
  s_nop 0
  v_mul_f32 v6, v18, v6
  v_cvt_pk_bf16_f32 v6, v6, v6
  v_lshlrev_b32 v18, 16, v6
  v_mov_b32 v60, 0
  v_mov_b32 v61, 0
  v_mov_b32 v62, 0
  v_mov_b32 v63, 0
  v_mov_b32 v64, 0
  v_mov_b32 v65, 0
  v_mov_b32 v66, 0
  v_mov_b32 v67, 0
  s_waitcnt vmcnt(8)
  v_lshlrev_b32 v70, 16, v20
  v_and_b32 v71, s16, v20
  v_lshlrev_b32 v72, 16, v21
  v_and_b32 v73, s16, v21
  v_lshlrev_b32 v74, 16, v22
  v_and_b32 v75, s16, v22
  v_lshlrev_b32 v76, 16, v23
  v_and_b32 v77, s16, v23
  v_fmac_f32 v60, v70, v10
  v_fmac_f32 v61, v71, v10
  v_fmac_f32 v62, v72, v10
  v_fmac_f32 v63, v73, v10
  v_fmac_f32 v64, v74, v10
  v_fmac_f32 v65, v75, v10
  v_fmac_f32 v66, v76, v10
  v_fmac_f32 v67, v77, v10
  s_waitcnt vmcnt(7)
  v_lshlrev_b32 v70, 16, v24
  v_and_b32 v71, s16, v24
  v_lshlrev_b32 v72, 16, v25
  v_and_b32 v73, s16, v25
  v_lshlrev_b32 v74, 16, v26
  v_and_b32 v75, s16, v26
  v_lshlrev_b32 v76, 16, v27
  v_and_b32 v77, s16, v27
  v_fmac_f32 v60, v70, v11
  v_fmac_f32 v61, v71, v11
  v_fmac_f32 v62, v72, v11
  v_fmac_f32 v63, v73, v11
  v_fmac_f32 v64, v74, v11
  v_fmac_f32 v65, v75, v11
  v_fmac_f32 v66, v76, v11
  v_fmac_f32 v67, v77, v11
  s_waitcnt vmcnt(6)
  v_lshlrev_b32 v70, 16, v28
  v_and_b32 v71, s16, v28
  v_lshlrev_b32 v72, 16, v29
  v_and_b32 v73, s16, v29
  v_lshlrev_b32 v74, 16, v30
  v_and_b32 v75, s16, v30
  v_lshlrev_b32 v76, 16, v31
  v_and_b32 v77, s16, v31
  v_fmac_f32 v60, v70, v12
  v_fmac_f32 v61, v71, v12
  v_fmac_f32 v62, v72, v12
  v_fmac_f32 v63, v73, v12
  v_fmac_f32 v64, v74, v12
  v_fmac_f32 v65, v75, v12
  v_fmac_f32 v66, v76, v12
  v_fmac_f32 v67, v77, v12
  s_waitcnt vmcnt(5)
  v_lshlrev_b32 v70, 16, v32
  v_and_b32 v71, s16, v32
  v_lshlrev_b32 v72, 16, v33
  v_and_b32 v73, s16, v33
  v_lshlrev_b32 v74, 16, v34
  v_and_b32 v75, s16, v34
  v_lshlrev_b32 v76, 16, v35
  v_and_b32 v77, s16, v35
  v_fmac_f32 v60, v70, v13
  v_fmac_f32 v61, v71, v13
  v_fmac_f32 v62, v72, v13
  v_fmac_f32 v63, v73, v13
  v_fmac_f32 v64, v74, v13
  v_fmac_f32 v65, v75, v13
  v_fmac_f32 v66, v76, v13
  v_fmac_f32 v67, v77, v13
  s_waitcnt vmcnt(4)
  v_lshlrev_b32 v70, 16, v36
  v_and_b32 v71, s16, v36
  v_lshlrev_b32 v72, 16, v37
  v_and_b32 v73, s16, v37
  v_lshlrev_b32 v74, 16, v38
  v_and_b32 v75, s16, v38
  v_lshlrev_b32 v76, 16, v39
  v_and_b32 v77, s16, v39
  v_fmac_f32 v60, v70, v14
  v_fmac_f32 v61, v71, v14
  v_fmac_f32 v62, v72, v14
  v_fmac_f32 v63, v73, v14
  v_fmac_f32 v64, v74, v14
  v_fmac_f32 v65, v75, v14
  v_fmac_f32 v66, v76, v14
  v_fmac_f32 v67, v77, v14
  s_waitcnt vmcnt(3)
  v_lshlrev_b32 v70, 16, v40
  v_and_b32 v71, s16, v40
  v_lshlrev_b32 v72, 16, v41
  v_and_b32 v73, s16, v41
  v_lshlrev_b32 v74, 16, v42
  v_and_b32 v75, s16, v42
  v_lshlrev_b32 v76, 16, v43
  v_and_b32 v77, s16, v43
  v_fmac_f32 v60, v70, v15
  v_fmac_f32 v61, v71, v15
  v_fmac_f32 v62, v72, v15
  v_fmac_f32 v63, v73, v15
  v_fmac_f32 v64, v74, v15
  v_fmac_f32 v65, v75, v15
  v_fmac_f32 v66, v76, v15
  v_fmac_f32 v67, v77, v15
  s_waitcnt vmcnt(2)
  v_lshlrev_b32 v70, 16, v44
  v_and_b32 v71, s16, v44
  v_lshlrev_b32 v72, 16, v45
  v_and_b32 v73, s16, v45
  v_lshlrev_b32 v74, 16, v46
  v_and_b32 v75, s16, v46
  v_lshlrev_b32 v76, 16, v47
  v_and_b32 v77, s16, v47
  v_fmac_f32 v60, v70, v16
  v_fmac_f32 v61, v71, v16
  v_fmac_f32 v62, v72, v16
  v_fmac_f32 v63, v73, v16
  v_fmac_f32 v64, v74, v16
  v_fmac_f32 v65, v75, v16
  v_fmac_f32 v66, v76, v16
  v_fmac_f32 v67, v77, v16
  s_waitcnt vmcnt(1)
  v_lshlrev_b32 v70, 16, v48
  v_and_b32 v71, s16, v48
  v_lshlrev_b32 v72, 16, v49
  v_and_b32 v73, s16, v49
  v_lshlrev_b32 v74, 16, v50
  v_and_b32 v75, s16, v50
  v_lshlrev_b32 v76, 16, v51
  v_and_b32 v77, s16, v51
  v_fmac_f32 v60, v70, v17
  v_fmac_f32 v61, v71, v17
  v_fmac_f32 v62, v72, v17
  v_fmac_f32 v63, v73, v17
  v_fmac_f32 v64, v74, v17
  v_fmac_f32 v65, v75, v17
  v_fmac_f32 v66, v76, v17
  v_fmac_f32 v67, v77, v17
  s_waitcnt vmcnt(0)
  v_lshlrev_b32 v70, 16, v52
  v_and_b32 v71, s16, v52
  v_lshlrev_b32 v72, 16, v53
  v_and_b32 v73, s16, v53
  v_lshlrev_b32 v74, 16, v54
  v_and_b32 v75, s16, v54
  v_lshlrev_b32 v76, 16, v55
  v_and_b32 v77, s16, v55
  v_fmac_f32 v60, v70, v18
  v_fmac_f32 v61, v71, v18
  v_fmac_f32 v62, v72, v18
  v_fmac_f32 v63, v73, v18
  v_fmac_f32 v64, v74, v18
  v_fmac_f32 v65, v75, v18
  v_fmac_f32 v66, v76, v18
  v_fmac_f32 v67, v77, v18
  v_lshlrev_b32 v6, 7, v2
  v_lshl_add_u32 v6, v1, 5, v6
  ds_write_b128 v6, v[60:63]
  ds_write_b128 v6, v[64:67] offset:16
  s_waitcnt lgkmcnt(0)
  s_barrier
  v_and_b32 v1, 31, v0
  v_lshrrev_b32 v2, 5, v0
  v_lshlrev_b32 v6, 10, v2
  v_lshl_add_u32 v6, v1, 2, v6
  ds_read_b32 v20, v6 offset:0
  ds_read_b32 v21, v6 offset:128
  ds_read_b32 v22, v6 offset:256
  ds_read_b32 v23, v6 offset:384
  ds_read_b32 v24, v6 offset:512
  ds_read_b32 v25, v6 offset:640
  ds_read_b32 v26, v6 offset:768
  ds_read_b32 v27, v6 offset:896
  s_waitcnt lgkmcnt(6)
  v_add_f32 v20, v20, v21
  s_waitcnt lgkmcnt(5)
  v_add_f32 v20, v20, v22
  s_waitcnt lgkmcnt(4)
  v_add_f32 v20, v20, v23
  s_waitcnt lgkmcnt(3)
  v_add_f32 v20, v20, v24
  s_waitcnt lgkmcnt(2)
  v_add_f32 v20, v20, v25
  s_waitcnt lgkmcnt(1)
  v_add_f32 v20, v20, v26
  s_waitcnt lgkmcnt(0)
  v_add_f32 v20, v20, v27
  v_lshlrev_b32 v6, 2, v0
  ds_write_b32 v6, v20 offset:8192
  s_waitcnt lgkmcnt(0)
  s_barrier
  v_readfirstlane_b32 s18, v0
  s_nop 3
  s_cmp_ge_u32 s18, 64
  s_cbranch_scc1 L_mod_done
  v_lshlrev_b32 v6, 2, v1
  ds_read_b32 v20, v6 offset:8192
  ds_read_b32 v21, v6 offset:8320
  ds_read_b32 v22, v6 offset:8448
  ds_read_b32 v23, v6 offset:8576
  ds_read_b32 v24, v6 offset:8704
  ds_read_b32 v25, v6 offset:8832
  ds_read_b32 v26, v6 offset:8960
  ds_read_b32 v27, v6 offset:9088
  s_waitcnt lgkmcnt(6)
  v_add_f32 v20, v20, v21
  s_waitcnt lgkmcnt(5)
  v_add_f32 v20, v20, v22
  s_waitcnt lgkmcnt(4)
  v_add_f32 v20, v20, v23
  s_waitcnt lgkmcnt(3)
  v_add_f32 v20, v20, v24
  s_waitcnt lgkmcnt(2)
  v_add_f32 v20, v20, v25
  s_waitcnt lgkmcnt(1)
  v_add_f32 v20, v20, v26
  s_waitcnt lgkmcnt(0)
  v_add_f32 v20, v20, v27
  v_cvt_pk_bf16_f32 v20, v20, v20
  v_lshlrev_b32 v20, 16, v20
  s_lshl_b32 s17, s20, 7
  v_cmp_gt_u32 vcc, 32, v0
  s_and_saveexec_b64 s[18:19], vcc
  s_nop 3
  buffer_store_dword v20, v6, s[12:15], s17 offen
L_mod_done:
L_k0_mod_kernel_end:
  s_endpgm
.globl k1_ln_kernel
.p2align 8
.type k1_ln_kernel,@function
k1_ln_kernel:
  s_cmp_ge_u32 s2, 256
  s_cbranch_scc1 L_k1_ln_kernel_end
  s_load_dwordx2 s[4:5], s[0:1], 0
  s_mov_b32 s6, 2359296
  s_mov_b32 s7, 0x00020000
  s_load_dwordx2 s[8:9], s[0:1], 104
  s_mov_b32 s10, 13824
  s_mov_b32 s11, 0x00020000
  s_load_dwordx2 s[12:13], s[0:1], 104
  s_mov_b32 s14, 18874368
  s_mov_b32 s15, 0x00020000
  s_load_dwordx2 s[16:17], s[0:1], 104
  s_mov_b32 s18, 2359296
  s_mov_b32 s19, 0x00020000
  s_load_dwordx2 s[20:21], s[0:1], 104
  s_mov_b32 s22, 2359296
  s_mov_b32 s23, 0x00020000
  s_load_dwordx2 s[32:33], s[0:1], 24
  s_mov_b32 s34, 4718592
  s_mov_b32 s35, 0x00020000
  s_mov_b32 s24, 0xffff0000
  v_and_b32 v1, 7, v0
  v_bfe_u32 v2, v0, 3, 1
  v_lshrrev_b32 v3, 4, v0
  s_lshl_b32 s25, s2, 3
  v_add_u32 v4, s25, v1
  v_mul_u32_u24 v4, 1152, v4
  v_lshl_add_u32 v4, v3, 5, v4
  v_lshl_add_u32 v4, v2, 4, v4
  s_lshr_b32 s26, s2, 2
  s_mul_i32 s26, s26, 36864
  s_and_b32 s27, s2, 3
  s_lshl_b32 s27, s27, 7
  s_add_u32 s26, s26, s27
  v_lshlrev_b32 v5, 10, v3
  v_lshl_add_u32 v5, v2, 9, v5
  v_lshl_add_u32 v5, v1, 4, v5
  v_add_u32 v5, s26, v5
  v_lshlrev_b32 v6, 6, v3
  v_lshl_add_u32 v6, v2, 5, v6
  v_lshlrev_b32 v7, 2, v0
  v_lshlrev_b32 v8, 2, v1
  s_waitcnt lgkmcnt(0)
  s_add_u32 s12, s12, 33554432
  s_addc_u32 s13, s13, 0
  s_add_u32 s16, s16, 1048576
  s_addc_u32 s17, s17, 0
  s_add_u32 s20, s20, 4194304
  s_addc_u32 s21, s21, 0
  buffer_load_dwordx4 v[10:13], v4, s[4:7], 0 offen
  s_mov_b32 s28, 0
  buffer_load_dwordx4 v[48:51], v6, s[8:11], s28 offen
  buffer_load_dwordx4 v[52:55], v6, s[8:11], s28 offen offset:16
  s_mov_b32 s28, 2304
  buffer_load_dwordx4 v[56:59], v6, s[8:11], s28 offen
  buffer_load_dwordx4 v[60:63], v6, s[8:11], s28 offen offset:16
  s_mul_i32 s29, s2, 18432
  v_lshlrev_b32 v9, 4, v0
  buffer_load_dwordx4 v[100:103], v9, s[32:35], s29 offen
  s_add_u32 s29, s29, 9216
  buffer_load_dwordx4 v[104:107], v9, s[32:35], s29 offen
  s_waitcnt vmcnt(2)
  v_lshlrev_b32 v20, 16, v10
  v_and_b32 v21, s24, v10
  v_lshlrev_b32 v22, 16, v11
  v_and_b32 v23, s24, v11
  v_lshlrev_b32 v24, 16, v12
  v_and_b32 v25, s24, v12
  v_lshlrev_b32 v26, 16, v13
  v_and_b32 v27, s24, v13
  v_add_f32 v9, v20, v21
  v_add_f32 v9, v9, v22
  v_add_f32 v9, v9, v23
  v_add_f32 v9, v9, v24
  v_add_f32 v9, v9, v25
  v_add_f32 v9, v9, v26
  v_add_f32 v9, v9, v27
  s_nop 1
  v_add_f32_dpp v9, v9, v9 row_ror:8 row_mask:0xf bank_mask:0xf
  v_mov_b32 v14, v9
  v_mov_b32 v15, v9
  s_nop 1
  v_permlane16_swap_b32 v14, v15
  v_add_f32 v9, v14, v15
  v_mov_b32 v14, v9
  v_mov_b32 v15, v9
  s_nop 1
  v_permlane32_swap_b32 v14, v15
  v_add_f32 v9, v14, v15
  ds_write_b32 v7, v9 offset:0
  s_waitcnt lgkmcnt(0)
  s_barrier
  ds_read_b32 v70, v8 offset:0
  ds_read_b32 v71, v8 offset:256
  ds_read_b32 v72, v8 offset:512
  ds_read_b32 v73, v8 offset:768
  ds_read_b32 v74, v8 offset:1024
  ds_read_b32 v75, v8 offset:1280
  ds_read_b32 v76, v8 offset:1536
  ds_read_b32 v77, v8 offset:1792
  ds_read_b32 v78, v8 offset:2048
  s_waitcnt lgkmcnt(7)
  v_add_f32 v9, v70, v71
  s_waitcnt lgkmcnt(6)
  v_add_f32 v9, v9, v72
  s_waitcnt lgkmcnt(5)
  v_add_f32 v9, v9, v73
  s_waitcnt lgkmcnt(4)
  v_add_f32 v9, v9, v74
  s_waitcnt lgkmcnt(3)
  v_add_f32 v9, v9, v75
  s_waitcnt lgkmcnt(2)
  v_add_f32 v9, v9, v76
  s_waitcnt lgkmcnt(1)
  v_add_f32 v9, v9, v77
  s_waitcnt lgkmcnt(0)
  v_add_f32 v9, v9, v78
  v_mul_f32 v9, 0x3ae38e39, v9
  v_sub_f32 v20, v20, v9
  v_sub_f32 v21, v21, v9
  v_sub_f32 v22, v22, v9
  v_sub_f32 v23, v23, v9
  v_sub_f32 v24, v24, v9
  v_sub_f32 v25, v25, v9
  v_sub_f32 v26, v26, v9
  v_sub_f32 v27, v27, v9
  v_mul_f32 v9, v20, v20
  v_fmac_f32 v9, v21, v21
  v_fmac_f32 v9, v22, v22
  v_fmac_f32 v9, v23, v23
  v_fmac_f32 v9, v24, v24
  v_fmac_f32 v9, v25, v25
  v_fmac_f32 v9, v26, v26
  v_fmac_f32 v9, v27, v27
  s_nop 1
  v_add_f32_dpp v9, v9, v9 row_ror:8 row_mask:0xf bank_mask:0xf
  v_mov_b32 v14, v9
  v_mov_b32 v15, v9
  s_nop 1
  v_permlane16_swap_b32 v14, v15
  v_add_f32 v9, v14, v15
  v_mov_b32 v14, v9
  v_mov_b32 v15, v9
  s_nop 1
  v_permlane32_swap_b32 v14, v15
  v_add_f32 v9, v14, v15
  ds_write_b32 v7, v9 offset:4096
  s_waitcnt lgkmcnt(0)
  s_barrier
  ds_read_b32 v70, v8 offset:4096
  ds_read_b32 v71, v8 offset:4352
  ds_read_b32 v72, v8 offset:4608
  ds_read_b32 v73, v8 offset:4864
  ds_read_b32 v74, v8 offset:5120
  ds_read_b32 v75, v8 offset:5376
  ds_read_b32 v76, v8 offset:5632
  ds_read_b32 v77, v8 offset:5888
  ds_read_b32 v78, v8 offset:6144
  s_waitcnt lgkmcnt(7)
  v_add_f32 v9, v70, v71
  s_waitcnt lgkmcnt(6)
  v_add_f32 v9, v9, v72
  s_waitcnt lgkmcnt(5)
  v_add_f32 v9, v9, v73
  s_waitcnt lgkmcnt(4)
  v_add_f32 v9, v9, v74
  s_waitcnt lgkmcnt(3)
  v_add_f32 v9, v9, v75
  s_waitcnt lgkmcnt(2)
  v_add_f32 v9, v9, v76
  s_waitcnt lgkmcnt(1)
  v_add_f32 v9, v9, v77
  s_waitcnt lgkmcnt(0)
  v_add_f32 v9, v9, v78
  v_mul_f32 v9, 0x3ae38e39, v9
  v_add_f32 v9, 0x3727c5ac, v9
  v_rsq_f32 v9, v9
  s_nop 0
  v_mul_f32 v20, v20, v9
  v_add_f32 v56, 1.0, v56
  v_mul_f32 v21, v21, v9
  v_add_f32 v57, 1.0, v57
  v_mul_f32 v22, v22, v9
  v_add_f32 v58, 1.0, v58
  v_mul_f32 v23, v23, v9
  v_add_f32 v59, 1.0, v59
  v_mul_f32 v24, v24, v9
  v_add_f32 v60, 1.0, v60
  v_mul_f32 v25, v25, v9
  v_add_f32 v61, 1.0, v61
  v_mul_f32 v26, v26, v9
  v_add_f32 v62, 1.0, v62
  v_mul_f32 v27, v27, v9
  v_add_f32 v63, 1.0, v63
  v_fma_f32 v20, v20, v56, v48
  v_fma_f32 v21, v21, v57, v49
  v_fma_f32 v22, v22, v58, v50
  v_fma_f32 v23, v23, v59, v51
  v_fma_f32 v24, v24, v60, v52
  v_fma_f32 v25, v25, v61, v53
  v_fma_f32 v26, v26, v62, v54
  v_fma_f32 v27, v27, v63, v55
  v_mul_f32 v20, 1040356334, v20
  v_mul_f32 v21, 1040356334, v21
  v_mul_f32 v22, 1040356334, v22
  v_mul_f32 v23, 1040356334, v23
  v_mul_f32 v24, 1040356334, v24
  v_mul_f32 v25, 1040356334, v25
  v_mul_f32 v26, 1040356334, v26
  v_mul_f32 v27, 1040356334, v27
  v_cvt_pk_bf16_f32 v68, v20, v21
  v_cvt_pk_bf16_f32 v69, v22, v23
  v_cvt_pk_bf16_f32 v70, v24, v25
  v_cvt_pk_bf16_f32 v71, v26, v27
  buffer_store_dwordx4 v[68:71], v5, s[16:19], 0 offen sc0 sc1
L_k1_ln_kernel_end:
  s_endpgm
.globl k2_attn_kernel
.p2align 8
.type k2_attn_kernel,@function
k2_attn_kernel:
  s_cmp_ge_u32 s2, 256
  s_cbranch_scc1 L_k2_attn_kernel_end
  s_load_dwordx2 s[4:5], s[0:1], 24
  s_mov_b32 s6, 4718592
  s_mov_b32 s7, 0x00020000
  s_load_dwordx2 s[8:9], s[0:1], 104
  s_mov_b32 s10, 2359296
  s_mov_b32 s11, 0x00020000
  s_load_dwordx2 s[12:13], s[0:1], 104
  s_mov_b32 s14, 16777216
  s_mov_b32 s15, 0x00020000
  s_load_dwordx2 s[28:29], s[0:1], 8
  s_mov_b32 s30, 524288
  s_mov_b32 s31, 0x00020000
  s_load_dwordx2 s[32:33], s[0:1], 16
  s_mov_b32 s34, 524288
  s_mov_b32 s35, 0x00020000
  s_load_dwordx2 s[36:37], s[0:1], 32
  s_mov_b32 s38, 4718592
  s_mov_b32 s39, 0x00020000
  s_load_dwordx2 s[52:53], s[0:1], 48
  s_mov_b32 s54, 5308416
  s_mov_b32 s55, 0x00020000
  s_load_dwordx2 s[56:57], s[0:1], 56
  s_mov_b32 s58, 5308416
  s_mov_b32 s59, 0x00020000
  s_load_dwordx2 s[96:97], s[0:1], 64
  s_mov_b32 s98, 5308416
  s_mov_b32 s99, 0x00020000
  v_lshrrev_b32 v1, 6, v0
  s_nop 0
  v_readfirstlane_b32 s16, v1
  v_and_b32 v0, 63, v0
  s_nop 3
  s_and_b32 s17, s2, 7
  s_lshl_b32 s17, s17, 1
  s_bfe_u32 s18, s2, 0x10003
  s_add_u32 s17, s17, s18
  s_lshr_b32 s18, s2, 4
  s_lshl_b32 s20, s18, 2
  s_add_u32 s20, s20, s16
  s_mul_i32 s21, s20, 36864
  s_lshl_b32 s22, s17, 9
  s_lshl_b32 s24, s16, 13
  s_lshl_b32 s26, s17, 19
  v_lshlrev_b32 v1, 4, v0
  s_waitcnt lgkmcnt(0)
  s_add_u32 s8, s8, 1048576
  s_addc_u32 s9, s9, 0
  s_add_u32 s12, s12, 16777216
  s_addc_u32 s13, s13, 0
  s_add_u32 s28, s28, s26
  s_addc_u32 s29, s29, 0
  s_add_u32 s32, s32, s26
  s_addc_u32 s33, s33, 0
  buffer_load_dwordx4 a[0:3], v1, s[8:11], s21 offen offset:0
  buffer_load_dwordx4 a[4:7], v1, s[8:11], s21 offen offset:1024
  buffer_load_dwordx4 a[8:11], v1, s[8:11], s21 offen offset:2048
  buffer_load_dwordx4 a[12:15], v1, s[8:11], s21 offen offset:3072
  s_add_u32 s21, s21, 4096
  buffer_load_dwordx4 a[16:19], v1, s[8:11], s21 offen offset:0
  buffer_load_dwordx4 a[20:23], v1, s[8:11], s21 offen offset:1024
  buffer_load_dwordx4 a[24:27], v1, s[8:11], s21 offen offset:2048
  buffer_load_dwordx4 a[28:31], v1, s[8:11], s21 offen offset:3072
  s_add_u32 s21, s21, 4096
  s_lshl_b32 s26, s16, 4
  s_add_u32 s26, s26, 0
  v_lshrrev_b32 v2, 5, v0
  v_add_u32 v2, s26, v2
  v_and_b32 v3, 3, v2
  v_lshlrev_b32 v3, 2, v3
  v_and_b32 v4, 31, v0
  v_xor_b32 v3, v3, v4
  v_lshlrev_b32 v2, 13, v2
  v_lshl_add_u32 v10, v3, 4, v2
  s_add_u32 m0, s24, 0
  s_nop 0
  buffer_load_dwordx4 v10, s[4:7], s22 offen lds
  s_lshl_b32 s26, s16, 4
  s_add_u32 s26, s26, 2
  v_lshrrev_b32 v2, 5, v0
  v_add_u32 v2, s26, v2
  v_and_b32 v3, 3, v2
  v_lshlrev_b32 v3, 2, v3
  v_and_b32 v4, 31, v0
  v_xor_b32 v3, v3, v4
  v_lshlrev_b32 v2, 13, v2
  v_lshl_add_u32 v11, v3, 4, v2
  s_add_u32 m0, s24, 1024
  s_nop 0
  buffer_load_dwordx4 v11, s[4:7], s22 offen lds
  s_lshl_b32 s26, s16, 4
  s_add_u32 s26, s26, 4
  v_lshrrev_b32 v2, 5, v0
  v_add_u32 v2, s26, v2
  v_and_b32 v3, 3, v2
  v_lshlrev_b32 v3, 2, v3
  v_and_b32 v4, 31, v0
  v_xor_b32 v3, v3, v4
  v_lshlrev_b32 v2, 13, v2
  v_lshl_add_u32 v12, v3, 4, v2
  s_add_u32 m0, s24, 2048
  s_nop 0
  buffer_load_dwordx4 v12, s[4:7], s22 offen lds
  s_lshl_b32 s26, s16, 4
  s_add_u32 s26, s26, 6
  v_lshrrev_b32 v2, 5, v0
  v_add_u32 v2, s26, v2
  v_and_b32 v3, 3, v2
  v_lshlrev_b32 v3, 2, v3
  v_and_b32 v4, 31, v0
  v_xor_b32 v3, v3, v4
  v_lshlrev_b32 v2, 13, v2
  v_lshl_add_u32 v13, v3, 4, v2
  s_add_u32 m0, s24, 3072
  s_nop 0
  buffer_load_dwordx4 v13, s[4:7], s22 offen lds
  s_lshl_b32 s26, s16, 4
  s_add_u32 s26, s26, 8
  v_lshrrev_b32 v2, 5, v0
  v_add_u32 v2, s26, v2
  v_and_b32 v3, 3, v2
  v_lshlrev_b32 v3, 2, v3
  v_and_b32 v4, 31, v0
  v_xor_b32 v3, v3, v4
  v_lshlrev_b32 v2, 13, v2
  v_lshl_add_u32 v14, v3, 4, v2
  s_add_u32 m0, s24, 4096
  s_nop 0
  buffer_load_dwordx4 v14, s[4:7], s22 offen lds
  s_lshl_b32 s26, s16, 4
  s_add_u32 s26, s26, 10
  v_lshrrev_b32 v2, 5, v0
  v_add_u32 v2, s26, v2
  v_and_b32 v3, 3, v2
  v_lshlrev_b32 v3, 2, v3
  v_and_b32 v4, 31, v0
  v_xor_b32 v3, v3, v4
  v_lshlrev_b32 v2, 13, v2
  v_lshl_add_u32 v15, v3, 4, v2
  s_add_u32 m0, s24, 5120
  s_nop 0
  buffer_load_dwordx4 v15, s[4:7], s22 offen lds
  s_lshl_b32 s26, s16, 4
  s_add_u32 s26, s26, 12
  v_lshrrev_b32 v2, 5, v0
  v_add_u32 v2, s26, v2
  v_and_b32 v3, 3, v2
  v_lshlrev_b32 v3, 2, v3
  v_and_b32 v4, 31, v0
  v_xor_b32 v3, v3, v4
  v_lshlrev_b32 v2, 13, v2
  v_lshl_add_u32 v16, v3, 4, v2
  s_add_u32 m0, s24, 6144
  s_nop 0
  buffer_load_dwordx4 v16, s[4:7], s22 offen lds
  s_lshl_b32 s26, s16, 4
  s_add_u32 s26, s26, 14
  v_lshrrev_b32 v2, 5, v0
  v_add_u32 v2, s26, v2
  v_and_b32 v3, 3, v2
  v_lshlrev_b32 v3, 2, v3
  v_and_b32 v4, 31, v0
  v_xor_b32 v3, v3, v4
  v_lshlrev_b32 v2, 13, v2
  v_lshl_add_u32 v17, v3, 4, v2
  s_add_u32 m0, s24, 7168
  s_nop 0
  buffer_load_dwordx4 v17, s[4:7], s22 offen lds
  s_add_u32 s22, s22, 524288
  v_lshrrev_b32 v2, 5, v0
  v_lshlrev_b32 v2, 3, v2
  v_bfe_u32 v3, v0, 2, 2
  v_add_u32 v2, v2, v3
  v_mul_u32_u24 v9, 512, v2
  v_bfe_u32 v3, v0, 4, 1
  v_mul_u32_u24 v3, 32, v3
  v_add_u32 v9, v9, v3
  v_and_b32 v3, 1, v0
  v_lshl_add_u32 v9, v3, 4, v9
  v_bfe_u32 v3, v0, 1, 1
  v_lshl_add_u32 v9, v3, 3, v9
  v_bfe_u32 v2, v0, 2, 2
  v_xor_b32 v3, 0, v2
  v_lshl_add_u32 v20, v3, 6, v9
  v_add_u32 v24, 0x10000, v20
  v_xor_b32 v3, 1, v2
  v_lshl_add_u32 v21, v3, 6, v9
  v_add_u32 v25, 0x10000, v21
  v_xor_b32 v3, 2, v2
  v_lshl_add_u32 v22, v3, 6, v9
  v_add_u32 v26, 0x10000, v22
  v_xor_b32 v3, 3, v2
  v_lshl_add_u32 v23, v3, 6, v9
  v_add_u32 v27, 0x10000, v23
  s_lshl_b32 s25, s16, 11
  s_mov_b32 s40, 0
  s_mov_b32 s41, 8192
  s_mov_b32 s42, 8192
  s_mov_b32 s43, 0
  s_lshr_b32 s26, s16, 1
  s_lshl_b32 s26, s26, 4
  s_and_b32 s27, s16, 1
  s_lshl_b32 s23, s27, 2
  s_add_u32 s26, s26, s23
  s_lshl_b32 s27, s27, 3
  v_lshrrev_b32 v2, 4, v0
  v_and_b32 v3, 15, v0
  v_add_u32 v4, s26, v2
  v_add_u32 v5, s27, v2
  v_xor_b32 v6, v5, v3
  v_lshlrev_b32 v6, 4, v6
  v_lshl_add_u32 v60, v4, 8, v6
  v_add_u32 v4, 8, v4
  v_add_u32 v5, 4, v5
  v_xor_b32 v6, v5, v3
  v_lshlrev_b32 v6, 4, v6
  v_lshl_add_u32 v6, v4, 8, v6
  v_subrev_u32 v61, 1024, v6
  s_lshl_b32 s27, s16, 3
  v_add_u32 v4, s27, v2
  v_lshlrev_b32 v5, 2, v2
  v_xor_b32 v5, v5, v3
  v_lshlrev_b32 v5, 4, v5
  v_lshl_add_u32 v62, v4, 8, v5
  s_add_u32 m0, s24, 32768
  s_nop 0
  buffer_load_dwordx4 v10, s[4:7], s22 offen lds
  s_add_u32 m0, s24, 33792
  s_nop 0
  buffer_load_dwordx4 v11, s[4:7], s22 offen lds
  s_add_u32 m0, s24, 34816
  s_nop 0
  buffer_load_dwordx4 v12, s[4:7], s22 offen lds
  s_add_u32 m0, s24, 35840
  s_nop 0
  buffer_load_dwordx4 v13, s[4:7], s22 offen lds
  s_add_u32 m0, s24, 36864
  s_nop 0
  buffer_load_dwordx4 v14, s[4:7], s22 offen lds
  s_add_u32 m0, s24, 37888
  s_nop 0
  buffer_load_dwordx4 v15, s[4:7], s22 offen lds
  s_add_u32 m0, s24, 38912
  s_nop 0
  buffer_load_dwordx4 v16, s[4:7], s22 offen lds
  s_add_u32 m0, s24, 39936
  s_nop 0
  buffer_load_dwordx4 v17, s[4:7], s22 offen lds
  s_add_u32 s22, s22, 524288
  s_waitcnt vmcnt(8) lgkmcnt(0)
  s_barrier
  ds_read_b64_tr_b16 v[28:29], v20 offset:0
  ds_read_b64_tr_b16 v[30:31], v20 offset:2048
  ds_read_b64_tr_b16 v[32:33], v21 offset:0
  ds_read_b64_tr_b16 v[34:35], v21 offset:2048
  ds_read_b64_tr_b16 v[36:37], v22 offset:0
  ds_read_b64_tr_b16 v[38:39], v22 offset:2048
  ds_read_b64_tr_b16 v[40:41], v23 offset:0
  ds_read_b64_tr_b16 v[42:43], v23 offset:2048
  s_waitcnt lgkmcnt(6)
  v_mfma_f32_32x32x16_bf16 v[64:79], v[28:31], a[0:3], 0
  ds_read_b64_tr_b16 v[44:45], v20 offset:256
  ds_read_b64_tr_b16 v[46:47], v20 offset:2304
  buffer_load_dwordx4 a[32:35], v1, s[8:11], s21 offen offset:0
  s_waitcnt lgkmcnt(6)
  v_mfma_f32_32x32x16_bf16 v[80:95], v[32:35], a[0:3], 0
  ds_read_b64_tr_b16 v[48:49], v21 offset:256
  ds_read_b64_tr_b16 v[50:51], v21 offset:2304
  s_waitcnt lgkmcnt(6)
  v_mfma_f32_32x32x16_bf16 v[96:111], v[36:39], a[0:3], 0
  ds_read_b64_tr_b16 v[28:29], v22 offset:256
  ds_read_b64_tr_b16 v[30:31], v22 offset:2304
  buffer_load_dwordx4 a[36:39], v1, s[8:11], s21 offen offset:1024
  s_waitcnt lgkmcnt(6)
  v_mfma_f32_32x32x16_bf16 v[112:127], v[40:43], a[0:3], 0
  ds_read_b64_tr_b16 v[32:33], v23 offset:256
  ds_read_b64_tr_b16 v[34:35], v23 offset:2304
  s_waitcnt lgkmcnt(6)
  v_mfma_f32_32x32x16_bf16 v[128:143], v[44:47], a[0:3], 0
  ds_read_b64_tr_b16 v[36:37], v20 offset:8192
  ds_read_b64_tr_b16 v[38:39], v20 offset:10240
  buffer_load_dwordx4 a[40:43], v1, s[8:11], s21 offen offset:2048
  s_waitcnt lgkmcnt(6)
  v_mfma_f32_32x32x16_bf16 v[144:159], v[48:51], a[0:3], 0
  ds_read_b64_tr_b16 v[40:41], v21 offset:8192
  ds_read_b64_tr_b16 v[42:43], v21 offset:10240
  s_waitcnt lgkmcnt(6)
  v_mfma_f32_32x32x16_bf16 v[160:175], v[28:31], a[0:3], 0
  ds_read_b64_tr_b16 v[44:45], v22 offset:8192
  ds_read_b64_tr_b16 v[46:47], v22 offset:10240
  buffer_load_dwordx4 a[44:47], v1, s[8:11], s21 offen offset:3072
  s_add_u32 s21, s21, 4096
  s_waitcnt lgkmcnt(6)
  v_mfma_f32_32x32x16_bf16 v[176:191], v[32:35], a[0:3], 0
  ds_read_b64_tr_b16 v[48:49], v23 offset:8192
  ds_read_b64_tr_b16 v[50:51], v23 offset:10240
  s_waitcnt lgkmcnt(6)
  v_mfma_f32_32x32x16_bf16 v[64:79], v[36:39], a[4:7], v[64:79]
  ds_read_b64_tr_b16 v[28:29], v20 offset:8448
  ds_read_b64_tr_b16 v[30:31], v20 offset:10496
  s_add_u32 m0, s24, 65536
  s_nop 0
  buffer_load_dwordx4 v10, s[4:7], s22 offen lds
  s_waitcnt lgkmcnt(6)
  v_mfma_f32_32x32x16_bf16 v[80:95], v[40:43], a[4:7], v[80:95]
  ds_read_b64_tr_b16 v[32:33], v21 offset:8448
  ds_read_b64_tr_b16 v[34:35], v21 offset:10496
  s_waitcnt lgkmcnt(6)
  v_mfma_f32_32x32x16_bf16 v[96:111], v[44:47], a[4:7], v[96:111]
  ds_read_b64_tr_b16 v[36:37], v22 offset:8448
  ds_read_b64_tr_b16 v[38:39], v22 offset:10496
  s_add_u32 m0, s24, 66560
  s_nop 0
  buffer_load_dwordx4 v11, s[4:7], s22 offen lds
  s_waitcnt lgkmcnt(6)
  v_mfma_f32_32x32x16_bf16 v[112:127], v[48:51], a[4:7], v[112:127]
  ds_read_b64_tr_b16 v[40:41], v23 offset:8448
  ds_read_b64_tr_b16 v[42:43], v23 offset:10496
  s_waitcnt lgkmcnt(6)
  v_mfma_f32_32x32x16_bf16 v[128:143], v[28:31], a[4:7], v[128:143]
  ds_read_b64_tr_b16 v[44:45], v20 offset:16384
  ds_read_b64_tr_b16 v[46:47], v20 offset:18432
  s_add_u32 m0, s24, 67584
  s_nop 0
  buffer_load_dwordx4 v12, s[4:7], s22 offen lds
  s_waitcnt lgkmcnt(6)
  v_mfma_f32_32x32x16_bf16 v[144:159], v[32:35], a[4:7], v[144:159]
  ds_read_b64_tr_b16 v[48:49], v21 offset:16384
  ds_read_b64_tr_b16 v[50:51], v21 offset:18432
  s_waitcnt lgkmcnt(6)
  v_mfma_f32_32x32x16_bf16 v[160:175], v[36:39], a[4:7], v[160:175]
  ds_read_b64_tr_b16 v[28:29], v22 offset:16384
  ds_read_b64_tr_b16 v[30:31], v22 offset:18432
  s_add_u32 m0, s24, 68608
  s_nop 0
  buffer_load_dwordx4 v13, s[4:7], s22 offen lds
  s_waitcnt lgkmcnt(6)
  v_mfma_f32_32x32x16_bf16 v[176:191], v[40:43], a[4:7], v[176:191]
  ds_read_b64_tr_b16 v[32:33], v23 offset:16384
  ds_read_b64_tr_b16 v[34:35], v23 offset:18432
  s_waitcnt lgkmcnt(6)
  v_mfma_f32_32x32x16_bf16 v[64:79], v[44:47], a[8:11], v[64:79]
  ds_read_b64_tr_b16 v[36:37], v20 offset:16640
  ds_read_b64_tr_b16 v[38:39], v20 offset:18688
  s_add_u32 m0, s24, 69632
  s_nop 0
  buffer_load_dwordx4 v14, s[4:7], s22 offen lds
  s_waitcnt lgkmcnt(6)
  v_mfma_f32_32x32x16_bf16 v[80:95], v[48:51], a[8:11], v[80:95]
  ds_read_b64_tr_b16 v[40:41], v21 offset:16640
  ds_read_b64_tr_b16 v[42:43], v21 offset:18688
  s_waitcnt lgkmcnt(6)
  v_mfma_f32_32x32x16_bf16 v[96:111], v[28:31], a[8:11], v[96:111]
  ds_read_b64_tr_b16 v[44:45], v22 offset:16640
  ds_read_b64_tr_b16 v[46:47], v22 offset:18688
  s_add_u32 m0, s24, 70656
  s_nop 0
  buffer_load_dwordx4 v15, s[4:7], s22 offen lds
  s_waitcnt lgkmcnt(6)
  v_mfma_f32_32x32x16_bf16 v[112:127], v[32:35], a[8:11], v[112:127]
  ds_read_b64_tr_b16 v[48:49], v23 offset:16640
  ds_read_b64_tr_b16 v[50:51], v23 offset:18688
  s_waitcnt lgkmcnt(6)
  v_mfma_f32_32x32x16_bf16 v[128:143], v[36:39], a[8:11], v[128:143]
  ds_read_b64_tr_b16 v[28:29], v20 offset:24576
  ds_read_b64_tr_b16 v[30:31], v20 offset:26624
  s_add_u32 m0, s24, 71680
  s_nop 0
  buffer_load_dwordx4 v16, s[4:7], s22 offen lds
  s_waitcnt lgkmcnt(6)
  v_mfma_f32_32x32x16_bf16 v[144:159], v[40:43], a[8:11], v[144:159]
  ds_read_b64_tr_b16 v[32:33], v21 offset:24576
  ds_read_b64_tr_b16 v[34:35], v21 offset:26624
  s_waitcnt lgkmcnt(6)
  v_mfma_f32_32x32x16_bf16 v[160:175], v[44:47], a[8:11], v[160:175]
  ds_read_b64_tr_b16 v[36:37], v22 offset:24576
  ds_read_b64_tr_b16 v[38:39], v22 offset:26624
  s_add_u32 m0, s24, 72704
  s_nop 0
  buffer_load_dwordx4 v17, s[4:7], s22 offen lds
  s_add_u32 s22, s22, 524288
  s_waitcnt lgkmcnt(6)
  v_mfma_f32_32x32x16_bf16 v[176:191], v[48:51], a[8:11], v[176:191]
  ds_read_b64_tr_b16 v[40:41], v23 offset:24576
  ds_read_b64_tr_b16 v[42:43], v23 offset:26624
  s_waitcnt lgkmcnt(6)
  v_mfma_f32_32x32x16_bf16 v[64:79], v[28:31], a[12:15], v[64:79]
  ds_read_b64_tr_b16 v[44:45], v20 offset:24832
  ds_read_b64_tr_b16 v[46:47], v20 offset:26880
  s_waitcnt lgkmcnt(6)
  v_mfma_f32_32x32x16_bf16 v[80:95], v[32:35], a[12:15], v[80:95]
  ds_read_b64_tr_b16 v[48:49], v21 offset:24832
  ds_read_b64_tr_b16 v[50:51], v21 offset:26880
  s_waitcnt lgkmcnt(6)
  v_mfma_f32_32x32x16_bf16 v[96:111], v[36:39], a[12:15], v[96:111]
  ds_read_b64_tr_b16 v[28:29], v22 offset:24832
  ds_read_b64_tr_b16 v[30:31], v22 offset:26880
  s_waitcnt lgkmcnt(6)
  v_mfma_f32_32x32x16_bf16 v[112:127], v[40:43], a[12:15], v[112:127]
  ds_read_b64_tr_b16 v[32:33], v23 offset:24832
  ds_read_b64_tr_b16 v[34:35], v23 offset:26880
  s_waitcnt lgkmcnt(6)
  v_mfma_f32_32x32x16_bf16 v[128:143], v[44:47], a[12:15], v[128:143]
  s_waitcnt vmcnt(12) lgkmcnt(0)
  s_barrier
  ds_read_b64_tr_b16 v[36:37], v20 offset:32768
  ds_read_b64_tr_b16 v[38:39], v20 offset:34816
  v_mfma_f32_32x32x16_bf16 v[144:159], v[48:51], a[12:15], v[144:159]
  ds_read_b64_tr_b16 v[40:41], v21 offset:32768
  ds_read_b64_tr_b16 v[42:43], v21 offset:34816
  v_mfma_f32_32x32x16_bf16 v[160:175], v[28:31], a[12:15], v[160:175]
  ds_read_b64_tr_b16 v[44:45], v22 offset:32768
  ds_read_b64_tr_b16 v[46:47], v22 offset:34816
  v_mfma_f32_32x32x16_bf16 v[176:191], v[32:35], a[12:15], v[176:191]
  ds_read_b64_tr_b16 v[48:49], v23 offset:32768
  ds_read_b64_tr_b16 v[50:51], v23 offset:34816
  s_waitcnt lgkmcnt(6)
  v_mfma_f32_32x32x16_bf16 v[64:79], v[36:39], a[16:19], v[64:79]
  ds_read_b64_tr_b16 v[28:29], v20 offset:33024
  ds_read_b64_tr_b16 v[30:31], v20 offset:35072
  buffer_load_dwordx4 a[48:51], v1, s[8:11], s21 offen offset:0
  v_accvgpr_write_b32 a0, 0
  s_waitcnt lgkmcnt(6)
  v_mfma_f32_32x32x16_bf16 v[80:95], v[40:43], a[16:19], v[80:95]
  ds_read_b64_tr_b16 v[32:33], v21 offset:33024
  ds_read_b64_tr_b16 v[34:35], v21 offset:35072
  s_waitcnt lgkmcnt(6)
  v_mfma_f32_32x32x16_bf16 v[96:111], v[44:47], a[16:19], v[96:111]
  ds_read_b64_tr_b16 v[36:37], v22 offset:33024
  ds_read_b64_tr_b16 v[38:39], v22 offset:35072
  buffer_load_dwordx4 a[52:55], v1, s[8:11], s21 offen offset:1024
  v_accvgpr_write_b32 a1, 0
  s_waitcnt lgkmcnt(6)
  v_mfma_f32_32x32x16_bf16 v[112:127], v[48:51], a[16:19], v[112:127]
  ds_read_b64_tr_b16 v[40:41], v23 offset:33024
  ds_read_b64_tr_b16 v[42:43], v23 offset:35072
  s_waitcnt lgkmcnt(6)
  v_mfma_f32_32x32x16_bf16 v[128:143], v[28:31], a[16:19], v[128:143]
  ds_read_b64_tr_b16 v[44:45], v20 offset:40960
  ds_read_b64_tr_b16 v[46:47], v20 offset:43008
  buffer_load_dwordx4 a[56:59], v1, s[8:11], s21 offen offset:2048
  v_accvgpr_write_b32 a2, 0
  s_waitcnt lgkmcnt(6)
  v_mfma_f32_32x32x16_bf16 v[144:159], v[32:35], a[16:19], v[144:159]
  ds_read_b64_tr_b16 v[48:49], v21 offset:40960
  ds_read_b64_tr_b16 v[50:51], v21 offset:43008
  s_waitcnt lgkmcnt(6)
  v_mfma_f32_32x32x16_bf16 v[160:175], v[36:39], a[16:19], v[160:175]
  ds_read_b64_tr_b16 v[28:29], v22 offset:40960
  ds_read_b64_tr_b16 v[30:31], v22 offset:43008
  buffer_load_dwordx4 a[60:63], v1, s[8:11], s21 offen offset:3072
  s_add_u32 s21, s21, 4096
  v_accvgpr_write_b32 a3, 0
  s_waitcnt lgkmcnt(6)
  v_mfma_f32_32x32x16_bf16 v[176:191], v[40:43], a[16:19], v[176:191]
  ds_read_b64_tr_b16 v[32:33], v23 offset:40960
  ds_read_b64_tr_b16 v[34:35], v23 offset:43008
  s_waitcnt lgkmcnt(6)
  v_mfma_f32_32x32x16_bf16 v[64:79], v[44:47], a[20:23], v[64:79]
  ds_read_b64_tr_b16 v[36:37], v20 offset:41216
  ds_read_b64_tr_b16 v[38:39], v20 offset:43264
  s_add_u32 m0, s24, 98304
  s_nop 0
  buffer_load_dwordx4 v10, s[4:7], s22 offen lds
  v_accvgpr_write_b32 a4, 0
  s_waitcnt lgkmcnt(6)
  v_mfma_f32_32x32x16_bf16 v[80:95], v[48:51], a[20:23], v[80:95]
  ds_read_b64_tr_b16 v[40:41], v21 offset:41216
  ds_read_b64_tr_b16 v[42:43], v21 offset:43264
  s_waitcnt lgkmcnt(6)
  v_mfma_f32_32x32x16_bf16 v[96:111], v[28:31], a[20:23], v[96:111]
  ds_read_b64_tr_b16 v[44:45], v22 offset:41216
  ds_read_b64_tr_b16 v[46:47], v22 offset:43264
  s_add_u32 m0, s24, 99328
  s_nop 0
  buffer_load_dwordx4 v11, s[4:7], s22 offen lds
  v_accvgpr_write_b32 a5, 0
  s_waitcnt lgkmcnt(6)
  v_mfma_f32_32x32x16_bf16 v[112:127], v[32:35], a[20:23], v[112:127]
  ds_read_b64_tr_b16 v[48:49], v23 offset:41216
  ds_read_b64_tr_b16 v[50:51], v23 offset:43264
  s_waitcnt lgkmcnt(6)
  v_mfma_f32_32x32x16_bf16 v[128:143], v[36:39], a[20:23], v[128:143]
  ds_read_b64_tr_b16 v[28:29], v20 offset:49152
  ds_read_b64_tr_b16 v[30:31], v20 offset:51200
  s_add_u32 m0, s24, 100352
  s_nop 0
  buffer_load_dwordx4 v12, s[4:7], s22 offen lds
  v_accvgpr_write_b32 a6, 0
  s_waitcnt lgkmcnt(6)
  v_mfma_f32_32x32x16_bf16 v[144:159], v[40:43], a[20:23], v[144:159]
  ds_read_b64_tr_b16 v[32:33], v21 offset:49152
  ds_read_b64_tr_b16 v[34:35], v21 offset:51200
  s_waitcnt lgkmcnt(6)
  v_mfma_f32_32x32x16_bf16 v[160:175], v[44:47], a[20:23], v[160:175]
  ds_read_b64_tr_b16 v[36:37], v22 offset:49152
  ds_read_b64_tr_b16 v[38:39], v22 offset:51200
  s_add_u32 m0, s24, 101376
  s_nop 0
  buffer_load_dwordx4 v13, s[4:7], s22 offen lds
  v_accvgpr_write_b32 a7, 0
  s_waitcnt lgkmcnt(6)
  v_mfma_f32_32x32x16_bf16 v[176:191], v[48:51], a[20:23], v[176:191]
  ds_read_b64_tr_b16 v[40:41], v23 offset:49152
  ds_read_b64_tr_b16 v[42:43], v23 offset:51200
  s_waitcnt lgkmcnt(6)
  v_mfma_f32_32x32x16_bf16 v[64:79], v[28:31], a[24:27], v[64:79]
  ds_read_b64_tr_b16 v[44:45], v20 offset:49408
  ds_read_b64_tr_b16 v[46:47], v20 offset:51456
  s_add_u32 m0, s24, 102400
  s_nop 0
  buffer_load_dwordx4 v14, s[4:7], s22 offen lds
  v_accvgpr_write_b32 a8, 0
  s_waitcnt lgkmcnt(6)
  v_mfma_f32_32x32x16_bf16 v[80:95], v[32:35], a[24:27], v[80:95]
  ds_read_b64_tr_b16 v[48:49], v21 offset:49408
  ds_read_b64_tr_b16 v[50:51], v21 offset:51456
  s_waitcnt lgkmcnt(6)
  v_mfma_f32_32x32x16_bf16 v[96:111], v[36:39], a[24:27], v[96:111]
  ds_read_b64_tr_b16 v[28:29], v22 offset:49408
  ds_read_b64_tr_b16 v[30:31], v22 offset:51456
  s_add_u32 m0, s24, 103424
  s_nop 0
  buffer_load_dwordx4 v15, s[4:7], s22 offen lds
  v_accvgpr_write_b32 a9, 0
  s_waitcnt lgkmcnt(6)
  v_mfma_f32_32x32x16_bf16 v[112:127], v[40:43], a[24:27], v[112:127]
  ds_read_b64_tr_b16 v[32:33], v23 offset:49408
  ds_read_b64_tr_b16 v[34:35], v23 offset:51456
  s_waitcnt lgkmcnt(6)
  v_mfma_f32_32x32x16_bf16 v[128:143], v[44:47], a[24:27], v[128:143]
  ds_read_b64_tr_b16 v[36:37], v20 offset:57344
  ds_read_b64_tr_b16 v[38:39], v20 offset:59392
  s_add_u32 m0, s24, 104448
  s_nop 0
  buffer_load_dwordx4 v16, s[4:7], s22 offen lds
  v_accvgpr_write_b32 a10, 0
  s_waitcnt lgkmcnt(6)
  v_mfma_f32_32x32x16_bf16 v[144:159], v[48:51], a[24:27], v[144:159]
  ds_read_b64_tr_b16 v[40:41], v21 offset:57344
  ds_read_b64_tr_b16 v[42:43], v21 offset:59392
  s_waitcnt lgkmcnt(6)
  v_mfma_f32_32x32x16_bf16 v[160:175], v[28:31], a[24:27], v[160:175]
  ds_read_b64_tr_b16 v[44:45], v22 offset:57344
  ds_read_b64_tr_b16 v[46:47], v22 offset:59392
  s_add_u32 m0, s24, 105472
  s_nop 0
  buffer_load_dwordx4 v17, s[4:7], s22 offen lds
  s_add_u32 s22, s22, 524288
  v_accvgpr_write_b32 a11, 0
  s_waitcnt lgkmcnt(6)
  v_mfma_f32_32x32x16_bf16 v[176:191], v[32:35], a[24:27], v[176:191]
  ds_read_b64_tr_b16 v[48:49], v23 offset:57344
  ds_read_b64_tr_b16 v[50:51], v23 offset:59392
  s_waitcnt lgkmcnt(6)
  v_mfma_f32_32x32x16_bf16 v[64:79], v[36:39], a[28:31], v[64:79]
  ds_read_b64_tr_b16 v[28:29], v20 offset:57600
  ds_read_b64_tr_b16 v[30:31], v20 offset:59648
  v_accvgpr_write_b32 a12, 0
  s_waitcnt lgkmcnt(6)
  v_mfma_f32_32x32x16_bf16 v[80:95], v[40:43], a[28:31], v[80:95]
  ds_read_b64_tr_b16 v[32:33], v21 offset:57600
  ds_read_b64_tr_b16 v[34:35], v21 offset:59648
  s_waitcnt lgkmcnt(6)
  v_mfma_f32_32x32x16_bf16 v[96:111], v[44:47], a[28:31], v[96:111]
  ds_read_b64_tr_b16 v[36:37], v22 offset:57600
  ds_read_b64_tr_b16 v[38:39], v22 offset:59648
  v_accvgpr_write_b32 a13, 0
  s_waitcnt lgkmcnt(6)
  v_mfma_f32_32x32x16_bf16 v[112:127], v[48:51], a[28:31], v[112:127]
  ds_read_b64_tr_b16 v[40:41], v23 offset:57600
  ds_read_b64_tr_b16 v[42:43], v23 offset:59648
  s_waitcnt lgkmcnt(6)
  v_mfma_f32_32x32x16_bf16 v[128:143], v[28:31], a[28:31], v[128:143]
  s_waitcnt vmcnt(12) lgkmcnt(0)
  s_barrier
  ds_read_b64_tr_b16 v[44:45], v24 offset:0
  ds_read_b64_tr_b16 v[46:47], v24 offset:2048
  v_accvgpr_write_b32 a14, 0
  v_mfma_f32_32x32x16_bf16 v[144:159], v[32:35], a[28:31], v[144:159]
  ds_read_b64_tr_b16 v[48:49], v25 offset:0
  ds_read_b64_tr_b16 v[50:51], v25 offset:2048
  v_mfma_f32_32x32x16_bf16 v[160:175], v[36:39], a[28:31], v[160:175]
  ds_read_b64_tr_b16 v[28:29], v26 offset:0
  ds_read_b64_tr_b16 v[30:31], v26 offset:2048
  v_accvgpr_write_b32 a15, 0
  v_mfma_f32_32x32x16_bf16 v[176:191], v[40:43], a[28:31], v[176:191]
  ds_read_b64_tr_b16 v[32:33], v27 offset:0
  ds_read_b64_tr_b16 v[34:35], v27 offset:2048
  s_waitcnt lgkmcnt(6)
  v_mfma_f32_32x32x16_bf16 v[64:79], v[44:47], a[32:35], v[64:79]
  ds_read_b64_tr_b16 v[36:37], v24 offset:256
  ds_read_b64_tr_b16 v[38:39], v24 offset:2304
  buffer_load_dwordx4 a[64:67], v1, s[8:11], s21 offen offset:0
  v_accvgpr_write_b32 a16, 0
  s_waitcnt lgkmcnt(6)
  v_mfma_f32_32x32x16_bf16 v[80:95], v[48:51], a[32:35], v[80:95]
  ds_read_b64_tr_b16 v[40:41], v25 offset:256
  ds_read_b64_tr_b16 v[42:43], v25 offset:2304
  s_waitcnt lgkmcnt(6)
  v_mfma_f32_32x32x16_bf16 v[96:111], v[28:31], a[32:35], v[96:111]
  ds_read_b64_tr_b16 v[44:45], v26 offset:256
  ds_read_b64_tr_b16 v[46:47], v26 offset:2304
  buffer_load_dwordx4 a[68:71], v1, s[8:11], s21 offen offset:1024
  v_accvgpr_write_b32 a17, 0
  s_waitcnt lgkmcnt(6)
  v_mfma_f32_32x32x16_bf16 v[112:127], v[32:35], a[32:35], v[112:127]
  ds_read_b64_tr_b16 v[48:49], v27 offset:256
  ds_read_b64_tr_b16 v[50:51], v27 offset:2304
  s_waitcnt lgkmcnt(6)
  v_mfma_f32_32x32x16_bf16 v[128:143], v[36:39], a[32:35], v[128:143]
  ds_read_b64_tr_b16 v[28:29], v24 offset:8192
  ds_read_b64_tr_b16 v[30:31], v24 offset:10240
  buffer_load_dwordx4 a[72:75], v1, s[8:11], s21 offen offset:2048
  v_accvgpr_write_b32 a18, 0
  s_waitcnt lgkmcnt(6)
  v_mfma_f32_32x32x16_bf16 v[144:159], v[40:43], a[32:35], v[144:159]
  ds_read_b64_tr_b16 v[32:33], v25 offset:8192
  ds_read_b64_tr_b16 v[34:35], v25 offset:10240
  s_waitcnt lgkmcnt(6)
  v_mfma_f32_32x32x16_bf16 v[160:175], v[44:47], a[32:35], v[160:175]
  ds_read_b64_tr_b16 v[36:37], v26 offset:8192
  ds_read_b64_tr_b16 v[38:39], v26 offset:10240
  buffer_load_dwordx4 a[76:79], v1, s[8:11], s21 offen offset:3072
  s_add_u32 s21, s21, 4096
  v_accvgpr_write_b32 a19, 0
  s_waitcnt lgkmcnt(6)
  v_mfma_f32_32x32x16_bf16 v[176:191], v[48:51], a[32:35], v[176:191]
  ds_read_b64_tr_b16 v[40:41], v27 offset:8192
  ds_read_b64_tr_b16 v[42:43], v27 offset:10240
  s_waitcnt lgkmcnt(6)
  v_mfma_f32_32x32x16_bf16 v[64:79], v[28:31], a[36:39], v[64:79]
  ds_read_b64_tr_b16 v[44:45], v24 offset:8448
  ds_read_b64_tr_b16 v[46:47], v24 offset:10496
  s_add_u32 m0, s24, 0
  s_nop 0
  buffer_load_dwordx4 v10, s[4:7], s22 offen lds
  v_accvgpr_write_b32 a20, 0
  s_waitcnt lgkmcnt(6)
  v_mfma_f32_32x32x16_bf16 v[80:95], v[32:35], a[36:39], v[80:95]
  ds_read_b64_tr_b16 v[48:49], v25 offset:8448
  ds_read_b64_tr_b16 v[50:51], v25 offset:10496
  s_waitcnt lgkmcnt(6)
  v_mfma_f32_32x32x16_bf16 v[96:111], v[36:39], a[36:39], v[96:111]
  ds_read_b64_tr_b16 v[28:29], v26 offset:8448
  ds_read_b64_tr_b16 v[30:31], v26 offset:10496
  s_add_u32 m0, s24, 1024
  s_nop 0
  buffer_load_dwordx4 v11, s[4:7], s22 offen lds
  v_accvgpr_write_b32 a21, 0
  s_waitcnt lgkmcnt(6)
  v_mfma_f32_32x32x16_bf16 v[112:127], v[40:43], a[36:39], v[112:127]
  ds_read_b64_tr_b16 v[32:33], v27 offset:8448
  ds_read_b64_tr_b16 v[34:35], v27 offset:10496
  s_waitcnt lgkmcnt(6)
  v_mfma_f32_32x32x16_bf16 v[128:143], v[44:47], a[36:39], v[128:143]
  ds_read_b64_tr_b16 v[36:37], v24 offset:16384
  ds_read_b64_tr_b16 v[38:39], v24 offset:18432
  s_add_u32 m0, s24, 2048
  s_nop 0
  buffer_load_dwordx4 v12, s[4:7], s22 offen lds
  v_accvgpr_write_b32 a22, 0
  s_waitcnt lgkmcnt(6)
  v_mfma_f32_32x32x16_bf16 v[144:159], v[48:51], a[36:39], v[144:159]
  ds_read_b64_tr_b16 v[40:41], v25 offset:16384
  ds_read_b64_tr_b16 v[42:43], v25 offset:18432
  s_waitcnt lgkmcnt(6)
  v_mfma_f32_32x32x16_bf16 v[160:175], v[28:31], a[36:39], v[160:175]
  ds_read_b64_tr_b16 v[44:45], v26 offset:16384
  ds_read_b64_tr_b16 v[46:47], v26 offset:18432
  s_add_u32 m0, s24, 3072
  s_nop 0
  buffer_load_dwordx4 v13, s[4:7], s22 offen lds
  v_accvgpr_write_b32 a23, 0
  s_waitcnt lgkmcnt(6)
  v_mfma_f32_32x32x16_bf16 v[176:191], v[32:35], a[36:39], v[176:191]
  ds_read_b64_tr_b16 v[48:49], v27 offset:16384
  ds_read_b64_tr_b16 v[50:51], v27 offset:18432
  s_waitcnt lgkmcnt(6)
  v_mfma_f32_32x32x16_bf16 v[64:79], v[36:39], a[40:43], v[64:79]
  ds_read_b64_tr_b16 v[28:29], v24 offset:16640
  ds_read_b64_tr_b16 v[30:31], v24 offset:18688
  s_add_u32 m0, s24, 4096
  s_nop 0
  buffer_load_dwordx4 v14, s[4:7], s22 offen lds
  v_accvgpr_write_b32 a24, 0
  s_waitcnt lgkmcnt(6)
  v_mfma_f32_32x32x16_bf16 v[80:95], v[40:43], a[40:43], v[80:95]
  ds_read_b64_tr_b16 v[32:33], v25 offset:16640
  ds_read_b64_tr_b16 v[34:35], v25 offset:18688
  s_waitcnt lgkmcnt(6)
  v_mfma_f32_32x32x16_bf16 v[96:111], v[44:47], a[40:43], v[96:111]
  ds_read_b64_tr_b16 v[36:37], v26 offset:16640
  ds_read_b64_tr_b16 v[38:39], v26 offset:18688
  s_add_u32 m0, s24, 5120
  s_nop 0
  buffer_load_dwordx4 v15, s[4:7], s22 offen lds
  v_accvgpr_write_b32 a25, 0
  s_waitcnt lgkmcnt(6)
  v_mfma_f32_32x32x16_bf16 v[112:127], v[48:51], a[40:43], v[112:127]
  ds_read_b64_tr_b16 v[40:41], v27 offset:16640
  ds_read_b64_tr_b16 v[42:43], v27 offset:18688
  s_waitcnt lgkmcnt(6)
  v_mfma_f32_32x32x16_bf16 v[128:143], v[28:31], a[40:43], v[128:143]
  ds_read_b64_tr_b16 v[44:45], v24 offset:24576
  ds_read_b64_tr_b16 v[46:47], v24 offset:26624
  s_add_u32 m0, s24, 6144
  s_nop 0
  buffer_load_dwordx4 v16, s[4:7], s22 offen lds
  v_accvgpr_write_b32 a26, 0
  s_waitcnt lgkmcnt(6)
  v_mfma_f32_32x32x16_bf16 v[144:159], v[32:35], a[40:43], v[144:159]
  ds_read_b64_tr_b16 v[48:49], v25 offset:24576
  ds_read_b64_tr_b16 v[50:51], v25 offset:26624
  s_waitcnt lgkmcnt(6)
  v_mfma_f32_32x32x16_bf16 v[160:175], v[36:39], a[40:43], v[160:175]
  ds_read_b64_tr_b16 v[28:29], v26 offset:24576
  ds_read_b64_tr_b16 v[30:31], v26 offset:26624
  s_add_u32 m0, s24, 7168
  s_nop 0
  buffer_load_dwordx4 v17, s[4:7], s22 offen lds
  s_add_u32 s22, s22, 524288
  v_accvgpr_write_b32 a27, 0
  s_waitcnt lgkmcnt(6)
  v_mfma_f32_32x32x16_bf16 v[176:191], v[40:43], a[40:43], v[176:191]
  ds_read_b64_tr_b16 v[32:33], v27 offset:24576
  ds_read_b64_tr_b16 v[34:35], v27 offset:26624
  s_waitcnt lgkmcnt(6)
  v_mfma_f32_32x32x16_bf16 v[64:79], v[44:47], a[44:47], v[64:79]
  ds_read_b64_tr_b16 v[36:37], v24 offset:24832
  ds_read_b64_tr_b16 v[38:39], v24 offset:26880
  v_accvgpr_write_b32 a28, 0
  s_waitcnt lgkmcnt(6)
  v_mfma_f32_32x32x16_bf16 v[80:95], v[48:51], a[44:47], v[80:95]
  ds_read_b64_tr_b16 v[40:41], v25 offset:24832
  ds_read_b64_tr_b16 v[42:43], v25 offset:26880
  s_waitcnt lgkmcnt(6)
  v_mfma_f32_32x32x16_bf16 v[96:111], v[28:31], a[44:47], v[96:111]
  ds_read_b64_tr_b16 v[44:45], v26 offset:24832
  ds_read_b64_tr_b16 v[46:47], v26 offset:26880
  v_accvgpr_write_b32 a29, 0
  s_waitcnt lgkmcnt(6)
  v_mfma_f32_32x32x16_bf16 v[112:127], v[32:35], a[44:47], v[112:127]
  ds_read_b64_tr_b16 v[48:49], v27 offset:24832
  ds_read_b64_tr_b16 v[50:51], v27 offset:26880
  s_waitcnt lgkmcnt(6)
  v_mfma_f32_32x32x16_bf16 v[128:143], v[36:39], a[44:47], v[128:143]
  s_waitcnt vmcnt(12) lgkmcnt(0)
  s_barrier
  ds_read_b64_tr_b16 v[28:29], v24 offset:32768
  ds_read_b64_tr_b16 v[30:31], v24 offset:34816
  v_accvgpr_write_b32 a30, 0
  v_mfma_f32_32x32x16_bf16 v[144:159], v[40:43], a[44:47], v[144:159]
  ds_read_b64_tr_b16 v[32:33], v25 offset:32768
  ds_read_b64_tr_b16 v[34:35], v25 offset:34816
  v_mfma_f32_32x32x16_bf16 v[160:175], v[44:47], a[44:47], v[160:175]
  ds_read_b64_tr_b16 v[36:37], v26 offset:32768
  ds_read_b64_tr_b16 v[38:39], v26 offset:34816
  v_accvgpr_write_b32 a31, 0
  v_mfma_f32_32x32x16_bf16 v[176:191], v[48:51], a[44:47], v[176:191]
  ds_read_b64_tr_b16 v[40:41], v27 offset:32768
  ds_read_b64_tr_b16 v[42:43], v27 offset:34816
  s_waitcnt lgkmcnt(6)
  v_mfma_f32_32x32x16_bf16 v[64:79], v[28:31], a[48:51], v[64:79]
  ds_read_b64_tr_b16 v[44:45], v24 offset:33024
  ds_read_b64_tr_b16 v[46:47], v24 offset:35072
  buffer_load_dwordx4 a[80:83], v1, s[8:11], s21 offen offset:0
  v_accvgpr_write_b32 a32, 0
  s_waitcnt lgkmcnt(6)
  v_mfma_f32_32x32x16_bf16 v[80:95], v[32:35], a[48:51], v[80:95]
  ds_read_b64_tr_b16 v[48:49], v25 offset:33024
  ds_read_b64_tr_b16 v[50:51], v25 offset:35072
  s_waitcnt lgkmcnt(6)
  v_mfma_f32_32x32x16_bf16 v[96:111], v[36:39], a[48:51], v[96:111]
  ds_read_b64_tr_b16 v[28:29], v26 offset:33024
  ds_read_b64_tr_b16 v[30:31], v26 offset:35072
  buffer_load_dwordx4 a[84:87], v1, s[8:11], s21 offen offset:1024
  v_accvgpr_write_b32 a33, 0
  s_waitcnt lgkmcnt(6)
  v_mfma_f32_32x32x16_bf16 v[112:127], v[40:43], a[48:51], v[112:127]
  ds_read_b64_tr_b16 v[32:33], v27 offset:33024
  ds_read_b64_tr_b16 v[34:35], v27 offset:35072
  s_waitcnt lgkmcnt(6)
  v_mfma_f32_32x32x16_bf16 v[128:143], v[44:47], a[48:51], v[128:143]
  ds_read_b64_tr_b16 v[36:37], v24 offset:40960
  ds_read_b64_tr_b16 v[38:39], v24 offset:43008
  buffer_load_dwordx4 a[88:91], v1, s[8:11], s21 offen offset:2048
  v_accvgpr_write_b32 a34, 0
  s_waitcnt lgkmcnt(6)
  v_mfma_f32_32x32x16_bf16 v[144:159], v[48:51], a[48:51], v[144:159]
  ds_read_b64_tr_b16 v[40:41], v25 offset:40960
  ds_read_b64_tr_b16 v[42:43], v25 offset:43008
  s_waitcnt lgkmcnt(6)
  v_mfma_f32_32x32x16_bf16 v[160:175], v[28:31], a[48:51], v[160:175]
  ds_read_b64_tr_b16 v[44:45], v26 offset:40960
  ds_read_b64_tr_b16 v[46:47], v26 offset:43008
  buffer_load_dwordx4 a[92:95], v1, s[8:11], s21 offen offset:3072
  s_add_u32 s21, s21, 4096
  v_accvgpr_write_b32 a35, 0
  s_waitcnt lgkmcnt(6)
  v_mfma_f32_32x32x16_bf16 v[176:191], v[32:35], a[48:51], v[176:191]
  ds_read_b64_tr_b16 v[48:49], v27 offset:40960
  ds_read_b64_tr_b16 v[50:51], v27 offset:43008
  s_waitcnt lgkmcnt(6)
  v_mfma_f32_32x32x16_bf16 v[64:79], v[36:39], a[52:55], v[64:79]
  ds_read_b64_tr_b16 v[28:29], v24 offset:41216
  ds_read_b64_tr_b16 v[30:31], v24 offset:43264
  s_add_u32 m0, s24, 32768
  s_nop 0
  buffer_load_dwordx4 v10, s[4:7], s22 offen lds
  v_accvgpr_write_b32 a36, 0
  s_waitcnt lgkmcnt(6)
  v_mfma_f32_32x32x16_bf16 v[80:95], v[40:43], a[52:55], v[80:95]
  ds_read_b64_tr_b16 v[32:33], v25 offset:41216
  ds_read_b64_tr_b16 v[34:35], v25 offset:43264
  s_waitcnt lgkmcnt(6)
  v_mfma_f32_32x32x16_bf16 v[96:111], v[44:47], a[52:55], v[96:111]
  ds_read_b64_tr_b16 v[36:37], v26 offset:41216
  ds_read_b64_tr_b16 v[38:39], v26 offset:43264
  s_add_u32 m0, s24, 33792
  s_nop 0
  buffer_load_dwordx4 v11, s[4:7], s22 offen lds
  v_accvgpr_write_b32 a37, 0
  s_waitcnt lgkmcnt(6)
  v_mfma_f32_32x32x16_bf16 v[112:127], v[48:51], a[52:55], v[112:127]
  ds_read_b64_tr_b16 v[40:41], v27 offset:41216
  ds_read_b64_tr_b16 v[42:43], v27 offset:43264
  s_waitcnt lgkmcnt(6)
  v_mfma_f32_32x32x16_bf16 v[128:143], v[28:31], a[52:55], v[128:143]
  ds_read_b64_tr_b16 v[44:45], v24 offset:49152
  ds_read_b64_tr_b16 v[46:47], v24 offset:51200
  s_add_u32 m0, s24, 34816
  s_nop 0
  buffer_load_dwordx4 v12, s[4:7], s22 offen lds
  v_accvgpr_write_b32 a38, 0
  s_waitcnt lgkmcnt(6)
  v_mfma_f32_32x32x16_bf16 v[144:159], v[32:35], a[52:55], v[144:159]
  ds_read_b64_tr_b16 v[48:49], v25 offset:49152
  ds_read_b64_tr_b16 v[50:51], v25 offset:51200
  s_waitcnt lgkmcnt(6)
  v_mfma_f32_32x32x16_bf16 v[160:175], v[36:39], a[52:55], v[160:175]
  ds_read_b64_tr_b16 v[28:29], v26 offset:49152
  ds_read_b64_tr_b16 v[30:31], v26 offset:51200
  s_add_u32 m0, s24, 35840
  s_nop 0
  buffer_load_dwordx4 v13, s[4:7], s22 offen lds
  v_accvgpr_write_b32 a39, 0
  s_waitcnt lgkmcnt(6)
  v_mfma_f32_32x32x16_bf16 v[176:191], v[40:43], a[52:55], v[176:191]
  ds_read_b64_tr_b16 v[32:33], v27 offset:49152
  ds_read_b64_tr_b16 v[34:35], v27 offset:51200
  s_waitcnt lgkmcnt(6)
  v_mfma_f32_32x32x16_bf16 v[64:79], v[44:47], a[56:59], v[64:79]
  ds_read_b64_tr_b16 v[36:37], v24 offset:49408
  ds_read_b64_tr_b16 v[38:39], v24 offset:51456
  s_add_u32 m0, s24, 36864
  s_nop 0
  buffer_load_dwordx4 v14, s[4:7], s22 offen lds
  v_accvgpr_write_b32 a40, 0
  s_waitcnt lgkmcnt(6)
  v_mfma_f32_32x32x16_bf16 v[80:95], v[48:51], a[56:59], v[80:95]
  ds_read_b64_tr_b16 v[40:41], v25 offset:49408
  ds_read_b64_tr_b16 v[42:43], v25 offset:51456
  s_waitcnt lgkmcnt(6)
  v_mfma_f32_32x32x16_bf16 v[96:111], v[28:31], a[56:59], v[96:111]
  ds_read_b64_tr_b16 v[44:45], v26 offset:49408
  ds_read_b64_tr_b16 v[46:47], v26 offset:51456
  s_add_u32 m0, s24, 37888
  s_nop 0
  buffer_load_dwordx4 v15, s[4:7], s22 offen lds
  v_accvgpr_write_b32 a41, 0
  s_waitcnt lgkmcnt(6)
  v_mfma_f32_32x32x16_bf16 v[112:127], v[32:35], a[56:59], v[112:127]
  ds_read_b64_tr_b16 v[48:49], v27 offset:49408
  ds_read_b64_tr_b16 v[50:51], v27 offset:51456
  s_waitcnt lgkmcnt(6)
  v_mfma_f32_32x32x16_bf16 v[128:143], v[36:39], a[56:59], v[128:143]
  ds_read_b64_tr_b16 v[28:29], v24 offset:57344
  ds_read_b64_tr_b16 v[30:31], v24 offset:59392
  s_add_u32 m0, s24, 38912
  s_nop 0
  buffer_load_dwordx4 v16, s[4:7], s22 offen lds
  v_accvgpr_write_b32 a42, 0
  s_waitcnt lgkmcnt(6)
  v_mfma_f32_32x32x16_bf16 v[144:159], v[40:43], a[56:59], v[144:159]
  ds_read_b64_tr_b16 v[32:33], v25 offset:57344
  ds_read_b64_tr_b16 v[34:35], v25 offset:59392
  s_waitcnt lgkmcnt(6)
  v_mfma_f32_32x32x16_bf16 v[160:175], v[44:47], a[56:59], v[160:175]
  ds_read_b64_tr_b16 v[36:37], v26 offset:57344
  ds_read_b64_tr_b16 v[38:39], v26 offset:59392
  s_add_u32 m0, s24, 39936
  s_nop 0
  buffer_load_dwordx4 v17, s[4:7], s22 offen lds
  s_add_u32 s22, s22, 524288
  v_accvgpr_write_b32 a43, 0
  s_waitcnt lgkmcnt(6)
  v_mfma_f32_32x32x16_bf16 v[176:191], v[48:51], a[56:59], v[176:191]
  ds_read_b64_tr_b16 v[40:41], v27 offset:57344
  ds_read_b64_tr_b16 v[42:43], v27 offset:59392
  s_waitcnt lgkmcnt(6)
  v_mfma_f32_32x32x16_bf16 v[64:79], v[28:31], a[60:63], v[64:79]
  ds_read_b64_tr_b16 v[44:45], v24 offset:57600
  ds_read_b64_tr_b16 v[46:47], v24 offset:59648
  v_accvgpr_write_b32 a44, 0
  s_waitcnt lgkmcnt(6)
  v_mfma_f32_32x32x16_bf16 v[80:95], v[32:35], a[60:63], v[80:95]
  ds_read_b64_tr_b16 v[48:49], v25 offset:57600
  ds_read_b64_tr_b16 v[50:51], v25 offset:59648
  s_waitcnt lgkmcnt(6)
  v_mfma_f32_32x32x16_bf16 v[96:111], v[36:39], a[60:63], v[96:111]
  ds_read_b64_tr_b16 v[28:29], v26 offset:57600
  ds_read_b64_tr_b16 v[30:31], v26 offset:59648
  v_accvgpr_write_b32 a45, 0
  s_waitcnt lgkmcnt(6)
  v_mfma_f32_32x32x16_bf16 v[112:127], v[40:43], a[60:63], v[112:127]
  ds_read_b64_tr_b16 v[32:33], v27 offset:57600
  ds_read_b64_tr_b16 v[34:35], v27 offset:59648
  s_waitcnt lgkmcnt(6)
  v_mfma_f32_32x32x16_bf16 v[128:143], v[44:47], a[60:63], v[128:143]
  s_waitcnt vmcnt(12) lgkmcnt(0)
  s_barrier
  ds_read_b64_tr_b16 v[36:37], v20 offset:0
  ds_read_b64_tr_b16 v[38:39], v20 offset:2048
  v_accvgpr_write_b32 a46, 0
  v_mfma_f32_32x32x16_bf16 v[144:159], v[48:51], a[60:63], v[144:159]
  ds_read_b64_tr_b16 v[40:41], v21 offset:0
  ds_read_b64_tr_b16 v[42:43], v21 offset:2048
  v_mfma_f32_32x32x16_bf16 v[160:175], v[28:31], a[60:63], v[160:175]
  ds_read_b64_tr_b16 v[44:45], v22 offset:0
  ds_read_b64_tr_b16 v[46:47], v22 offset:2048
  v_accvgpr_write_b32 a47, 0
  v_mfma_f32_32x32x16_bf16 v[176:191], v[32:35], a[60:63], v[176:191]
  ds_read_b64_tr_b16 v[48:49], v23 offset:0
  ds_read_b64_tr_b16 v[50:51], v23 offset:2048
  s_waitcnt lgkmcnt(6)
  v_mfma_f32_32x32x16_bf16 v[64:79], v[36:39], a[64:67], v[64:79]
  ds_read_b64_tr_b16 v[28:29], v20 offset:256
  ds_read_b64_tr_b16 v[30:31], v20 offset:2304
  buffer_load_dwordx4 a[96:99], v1, s[8:11], s21 offen offset:0
  v_accvgpr_write_b32 a48, 0
  s_waitcnt lgkmcnt(6)
  v_mfma_f32_32x32x16_bf16 v[80:95], v[40:43], a[64:67], v[80:95]
  ds_read_b64_tr_b16 v[32:33], v21 offset:256
  ds_read_b64_tr_b16 v[34:35], v21 offset:2304
  s_waitcnt lgkmcnt(6)
  v_mfma_f32_32x32x16_bf16 v[96:111], v[44:47], a[64:67], v[96:111]
  ds_read_b64_tr_b16 v[36:37], v22 offset:256
  ds_read_b64_tr_b16 v[38:39], v22 offset:2304
  buffer_load_dwordx4 a[100:103], v1, s[8:11], s21 offen offset:1024
  v_accvgpr_write_b32 a49, 0
  s_waitcnt lgkmcnt(6)
  v_mfma_f32_32x32x16_bf16 v[112:127], v[48:51], a[64:67], v[112:127]
  ds_read_b64_tr_b16 v[40:41], v23 offset:256
  ds_read_b64_tr_b16 v[42:43], v23 offset:2304
  s_waitcnt lgkmcnt(6)
  v_mfma_f32_32x32x16_bf16 v[128:143], v[28:31], a[64:67], v[128:143]
  ds_read_b64_tr_b16 v[44:45], v20 offset:8192
  ds_read_b64_tr_b16 v[46:47], v20 offset:10240
  buffer_load_dwordx4 a[104:107], v1, s[8:11], s21 offen offset:2048
  v_accvgpr_write_b32 a50, 0
  s_waitcnt lgkmcnt(6)
  v_mfma_f32_32x32x16_bf16 v[144:159], v[32:35], a[64:67], v[144:159]
  ds_read_b64_tr_b16 v[48:49], v21 offset:8192
  ds_read_b64_tr_b16 v[50:51], v21 offset:10240
  s_waitcnt lgkmcnt(6)
  v_mfma_f32_32x32x16_bf16 v[160:175], v[36:39], a[64:67], v[160:175]
  ds_read_b64_tr_b16 v[28:29], v22 offset:8192
  ds_read_b64_tr_b16 v[30:31], v22 offset:10240
  buffer_load_dwordx4 a[108:111], v1, s[8:11], s21 offen offset:3072
  s_add_u32 s21, s21, 4096
  v_accvgpr_write_b32 a51, 0
  s_waitcnt lgkmcnt(6)
  v_mfma_f32_32x32x16_bf16 v[176:191], v[40:43], a[64:67], v[176:191]
  ds_read_b64_tr_b16 v[32:33], v23 offset:8192
  ds_read_b64_tr_b16 v[34:35], v23 offset:10240
  s_waitcnt lgkmcnt(6)
  v_mfma_f32_32x32x16_bf16 v[64:79], v[44:47], a[68:71], v[64:79]
  ds_read_b64_tr_b16 v[36:37], v20 offset:8448
  ds_read_b64_tr_b16 v[38:39], v20 offset:10496
  s_add_u32 m0, s24, 65536
  s_nop 0
  buffer_load_dwordx4 v10, s[4:7], s22 offen lds
  v_accvgpr_write_b32 a52, 0
  s_waitcnt lgkmcnt(6)
  v_mfma_f32_32x32x16_bf16 v[80:95], v[48:51], a[68:71], v[80:95]
  ds_read_b64_tr_b16 v[40:41], v21 offset:8448
  ds_read_b64_tr_b16 v[42:43], v21 offset:10496
  s_waitcnt lgkmcnt(6)
  v_mfma_f32_32x32x16_bf16 v[96:111], v[28:31], a[68:71], v[96:111]
  ds_read_b64_tr_b16 v[44:45], v22 offset:8448
  ds_read_b64_tr_b16 v[46:47], v22 offset:10496
  s_add_u32 m0, s24, 66560
  s_nop 0
  buffer_load_dwordx4 v11, s[4:7], s22 offen lds
  v_accvgpr_write_b32 a53, 0
  s_waitcnt lgkmcnt(6)
  v_mfma_f32_32x32x16_bf16 v[112:127], v[32:35], a[68:71], v[112:127]
  ds_read_b64_tr_b16 v[48:49], v23 offset:8448
  ds_read_b64_tr_b16 v[50:51], v23 offset:10496
  s_waitcnt lgkmcnt(6)
  v_mfma_f32_32x32x16_bf16 v[128:143], v[36:39], a[68:71], v[128:143]
  ds_read_b64_tr_b16 v[28:29], v20 offset:16384
  ds_read_b64_tr_b16 v[30:31], v20 offset:18432
  s_add_u32 m0, s24, 67584
  s_nop 0
  buffer_load_dwordx4 v12, s[4:7], s22 offen lds
  v_accvgpr_write_b32 a54, 0
  s_waitcnt lgkmcnt(6)
  v_mfma_f32_32x32x16_bf16 v[144:159], v[40:43], a[68:71], v[144:159]
  ds_read_b64_tr_b16 v[32:33], v21 offset:16384
  ds_read_b64_tr_b16 v[34:35], v21 offset:18432
  s_waitcnt lgkmcnt(6)
  v_mfma_f32_32x32x16_bf16 v[160:175], v[44:47], a[68:71], v[160:175]
  ds_read_b64_tr_b16 v[36:37], v22 offset:16384
  ds_read_b64_tr_b16 v[38:39], v22 offset:18432
  s_add_u32 m0, s24, 68608
  s_nop 0
  buffer_load_dwordx4 v13, s[4:7], s22 offen lds
  v_accvgpr_write_b32 a55, 0
  s_waitcnt lgkmcnt(6)
  v_mfma_f32_32x32x16_bf16 v[176:191], v[48:51], a[68:71], v[176:191]
  ds_read_b64_tr_b16 v[40:41], v23 offset:16384
  ds_read_b64_tr_b16 v[42:43], v23 offset:18432
  s_waitcnt lgkmcnt(6)
  v_mfma_f32_32x32x16_bf16 v[64:79], v[28:31], a[72:75], v[64:79]
  ds_read_b64_tr_b16 v[44:45], v20 offset:16640
  ds_read_b64_tr_b16 v[46:47], v20 offset:18688
  s_add_u32 m0, s24, 69632
  s_nop 0
  buffer_load_dwordx4 v14, s[4:7], s22 offen lds
  v_accvgpr_write_b32 a56, 0
  s_waitcnt lgkmcnt(6)
  v_mfma_f32_32x32x16_bf16 v[80:95], v[32:35], a[72:75], v[80:95]
  ds_read_b64_tr_b16 v[48:49], v21 offset:16640
  ds_read_b64_tr_b16 v[50:51], v21 offset:18688
  s_waitcnt lgkmcnt(6)
  v_mfma_f32_32x32x16_bf16 v[96:111], v[36:39], a[72:75], v[96:111]
  ds_read_b64_tr_b16 v[28:29], v22 offset:16640
  ds_read_b64_tr_b16 v[30:31], v22 offset:18688
  s_add_u32 m0, s24, 70656
  s_nop 0
  buffer_load_dwordx4 v15, s[4:7], s22 offen lds
  v_accvgpr_write_b32 a57, 0
  s_waitcnt lgkmcnt(6)
  v_mfma_f32_32x32x16_bf16 v[112:127], v[40:43], a[72:75], v[112:127]
  ds_read_b64_tr_b16 v[32:33], v23 offset:16640
  ds_read_b64_tr_b16 v[34:35], v23 offset:18688
  s_waitcnt lgkmcnt(6)
  v_mfma_f32_32x32x16_bf16 v[128:143], v[44:47], a[72:75], v[128:143]
  ds_read_b64_tr_b16 v[36:37], v20 offset:24576
  ds_read_b64_tr_b16 v[38:39], v20 offset:26624
  s_add_u32 m0, s24, 71680
  s_nop 0
  buffer_load_dwordx4 v16, s[4:7], s22 offen lds
  v_accvgpr_write_b32 a58, 0
  s_waitcnt lgkmcnt(6)
  v_mfma_f32_32x32x16_bf16 v[144:159], v[48:51], a[72:75], v[144:159]
  ds_read_b64_tr_b16 v[40:41], v21 offset:24576
  ds_read_b64_tr_b16 v[42:43], v21 offset:26624
  s_waitcnt lgkmcnt(6)
  v_mfma_f32_32x32x16_bf16 v[160:175], v[28:31], a[72:75], v[160:175]
  ds_read_b64_tr_b16 v[44:45], v22 offset:24576
  ds_read_b64_tr_b16 v[46:47], v22 offset:26624
  s_add_u32 m0, s24, 72704
  s_nop 0
  buffer_load_dwordx4 v17, s[4:7], s22 offen lds
  s_add_u32 s22, s22, 524288
  v_accvgpr_write_b32 a59, 0
  s_waitcnt lgkmcnt(6)
  v_mfma_f32_32x32x16_bf16 v[176:191], v[32:35], a[72:75], v[176:191]
  ds_read_b64_tr_b16 v[48:49], v23 offset:24576
  ds_read_b64_tr_b16 v[50:51], v23 offset:26624
  s_waitcnt lgkmcnt(6)
  v_mfma_f32_32x32x16_bf16 v[64:79], v[36:39], a[76:79], v[64:79]
  ds_read_b64_tr_b16 v[28:29], v20 offset:24832
  ds_read_b64_tr_b16 v[30:31], v20 offset:26880
  v_accvgpr_write_b32 a60, 0
  s_waitcnt lgkmcnt(6)
  v_mfma_f32_32x32x16_bf16 v[80:95], v[40:43], a[76:79], v[80:95]
  ds_read_b64_tr_b16 v[32:33], v21 offset:24832
  ds_read_b64_tr_b16 v[34:35], v21 offset:26880
  s_waitcnt lgkmcnt(6)
  v_mfma_f32_32x32x16_bf16 v[96:111], v[44:47], a[76:79], v[96:111]
  ds_read_b64_tr_b16 v[36:37], v22 offset:24832
  ds_read_b64_tr_b16 v[38:39], v22 offset:26880
  v_accvgpr_write_b32 a61, 0
  s_waitcnt lgkmcnt(6)
  v_mfma_f32_32x32x16_bf16 v[112:127], v[48:51], a[76:79], v[112:127]
  ds_read_b64_tr_b16 v[40:41], v23 offset:24832
  ds_read_b64_tr_b16 v[42:43], v23 offset:26880
  s_waitcnt lgkmcnt(6)
  v_mfma_f32_32x32x16_bf16 v[128:143], v[28:31], a[76:79], v[128:143]
  s_waitcnt vmcnt(12) lgkmcnt(0)
  s_barrier
  ds_read_b64_tr_b16 v[44:45], v20 offset:32768
  ds_read_b64_tr_b16 v[46:47], v20 offset:34816
  v_accvgpr_write_b32 a62, 0
  v_mfma_f32_32x32x16_bf16 v[144:159], v[32:35], a[76:79], v[144:159]
  ds_read_b64_tr_b16 v[48:49], v21 offset:32768
  ds_read_b64_tr_b16 v[50:51], v21 offset:34816
  v_mfma_f32_32x32x16_bf16 v[160:175], v[36:39], a[76:79], v[160:175]
  ds_read_b64_tr_b16 v[28:29], v22 offset:32768
  ds_read_b64_tr_b16 v[30:31], v22 offset:34816
  v_accvgpr_write_b32 a63, 0
  v_mfma_f32_32x32x16_bf16 v[176:191], v[40:43], a[76:79], v[176:191]
  ds_read_b64_tr_b16 v[32:33], v23 offset:32768
  ds_read_b64_tr_b16 v[34:35], v23 offset:34816
  s_waitcnt lgkmcnt(6)
  v_mfma_f32_32x32x16_bf16 v[64:79], v[44:47], a[80:83], v[64:79]
  ds_read_b64_tr_b16 v[36:37], v20 offset:33024
  ds_read_b64_tr_b16 v[38:39], v20 offset:35072
  buffer_load_dwordx4 a[112:115], v1, s[8:11], s21 offen offset:0
  v_accvgpr_write_b32 a64, 0
  s_waitcnt lgkmcnt(6)
  v_mfma_f32_32x32x16_bf16 v[80:95], v[48:51], a[80:83], v[80:95]
  ds_read_b64_tr_b16 v[40:41], v21 offset:33024
  ds_read_b64_tr_b16 v[42:43], v21 offset:35072
  s_waitcnt lgkmcnt(6)
  v_mfma_f32_32x32x16_bf16 v[96:111], v[28:31], a[80:83], v[96:111]
  ds_read_b64_tr_b16 v[44:45], v22 offset:33024
  ds_read_b64_tr_b16 v[46:47], v22 offset:35072
  buffer_load_dwordx4 a[116:119], v1, s[8:11], s21 offen offset:1024
  v_accvgpr_write_b32 a65, 0
  s_waitcnt lgkmcnt(6)
  v_mfma_f32_32x32x16_bf16 v[112:127], v[32:35], a[80:83], v[112:127]
  ds_read_b64_tr_b16 v[48:49], v23 offset:33024
  ds_read_b64_tr_b16 v[50:51], v23 offset:35072
  s_waitcnt lgkmcnt(6)
  v_mfma_f32_32x32x16_bf16 v[128:143], v[36:39], a[80:83], v[128:143]
  ds_read_b64_tr_b16 v[28:29], v20 offset:40960
  ds_read_b64_tr_b16 v[30:31], v20 offset:43008
  buffer_load_dwordx4 a[120:123], v1, s[8:11], s21 offen offset:2048
  v_accvgpr_write_b32 a66, 0
  s_waitcnt lgkmcnt(6)
  v_mfma_f32_32x32x16_bf16 v[144:159], v[40:43], a[80:83], v[144:159]
  ds_read_b64_tr_b16 v[32:33], v21 offset:40960
  ds_read_b64_tr_b16 v[34:35], v21 offset:43008
  s_waitcnt lgkmcnt(6)
  v_mfma_f32_32x32x16_bf16 v[160:175], v[44:47], a[80:83], v[160:175]
  ds_read_b64_tr_b16 v[36:37], v22 offset:40960
  ds_read_b64_tr_b16 v[38:39], v22 offset:43008
  buffer_load_dwordx4 a[124:127], v1, s[8:11], s21 offen offset:3072
  s_add_u32 s21, s21, 4096
  v_accvgpr_write_b32 a67, 0
  s_waitcnt lgkmcnt(6)
  v_mfma_f32_32x32x16_bf16 v[176:191], v[48:51], a[80:83], v[176:191]
  ds_read_b64_tr_b16 v[40:41], v23 offset:40960
  ds_read_b64_tr_b16 v[42:43], v23 offset:43008
  s_waitcnt lgkmcnt(6)
  v_mfma_f32_32x32x16_bf16 v[64:79], v[28:31], a[84:87], v[64:79]
  ds_read_b64_tr_b16 v[44:45], v20 offset:41216
  ds_read_b64_tr_b16 v[46:47], v20 offset:43264
  s_add_u32 m0, s24, 98304
  s_nop 0
  buffer_load_dwordx4 v10, s[4:7], s22 offen lds
  v_accvgpr_write_b32 a68, 0
  s_waitcnt lgkmcnt(6)
  v_mfma_f32_32x32x16_bf16 v[80:95], v[32:35], a[84:87], v[80:95]
  ds_read_b64_tr_b16 v[48:49], v21 offset:41216
  ds_read_b64_tr_b16 v[50:51], v21 offset:43264
  s_waitcnt lgkmcnt(6)
  v_mfma_f32_32x32x16_bf16 v[96:111], v[36:39], a[84:87], v[96:111]
  ds_read_b64_tr_b16 v[28:29], v22 offset:41216
  ds_read_b64_tr_b16 v[30:31], v22 offset:43264
  s_add_u32 m0, s24, 99328
  s_nop 0
  buffer_load_dwordx4 v11, s[4:7], s22 offen lds
  v_accvgpr_write_b32 a69, 0
  s_waitcnt lgkmcnt(6)
  v_mfma_f32_32x32x16_bf16 v[112:127], v[40:43], a[84:87], v[112:127]
  ds_read_b64_tr_b16 v[32:33], v23 offset:41216
  ds_read_b64_tr_b16 v[34:35], v23 offset:43264
  s_waitcnt lgkmcnt(6)
  v_mfma_f32_32x32x16_bf16 v[128:143], v[44:47], a[84:87], v[128:143]
  ds_read_b64_tr_b16 v[36:37], v20 offset:49152
  ds_read_b64_tr_b16 v[38:39], v20 offset:51200
  s_add_u32 m0, s24, 100352
  s_nop 0
  buffer_load_dwordx4 v12, s[4:7], s22 offen lds
  v_accvgpr_write_b32 a70, 0
  s_waitcnt lgkmcnt(6)
  v_mfma_f32_32x32x16_bf16 v[144:159], v[48:51], a[84:87], v[144:159]
  ds_read_b64_tr_b16 v[40:41], v21 offset:49152
  ds_read_b64_tr_b16 v[42:43], v21 offset:51200
  s_waitcnt lgkmcnt(6)
  v_mfma_f32_32x32x16_bf16 v[160:175], v[28:31], a[84:87], v[160:175]
  ds_read_b64_tr_b16 v[44:45], v22 offset:49152
  ds_read_b64_tr_b16 v[46:47], v22 offset:51200
  s_add_u32 m0, s24, 101376
  s_nop 0
  buffer_load_dwordx4 v13, s[4:7], s22 offen lds
  v_accvgpr_write_b32 a71, 0
  s_waitcnt lgkmcnt(6)
  v_mfma_f32_32x32x16_bf16 v[176:191], v[32:35], a[84:87], v[176:191]
  ds_read_b64_tr_b16 v[48:49], v23 offset:49152
  ds_read_b64_tr_b16 v[50:51], v23 offset:51200
  s_waitcnt lgkmcnt(6)
  v_mfma_f32_32x32x16_bf16 v[64:79], v[36:39], a[88:91], v[64:79]
  ds_read_b64_tr_b16 v[28:29], v20 offset:49408
  ds_read_b64_tr_b16 v[30:31], v20 offset:51456
  s_add_u32 m0, s24, 102400
  s_nop 0
  buffer_load_dwordx4 v14, s[4:7], s22 offen lds
  v_accvgpr_write_b32 a72, 0
  s_waitcnt lgkmcnt(6)
  v_mfma_f32_32x32x16_bf16 v[80:95], v[40:43], a[88:91], v[80:95]
  ds_read_b64_tr_b16 v[32:33], v21 offset:49408
  ds_read_b64_tr_b16 v[34:35], v21 offset:51456
  s_waitcnt lgkmcnt(6)
  v_mfma_f32_32x32x16_bf16 v[96:111], v[44:47], a[88:91], v[96:111]
  ds_read_b64_tr_b16 v[36:37], v22 offset:49408
  ds_read_b64_tr_b16 v[38:39], v22 offset:51456
  s_add_u32 m0, s24, 103424
  s_nop 0
  buffer_load_dwordx4 v15, s[4:7], s22 offen lds
  v_accvgpr_write_b32 a73, 0
  s_waitcnt lgkmcnt(6)
  v_mfma_f32_32x32x16_bf16 v[112:127], v[48:51], a[88:91], v[112:127]
  ds_read_b64_tr_b16 v[40:41], v23 offset:49408
  ds_read_b64_tr_b16 v[42:43], v23 offset:51456
  s_waitcnt lgkmcnt(6)
  v_mfma_f32_32x32x16_bf16 v[128:143], v[28:31], a[88:91], v[128:143]
  ds_read_b64_tr_b16 v[44:45], v20 offset:57344
  ds_read_b64_tr_b16 v[46:47], v20 offset:59392
  s_add_u32 m0, s24, 104448
  s_nop 0
  buffer_load_dwordx4 v16, s[4:7], s22 offen lds
  v_accvgpr_write_b32 a74, 0
  s_waitcnt lgkmcnt(6)
  v_mfma_f32_32x32x16_bf16 v[144:159], v[32:35], a[88:91], v[144:159]
  ds_read_b64_tr_b16 v[48:49], v21 offset:57344
  ds_read_b64_tr_b16 v[50:51], v21 offset:59392
  s_waitcnt lgkmcnt(6)
  v_mfma_f32_32x32x16_bf16 v[160:175], v[36:39], a[88:91], v[160:175]
  ds_read_b64_tr_b16 v[28:29], v22 offset:57344
  ds_read_b64_tr_b16 v[30:31], v22 offset:59392
  s_add_u32 m0, s24, 105472
  s_nop 0
  buffer_load_dwordx4 v17, s[4:7], s22 offen lds
  s_add_u32 s22, s22, 524288
  v_accvgpr_write_b32 a75, 0
  s_waitcnt lgkmcnt(6)
  v_mfma_f32_32x32x16_bf16 v[176:191], v[40:43], a[88:91], v[176:191]
  ds_read_b64_tr_b16 v[32:33], v23 offset:57344
  ds_read_b64_tr_b16 v[34:35], v23 offset:59392
  s_waitcnt lgkmcnt(6)
  v_mfma_f32_32x32x16_bf16 v[64:79], v[44:47], a[92:95], v[64:79]
  ds_read_b64_tr_b16 v[36:37], v20 offset:57600
  ds_read_b64_tr_b16 v[38:39], v20 offset:59648
  v_accvgpr_write_b32 a76, 0
  s_waitcnt lgkmcnt(6)
  v_mfma_f32_32x32x16_bf16 v[80:95], v[48:51], a[92:95], v[80:95]
  ds_read_b64_tr_b16 v[40:41], v21 offset:57600
  ds_read_b64_tr_b16 v[42:43], v21 offset:59648
  s_waitcnt lgkmcnt(6)
  v_mfma_f32_32x32x16_bf16 v[96:111], v[28:31], a[92:95], v[96:111]
  ds_read_b64_tr_b16 v[44:45], v22 offset:57600
  ds_read_b64_tr_b16 v[46:47], v22 offset:59648
  v_accvgpr_write_b32 a77, 0
  s_waitcnt lgkmcnt(6)
  v_mfma_f32_32x32x16_bf16 v[112:127], v[32:35], a[92:95], v[112:127]
  ds_read_b64_tr_b16 v[48:49], v23 offset:57600
  ds_read_b64_tr_b16 v[50:51], v23 offset:59648
  s_waitcnt lgkmcnt(6)
  v_mfma_f32_32x32x16_bf16 v[128:143], v[36:39], a[92:95], v[128:143]
  s_waitcnt vmcnt(12) lgkmcnt(0)
  s_barrier
  ds_read_b64_tr_b16 v[28:29], v24 offset:0
  ds_read_b64_tr_b16 v[30:31], v24 offset:2048
  v_accvgpr_write_b32 a78, 0
  v_mfma_f32_32x32x16_bf16 v[144:159], v[40:43], a[92:95], v[144:159]
  ds_read_b64_tr_b16 v[32:33], v25 offset:0
  ds_read_b64_tr_b16 v[34:35], v25 offset:2048
  v_mfma_f32_32x32x16_bf16 v[160:175], v[44:47], a[92:95], v[160:175]
  ds_read_b64_tr_b16 v[36:37], v26 offset:0
  ds_read_b64_tr_b16 v[38:39], v26 offset:2048
  v_accvgpr_write_b32 a79, 0
  v_mfma_f32_32x32x16_bf16 v[176:191], v[48:51], a[92:95], v[176:191]
  ds_read_b64_tr_b16 v[40:41], v27 offset:0
  ds_read_b64_tr_b16 v[42:43], v27 offset:2048
  s_waitcnt lgkmcnt(6)
  v_mfma_f32_32x32x16_bf16 v[64:79], v[28:31], a[96:99], v[64:79]
  ds_read_b64_tr_b16 v[44:45], v24 offset:256
  ds_read_b64_tr_b16 v[46:47], v24 offset:2304
  buffer_load_dwordx4 a[128:131], v1, s[8:11], s21 offen offset:0
  v_accvgpr_write_b32 a80, 0
  s_waitcnt lgkmcnt(6)
  v_mfma_f32_32x32x16_bf16 v[80:95], v[32:35], a[96:99], v[80:95]
  ds_read_b64_tr_b16 v[48:49], v25 offset:256
  ds_read_b64_tr_b16 v[50:51], v25 offset:2304
  s_waitcnt lgkmcnt(6)
  v_mfma_f32_32x32x16_bf16 v[96:111], v[36:39], a[96:99], v[96:111]
  ds_read_b64_tr_b16 v[28:29], v26 offset:256
  ds_read_b64_tr_b16 v[30:31], v26 offset:2304
  buffer_load_dwordx4 a[132:135], v1, s[8:11], s21 offen offset:1024
  v_accvgpr_write_b32 a81, 0
  s_waitcnt lgkmcnt(6)
  v_mfma_f32_32x32x16_bf16 v[112:127], v[40:43], a[96:99], v[112:127]
  ds_read_b64_tr_b16 v[32:33], v27 offset:256
  ds_read_b64_tr_b16 v[34:35], v27 offset:2304
  s_waitcnt lgkmcnt(6)
  v_mfma_f32_32x32x16_bf16 v[128:143], v[44:47], a[96:99], v[128:143]
  ds_read_b64_tr_b16 v[36:37], v24 offset:8192
  ds_read_b64_tr_b16 v[38:39], v24 offset:10240
  buffer_load_dwordx4 a[136:139], v1, s[8:11], s21 offen offset:2048
  v_accvgpr_write_b32 a82, 0
  s_waitcnt lgkmcnt(6)
  v_mfma_f32_32x32x16_bf16 v[144:159], v[48:51], a[96:99], v[144:159]
  ds_read_b64_tr_b16 v[40:41], v25 offset:8192
  ds_read_b64_tr_b16 v[42:43], v25 offset:10240
  s_waitcnt lgkmcnt(6)
  v_mfma_f32_32x32x16_bf16 v[160:175], v[28:31], a[96:99], v[160:175]
  ds_read_b64_tr_b16 v[44:45], v26 offset:8192
  ds_read_b64_tr_b16 v[46:47], v26 offset:10240
  buffer_load_dwordx4 a[140:143], v1, s[8:11], s21 offen offset:3072
  s_add_u32 s21, s21, 4096
  v_accvgpr_write_b32 a83, 0
  s_waitcnt lgkmcnt(6)
  v_mfma_f32_32x32x16_bf16 v[176:191], v[32:35], a[96:99], v[176:191]
  ds_read_b64_tr_b16 v[48:49], v27 offset:8192
  ds_read_b64_tr_b16 v[50:51], v27 offset:10240
  s_waitcnt lgkmcnt(6)
  v_mfma_f32_32x32x16_bf16 v[64:79], v[36:39], a[100:103], v[64:79]
  ds_read_b64_tr_b16 v[28:29], v24 offset:8448
  ds_read_b64_tr_b16 v[30:31], v24 offset:10496
  s_add_u32 m0, s24, 0
  s_nop 0
  buffer_load_dwordx4 v10, s[4:7], s22 offen lds
  v_accvgpr_write_b32 a84, 0
  s_waitcnt lgkmcnt(6)
  v_mfma_f32_32x32x16_bf16 v[80:95], v[40:43], a[100:103], v[80:95]
  ds_read_b64_tr_b16 v[32:33], v25 offset:8448
  ds_read_b64_tr_b16 v[34:35], v25 offset:10496
  s_waitcnt lgkmcnt(6)
  v_mfma_f32_32x32x16_bf16 v[96:111], v[44:47], a[100:103], v[96:111]
  ds_read_b64_tr_b16 v[36:37], v26 offset:8448
  ds_read_b64_tr_b16 v[38:39], v26 offset:10496
  s_add_u32 m0, s24, 1024
  s_nop 0
  buffer_load_dwordx4 v11, s[4:7], s22 offen lds
  v_accvgpr_write_b32 a85, 0
  s_waitcnt lgkmcnt(6)
  v_mfma_f32_32x32x16_bf16 v[112:127], v[48:51], a[100:103], v[112:127]
  ds_read_b64_tr_b16 v[40:41], v27 offset:8448
  ds_read_b64_tr_b16 v[42:43], v27 offset:10496
  s_waitcnt lgkmcnt(6)
  v_mfma_f32_32x32x16_bf16 v[128:143], v[28:31], a[100:103], v[128:143]
  ds_read_b64_tr_b16 v[44:45], v24 offset:16384
  ds_read_b64_tr_b16 v[46:47], v24 offset:18432
  s_add_u32 m0, s24, 2048
  s_nop 0
  buffer_load_dwordx4 v12, s[4:7], s22 offen lds
  v_accvgpr_write_b32 a86, 0
  s_waitcnt lgkmcnt(6)
  v_mfma_f32_32x32x16_bf16 v[144:159], v[32:35], a[100:103], v[144:159]
  ds_read_b64_tr_b16 v[48:49], v25 offset:16384
  ds_read_b64_tr_b16 v[50:51], v25 offset:18432
  s_waitcnt lgkmcnt(6)
  v_mfma_f32_32x32x16_bf16 v[160:175], v[36:39], a[100:103], v[160:175]
  ds_read_b64_tr_b16 v[28:29], v26 offset:16384
  ds_read_b64_tr_b16 v[30:31], v26 offset:18432
  s_add_u32 m0, s24, 3072
  s_nop 0
  buffer_load_dwordx4 v13, s[4:7], s22 offen lds
  v_accvgpr_write_b32 a87, 0
  s_waitcnt lgkmcnt(6)
  v_mfma_f32_32x32x16_bf16 v[176:191], v[40:43], a[100:103], v[176:191]
  ds_read_b64_tr_b16 v[32:33], v27 offset:16384
  ds_read_b64_tr_b16 v[34:35], v27 offset:18432
  s_waitcnt lgkmcnt(6)
  v_mfma_f32_32x32x16_bf16 v[64:79], v[44:47], a[104:107], v[64:79]
  ds_read_b64_tr_b16 v[36:37], v24 offset:16640
  ds_read_b64_tr_b16 v[38:39], v24 offset:18688
  s_add_u32 m0, s24, 4096
  s_nop 0
  buffer_load_dwordx4 v14, s[4:7], s22 offen lds
  v_accvgpr_write_b32 a88, 0
  s_waitcnt lgkmcnt(6)
  v_mfma_f32_32x32x16_bf16 v[80:95], v[48:51], a[104:107], v[80:95]
  ds_read_b64_tr_b16 v[40:41], v25 offset:16640
  ds_read_b64_tr_b16 v[42:43], v25 offset:18688
  s_waitcnt lgkmcnt(6)
  v_mfma_f32_32x32x16_bf16 v[96:111], v[28:31], a[104:107], v[96:111]
  ds_read_b64_tr_b16 v[44:45], v26 offset:16640
  ds_read_b64_tr_b16 v[46:47], v26 offset:18688
  s_add_u32 m0, s24, 5120
  s_nop 0
  buffer_load_dwordx4 v15, s[4:7], s22 offen lds
  v_accvgpr_write_b32 a89, 0
  s_waitcnt lgkmcnt(6)
  v_mfma_f32_32x32x16_bf16 v[112:127], v[32:35], a[104:107], v[112:127]
  ds_read_b64_tr_b16 v[48:49], v27 offset:16640
  ds_read_b64_tr_b16 v[50:51], v27 offset:18688
  s_waitcnt lgkmcnt(6)
  v_mfma_f32_32x32x16_bf16 v[128:143], v[36:39], a[104:107], v[128:143]
  ds_read_b64_tr_b16 v[28:29], v24 offset:24576
  ds_read_b64_tr_b16 v[30:31], v24 offset:26624
  s_add_u32 m0, s24, 6144
  s_nop 0
  buffer_load_dwordx4 v16, s[4:7], s22 offen lds
  v_accvgpr_write_b32 a90, 0
  s_waitcnt lgkmcnt(6)
  v_mfma_f32_32x32x16_bf16 v[144:159], v[40:43], a[104:107], v[144:159]
  ds_read_b64_tr_b16 v[32:33], v25 offset:24576
  ds_read_b64_tr_b16 v[34:35], v25 offset:26624
  s_waitcnt lgkmcnt(6)
  v_mfma_f32_32x32x16_bf16 v[160:175], v[44:47], a[104:107], v[160:175]
  ds_read_b64_tr_b16 v[36:37], v26 offset:24576
  ds_read_b64_tr_b16 v[38:39], v26 offset:26624
  s_add_u32 m0, s24, 7168
  s_nop 0
  buffer_load_dwordx4 v17, s[4:7], s22 offen lds
  s_add_u32 s22, s22, 524288
  v_accvgpr_write_b32 a91, 0
  s_waitcnt lgkmcnt(6)
  v_mfma_f32_32x32x16_bf16 v[176:191], v[48:51], a[104:107], v[176:191]
  ds_read_b64_tr_b16 v[40:41], v27 offset:24576
  ds_read_b64_tr_b16 v[42:43], v27 offset:26624
  s_waitcnt lgkmcnt(6)
  v_mfma_f32_32x32x16_bf16 v[64:79], v[28:31], a[108:111], v[64:79]
  ds_read_b64_tr_b16 v[44:45], v24 offset:24832
  ds_read_b64_tr_b16 v[46:47], v24 offset:26880
  v_accvgpr_write_b32 a92, 0
  s_waitcnt lgkmcnt(6)
  v_mfma_f32_32x32x16_bf16 v[80:95], v[32:35], a[108:111], v[80:95]
  ds_read_b64_tr_b16 v[48:49], v25 offset:24832
  ds_read_b64_tr_b16 v[50:51], v25 offset:26880
  s_waitcnt lgkmcnt(6)
  v_mfma_f32_32x32x16_bf16 v[96:111], v[36:39], a[108:111], v[96:111]
  ds_read_b64_tr_b16 v[28:29], v26 offset:24832
  ds_read_b64_tr_b16 v[30:31], v26 offset:26880
  v_accvgpr_write_b32 a93, 0
  s_waitcnt lgkmcnt(6)
  v_mfma_f32_32x32x16_bf16 v[112:127], v[40:43], a[108:111], v[112:127]
  ds_read_b64_tr_b16 v[32:33], v27 offset:24832
  ds_read_b64_tr_b16 v[34:35], v27 offset:26880
  s_waitcnt lgkmcnt(6)
  v_mfma_f32_32x32x16_bf16 v[128:143], v[44:47], a[108:111], v[128:143]
  s_waitcnt vmcnt(12) lgkmcnt(0)
  s_barrier
  ds_read_b64_tr_b16 v[36:37], v24 offset:32768
  ds_read_b64_tr_b16 v[38:39], v24 offset:34816
  v_accvgpr_write_b32 a94, 0
  v_mfma_f32_32x32x16_bf16 v[144:159], v[48:51], a[108:111], v[144:159]
  ds_read_b64_tr_b16 v[40:41], v25 offset:32768
  ds_read_b64_tr_b16 v[42:43], v25 offset:34816
  v_mfma_f32_32x32x16_bf16 v[160:175], v[28:31], a[108:111], v[160:175]
  ds_read_b64_tr_b16 v[44:45], v26 offset:32768
  ds_read_b64_tr_b16 v[46:47], v26 offset:34816
  v_accvgpr_write_b32 a95, 0
  v_mfma_f32_32x32x16_bf16 v[176:191], v[32:35], a[108:111], v[176:191]
  ds_read_b64_tr_b16 v[48:49], v27 offset:32768
  ds_read_b64_tr_b16 v[50:51], v27 offset:34816
  s_waitcnt lgkmcnt(6)
  v_mfma_f32_32x32x16_bf16 v[64:79], v[36:39], a[112:115], v[64:79]
  ds_read_b64_tr_b16 v[28:29], v24 offset:33024
  ds_read_b64_tr_b16 v[30:31], v24 offset:35072
  v_accvgpr_write_b32 a96, 0
  s_waitcnt lgkmcnt(6)
  v_mfma_f32_32x32x16_bf16 v[80:95], v[40:43], a[112:115], v[80:95]
  ds_read_b64_tr_b16 v[32:33], v25 offset:33024
  ds_read_b64_tr_b16 v[34:35], v25 offset:35072
  s_waitcnt lgkmcnt(6)
  v_mfma_f32_32x32x16_bf16 v[96:111], v[44:47], a[112:115], v[96:111]
  ds_read_b64_tr_b16 v[36:37], v26 offset:33024
  ds_read_b64_tr_b16 v[38:39], v26 offset:35072
  v_accvgpr_write_b32 a97, 0
  s_waitcnt lgkmcnt(6)
  v_mfma_f32_32x32x16_bf16 v[112:127], v[48:51], a[112:115], v[112:127]
  ds_read_b64_tr_b16 v[40:41], v27 offset:33024
  ds_read_b64_tr_b16 v[42:43], v27 offset:35072
  s_waitcnt lgkmcnt(6)
  v_mfma_f32_32x32x16_bf16 v[128:143], v[28:31], a[112:115], v[128:143]
  ds_read_b64_tr_b16 v[44:45], v24 offset:40960
  ds_read_b64_tr_b16 v[46:47], v24 offset:43008
  v_accvgpr_write_b32 a98, 0
  s_waitcnt lgkmcnt(6)
  v_mfma_f32_32x32x16_bf16 v[144:159], v[32:35], a[112:115], v[144:159]
  ds_read_b64_tr_b16 v[48:49], v25 offset:40960
  ds_read_b64_tr_b16 v[50:51], v25 offset:43008
  s_waitcnt lgkmcnt(6)
  v_mfma_f32_32x32x16_bf16 v[160:175], v[36:39], a[112:115], v[160:175]
  ds_read_b64_tr_b16 v[28:29], v26 offset:40960
  ds_read_b64_tr_b16 v[30:31], v26 offset:43008
  v_accvgpr_write_b32 a99, 0
  s_waitcnt lgkmcnt(6)
  v_mfma_f32_32x32x16_bf16 v[176:191], v[40:43], a[112:115], v[176:191]
  ds_read_b64_tr_b16 v[32:33], v27 offset:40960
  ds_read_b64_tr_b16 v[34:35], v27 offset:43008
  s_waitcnt lgkmcnt(6)
  v_mfma_f32_32x32x16_bf16 v[64:79], v[44:47], a[116:119], v[64:79]
  ds_read_b64_tr_b16 v[36:37], v24 offset:41216
  ds_read_b64_tr_b16 v[38:39], v24 offset:43264
  v_accvgpr_write_b32 a100, 0
  s_waitcnt lgkmcnt(6)
  v_mfma_f32_32x32x16_bf16 v[80:95], v[48:51], a[116:119], v[80:95]
  ds_read_b64_tr_b16 v[40:41], v25 offset:41216
  ds_read_b64_tr_b16 v[42:43], v25 offset:43264
  s_waitcnt lgkmcnt(6)
  v_mfma_f32_32x32x16_bf16 v[96:111], v[28:31], a[116:119], v[96:111]
  ds_read_b64_tr_b16 v[44:45], v26 offset:41216
  ds_read_b64_tr_b16 v[46:47], v26 offset:43264
  v_accvgpr_write_b32 a101, 0
  s_waitcnt lgkmcnt(6)
  v_mfma_f32_32x32x16_bf16 v[112:127], v[32:35], a[116:119], v[112:127]
  ds_read_b64_tr_b16 v[48:49], v27 offset:41216
  ds_read_b64_tr_b16 v[50:51], v27 offset:43264
  s_waitcnt lgkmcnt(6)
  v_mfma_f32_32x32x16_bf16 v[128:143], v[36:39], a[116:119], v[128:143]
  ds_read_b64_tr_b16 v[28:29], v24 offset:49152
  ds_read_b64_tr_b16 v[30:31], v24 offset:51200
  v_accvgpr_write_b32 a102, 0
  s_waitcnt lgkmcnt(6)
  v_mfma_f32_32x32x16_bf16 v[144:159], v[40:43], a[116:119], v[144:159]
  ds_read_b64_tr_b16 v[32:33], v25 offset:49152
  ds_read_b64_tr_b16 v[34:35], v25 offset:51200
  s_waitcnt lgkmcnt(6)
  v_mfma_f32_32x32x16_bf16 v[160:175], v[44:47], a[116:119], v[160:175]
  ds_read_b64_tr_b16 v[36:37], v26 offset:49152
  ds_read_b64_tr_b16 v[38:39], v26 offset:51200
  v_accvgpr_write_b32 a103, 0
  s_waitcnt lgkmcnt(6)
  v_mfma_f32_32x32x16_bf16 v[176:191], v[48:51], a[116:119], v[176:191]
  ds_read_b64_tr_b16 v[40:41], v27 offset:49152
  ds_read_b64_tr_b16 v[42:43], v27 offset:51200
  s_waitcnt lgkmcnt(6)
  v_mfma_f32_32x32x16_bf16 v[64:79], v[28:31], a[120:123], v[64:79]
  ds_read_b64_tr_b16 v[44:45], v24 offset:49408
  ds_read_b64_tr_b16 v[46:47], v24 offset:51456
  v_accvgpr_write_b32 a104, 0
  s_waitcnt lgkmcnt(6)
  v_mfma_f32_32x32x16_bf16 v[80:95], v[32:35], a[120:123], v[80:95]
  ds_read_b64_tr_b16 v[48:49], v25 offset:49408
  ds_read_b64_tr_b16 v[50:51], v25 offset:51456
  s_waitcnt lgkmcnt(6)
  v_mfma_f32_32x32x16_bf16 v[96:111], v[36:39], a[120:123], v[96:111]
  ds_read_b64_tr_b16 v[28:29], v26 offset:49408
  ds_read_b64_tr_b16 v[30:31], v26 offset:51456
  v_accvgpr_write_b32 a105, 0
  s_waitcnt lgkmcnt(6)
  v_mfma_f32_32x32x16_bf16 v[112:127], v[40:43], a[120:123], v[112:127]
  ds_read_b64_tr_b16 v[32:33], v27 offset:49408
  ds_read_b64_tr_b16 v[34:35], v27 offset:51456
  s_waitcnt lgkmcnt(6)
  v_mfma_f32_32x32x16_bf16 v[128:143], v[44:47], a[120:123], v[128:143]
  ds_read_b64_tr_b16 v[36:37], v24 offset:57344
  ds_read_b64_tr_b16 v[38:39], v24 offset:59392
  v_accvgpr_write_b32 a106, 0
  s_waitcnt lgkmcnt(6)
  v_mfma_f32_32x32x16_bf16 v[144:159], v[48:51], a[120:123], v[144:159]
  ds_read_b64_tr_b16 v[40:41], v25 offset:57344
  ds_read_b64_tr_b16 v[42:43], v25 offset:59392
  s_waitcnt lgkmcnt(6)
  v_mfma_f32_32x32x16_bf16 v[160:175], v[28:31], a[120:123], v[160:175]
  ds_read_b64_tr_b16 v[44:45], v26 offset:57344
  ds_read_b64_tr_b16 v[46:47], v26 offset:59392
  v_accvgpr_write_b32 a107, 0
  s_waitcnt lgkmcnt(6)
  v_mfma_f32_32x32x16_bf16 v[176:191], v[32:35], a[120:123], v[176:191]
  ds_read_b64_tr_b16 v[48:49], v27 offset:57344
  ds_read_b64_tr_b16 v[50:51], v27 offset:59392
  s_waitcnt lgkmcnt(6)
  v_mfma_f32_32x32x16_bf16 v[64:79], v[36:39], a[124:127], v[64:79]
  ds_read_b64_tr_b16 v[28:29], v24 offset:57600
  ds_read_b64_tr_b16 v[30:31], v24 offset:59648
  v_accvgpr_write_b32 a108, 0
  s_waitcnt lgkmcnt(6)
  v_mfma_f32_32x32x16_bf16 v[80:95], v[40:43], a[124:127], v[80:95]
  ds_read_b64_tr_b16 v[32:33], v25 offset:57600
  ds_read_b64_tr_b16 v[34:35], v25 offset:59648
  s_waitcnt lgkmcnt(6)
  v_mfma_f32_32x32x16_bf16 v[96:111], v[44:47], a[124:127], v[96:111]
  ds_read_b64_tr_b16 v[36:37], v26 offset:57600
  ds_read_b64_tr_b16 v[38:39], v26 offset:59648
  v_accvgpr_write_b32 a109, 0
  s_waitcnt lgkmcnt(6)
  v_mfma_f32_32x32x16_bf16 v[112:127], v[48:51], a[124:127], v[112:127]
  ds_read_b64_tr_b16 v[40:41], v27 offset:57600
  ds_read_b64_tr_b16 v[42:43], v27 offset:59648
  s_waitcnt lgkmcnt(6)
  v_mfma_f32_32x32x16_bf16 v[128:143], v[28:31], a[124:127], v[128:143]
  s_waitcnt vmcnt(0) lgkmcnt(0)
  s_barrier
  ds_read_b64_tr_b16 v[44:45], v20 offset:0
  ds_read_b64_tr_b16 v[46:47], v20 offset:2048
  v_accvgpr_write_b32 a110, 0
  v_mfma_f32_32x32x16_bf16 v[144:159], v[32:35], a[124:127], v[144:159]
  ds_read_b64_tr_b16 v[48:49], v20 offset:8192
  ds_read_b64_tr_b16 v[50:51], v20 offset:10240
  v_mfma_f32_32x32x16_bf16 v[160:175], v[36:39], a[124:127], v[160:175]
  ds_read_b64_tr_b16 v[28:29], v20 offset:16384
  ds_read_b64_tr_b16 v[30:31], v20 offset:18432
  v_accvgpr_write_b32 a111, 0
  v_mfma_f32_32x32x16_bf16 v[176:191], v[40:43], a[124:127], v[176:191]
  ds_read_b64_tr_b16 v[32:33], v20 offset:24576
  ds_read_b64_tr_b16 v[34:35], v20 offset:26624
  s_waitcnt lgkmcnt(6)
  v_mfma_f32_32x32x16_bf16 v[64:79], v[44:47], a[128:131], v[64:79]
  ds_read_b64_tr_b16 v[36:37], v21 offset:0
  ds_read_b64_tr_b16 v[38:39], v21 offset:2048
  s_waitcnt lgkmcnt(6)
  v_mfma_f32_32x32x16_bf16 v[64:79], v[48:51], a[132:135], v[64:79]
  ds_read_b64_tr_b16 v[40:41], v21 offset:8192
  ds_read_b64_tr_b16 v[42:43], v21 offset:10240
  s_waitcnt lgkmcnt(6)
  v_mfma_f32_32x32x16_bf16 v[64:79], v[28:31], a[136:139], v[64:79]
  ds_read_b64_tr_b16 v[44:45], v21 offset:16384
  ds_read_b64_tr_b16 v[46:47], v21 offset:18432
  s_add_u32 m0, s25, 49152
  s_waitcnt lgkmcnt(6)
  v_mfma_f32_32x32x16_bf16 v[64:79], v[32:35], a[140:143], v[64:79]
  ds_read_b64_tr_b16 v[48:49], v21 offset:24576
  ds_read_b64_tr_b16 v[50:51], v21 offset:26624
  s_nop 0
  s_waitcnt lgkmcnt(6)
  v_mfma_f32_32x32x16_bf16 v[80:95], v[36:39], a[128:131], v[80:95]
  ds_read_b64_tr_b16 v[28:29], v22 offset:0
  ds_read_b64_tr_b16 v[30:31], v22 offset:2048
  buffer_load_dwordx4 v60, s[28:31], s40 offen lds
  s_waitcnt lgkmcnt(6)
  v_mfma_f32_32x32x16_bf16 v[80:95], v[40:43], a[132:135], v[80:95]
  ds_read_b64_tr_b16 v[32:33], v22 offset:8192
  ds_read_b64_tr_b16 v[34:35], v22 offset:10240
  buffer_load_dwordx4 v61, s[28:31], s40 offen offset:1024 lds
  s_waitcnt lgkmcnt(6)
  v_mfma_f32_32x32x16_bf16 v[80:95], v[44:47], a[136:139], v[80:95]
  ds_read_b64_tr_b16 v[36:37], v22 offset:16384
  ds_read_b64_tr_b16 v[38:39], v22 offset:18432
  s_add_u32 s40, s40, 16384
  v_cvt_pk_bf16_f32 v192, v64, v65
  v_cvt_pk_bf16_f32 v193, v66, v67
  v_cvt_pk_bf16_f32 v194, v68, v69
  s_waitcnt lgkmcnt(6)
  v_mfma_f32_32x32x16_bf16 v[80:95], v[48:51], a[140:143], v[80:95]
  ds_read_b64_tr_b16 v[40:41], v22 offset:24576
  ds_read_b64_tr_b16 v[42:43], v22 offset:26624
  s_add_u32 m0, s25, 57344
  v_cvt_pk_bf16_f32 v195, v70, v71
  v_cvt_pk_bf16_f32 v196, v72, v73
  v_cvt_pk_bf16_f32 v197, v74, v75
  s_waitcnt lgkmcnt(6)
  v_mfma_f32_32x32x16_bf16 v[96:111], v[28:31], a[128:131], v[96:111]
  ds_read_b64_tr_b16 v[44:45], v23 offset:0
  ds_read_b64_tr_b16 v[46:47], v23 offset:2048
  s_nop 0
  v_cvt_pk_bf16_f32 v198, v76, v77
  v_cvt_pk_bf16_f32 v199, v78, v79
  s_waitcnt lgkmcnt(6)
  v_mfma_f32_32x32x16_bf16 v[96:111], v[32:35], a[132:135], v[96:111]
  ds_read_b64_tr_b16 v[48:49], v23 offset:8192
  ds_read_b64_tr_b16 v[50:51], v23 offset:10240
  buffer_load_dwordx4 v60, s[28:31], s41 offen lds
  s_waitcnt lgkmcnt(6)
  v_mfma_f32_32x32x16_bf16 v[96:111], v[36:39], a[136:139], v[96:111]
  ds_read_b64_tr_b16 v[28:29], v23 offset:16384
  ds_read_b64_tr_b16 v[30:31], v23 offset:18432
  buffer_load_dwordx4 v61, s[28:31], s41 offen offset:1024 lds
  v_cvt_pk_bf16_f32 v200, v80, v81
  v_cvt_pk_bf16_f32 v201, v82, v83
  v_cvt_pk_bf16_f32 v202, v84, v85
  s_waitcnt lgkmcnt(6)
  v_mfma_f32_32x32x16_bf16 v[96:111], v[40:43], a[140:143], v[96:111]
  ds_read_b64_tr_b16 v[32:33], v23 offset:24576
  ds_read_b64_tr_b16 v[34:35], v23 offset:26624
  s_add_u32 s41, s41, 16384
  v_cvt_pk_bf16_f32 v203, v86, v87
  v_cvt_pk_bf16_f32 v204, v88, v89
  v_cvt_pk_bf16_f32 v205, v90, v91
  s_waitcnt lgkmcnt(6)
  v_mfma_f32_32x32x16_bf16 v[112:127], v[44:47], a[128:131], v[112:127]
  ds_read_b64_tr_b16 v[36:37], v20 offset:256
  ds_read_b64_tr_b16 v[38:39], v20 offset:2304
  s_add_u32 m0, s25, 122880
  v_cvt_pk_bf16_f32 v206, v92, v93
  v_cvt_pk_bf16_f32 v207, v94, v95
  s_waitcnt lgkmcnt(6)
  v_mfma_f32_32x32x16_bf16 v[112:127], v[48:51], a[132:135], v[112:127]
  ds_read_b64_tr_b16 v[40:41], v20 offset:8448
  ds_read_b64_tr_b16 v[42:43], v20 offset:10496
  s_nop 0
  s_waitcnt lgkmcnt(6)
  v_mfma_f32_32x32x16_bf16 v[112:127], v[28:31], a[136:139], v[112:127]
  ds_read_b64_tr_b16 v[44:45], v20 offset:16640
  ds_read_b64_tr_b16 v[46:47], v20 offset:18688
  buffer_load_dwordx4 v62, s[32:35], s43 offen lds
  v_cvt_pk_bf16_f32 v208, v96, v97
  v_cvt_pk_bf16_f32 v209, v98, v99
  v_cvt_pk_bf16_f32 v210, v100, v101
  s_waitcnt lgkmcnt(6)
  v_mfma_f32_32x32x16_bf16 v[112:127], v[32:35], a[140:143], v[112:127]
  ds_read_b64_tr_b16 v[48:49], v20 offset:24832
  ds_read_b64_tr_b16 v[50:51], v20 offset:26880
  buffer_load_dwordx4 v62, s[32:35], s43 offen offset:1024 lds
  v_cvt_pk_bf16_f32 v211, v102, v103
  v_cvt_pk_bf16_f32 v212, v104, v105
  v_cvt_pk_bf16_f32 v213, v106, v107
  s_waitcnt lgkmcnt(6)
  v_mfma_f32_32x32x16_bf16 v[128:143], v[36:39], a[128:131], v[128:143]
  ds_read_b64_tr_b16 v[28:29], v21 offset:256
  ds_read_b64_tr_b16 v[30:31], v21 offset:2304
  s_add_u32 s43, s43, 16384
  v_cvt_pk_bf16_f32 v214, v108, v109
  v_cvt_pk_bf16_f32 v215, v110, v111
  s_waitcnt lgkmcnt(6)
  v_mfma_f32_32x32x16_bf16 v[128:143], v[40:43], a[132:135], v[128:143]
  ds_read_b64_tr_b16 v[32:33], v21 offset:8448
  ds_read_b64_tr_b16 v[34:35], v21 offset:10496
  s_waitcnt lgkmcnt(6)
  v_mfma_f32_32x32x16_bf16 v[128:143], v[44:47], a[136:139], v[128:143]
  ds_read_b64_tr_b16 v[36:37], v21 offset:16640
  ds_read_b64_tr_b16 v[38:39], v21 offset:18688
  v_accvgpr_write_b32 a112, 0
  v_cvt_pk_bf16_f32 v216, v112, v113
  v_cvt_pk_bf16_f32 v217, v114, v115
  v_cvt_pk_bf16_f32 v218, v116, v117
  s_waitcnt lgkmcnt(6)
  v_mfma_f32_32x32x16_bf16 v[128:143], v[48:51], a[140:143], v[128:143]
  ds_read_b64_tr_b16 v[40:41], v21 offset:24832
  ds_read_b64_tr_b16 v[42:43], v21 offset:26880
  v_accvgpr_write_b32 a113, 0
  v_cvt_pk_bf16_f32 v219, v118, v119
  v_cvt_pk_bf16_f32 v220, v120, v121
  v_cvt_pk_bf16_f32 v221, v122, v123
  s_waitcnt lgkmcnt(6)
  v_mfma_f32_32x32x16_bf16 v[144:159], v[28:31], a[128:131], v[144:159]
  ds_read_b64_tr_b16 v[44:45], v22 offset:256
  ds_read_b64_tr_b16 v[46:47], v22 offset:2304
  v_accvgpr_write_b32 a114, 0
  v_cvt_pk_bf16_f32 v222, v124, v125
  v_cvt_pk_bf16_f32 v223, v126, v127
  s_waitcnt lgkmcnt(6)
  v_mfma_f32_32x32x16_bf16 v[144:159], v[32:35], a[132:135], v[144:159]
  ds_read_b64_tr_b16 v[48:49], v22 offset:8448
  ds_read_b64_tr_b16 v[50:51], v22 offset:10496
  v_accvgpr_write_b32 a115, 0
  s_waitcnt lgkmcnt(6)
  v_mfma_f32_32x32x16_bf16 v[144:159], v[36:39], a[136:139], v[144:159]
  ds_read_b64_tr_b16 v[28:29], v22 offset:16640
  ds_read_b64_tr_b16 v[30:31], v22 offset:18688
  v_accvgpr_write_b32 a116, 0
  v_cvt_pk_bf16_f32 v224, v128, v129
  v_cvt_pk_bf16_f32 v225, v130, v131
  v_cvt_pk_bf16_f32 v226, v132, v133
  s_waitcnt lgkmcnt(6)
  v_mfma_f32_32x32x16_bf16 v[144:159], v[40:43], a[140:143], v[144:159]
  ds_read_b64_tr_b16 v[32:33], v22 offset:24832
  ds_read_b64_tr_b16 v[34:35], v22 offset:26880
  v_accvgpr_write_b32 a117, 0
  v_cvt_pk_bf16_f32 v227, v134, v135
  v_cvt_pk_bf16_f32 v228, v136, v137
  v_cvt_pk_bf16_f32 v229, v138, v139
  s_waitcnt lgkmcnt(6)
  v_mfma_f32_32x32x16_bf16 v[160:175], v[44:47], a[128:131], v[160:175]
  ds_read_b64_tr_b16 v[36:37], v23 offset:256
  ds_read_b64_tr_b16 v[38:39], v23 offset:2304
  v_accvgpr_write_b32 a118, 0
  v_cvt_pk_bf16_f32 v230, v140, v141
  v_cvt_pk_bf16_f32 v231, v142, v143
  s_waitcnt lgkmcnt(6)
  v_mfma_f32_32x32x16_bf16 v[160:175], v[48:51], a[132:135], v[160:175]
  ds_read_b64_tr_b16 v[40:41], v23 offset:8448
  ds_read_b64_tr_b16 v[42:43], v23 offset:10496
  v_accvgpr_write_b32 a119, 0
  s_waitcnt lgkmcnt(6)
  v_mfma_f32_32x32x16_bf16 v[160:175], v[28:31], a[136:139], v[160:175]
  ds_read_b64_tr_b16 v[44:45], v23 offset:16640
  ds_read_b64_tr_b16 v[46:47], v23 offset:18688
  v_accvgpr_write_b32 a120, 0
  v_cvt_pk_bf16_f32 v232, v144, v145
  v_cvt_pk_bf16_f32 v233, v146, v147
  v_cvt_pk_bf16_f32 v234, v148, v149
  s_waitcnt lgkmcnt(6)
  v_mfma_f32_32x32x16_bf16 v[160:175], v[32:35], a[140:143], v[160:175]
  ds_read_b64_tr_b16 v[48:49], v23 offset:24832
  ds_read_b64_tr_b16 v[50:51], v23 offset:26880
  v_accvgpr_write_b32 a121, 0
  v_cvt_pk_bf16_f32 v235, v150, v151
  v_cvt_pk_bf16_f32 v236, v152, v153
  v_cvt_pk_bf16_f32 v237, v154, v155
  s_waitcnt lgkmcnt(6)
  v_mfma_f32_32x32x16_bf16 v[176:191], v[36:39], a[128:131], v[176:191]
  v_accvgpr_write_b32 a122, 0
  v_cvt_pk_bf16_f32 v238, v156, v157
  v_cvt_pk_bf16_f32 v239, v158, v159
  s_waitcnt lgkmcnt(4)
  v_mfma_f32_32x32x16_bf16 v[176:191], v[40:43], a[132:135], v[176:191]
  v_accvgpr_write_b32 a123, 0
  s_waitcnt lgkmcnt(2)
  v_mfma_f32_32x32x16_bf16 v[176:191], v[44:47], a[136:139], v[176:191]
  v_accvgpr_write_b32 a124, 0
  v_cvt_pk_bf16_f32 v240, v160, v161
  v_cvt_pk_bf16_f32 v241, v162, v163
  v_cvt_pk_bf16_f32 v242, v164, v165
  s_waitcnt lgkmcnt(0)
  v_mfma_f32_32x32x16_bf16 v[176:191], v[48:51], a[140:143], v[176:191]
  v_accvgpr_write_b32 a125, 0
  v_cvt_pk_bf16_f32 v243, v166, v167
  v_cvt_pk_bf16_f32 v244, v168, v169
  v_cvt_pk_bf16_f32 v245, v170, v171
  v_accvgpr_write_b32 a126, 0
  v_accvgpr_write_b32 a127, 0
  v_cvt_pk_bf16_f32 v246, v172, v173
  v_cvt_pk_bf16_f32 v247, v174, v175
  s_nop 3
  v_cvt_pk_bf16_f32 v248, v176, v177
  v_cvt_pk_bf16_f32 v249, v178, v179
  v_cvt_pk_bf16_f32 v250, v180, v181
  v_cvt_pk_bf16_f32 v251, v182, v183
  v_cvt_pk_bf16_f32 v252, v184, v185
  v_cvt_pk_bf16_f32 v253, v186, v187
  v_cvt_pk_bf16_f32 v254, v188, v189
  v_cvt_pk_bf16_f32 v255, v190, v191
  s_barrier
  s_add_u32 m0, s25, 0
  s_nop 0
  buffer_load_dwordx4 v60, s[28:31], s40 offen lds
  buffer_load_dwordx4 v61, s[28:31], s40 offen offset:1024 lds
  s_add_u32 s40, s40, 16384
  s_add_u32 m0, s25, 65536
  s_nop 0
  buffer_load_dwordx4 v62, s[32:35], s42 offen lds
  buffer_load_dwordx4 v62, s[32:35], s42 offen offset:1024 lds
  s_add_u32 s42, s42, 16384
  s_add_u32 m0, s25, 8192
  s_nop 0
  buffer_load_dwordx4 v60, s[28:31], s41 offen lds
  buffer_load_dwordx4 v61, s[28:31], s41 offen offset:1024 lds
  s_add_u32 s41, s41, 16384
  s_add_u32 m0, s25, 73728
  s_nop 0
  buffer_load_dwordx4 v62, s[32:35], s43 offen lds
  buffer_load_dwordx4 v62, s[32:35], s43 offen offset:1024 lds
  s_add_u32 s43, s43, 16384
  s_add_u32 m0, s25, 16384
  s_nop 0
  buffer_load_dwordx4 v60, s[28:31], s40 offen lds
  buffer_load_dwordx4 v61, s[28:31], s40 offen offset:1024 lds
  s_add_u32 s40, s40, 16384
  s_add_u32 m0, s25, 81920
  s_nop 0
  buffer_load_dwordx4 v62, s[32:35], s42 offen lds
  buffer_load_dwordx4 v62, s[32:35], s42 offen offset:1024 lds
  s_add_u32 s42, s42, 16384
  s_add_u32 m0, s25, 24576
  s_nop 0
  buffer_load_dwordx4 v60, s[28:31], s41 offen lds
  buffer_load_dwordx4 v61, s[28:31], s41 offen offset:1024 lds
  s_add_u32 s41, s41, 16384
  v_and_b32 v2, 31, v0
  v_lshrrev_b32 v3, 5, v0
  v_and_b32 v4, 15, v0
  v_xor_b32 v3, v3, v4
  v_lshlrev_b32 v3, 4, v3
  v_lshl_add_u32 v3, v2, 8, v3
  v_xor_b32 v10, 0, v3
  v_xor_b32 v11, 32, v3
  v_xor_b32 v12, 64, v3
  v_xor_b32 v13, 96, v3
  v_xor_b32 v14, 128, v3
  v_xor_b32 v15, 160, v3
  v_xor_b32 v16, 192, v3
  v_xor_b32 v17, 224, v3
  v_lshrrev_b32 v2, 5, v0
  v_lshlrev_b32 v2, 3, v2
  v_bfe_u32 v3, v0, 2, 2
  v_add_u32 v2, v2, v3
  v_mul_u32_u24 v9, 256, v2
  v_bfe_u32 v3, v0, 4, 1
  v_mul_u32_u24 v3, 32, v3
  v_add_u32 v9, v9, v3
  v_and_b32 v3, 1, v0
  v_lshl_add_u32 v9, v3, 4, v9
  v_bfe_u32 v3, v0, 1, 1
  v_lshl_add_u32 v9, v3, 3, v9
  v_add_u32 v9, 0x10000, v9
  v_bfe_u32 v2, v0, 2, 2
  v_xor_b32 v3, 0, v2
  v_lshl_add_u32 v18, v3, 6, v9
  v_xor_b32 v3, 1, v2
  v_lshl_add_u32 v19, v3, 6, v9
  v_xor_b32 v3, 2, v2
  v_lshl_add_u32 v20, v3, 6, v9
  v_xor_b32 v3, 3, v2
  v_lshl_add_u32 v21, v3, 6, v9
  s_mul_i32 s49, s2, 20736
  s_mul_i32 s50, s16, 5184
  s_add_u32 s49, s49, s50
  s_mul_i32 s51, s2, 18432
  s_mul_i32 s50, s16, 4608
  s_add_u32 s51, s51, s50
  s_mov_b32 s46, 1114636288
  s_mov_b32 s47, 1114636288
  s_mov_b32 s48, 0
  s_waitcnt vmcnt(14)
  s_barrier
  buffer_load_dwordx4 v[52:55], v1, s[36:39], s51 offen
  ds_read_b128 v[128:131], v10 offset:49152
  ds_read_b128 v[132:135], v11 offset:49152
  ds_read_b128 v[136:139], v12 offset:49152
  ds_read_b128 v[140:143], v13 offset:49152
  ds_read_b128 v[144:147], v14 offset:49152
  ds_read_b128 v[148:151], v15 offset:49152
  ds_read_b128 v[152:155], v16 offset:49152
  ds_read_b128 v[156:159], v17 offset:49152
  s_waitcnt lgkmcnt(7)
  v_mfma_f32_32x32x16_bf16 v[64:79], v[128:131], v[192:195], 0
  s_waitcnt lgkmcnt(6)
  v_mfma_f32_32x32x16_bf16 v[64:79], v[132:135], v[196:199], v[64:79]
  s_waitcnt lgkmcnt(5)
  v_mfma_f32_32x32x16_bf16 v[64:79], v[136:139], v[200:203], v[64:79]
  s_waitcnt lgkmcnt(4)
  v_mfma_f32_32x32x16_bf16 v[64:79], v[140:143], v[204:207], v[64:79]
  s_waitcnt lgkmcnt(3)
  v_mfma_f32_32x32x16_bf16 v[64:79], v[144:147], v[208:211], v[64:79]
  s_waitcnt lgkmcnt(2)
  v_mfma_f32_32x32x16_bf16 v[64:79], v[148:151], v[212:215], v[64:79]
  s_waitcnt lgkmcnt(1)
  v_mfma_f32_32x32x16_bf16 v[64:79], v[152:155], v[216:219], v[64:79]
  s_waitcnt lgkmcnt(0)
  v_mfma_f32_32x32x16_bf16 v[64:79], v[156:159], v[220:223], v[64:79]
  v_mfma_f32_32x32x16_bf16 v[80:95], v[128:131], v[224:227], 0
  v_mfma_f32_32x32x16_bf16 v[80:95], v[132:135], v[228:231], v[80:95]
  v_mfma_f32_32x32x16_bf16 v[80:95], v[136:139], v[232:235], v[80:95]
  v_mfma_f32_32x32x16_bf16 v[80:95], v[140:143], v[236:239], v[80:95]
  v_mfma_f32_32x32x16_bf16 v[80:95], v[144:147], v[240:243], v[80:95]
  v_mfma_f32_32x32x16_bf16 v[80:95], v[148:151], v[244:247], v[80:95]
  v_mfma_f32_32x32x16_bf16 v[80:95], v[152:155], v[248:251], v[80:95]
  v_mfma_f32_32x32x16_bf16 v[80:95], v[156:159], v[252:255], v[80:95]
  ds_read_b128 v[128:131], v10 offset:57344
  ds_read_b128 v[132:135], v11 offset:57344
  ds_read_b128 v[136:139], v12 offset:57344
  ds_read_b128 v[140:143], v13 offset:57344
  ds_read_b128 v[144:147], v14 offset:57344
  ds_read_b128 v[148:151], v15 offset:57344
  ds_read_b128 v[152:155], v16 offset:57344
  ds_read_b128 v[156:159], v17 offset:57344
  v_max3_f32 v46, v64, v65, v66
  v_max3_f32 v46, v46, v67, v68
  v_max3_f32 v46, v46, v69, v70
  v_max3_f32 v46, v46, v71, v72
  v_max3_f32 v46, v46, v73, v74
  v_max3_f32 v46, v46, v75, v76
  v_max3_f32 v46, v46, v77, v78
  v_max_f32 v46, v46, v79
  v_mov_b32 v2, v46
  v_mov_b32 v3, v46
  s_nop 1
  v_permlane32_swap_b32 v2, v3
  v_max_f32 v2, v2, v3
  v_sub_f32 v64, v64, v2
  v_sub_f32 v96, 0, v2
  v_sub_f32 v65, v65, v2
  v_sub_f32 v97, 0, v2
  v_sub_f32 v66, v66, v2
  v_sub_f32 v98, 0, v2
  v_sub_f32 v67, v67, v2
  v_sub_f32 v99, 0, v2
  v_sub_f32 v68, v68, v2
  v_sub_f32 v100, 0, v2
  v_sub_f32 v69, v69, v2
  v_sub_f32 v101, 0, v2
  v_sub_f32 v70, v70, v2
  v_sub_f32 v102, 0, v2
  v_sub_f32 v71, v71, v2
  v_sub_f32 v103, 0, v2
  v_sub_f32 v72, v72, v2
  v_sub_f32 v104, 0, v2
  v_sub_f32 v73, v73, v2
  v_sub_f32 v105, 0, v2
  v_sub_f32 v74, v74, v2
  v_sub_f32 v106, 0, v2
  v_sub_f32 v75, v75, v2
  v_sub_f32 v107, 0, v2
  v_sub_f32 v76, v76, v2
  v_sub_f32 v108, 0, v2
  v_sub_f32 v77, v77, v2
  v_sub_f32 v109, 0, v2
  v_sub_f32 v78, v78, v2
  v_sub_f32 v110, 0, v2
  v_sub_f32 v79, v79, v2
  v_sub_f32 v111, 0, v2
  v_max3_f32 v46, v80, v81, v82
  v_max3_f32 v46, v46, v83, v84
  v_max3_f32 v46, v46, v85, v86
  v_max3_f32 v46, v46, v87, v88
  v_max3_f32 v46, v46, v89, v90
  v_max3_f32 v46, v46, v91, v92
  v_max3_f32 v46, v46, v93, v94
  v_max_f32 v46, v46, v95
  v_mov_b32 v2, v46
  v_mov_b32 v3, v46
  s_nop 1
  v_permlane32_swap_b32 v2, v3
  v_max_f32 v2, v2, v3
  v_sub_f32 v80, v80, v2
  v_sub_f32 v112, 0, v2
  v_sub_f32 v81, v81, v2
  v_sub_f32 v113, 0, v2
  v_sub_f32 v82, v82, v2
  v_sub_f32 v114, 0, v2
  v_sub_f32 v83, v83, v2
  v_sub_f32 v115, 0, v2
  v_sub_f32 v84, v84, v2
  v_sub_f32 v116, 0, v2
  v_sub_f32 v85, v85, v2
  v_sub_f32 v117, 0, v2
  v_sub_f32 v86, v86, v2
  v_sub_f32 v118, 0, v2
  v_sub_f32 v87, v87, v2
  v_sub_f32 v119, 0, v2
  v_sub_f32 v88, v88, v2
  v_sub_f32 v120, 0, v2
  v_sub_f32 v89, v89, v2
  v_sub_f32 v121, 0, v2
  v_sub_f32 v90, v90, v2
  v_sub_f32 v122, 0, v2
  v_sub_f32 v91, v91, v2
  v_sub_f32 v123, 0, v2
  v_sub_f32 v92, v92, v2
  v_sub_f32 v124, 0, v2
  v_sub_f32 v93, v93, v2
  v_sub_f32 v125, 0, v2
  v_sub_f32 v94, v94, v2
  v_sub_f32 v126, 0, v2
  v_sub_f32 v95, v95, v2
  v_sub_f32 v127, 0, v2
  v_mov_b32 v44, 0
  v_mov_b32 v45, 0
  v_exp_f32 v64, v64
  v_exp_f32 v65, v65
  v_add_f32 v44, v44, v64
  v_exp_f32 v66, v66
  v_add_f32 v44, v44, v65
  v_exp_f32 v67, v67
  v_add_f32 v44, v44, v66
  v_cvt_pk_bf16_f32 v28, v64, v65
  v_exp_f32 v68, v68
  v_add_f32 v44, v44, v67
  v_exp_f32 v69, v69
  v_add_f32 v44, v44, v68
  v_cvt_pk_bf16_f32 v29, v66, v67
  v_exp_f32 v70, v70
  v_add_f32 v44, v44, v69
  v_exp_f32 v71, v71
  v_add_f32 v44, v44, v70
  v_cvt_pk_bf16_f32 v30, v68, v69
  v_add_f32 v44, v44, v71
  v_cvt_pk_bf16_f32 v31, v70, v71
  v_exp_f32 v72, v72
  v_exp_f32 v73, v73
  v_add_f32 v44, v44, v72
  v_exp_f32 v74, v74
  v_add_f32 v44, v44, v73
  v_exp_f32 v75, v75
  v_add_f32 v44, v44, v74
  v_cvt_pk_bf16_f32 v32, v72, v73
  v_exp_f32 v76, v76
  v_add_f32 v44, v44, v75
  v_exp_f32 v77, v77
  v_add_f32 v44, v44, v76
  v_cvt_pk_bf16_f32 v33, v74, v75
  v_exp_f32 v78, v78
  v_add_f32 v44, v44, v77
  v_exp_f32 v79, v79
  v_add_f32 v44, v44, v78
  v_cvt_pk_bf16_f32 v34, v76, v77
  v_add_f32 v44, v44, v79
  v_cvt_pk_bf16_f32 v35, v78, v79
  ds_read_b64_tr_b16 v[160:161], v18 offset:57344
  ds_read_b64_tr_b16 v[162:163], v18 offset:58368
  ds_read_b64_tr_b16 v[164:165], v19 offset:57344
  ds_read_b64_tr_b16 v[166:167], v19 offset:58368
  ds_read_b64_tr_b16 v[168:169], v20 offset:57344
  ds_read_b64_tr_b16 v[170:171], v20 offset:58368
  ds_read_b64_tr_b16 v[172:173], v21 offset:57344
  ds_read_b64_tr_b16 v[174:175], v21 offset:58368
  s_waitcnt lgkmcnt(0)
L_attn_loop:
  s_cmp_eq_u32 s48, 7
  s_cselect_b32 s47, 0x7f800000, s46
  v_mfma_f32_32x32x16_bf16 v[64:79], v[128:131], v[192:195], v[96:111]
  ds_read_b64_tr_b16 v[176:177], v18 offset:61440
  ds_read_b64_tr_b16 v[178:179], v18 offset:62464
  v_exp_f32 v80, v80
  v_exp_f32 v81, v81
  v_mfma_f32_32x32x16_bf16 v[64:79], v[132:135], v[196:199], v[64:79]
  ds_read_b64_tr_b16 v[180:181], v19 offset:61440
  ds_read_b64_tr_b16 v[182:183], v19 offset:62464
  v_add_f32 v45, v45, v80
  v_exp_f32 v82, v82
  v_add_f32 v45, v45, v81
  v_mfma_f32_32x32x16_bf16 v[64:79], v[136:139], v[200:203], v[64:79]
  ds_read_b64_tr_b16 v[184:185], v20 offset:61440
  ds_read_b64_tr_b16 v[186:187], v20 offset:62464
  v_exp_f32 v83, v83
  v_add_f32 v45, v45, v82
  v_mfma_f32_32x32x16_bf16 v[64:79], v[140:143], v[204:207], v[64:79]
  ds_read_b64_tr_b16 v[188:189], v21 offset:61440
  ds_read_b64_tr_b16 v[190:191], v21 offset:62464
  v_cvt_pk_bf16_f32 v36, v80, v81
  v_exp_f32 v84, v84
  v_add_f32 v45, v45, v83
  v_mfma_f32_32x32x16_bf16 v[64:79], v[144:147], v[208:211], v[64:79]
  v_exp_f32 v85, v85
  v_add_f32 v45, v45, v84
  v_cvt_pk_bf16_f32 v37, v82, v83
  v_exp_f32 v86, v86
  s_add_u32 m0, s25, 90112
  v_mfma_f32_32x32x16_bf16 v[64:79], v[148:151], v[212:215], v[64:79]
  buffer_load_dwordx4 v62, s[32:35], s43 offen lds
  v_mfma_f32_32x32x16_bf16 v[64:79], v[152:155], v[216:219], v[64:79]
  buffer_load_dwordx4 v62, s[32:35], s43 offen offset:1024 lds
  s_add_u32 s43, s43, 16384
  v_mfma_f32_32x32x16_bf16 v[64:79], v[156:159], v[220:223], v[64:79]
  v_add_f32 v45, v45, v85
  v_exp_f32 v87, v87
  v_add_f32 v45, v45, v86
  s_waitcnt lgkmcnt(0)
  v_mfma_f32_32x32x16_bf16 a[0:15], v[160:163], v[28:31], a[0:15]
  v_cvt_pk_bf16_f32 v38, v84, v85
  v_add_f32 v45, v45, v87
  v_cvt_pk_bf16_f32 v39, v86, v87
  v_exp_f32 v88, v88
  v_mfma_f32_32x32x16_bf16 a[16:31], v[164:167], v[28:31], a[16:31]
  v_exp_f32 v89, v89
  v_add_f32 v45, v45, v88
  v_exp_f32 v90, v90
  v_add_f32 v45, v45, v89
  v_mfma_f32_32x32x16_bf16 a[32:47], v[168:171], v[28:31], a[32:47]
  v_max3_f32 v46, v64, v65, v66
  v_max3_f32 v46, v46, v67, v68
  v_max3_f32 v46, v46, v69, v70
  v_max3_f32 v46, v46, v71, v72
  v_max3_f32 v46, v46, v73, v74
  v_max3_f32 v46, v46, v75, v76
  v_mfma_f32_32x32x16_bf16 a[48:63], v[172:175], v[28:31], a[48:63]
  v_max3_f32 v46, v46, v77, v78
  v_max_f32 v46, v46, v79
  v_cmp_lt_f32 vcc, s46, v46
  v_exp_f32 v91, v91
  v_add_f32 v45, v45, v90
  v_mfma_f32_32x32x16_bf16 a[0:15], v[176:179], v[32:35], a[0:15]
  v_cvt_pk_bf16_f32 v40, v88, v89
  v_exp_f32 v92, v92
  v_add_f32 v45, v45, v91
  v_exp_f32 v93, v93
  v_mfma_f32_32x32x16_bf16 a[16:31], v[180:183], v[32:35], a[16:31]
  v_add_f32 v45, v45, v92
  v_cvt_pk_bf16_f32 v41, v90, v91
  v_exp_f32 v94, v94
  v_add_f32 v45, v45, v93
  v_mfma_f32_32x32x16_bf16 a[32:47], v[184:187], v[32:35], a[32:47]
  v_exp_f32 v95, v95
  v_add_f32 v45, v45, v94
  v_cvt_pk_bf16_f32 v42, v92, v93
  v_add_f32 v45, v45, v95
  v_cvt_pk_bf16_f32 v43, v94, v95
  v_mfma_f32_32x32x16_bf16 a[48:63], v[188:191], v[32:35], a[48:63]
  s_waitcnt vmcnt(9)
  s_nop 0
  s_cbranch_vccnz L_slowA0
L_slowA0_back:
  s_barrier
  v_mfma_f32_32x32x16_bf16 v[80:95], v[128:131], v[224:227], v[112:127]
  ds_read_b128 v[128:131], v10 offset:0
  v_exp_f32 v64, v64
  v_exp_f32 v65, v65
  v_add_f32 v44, v44, v64
  v_exp_f32 v66, v66
  v_mfma_f32_32x32x16_bf16 v[80:95], v[132:135], v[228:231], v[80:95]
  ds_read_b128 v[132:135], v11 offset:0
  v_add_f32 v44, v44, v65
  v_exp_f32 v67, v67
  v_add_f32 v44, v44, v66
  v_cvt_pk_bf16_f32 v28, v64, v65
  v_mfma_f32_32x32x16_bf16 v[80:95], v[136:139], v[232:235], v[80:95]
  ds_read_b128 v[136:139], v12 offset:0
  v_exp_f32 v68, v68
  v_add_f32 v44, v44, v67
  v_exp_f32 v69, v69
  v_add_f32 v44, v44, v68
  v_mfma_f32_32x32x16_bf16 v[80:95], v[140:143], v[236:239], v[80:95]
  ds_read_b128 v[140:143], v13 offset:0
  v_cvt_pk_bf16_f32 v29, v66, v67
  v_exp_f32 v70, v70
  v_add_f32 v44, v44, v69
  v_exp_f32 v71, v71
  v_mfma_f32_32x32x16_bf16 v[80:95], v[144:147], v[240:243], v[80:95]
  ds_read_b128 v[144:147], v14 offset:0
  v_add_f32 v44, v44, v70
  v_cvt_pk_bf16_f32 v30, v68, v69
  v_add_f32 v44, v44, v71
  v_cvt_pk_bf16_f32 v31, v70, v71
  v_exp_f32 v72, v72
  v_mfma_f32_32x32x16_bf16 v[80:95], v[148:151], v[244:247], v[80:95]
  ds_read_b128 v[148:151], v15 offset:0
  v_exp_f32 v73, v73
  v_add_f32 v44, v44, v72
  v_exp_f32 v74, v74
  v_add_f32 v44, v44, v73
  v_mfma_f32_32x32x16_bf16 v[80:95], v[152:155], v[248:251], v[80:95]
  ds_read_b128 v[152:155], v16 offset:0
  v_exp_f32 v75, v75
  v_add_f32 v44, v44, v74
  v_cvt_pk_bf16_f32 v32, v72, v73
  v_exp_f32 v76, v76
  v_mfma_f32_32x32x16_bf16 v[80:95], v[156:159], v[252:255], v[80:95]
  ds_read_b128 v[156:159], v17 offset:0
  v_add_f32 v44, v44, v75
  v_exp_f32 v77, v77
  v_add_f32 v44, v44, v76
  v_cvt_pk_bf16_f32 v33, v74, v75
  s_add_u32 m0, s25, 32768
  v_mfma_f32_32x32x16_bf16 a[64:79], v[160:163], v[36:39], a[64:79]
  buffer_load_dwordx4 v60, s[28:31], s40 offen lds
  v_mfma_f32_32x32x16_bf16 a[80:95], v[164:167], v[36:39], a[80:95]
  buffer_load_dwordx4 v61, s[28:31], s40 offen offset:1024 lds
  s_add_u32 s40, s40, 16384
  v_mfma_f32_32x32x16_bf16 a[96:111], v[168:171], v[36:39], a[96:111]
  buffer_load_dwordx4 v[52:55], v1, s[36:39], s51 offen
  v_mfma_f32_32x32x16_bf16 a[112:127], v[172:175], v[36:39], a[112:127]
  ds_read_b64_tr_b16 v[160:161], v18 offset:0
  ds_read_b64_tr_b16 v[162:163], v18 offset:1024
  v_max3_f32 v46, v80, v81, v82
  v_max3_f32 v46, v46, v83, v84
  v_max3_f32 v46, v46, v85, v86
  v_max3_f32 v46, v46, v87, v88
  v_max3_f32 v46, v46, v89, v90
  v_mfma_f32_32x32x16_bf16 a[64:79], v[176:179], v[40:43], a[64:79]
  ds_read_b64_tr_b16 v[164:165], v19 offset:0
  ds_read_b64_tr_b16 v[166:167], v19 offset:1024
  v_max3_f32 v46, v46, v91, v92
  v_max3_f32 v46, v46, v93, v94
  v_max_f32 v46, v46, v95
  v_cmp_lt_f32 vcc, s46, v46
  v_mfma_f32_32x32x16_bf16 a[80:95], v[180:183], v[40:43], a[80:95]
  ds_read_b64_tr_b16 v[168:169], v20 offset:0
  ds_read_b64_tr_b16 v[170:171], v20 offset:1024
  v_exp_f32 v78, v78
  v_add_f32 v44, v44, v77
  v_exp_f32 v79, v79
  v_mfma_f32_32x32x16_bf16 a[96:111], v[184:187], v[40:43], a[96:111]
  ds_read_b64_tr_b16 v[172:173], v21 offset:0
  ds_read_b64_tr_b16 v[174:175], v21 offset:1024
  v_add_f32 v44, v44, v78
  v_cvt_pk_bf16_f32 v34, v76, v77
  v_add_f32 v44, v44, v79
  v_cvt_pk_bf16_f32 v35, v78, v79
  s_waitcnt lgkmcnt(8)
  v_mfma_f32_32x32x16_bf16 a[112:127], v[188:191], v[40:43], a[112:127]
  s_cbranch_vccnz L_slowB0
L_slowB0_back:
  v_mfma_f32_32x32x16_bf16 v[64:79], v[128:131], v[192:195], v[96:111]
  ds_read_b64_tr_b16 v[176:177], v18 offset:4096
  ds_read_b64_tr_b16 v[178:179], v18 offset:5120
  v_exp_f32 v80, v80
  v_exp_f32 v81, v81
  v_mfma_f32_32x32x16_bf16 v[64:79], v[132:135], v[196:199], v[64:79]
  ds_read_b64_tr_b16 v[180:181], v19 offset:4096
  ds_read_b64_tr_b16 v[182:183], v19 offset:5120
  v_add_f32 v45, v45, v80
  v_exp_f32 v82, v82
  v_add_f32 v45, v45, v81
  v_mfma_f32_32x32x16_bf16 v[64:79], v[136:139], v[200:203], v[64:79]
  ds_read_b64_tr_b16 v[184:185], v20 offset:4096
  ds_read_b64_tr_b16 v[186:187], v20 offset:5120
  v_exp_f32 v83, v83
  v_add_f32 v45, v45, v82
  v_mfma_f32_32x32x16_bf16 v[64:79], v[140:143], v[204:207], v[64:79]
  ds_read_b64_tr_b16 v[188:189], v21 offset:4096
  ds_read_b64_tr_b16 v[190:191], v21 offset:5120
  v_cvt_pk_bf16_f32 v36, v80, v81
  v_exp_f32 v84, v84
  v_add_f32 v45, v45, v83
  v_mfma_f32_32x32x16_bf16 v[64:79], v[144:147], v[208:211], v[64:79]
  v_exp_f32 v85, v85
  v_add_f32 v45, v45, v84
  v_cvt_pk_bf16_f32 v37, v82, v83
  v_exp_f32 v86, v86
  s_add_u32 m0, s25, 98304
  v_mfma_f32_32x32x16_bf16 v[64:79], v[148:151], v[212:215], v[64:79]
  buffer_load_dwordx4 v62, s[32:35], s42 offen lds
  v_mfma_f32_32x32x16_bf16 v[64:79], v[152:155], v[216:219], v[64:79]
  buffer_load_dwordx4 v62, s[32:35], s42 offen offset:1024 lds
  s_add_u32 s42, s42, 16384
  v_mfma_f32_32x32x16_bf16 v[64:79], v[156:159], v[220:223], v[64:79]
  v_add_f32 v45, v45, v85
  v_exp_f32 v87, v87
  v_add_f32 v45, v45, v86
  s_waitcnt lgkmcnt(0)
  v_mfma_f32_32x32x16_bf16 a[0:15], v[160:163], v[28:31], a[0:15]
  v_cvt_pk_bf16_f32 v38, v84, v85
  v_add_f32 v45, v45, v87
  v_cvt_pk_bf16_f32 v39, v86, v87
  v_exp_f32 v88, v88
  v_mfma_f32_32x32x16_bf16 a[16:31], v[164:167], v[28:31], a[16:31]
  v_exp_f32 v89, v89
  v_add_f32 v45, v45, v88
  v_exp_f32 v90, v90
  v_add_f32 v45, v45, v89
  v_mfma_f32_32x32x16_bf16 a[32:47], v[168:171], v[28:31], a[32:47]
  v_max3_f32 v46, v64, v65, v66
  v_max3_f32 v46, v46, v67, v68
  v_max3_f32 v46, v46, v69, v70
  v_max3_f32 v46, v46, v71, v72
  v_max3_f32 v46, v46, v73, v74
  v_max3_f32 v46, v46, v75, v76
  v_mfma_f32_32x32x16_bf16 a[48:63], v[172:175], v[28:31], a[48:63]
  v_max3_f32 v46, v46, v77, v78
  v_max_f32 v46, v46, v79
  v_cmp_lt_f32 vcc, s46, v46
  v_exp_f32 v91, v91
  v_add_f32 v45, v45, v90
  v_mfma_f32_32x32x16_bf16 a[0:15], v[176:179], v[32:35], a[0:15]
  v_cvt_pk_bf16_f32 v40, v88, v89
  v_exp_f32 v92, v92
  v_add_f32 v45, v45, v91
  v_exp_f32 v93, v93
  v_mfma_f32_32x32x16_bf16 a[16:31], v[180:183], v[32:35], a[16:31]
  v_add_f32 v45, v45, v92
  v_cvt_pk_bf16_f32 v41, v90, v91
  v_exp_f32 v94, v94
  v_add_f32 v45, v45, v93
  v_mfma_f32_32x32x16_bf16 a[32:47], v[184:187], v[32:35], a[32:47]
  v_exp_f32 v95, v95
  v_add_f32 v45, v45, v94
  v_cvt_pk_bf16_f32 v42, v92, v93
  v_add_f32 v45, v45, v95
  v_cvt_pk_bf16_f32 v43, v94, v95
  v_mfma_f32_32x32x16_bf16 a[48:63], v[188:191], v[32:35], a[48:63]
  s_nop 0
  s_cbranch_vccnz L_slowA1
L_slowA1_back:
  v_mfma_f32_32x32x16_bf16 v[80:95], v[128:131], v[224:227], v[112:127]
  ds_read_b128 v[128:131], v10 offset:8192
  v_exp_f32 v64, v64
  v_exp_f32 v65, v65
  v_add_f32 v44, v44, v64
  v_mfma_f32_32x32x16_bf16 v[80:95], v[132:135], v[228:231], v[80:95]
  ds_read_b128 v[132:135], v11 offset:8192
  v_exp_f32 v66, v66
  v_add_f32 v44, v44, v65
  v_exp_f32 v67, v67
  v_add_f32 v44, v44, v66
  v_mfma_f32_32x32x16_bf16 v[80:95], v[136:139], v[232:235], v[80:95]
  ds_read_b128 v[136:139], v12 offset:8192
  v_cvt_pk_bf16_f32 v28, v64, v65
  v_exp_f32 v68, v68
  v_add_f32 v44, v44, v67
  v_exp_f32 v69, v69
  v_mfma_f32_32x32x16_bf16 v[80:95], v[140:143], v[236:239], v[80:95]
  ds_read_b128 v[140:143], v13 offset:8192
  v_add_f32 v44, v44, v68
  v_cvt_pk_bf16_f32 v29, v66, v67
  v_exp_f32 v70, v70
  v_add_f32 v44, v44, v69
  v_mfma_f32_32x32x16_bf16 v[80:95], v[144:147], v[240:243], v[80:95]
  ds_read_b128 v[144:147], v14 offset:8192
  v_exp_f32 v71, v71
  v_add_f32 v44, v44, v70
  v_cvt_pk_bf16_f32 v30, v68, v69
  v_add_f32 v44, v44, v71
  v_mfma_f32_32x32x16_bf16 v[80:95], v[148:151], v[244:247], v[80:95]
  ds_read_b128 v[148:151], v15 offset:8192
  v_cvt_pk_bf16_f32 v31, v70, v71
  v_exp_f32 v72, v72
  v_exp_f32 v73, v73
  v_add_f32 v44, v44, v72
  v_mfma_f32_32x32x16_bf16 v[80:95], v[152:155], v[248:251], v[80:95]
  ds_read_b128 v[152:155], v16 offset:8192
  v_exp_f32 v74, v74
  v_add_f32 v44, v44, v73
  v_exp_f32 v75, v75
  v_mfma_f32_32x32x16_bf16 v[80:95], v[156:159], v[252:255], v[80:95]
  ds_read_b128 v[156:159], v17 offset:8192
  v_add_f32 v44, v44, v74
  v_cvt_pk_bf16_f32 v32, v72, v73
  v_exp_f32 v76, v76
  s_add_u32 m0, s25, 40960
  v_mfma_f32_32x32x16_bf16 a[64:79], v[160:163], v[36:39], a[64:79]
  buffer_load_dwordx4 v60, s[28:31], s41 offen lds
  v_mfma_f32_32x32x16_bf16 a[80:95], v[164:167], v[36:39], a[80:95]
  buffer_load_dwordx4 v61, s[28:31], s41 offen offset:1024 lds
  s_add_u32 s41, s41, 16384
  v_mfma_f32_32x32x16_bf16 a[96:111], v[168:171], v[36:39], a[96:111]
  v_add_f32 v44, v44, v75
  v_exp_f32 v77, v77
  v_add_f32 v44, v44, v76
  v_cvt_pk_bf16_f32 v33, v74, v75
  v_exp_f32 v78, v78
  v_mfma_f32_32x32x16_bf16 a[112:127], v[172:175], v[36:39], a[112:127]
  ds_read_b64_tr_b16 v[160:161], v18 offset:8192
  ds_read_b64_tr_b16 v[162:163], v18 offset:9216
  v_max3_f32 v46, v80, v81, v82
  v_max3_f32 v46, v46, v83, v84
  v_max3_f32 v46, v46, v85, v86
  v_max3_f32 v46, v46, v87, v88
  v_mfma_f32_32x32x16_bf16 a[64:79], v[176:179], v[40:43], a[64:79]
  ds_read_b64_tr_b16 v[164:165], v19 offset:8192
  ds_read_b64_tr_b16 v[166:167], v19 offset:9216
  v_max3_f32 v46, v46, v89, v90
  v_max3_f32 v46, v46, v91, v92
  v_max3_f32 v46, v46, v93, v94
  v_max_f32 v46, v46, v95
  v_mfma_f32_32x32x16_bf16 a[80:95], v[180:183], v[40:43], a[80:95]
  ds_read_b64_tr_b16 v[168:169], v20 offset:8192
  ds_read_b64_tr_b16 v[170:171], v20 offset:9216
  v_cmp_lt_f32 vcc, s46, v46
  v_add_f32 v44, v44, v77
  v_exp_f32 v79, v79
  v_add_f32 v44, v44, v78
  v_mfma_f32_32x32x16_bf16 a[96:111], v[184:187], v[40:43], a[96:111]
  ds_read_b64_tr_b16 v[172:173], v21 offset:8192
  ds_read_b64_tr_b16 v[174:175], v21 offset:9216
  v_cvt_pk_bf16_f32 v34, v76, v77
  v_add_f32 v44, v44, v79
  v_cvt_pk_bf16_f32 v35, v78, v79
  s_waitcnt lgkmcnt(8)
  v_mfma_f32_32x32x16_bf16 a[112:127], v[188:191], v[40:43], a[112:127]
  s_cbranch_vccnz L_slowB1
L_slowB1_back:
  v_mfma_f32_32x32x16_bf16 v[64:79], v[128:131], v[192:195], v[96:111]
  ds_read_b64_tr_b16 v[176:177], v18 offset:12288
  ds_read_b64_tr_b16 v[178:179], v18 offset:13312
  v_exp_f32 v80, v80
  v_exp_f32 v81, v81
  v_mfma_f32_32x32x16_bf16 v[64:79], v[132:135], v[196:199], v[64:79]
  ds_read_b64_tr_b16 v[180:181], v19 offset:12288
  ds_read_b64_tr_b16 v[182:183], v19 offset:13312
  v_add_f32 v45, v45, v80
  v_exp_f32 v82, v82
  v_add_f32 v45, v45, v81
  v_mfma_f32_32x32x16_bf16 v[64:79], v[136:139], v[200:203], v[64:79]
  ds_read_b64_tr_b16 v[184:185], v20 offset:12288
  ds_read_b64_tr_b16 v[186:187], v20 offset:13312
  v_exp_f32 v83, v83
  v_add_f32 v45, v45, v82
  v_mfma_f32_32x32x16_bf16 v[64:79], v[140:143], v[204:207], v[64:79]
  ds_read_b64_tr_b16 v[188:189], v21 offset:12288
  ds_read_b64_tr_b16 v[190:191], v21 offset:13312
  v_cvt_pk_bf16_f32 v36, v80, v81
  v_exp_f32 v84, v84
  v_add_f32 v45, v45, v83
  v_mfma_f32_32x32x16_bf16 v[64:79], v[144:147], v[208:211], v[64:79]
  v_exp_f32 v85, v85
  v_add_f32 v45, v45, v84
  v_cvt_pk_bf16_f32 v37, v82, v83
  v_exp_f32 v86, v86
  s_add_u32 m0, s25, 106496
  v_mfma_f32_32x32x16_bf16 v[64:79], v[148:151], v[212:215], v[64:79]
  buffer_load_dwordx4 v62, s[32:35], s43 offen lds
  v_mfma_f32_32x32x16_bf16 v[64:79], v[152:155], v[216:219], v[64:79]
  buffer_load_dwordx4 v62, s[32:35], s43 offen offset:1024 lds
  s_add_u32 s43, s43, 16384
  v_mfma_f32_32x32x16_bf16 v[64:79], v[156:159], v[220:223], v[64:79]
  v_add_f32 v45, v45, v85
  v_exp_f32 v87, v87
  v_add_f32 v45, v45, v86
  s_waitcnt lgkmcnt(0)
  v_mfma_f32_32x32x16_bf16 a[0:15], v[160:163], v[28:31], a[0:15]
  v_cvt_pk_bf16_f32 v38, v84, v85
  v_add_f32 v45, v45, v87
  v_cvt_pk_bf16_f32 v39, v86, v87
  v_exp_f32 v88, v88
  v_mfma_f32_32x32x16_bf16 a[16:31], v[164:167], v[28:31], a[16:31]
  v_exp_f32 v89, v89
  v_add_f32 v45, v45, v88
  v_exp_f32 v90, v90
  v_add_f32 v45, v45, v89
  v_mfma_f32_32x32x16_bf16 a[32:47], v[168:171], v[28:31], a[32:47]
  v_max3_f32 v46, v64, v65, v66
  v_max3_f32 v46, v46, v67, v68
  v_max3_f32 v46, v46, v69, v70
  v_max3_f32 v46, v46, v71, v72
  v_max3_f32 v46, v46, v73, v74
  v_max3_f32 v46, v46, v75, v76
  v_mfma_f32_32x32x16_bf16 a[48:63], v[172:175], v[28:31], a[48:63]
  v_max3_f32 v46, v46, v77, v78
  v_max_f32 v46, v46, v79
  v_cmp_lt_f32 vcc, s46, v46
  v_exp_f32 v91, v91
  v_add_f32 v45, v45, v90
  v_mfma_f32_32x32x16_bf16 a[0:15], v[176:179], v[32:35], a[0:15]
  v_cvt_pk_bf16_f32 v40, v88, v89
  v_exp_f32 v92, v92
  v_add_f32 v45, v45, v91
  v_exp_f32 v93, v93
  v_mfma_f32_32x32x16_bf16 a[16:31], v[180:183], v[32:35], a[16:31]
  v_add_f32 v45, v45, v92
  v_cvt_pk_bf16_f32 v41, v90, v91
  v_exp_f32 v94, v94
  v_add_f32 v45, v45, v93
  v_mfma_f32_32x32x16_bf16 a[32:47], v[184:187], v[32:35], a[32:47]
  v_exp_f32 v95, v95
  v_add_f32 v45, v45, v94
  v_cvt_pk_bf16_f32 v42, v92, v93
  v_add_f32 v45, v45, v95
  v_cvt_pk_bf16_f32 v43, v94, v95
  v_mfma_f32_32x32x16_bf16 a[48:63], v[188:191], v[32:35], a[48:63]
  s_waitcnt vmcnt(9)
  s_nop 0
  s_cbranch_vccnz L_slowA2
L_slowA2_back:
  s_barrier
  v_mfma_f32_32x32x16_bf16 v[80:95], v[128:131], v[224:227], v[112:127]
  ds_read_b128 v[128:131], v10 offset:16384
  v_exp_f32 v64, v64
  v_exp_f32 v65, v65
  v_add_f32 v44, v44, v64
  v_exp_f32 v66, v66
  v_mfma_f32_32x32x16_bf16 v[80:95], v[132:135], v[228:231], v[80:95]
  ds_read_b128 v[132:135], v11 offset:16384
  v_add_f32 v44, v44, v65
  v_exp_f32 v67, v67
  v_add_f32 v44, v44, v66
  v_cvt_pk_bf16_f32 v28, v64, v65
  v_mfma_f32_32x32x16_bf16 v[80:95], v[136:139], v[232:235], v[80:95]
  ds_read_b128 v[136:139], v12 offset:16384
  v_exp_f32 v68, v68
  v_add_f32 v44, v44, v67
  v_exp_f32 v69, v69
  v_add_f32 v44, v44, v68
  v_mfma_f32_32x32x16_bf16 v[80:95], v[140:143], v[236:239], v[80:95]
  ds_read_b128 v[140:143], v13 offset:16384
  v_cvt_pk_bf16_f32 v29, v66, v67
  v_exp_f32 v70, v70
  v_add_f32 v44, v44, v69
  v_exp_f32 v71, v71
  v_mfma_f32_32x32x16_bf16 v[80:95], v[144:147], v[240:243], v[80:95]
  ds_read_b128 v[144:147], v14 offset:16384
  v_add_f32 v44, v44, v70
  v_cvt_pk_bf16_f32 v30, v68, v69
  v_add_f32 v44, v44, v71
  v_cvt_pk_bf16_f32 v31, v70, v71
  v_exp_f32 v72, v72
  v_mfma_f32_32x32x16_bf16 v[80:95], v[148:151], v[244:247], v[80:95]
  ds_read_b128 v[148:151], v15 offset:16384
  v_exp_f32 v73, v73
  v_add_f32 v44, v44, v72
  v_exp_f32 v74, v74
  v_add_f32 v44, v44, v73
  v_mfma_f32_32x32x16_bf16 v[80:95], v[152:155], v[248:251], v[80:95]
  ds_read_b128 v[152:155], v16 offset:16384
  v_exp_f32 v75, v75
  v_add_f32 v44, v44, v74
  v_cvt_pk_bf16_f32 v32, v72, v73
  v_exp_f32 v76, v76
  v_mfma_f32_32x32x16_bf16 v[80:95], v[156:159], v[252:255], v[80:95]
  ds_read_b128 v[156:159], v17 offset:16384
  v_add_f32 v44, v44, v75
  v_exp_f32 v77, v77
  v_add_f32 v44, v44, v76
  v_cvt_pk_bf16_f32 v33, v74, v75
  s_add_u32 m0, s25, 49152
  v_mfma_f32_32x32x16_bf16 a[64:79], v[160:163], v[36:39], a[64:79]
  buffer_load_dwordx4 v60, s[28:31], s40 offen lds
  v_mfma_f32_32x32x16_bf16 a[80:95], v[164:167], v[36:39], a[80:95]
  buffer_load_dwordx4 v61, s[28:31], s40 offen offset:1024 lds
  s_add_u32 s40, s40, 16384
  v_mfma_f32_32x32x16_bf16 a[96:111], v[168:171], v[36:39], a[96:111]
  buffer_load_dwordx4 v[52:55], v1, s[52:55], s49 offen
  v_mfma_f32_32x32x16_bf16 a[112:127], v[172:175], v[36:39], a[112:127]
  ds_read_b64_tr_b16 v[160:161], v18 offset:16384
  ds_read_b64_tr_b16 v[162:163], v18 offset:17408
  v_max3_f32 v46, v80, v81, v82
  v_max3_f32 v46, v46, v83, v84
  v_max3_f32 v46, v46, v85, v86
  v_max3_f32 v46, v46, v87, v88
  v_max3_f32 v46, v46, v89, v90
  v_mfma_f32_32x32x16_bf16 a[64:79], v[176:179], v[40:43], a[64:79]
  ds_read_b64_tr_b16 v[164:165], v19 offset:16384
  ds_read_b64_tr_b16 v[166:167], v19 offset:17408
  v_max3_f32 v46, v46, v91, v92
  v_max3_f32 v46, v46, v93, v94
  v_max_f32 v46, v46, v95
  v_cmp_lt_f32 vcc, s46, v46
  v_mfma_f32_32x32x16_bf16 a[80:95], v[180:183], v[40:43], a[80:95]
  ds_read_b64_tr_b16 v[168:169], v20 offset:16384
  ds_read_b64_tr_b16 v[170:171], v20 offset:17408
  v_exp_f32 v78, v78
  v_add_f32 v44, v44, v77
  v_exp_f32 v79, v79
  v_mfma_f32_32x32x16_bf16 a[96:111], v[184:187], v[40:43], a[96:111]
  ds_read_b64_tr_b16 v[172:173], v21 offset:16384
  ds_read_b64_tr_b16 v[174:175], v21 offset:17408
  v_add_f32 v44, v44, v78
  v_cvt_pk_bf16_f32 v34, v76, v77
  v_add_f32 v44, v44, v79
  v_cvt_pk_bf16_f32 v35, v78, v79
  s_waitcnt lgkmcnt(8)
  v_mfma_f32_32x32x16_bf16 a[112:127], v[188:191], v[40:43], a[112:127]
  s_cbranch_vccnz L_slowB2
L_slowB2_back:
  v_mfma_f32_32x32x16_bf16 v[64:79], v[128:131], v[192:195], v[96:111]
  ds_read_b64_tr_b16 v[176:177], v18 offset:20480
  ds_read_b64_tr_b16 v[178:179], v18 offset:21504
  v_exp_f32 v80, v80
  v_exp_f32 v81, v81
  v_mfma_f32_32x32x16_bf16 v[64:79], v[132:135], v[196:199], v[64:79]
  ds_read_b64_tr_b16 v[180:181], v19 offset:20480
  ds_read_b64_tr_b16 v[182:183], v19 offset:21504
  v_add_f32 v45, v45, v80
  v_exp_f32 v82, v82
  v_add_f32 v45, v45, v81
  v_mfma_f32_32x32x16_bf16 v[64:79], v[136:139], v[200:203], v[64:79]
  ds_read_b64_tr_b16 v[184:185], v20 offset:20480
  ds_read_b64_tr_b16 v[186:187], v20 offset:21504
  v_exp_f32 v83, v83
  v_add_f32 v45, v45, v82
  v_mfma_f32_32x32x16_bf16 v[64:79], v[140:143], v[204:207], v[64:79]
  ds_read_b64_tr_b16 v[188:189], v21 offset:20480
  ds_read_b64_tr_b16 v[190:191], v21 offset:21504
  v_cvt_pk_bf16_f32 v36, v80, v81
  v_exp_f32 v84, v84
  v_add_f32 v45, v45, v83
  v_mfma_f32_32x32x16_bf16 v[64:79], v[144:147], v[208:211], v[64:79]
  v_exp_f32 v85, v85
  v_add_f32 v45, v45, v84
  v_cvt_pk_bf16_f32 v37, v82, v83
  v_exp_f32 v86, v86
  s_add_u32 m0, s25, 114688
  v_mfma_f32_32x32x16_bf16 v[64:79], v[148:151], v[212:215], v[64:79]
  buffer_load_dwordx4 v62, s[32:35], s42 offen lds
  v_mfma_f32_32x32x16_bf16 v[64:79], v[152:155], v[216:219], v[64:79]
  buffer_load_dwordx4 v62, s[32:35], s42 offen offset:1024 lds
  s_add_u32 s42, s42, 16384
  v_mfma_f32_32x32x16_bf16 v[64:79], v[156:159], v[220:223], v[64:79]
  v_add_f32 v45, v45, v85
  v_exp_f32 v87, v87
  v_add_f32 v45, v45, v86
  s_waitcnt lgkmcnt(0)
  v_mfma_f32_32x32x16_bf16 a[0:15], v[160:163], v[28:31], a[0:15]
  v_cvt_pk_bf16_f32 v38, v84, v85
  v_add_f32 v45, v45, v87
  v_cvt_pk_bf16_f32 v39, v86, v87
  v_exp_f32 v88, v88
  v_mfma_f32_32x32x16_bf16 a[16:31], v[164:167], v[28:31], a[16:31]
  v_exp_f32 v89, v89
  v_add_f32 v45, v45, v88
  v_exp_f32 v90, v90
  v_add_f32 v45, v45, v89
  v_mfma_f32_32x32x16_bf16 a[32:47], v[168:171], v[28:31], a[32:47]
  v_max3_f32 v46, v64, v65, v66
  v_max3_f32 v46, v46, v67, v68
  v_max3_f32 v46, v46, v69, v70
  v_max3_f32 v46, v46, v71, v72
  v_max3_f32 v46, v46, v73, v74
  v_max3_f32 v46, v46, v75, v76
  v_mfma_f32_32x32x16_bf16 a[48:63], v[172:175], v[28:31], a[48:63]
  v_max3_f32 v46, v46, v77, v78
  v_max_f32 v46, v46, v79
  v_cmp_lt_f32 vcc, s46, v46
  v_exp_f32 v91, v91
  v_add_f32 v45, v45, v90
  v_mfma_f32_32x32x16_bf16 a[0:15], v[176:179], v[32:35], a[0:15]
  v_cvt_pk_bf16_f32 v40, v88, v89
  v_exp_f32 v92, v92
  v_add_f32 v45, v45, v91
  v_exp_f32 v93, v93
  v_mfma_f32_32x32x16_bf16 a[16:31], v[180:183], v[32:35], a[16:31]
  v_add_f32 v45, v45, v92
  v_cvt_pk_bf16_f32 v41, v90, v91
  v_exp_f32 v94, v94
  v_add_f32 v45, v45, v93
  v_mfma_f32_32x32x16_bf16 a[32:47], v[184:187], v[32:35], a[32:47]
  v_exp_f32 v95, v95
  v_add_f32 v45, v45, v94
  v_cvt_pk_bf16_f32 v42, v92, v93
  v_add_f32 v45, v45, v95
  v_cvt_pk_bf16_f32 v43, v94, v95
  v_mfma_f32_32x32x16_bf16 a[48:63], v[188:191], v[32:35], a[48:63]
  s_nop 0
  s_cbranch_vccnz L_slowA3
L_slowA3_back:
  v_mfma_f32_32x32x16_bf16 v[80:95], v[128:131], v[224:227], v[112:127]
  ds_read_b128 v[128:131], v10 offset:24576
  v_exp_f32 v64, v64
  v_exp_f32 v65, v65
  v_add_f32 v44, v44, v64
  v_mfma_f32_32x32x16_bf16 v[80:95], v[132:135], v[228:231], v[80:95]
  ds_read_b128 v[132:135], v11 offset:24576
  v_exp_f32 v66, v66
  v_add_f32 v44, v44, v65
  v_exp_f32 v67, v67
  v_add_f32 v44, v44, v66
  v_mfma_f32_32x32x16_bf16 v[80:95], v[136:139], v[232:235], v[80:95]
  ds_read_b128 v[136:139], v12 offset:24576
  v_cvt_pk_bf16_f32 v28, v64, v65
  v_exp_f32 v68, v68
  v_add_f32 v44, v44, v67
  v_exp_f32 v69, v69
  v_mfma_f32_32x32x16_bf16 v[80:95], v[140:143], v[236:239], v[80:95]
  ds_read_b128 v[140:143], v13 offset:24576
  v_add_f32 v44, v44, v68
  v_cvt_pk_bf16_f32 v29, v66, v67
  v_exp_f32 v70, v70
  v_add_f32 v44, v44, v69
  v_mfma_f32_32x32x16_bf16 v[80:95], v[144:147], v[240:243], v[80:95]
  ds_read_b128 v[144:147], v14 offset:24576
  v_exp_f32 v71, v71
  v_add_f32 v44, v44, v70
  v_cvt_pk_bf16_f32 v30, v68, v69
  v_add_f32 v44, v44, v71
  v_mfma_f32_32x32x16_bf16 v[80:95], v[148:151], v[244:247], v[80:95]
  ds_read_b128 v[148:151], v15 offset:24576
  v_cvt_pk_bf16_f32 v31, v70, v71
  v_exp_f32 v72, v72
  v_exp_f32 v73, v73
  v_add_f32 v44, v44, v72
  v_mfma_f32_32x32x16_bf16 v[80:95], v[152:155], v[248:251], v[80:95]
  ds_read_b128 v[152:155], v16 offset:24576
  v_exp_f32 v74, v74
  v_add_f32 v44, v44, v73
  v_exp_f32 v75, v75
  v_mfma_f32_32x32x16_bf16 v[80:95], v[156:159], v[252:255], v[80:95]
  ds_read_b128 v[156:159], v17 offset:24576
  v_add_f32 v44, v44, v74
  v_cvt_pk_bf16_f32 v32, v72, v73
  v_exp_f32 v76, v76
  s_add_u32 m0, s25, 57344
  v_mfma_f32_32x32x16_bf16 a[64:79], v[160:163], v[36:39], a[64:79]
  buffer_load_dwordx4 v60, s[28:31], s41 offen lds
  v_mfma_f32_32x32x16_bf16 a[80:95], v[164:167], v[36:39], a[80:95]
  buffer_load_dwordx4 v61, s[28:31], s41 offen offset:1024 lds
  s_add_u32 s41, s41, 16384
  v_mfma_f32_32x32x16_bf16 a[96:111], v[168:171], v[36:39], a[96:111]
  v_add_f32 v44, v44, v75
  v_exp_f32 v77, v77
  v_add_f32 v44, v44, v76
  v_cvt_pk_bf16_f32 v33, v74, v75
  v_exp_f32 v78, v78
  v_mfma_f32_32x32x16_bf16 a[112:127], v[172:175], v[36:39], a[112:127]
  ds_read_b64_tr_b16 v[160:161], v18 offset:24576
  ds_read_b64_tr_b16 v[162:163], v18 offset:25600
  v_max3_f32 v46, v80, v81, v82
  v_max3_f32 v46, v46, v83, v84
  v_max3_f32 v46, v46, v85, v86
  v_max3_f32 v46, v46, v87, v88
  v_mfma_f32_32x32x16_bf16 a[64:79], v[176:179], v[40:43], a[64:79]
  ds_read_b64_tr_b16 v[164:165], v19 offset:24576
  ds_read_b64_tr_b16 v[166:167], v19 offset:25600
  v_max3_f32 v46, v46, v89, v90
  v_max3_f32 v46, v46, v91, v92
  v_max3_f32 v46, v46, v93, v94
  v_max_f32 v46, v46, v95
  v_mfma_f32_32x32x16_bf16 a[80:95], v[180:183], v[40:43], a[80:95]
  ds_read_b64_tr_b16 v[168:169], v20 offset:24576
  ds_read_b64_tr_b16 v[170:171], v20 offset:25600
  v_cmp_lt_f32 vcc, s46, v46
  v_add_f32 v44, v44, v77
  v_exp_f32 v79, v79
  v_add_f32 v44, v44, v78
  v_mfma_f32_32x32x16_bf16 a[96:111], v[184:187], v[40:43], a[96:111]
  ds_read_b64_tr_b16 v[172:173], v21 offset:24576
  ds_read_b64_tr_b16 v[174:175], v21 offset:25600
  v_cvt_pk_bf16_f32 v34, v76, v77
  v_add_f32 v44, v44, v79
  v_cvt_pk_bf16_f32 v35, v78, v79
  s_waitcnt lgkmcnt(8)
  v_mfma_f32_32x32x16_bf16 a[112:127], v[188:191], v[40:43], a[112:127]
  s_cbranch_vccnz L_slowB3
L_slowB3_back:
  v_mfma_f32_32x32x16_bf16 v[64:79], v[128:131], v[192:195], v[96:111]
  ds_read_b64_tr_b16 v[176:177], v18 offset:28672
  ds_read_b64_tr_b16 v[178:179], v18 offset:29696
  v_exp_f32 v80, v80
  v_exp_f32 v81, v81
  v_mfma_f32_32x32x16_bf16 v[64:79], v[132:135], v[196:199], v[64:79]
  ds_read_b64_tr_b16 v[180:181], v19 offset:28672
  ds_read_b64_tr_b16 v[182:183], v19 offset:29696
  v_add_f32 v45, v45, v80
  v_exp_f32 v82, v82
  v_add_f32 v45, v45, v81
  v_mfma_f32_32x32x16_bf16 v[64:79], v[136:139], v[200:203], v[64:79]
  ds_read_b64_tr_b16 v[184:185], v20 offset:28672
  ds_read_b64_tr_b16 v[186:187], v20 offset:29696
  v_exp_f32 v83, v83
  v_add_f32 v45, v45, v82
  v_mfma_f32_32x32x16_bf16 v[64:79], v[140:143], v[204:207], v[64:79]
  ds_read_b64_tr_b16 v[188:189], v21 offset:28672
  ds_read_b64_tr_b16 v[190:191], v21 offset:29696
  v_cvt_pk_bf16_f32 v36, v80, v81
  v_exp_f32 v84, v84
  v_add_f32 v45, v45, v83
  v_mfma_f32_32x32x16_bf16 v[64:79], v[144:147], v[208:211], v[64:79]
  v_exp_f32 v85, v85
  v_add_f32 v45, v45, v84
  v_cvt_pk_bf16_f32 v37, v82, v83
  v_exp_f32 v86, v86
  s_add_u32 m0, s25, 122880
  v_mfma_f32_32x32x16_bf16 v[64:79], v[148:151], v[212:215], v[64:79]
  buffer_load_dwordx4 v62, s[32:35], s43 offen lds
  v_mfma_f32_32x32x16_bf16 v[64:79], v[152:155], v[216:219], v[64:79]
  buffer_load_dwordx4 v62, s[32:35], s43 offen offset:1024 lds
  s_add_u32 s43, s43, 16384
  v_mfma_f32_32x32x16_bf16 v[64:79], v[156:159], v[220:223], v[64:79]
  v_add_f32 v45, v45, v85
  v_exp_f32 v87, v87
  v_add_f32 v45, v45, v86
  s_waitcnt lgkmcnt(0)
  v_mfma_f32_32x32x16_bf16 a[0:15], v[160:163], v[28:31], a[0:15]
  v_cvt_pk_bf16_f32 v38, v84, v85
  v_add_f32 v45, v45, v87
  v_cvt_pk_bf16_f32 v39, v86, v87
  v_exp_f32 v88, v88
  v_mfma_f32_32x32x16_bf16 a[16:31], v[164:167], v[28:31], a[16:31]
  v_exp_f32 v89, v89
  v_add_f32 v45, v45, v88
  v_exp_f32 v90, v90
  v_add_f32 v45, v45, v89
  v_mfma_f32_32x32x16_bf16 a[32:47], v[168:171], v[28:31], a[32:47]
  v_max3_f32 v46, v64, v65, v66
  v_max3_f32 v46, v46, v67, v68
  v_max3_f32 v46, v46, v69, v70
  v_max3_f32 v46, v46, v71, v72
  v_max3_f32 v46, v46, v73, v74
  v_max3_f32 v46, v46, v75, v76
  v_mfma_f32_32x32x16_bf16 a[48:63], v[172:175], v[28:31], a[48:63]
  v_max3_f32 v46, v46, v77, v78
  v_max_f32 v46, v46, v79
  v_cmp_lt_f32 vcc, s46, v46
  v_exp_f32 v91, v91
  v_add_f32 v45, v45, v90
  v_mfma_f32_32x32x16_bf16 a[0:15], v[176:179], v[32:35], a[0:15]
  v_cvt_pk_bf16_f32 v40, v88, v89
  v_exp_f32 v92, v92
  v_add_f32 v45, v45, v91
  v_exp_f32 v93, v93
  v_mfma_f32_32x32x16_bf16 a[16:31], v[180:183], v[32:35], a[16:31]
  v_add_f32 v45, v45, v92
  v_cvt_pk_bf16_f32 v41, v90, v91
  v_exp_f32 v94, v94
  v_add_f32 v45, v45, v93
  v_mfma_f32_32x32x16_bf16 a[32:47], v[184:187], v[32:35], a[32:47]
  v_exp_f32 v95, v95
  v_add_f32 v45, v45, v94
  v_cvt_pk_bf16_f32 v42, v92, v93
  v_add_f32 v45, v45, v95
  v_cvt_pk_bf16_f32 v43, v94, v95
  v_mfma_f32_32x32x16_bf16 a[48:63], v[188:191], v[32:35], a[48:63]
  s_waitcnt vmcnt(9)
  s_nop 0
  s_cbranch_vccnz L_slowA4
L_slowA4_back:
  s_barrier
  v_mfma_f32_32x32x16_bf16 v[80:95], v[128:131], v[224:227], v[112:127]
  ds_read_b128 v[128:131], v10 offset:32768
  v_exp_f32 v64, v64
  v_exp_f32 v65, v65
  v_add_f32 v44, v44, v64
  v_exp_f32 v66, v66
  v_mfma_f32_32x32x16_bf16 v[80:95], v[132:135], v[228:231], v[80:95]
  ds_read_b128 v[132:135], v11 offset:32768
  v_add_f32 v44, v44, v65
  v_exp_f32 v67, v67
  v_add_f32 v44, v44, v66
  v_cvt_pk_bf16_f32 v28, v64, v65
  v_mfma_f32_32x32x16_bf16 v[80:95], v[136:139], v[232:235], v[80:95]
  ds_read_b128 v[136:139], v12 offset:32768
  v_exp_f32 v68, v68
  v_add_f32 v44, v44, v67
  v_exp_f32 v69, v69
  v_add_f32 v44, v44, v68
  v_mfma_f32_32x32x16_bf16 v[80:95], v[140:143], v[236:239], v[80:95]
  ds_read_b128 v[140:143], v13 offset:32768
  v_cvt_pk_bf16_f32 v29, v66, v67
  v_exp_f32 v70, v70
  v_add_f32 v44, v44, v69
  v_exp_f32 v71, v71
  v_mfma_f32_32x32x16_bf16 v[80:95], v[144:147], v[240:243], v[80:95]
  ds_read_b128 v[144:147], v14 offset:32768
  v_add_f32 v44, v44, v70
  v_cvt_pk_bf16_f32 v30, v68, v69
  v_add_f32 v44, v44, v71
  v_cvt_pk_bf16_f32 v31, v70, v71
  v_exp_f32 v72, v72
  v_mfma_f32_32x32x16_bf16 v[80:95], v[148:151], v[244:247], v[80:95]
  ds_read_b128 v[148:151], v15 offset:32768
  v_exp_f32 v73, v73
  v_add_f32 v44, v44, v72
  v_exp_f32 v74, v74
  v_add_f32 v44, v44, v73
  v_mfma_f32_32x32x16_bf16 v[80:95], v[152:155], v[248:251], v[80:95]
  ds_read_b128 v[152:155], v16 offset:32768
  v_exp_f32 v75, v75
  v_add_f32 v44, v44, v74
  v_cvt_pk_bf16_f32 v32, v72, v73
  v_exp_f32 v76, v76
  v_mfma_f32_32x32x16_bf16 v[80:95], v[156:159], v[252:255], v[80:95]
  ds_read_b128 v[156:159], v17 offset:32768
  v_add_f32 v44, v44, v75
  v_exp_f32 v77, v77
  v_add_f32 v44, v44, v76
  v_cvt_pk_bf16_f32 v33, v74, v75
  s_add_u32 m0, s25, 0
  v_mfma_f32_32x32x16_bf16 a[64:79], v[160:163], v[36:39], a[64:79]
  buffer_load_dwordx4 v60, s[28:31], s40 offen lds
  v_mfma_f32_32x32x16_bf16 a[80:95], v[164:167], v[36:39], a[80:95]
  buffer_load_dwordx4 v61, s[28:31], s40 offen offset:1024 lds
  s_add_u32 s40, s40, 16384
  v_mfma_f32_32x32x16_bf16 a[96:111], v[168:171], v[36:39], a[96:111]
  buffer_load_dwordx4 v[52:55], v1, s[56:59], s49 offen
  v_mfma_f32_32x32x16_bf16 a[112:127], v[172:175], v[36:39], a[112:127]
  ds_read_b64_tr_b16 v[160:161], v18 offset:32768
  ds_read_b64_tr_b16 v[162:163], v18 offset:33792
  v_max3_f32 v46, v80, v81, v82
  v_max3_f32 v46, v46, v83, v84
  v_max3_f32 v46, v46, v85, v86
  v_max3_f32 v46, v46, v87, v88
  v_max3_f32 v46, v46, v89, v90
  v_mfma_f32_32x32x16_bf16 a[64:79], v[176:179], v[40:43], a[64:79]
  ds_read_b64_tr_b16 v[164:165], v19 offset:32768
  ds_read_b64_tr_b16 v[166:167], v19 offset:33792
  v_max3_f32 v46, v46, v91, v92
  v_max3_f32 v46, v46, v93, v94
  v_max_f32 v46, v46, v95
  v_cmp_lt_f32 vcc, s46, v46
  v_mfma_f32_32x32x16_bf16 a[80:95], v[180:183], v[40:43], a[80:95]
  ds_read_b64_tr_b16 v[168:169], v20 offset:32768
  ds_read_b64_tr_b16 v[170:171], v20 offset:33792
  v_exp_f32 v78, v78
  v_add_f32 v44, v44, v77
  v_exp_f32 v79, v79
  v_mfma_f32_32x32x16_bf16 a[96:111], v[184:187], v[40:43], a[96:111]
  ds_read_b64_tr_b16 v[172:173], v21 offset:32768
  ds_read_b64_tr_b16 v[174:175], v21 offset:33792
  v_add_f32 v44, v44, v78
  v_cvt_pk_bf16_f32 v34, v76, v77
  v_add_f32 v44, v44, v79
  v_cvt_pk_bf16_f32 v35, v78, v79
  s_waitcnt lgkmcnt(8)
  v_mfma_f32_32x32x16_bf16 a[112:127], v[188:191], v[40:43], a[112:127]
  s_cbranch_vccnz L_slowB4
L_slowB4_back:
  v_mfma_f32_32x32x16_bf16 v[64:79], v[128:131], v[192:195], v[96:111]
  ds_read_b64_tr_b16 v[176:177], v18 offset:36864
  ds_read_b64_tr_b16 v[178:179], v18 offset:37888
  v_exp_f32 v80, v80
  v_exp_f32 v81, v81
  v_mfma_f32_32x32x16_bf16 v[64:79], v[132:135], v[196:199], v[64:79]
  ds_read_b64_tr_b16 v[180:181], v19 offset:36864
  ds_read_b64_tr_b16 v[182:183], v19 offset:37888
  v_add_f32 v45, v45, v80
  v_exp_f32 v82, v82
  v_add_f32 v45, v45, v81
  v_mfma_f32_32x32x16_bf16 v[64:79], v[136:139], v[200:203], v[64:79]
  ds_read_b64_tr_b16 v[184:185], v20 offset:36864
  ds_read_b64_tr_b16 v[186:187], v20 offset:37888
  v_exp_f32 v83, v83
  v_add_f32 v45, v45, v82
  v_mfma_f32_32x32x16_bf16 v[64:79], v[140:143], v[204:207], v[64:79]
  ds_read_b64_tr_b16 v[188:189], v21 offset:36864
  ds_read_b64_tr_b16 v[190:191], v21 offset:37888
  v_cvt_pk_bf16_f32 v36, v80, v81
  v_exp_f32 v84, v84
  v_add_f32 v45, v45, v83
  v_mfma_f32_32x32x16_bf16 v[64:79], v[144:147], v[208:211], v[64:79]
  v_exp_f32 v85, v85
  v_add_f32 v45, v45, v84
  v_cvt_pk_bf16_f32 v37, v82, v83
  v_exp_f32 v86, v86
  s_add_u32 m0, s25, 65536
  v_mfma_f32_32x32x16_bf16 v[64:79], v[148:151], v[212:215], v[64:79]
  buffer_load_dwordx4 v62, s[32:35], s42 offen lds
  v_mfma_f32_32x32x16_bf16 v[64:79], v[152:155], v[216:219], v[64:79]
  buffer_load_dwordx4 v62, s[32:35], s42 offen offset:1024 lds
  s_add_u32 s42, s42, 16384
  v_mfma_f32_32x32x16_bf16 v[64:79], v[156:159], v[220:223], v[64:79]
  v_add_f32 v45, v45, v85
  v_exp_f32 v87, v87
  v_add_f32 v45, v45, v86
  s_waitcnt lgkmcnt(0)
  v_mfma_f32_32x32x16_bf16 a[0:15], v[160:163], v[28:31], a[0:15]
  v_cvt_pk_bf16_f32 v38, v84, v85
  v_add_f32 v45, v45, v87
  v_cvt_pk_bf16_f32 v39, v86, v87
  v_exp_f32 v88, v88
  v_mfma_f32_32x32x16_bf16 a[16:31], v[164:167], v[28:31], a[16:31]
  v_exp_f32 v89, v89
  v_add_f32 v45, v45, v88
  v_exp_f32 v90, v90
  v_add_f32 v45, v45, v89
  v_mfma_f32_32x32x16_bf16 a[32:47], v[168:171], v[28:31], a[32:47]
  v_max3_f32 v46, v64, v65, v66
  v_max3_f32 v46, v46, v67, v68
  v_max3_f32 v46, v46, v69, v70
  v_max3_f32 v46, v46, v71, v72
  v_max3_f32 v46, v46, v73, v74
  v_max3_f32 v46, v46, v75, v76
  v_mfma_f32_32x32x16_bf16 a[48:63], v[172:175], v[28:31], a[48:63]
  v_max3_f32 v46, v46, v77, v78
  v_max_f32 v46, v46, v79
  v_cmp_lt_f32 vcc, s46, v46
  v_exp_f32 v91, v91
  v_add_f32 v45, v45, v90
  v_mfma_f32_32x32x16_bf16 a[0:15], v[176:179], v[32:35], a[0:15]
  v_cvt_pk_bf16_f32 v40, v88, v89
  v_exp_f32 v92, v92
  v_add_f32 v45, v45, v91
  v_exp_f32 v93, v93
  v_mfma_f32_32x32x16_bf16 a[16:31], v[180:183], v[32:35], a[16:31]
  v_add_f32 v45, v45, v92
  v_cvt_pk_bf16_f32 v41, v90, v91
  v_exp_f32 v94, v94
  v_add_f32 v45, v45, v93
  v_mfma_f32_32x32x16_bf16 a[32:47], v[184:187], v[32:35], a[32:47]
  v_exp_f32 v95, v95
  v_add_f32 v45, v45, v94
  v_cvt_pk_bf16_f32 v42, v92, v93
  v_add_f32 v45, v45, v95
  v_cvt_pk_bf16_f32 v43, v94, v95
  v_mfma_f32_32x32x16_bf16 a[48:63], v[188:191], v[32:35], a[48:63]
  s_nop 0
  s_cbranch_vccnz L_slowA5
L_slowA5_back:
  v_mfma_f32_32x32x16_bf16 v[80:95], v[128:131], v[224:227], v[112:127]
  ds_read_b128 v[128:131], v10 offset:40960
  v_exp_f32 v64, v64
  v_exp_f32 v65, v65
  v_add_f32 v44, v44, v64
  v_mfma_f32_32x32x16_bf16 v[80:95], v[132:135], v[228:231], v[80:95]
  ds_read_b128 v[132:135], v11 offset:40960
  v_exp_f32 v66, v66
  v_add_f32 v44, v44, v65
  v_exp_f32 v67, v67
  v_add_f32 v44, v44, v66
  v_mfma_f32_32x32x16_bf16 v[80:95], v[136:139], v[232:235], v[80:95]
  ds_read_b128 v[136:139], v12 offset:40960
  v_cvt_pk_bf16_f32 v28, v64, v65
  v_exp_f32 v68, v68
  v_add_f32 v44, v44, v67
  v_exp_f32 v69, v69
  v_mfma_f32_32x32x16_bf16 v[80:95], v[140:143], v[236:239], v[80:95]
  ds_read_b128 v[140:143], v13 offset:40960
  v_add_f32 v44, v44, v68
  v_cvt_pk_bf16_f32 v29, v66, v67
  v_exp_f32 v70, v70
  v_add_f32 v44, v44, v69
  v_mfma_f32_32x32x16_bf16 v[80:95], v[144:147], v[240:243], v[80:95]
  ds_read_b128 v[144:147], v14 offset:40960
  v_exp_f32 v71, v71
  v_add_f32 v44, v44, v70
  v_cvt_pk_bf16_f32 v30, v68, v69
  v_add_f32 v44, v44, v71
  v_mfma_f32_32x32x16_bf16 v[80:95], v[148:151], v[244:247], v[80:95]
  ds_read_b128 v[148:151], v15 offset:40960
  v_cvt_pk_bf16_f32 v31, v70, v71
  v_exp_f32 v72, v72
  v_exp_f32 v73, v73
  v_add_f32 v44, v44, v72
  v_mfma_f32_32x32x16_bf16 v[80:95], v[152:155], v[248:251], v[80:95]
  ds_read_b128 v[152:155], v16 offset:40960
  v_exp_f32 v74, v74
  v_add_f32 v44, v44, v73
  v_exp_f32 v75, v75
  v_mfma_f32_32x32x16_bf16 v[80:95], v[156:159], v[252:255], v[80:95]
  ds_read_b128 v[156:159], v17 offset:40960
  v_add_f32 v44, v44, v74
  v_cvt_pk_bf16_f32 v32, v72, v73
  v_exp_f32 v76, v76
  s_add_u32 m0, s25, 8192
  v_mfma_f32_32x32x16_bf16 a[64:79], v[160:163], v[36:39], a[64:79]
  buffer_load_dwordx4 v60, s[28:31], s41 offen lds
  v_mfma_f32_32x32x16_bf16 a[80:95], v[164:167], v[36:39], a[80:95]
  buffer_load_dwordx4 v61, s[28:31], s41 offen offset:1024 lds
  s_add_u32 s41, s41, 16384
  v_mfma_f32_32x32x16_bf16 a[96:111], v[168:171], v[36:39], a[96:111]
  v_add_f32 v44, v44, v75
  v_exp_f32 v77, v77
  v_add_f32 v44, v44, v76
  v_cvt_pk_bf16_f32 v33, v74, v75
  v_exp_f32 v78, v78
  v_mfma_f32_32x32x16_bf16 a[112:127], v[172:175], v[36:39], a[112:127]
  ds_read_b64_tr_b16 v[160:161], v18 offset:40960
  ds_read_b64_tr_b16 v[162:163], v18 offset:41984
  v_max3_f32 v46, v80, v81, v82
  v_max3_f32 v46, v46, v83, v84
  v_max3_f32 v46, v46, v85, v86
  v_max3_f32 v46, v46, v87, v88
  v_mfma_f32_32x32x16_bf16 a[64:79], v[176:179], v[40:43], a[64:79]
  ds_read_b64_tr_b16 v[164:165], v19 offset:40960
  ds_read_b64_tr_b16 v[166:167], v19 offset:41984
  v_max3_f32 v46, v46, v89, v90
  v_max3_f32 v46, v46, v91, v92
  v_max3_f32 v46, v46, v93, v94
  v_max_f32 v46, v46, v95
  v_mfma_f32_32x32x16_bf16 a[80:95], v[180:183], v[40:43], a[80:95]
  ds_read_b64_tr_b16 v[168:169], v20 offset:40960
  ds_read_b64_tr_b16 v[170:171], v20 offset:41984
  v_cmp_lt_f32 vcc, s46, v46
  v_add_f32 v44, v44, v77
  v_exp_f32 v79, v79
  v_add_f32 v44, v44, v78
  v_mfma_f32_32x32x16_bf16 a[96:111], v[184:187], v[40:43], a[96:111]
  ds_read_b64_tr_b16 v[172:173], v21 offset:40960
  ds_read_b64_tr_b16 v[174:175], v21 offset:41984
  v_cvt_pk_bf16_f32 v34, v76, v77
  v_add_f32 v44, v44, v79
  v_cvt_pk_bf16_f32 v35, v78, v79
  s_waitcnt lgkmcnt(8)
  v_mfma_f32_32x32x16_bf16 a[112:127], v[188:191], v[40:43], a[112:127]
  s_cbranch_vccnz L_slowB5
L_slowB5_back:
  v_mfma_f32_32x32x16_bf16 v[64:79], v[128:131], v[192:195], v[96:111]
  ds_read_b64_tr_b16 v[176:177], v18 offset:45056
  ds_read_b64_tr_b16 v[178:179], v18 offset:46080
  v_exp_f32 v80, v80
  v_exp_f32 v81, v81
  v_mfma_f32_32x32x16_bf16 v[64:79], v[132:135], v[196:199], v[64:79]
  ds_read_b64_tr_b16 v[180:181], v19 offset:45056
  ds_read_b64_tr_b16 v[182:183], v19 offset:46080
  v_add_f32 v45, v45, v80
  v_exp_f32 v82, v82
  v_add_f32 v45, v45, v81
  v_mfma_f32_32x32x16_bf16 v[64:79], v[136:139], v[200:203], v[64:79]
  ds_read_b64_tr_b16 v[184:185], v20 offset:45056
  ds_read_b64_tr_b16 v[186:187], v20 offset:46080
  v_exp_f32 v83, v83
  v_add_f32 v45, v45, v82
  v_mfma_f32_32x32x16_bf16 v[64:79], v[140:143], v[204:207], v[64:79]
  ds_read_b64_tr_b16 v[188:189], v21 offset:45056
  ds_read_b64_tr_b16 v[190:191], v21 offset:46080
  v_cvt_pk_bf16_f32 v36, v80, v81
  v_exp_f32 v84, v84
  v_add_f32 v45, v45, v83
  v_mfma_f32_32x32x16_bf16 v[64:79], v[144:147], v[208:211], v[64:79]
  v_exp_f32 v85, v85
  v_add_f32 v45, v45, v84
  v_cvt_pk_bf16_f32 v37, v82, v83
  v_exp_f32 v86, v86
  s_add_u32 m0, s25, 73728
  v_mfma_f32_32x32x16_bf16 v[64:79], v[148:151], v[212:215], v[64:79]
  buffer_load_dwordx4 v62, s[32:35], s43 offen lds
  v_mfma_f32_32x32x16_bf16 v[64:79], v[152:155], v[216:219], v[64:79]
  buffer_load_dwordx4 v62, s[32:35], s43 offen offset:1024 lds
  s_add_u32 s43, s43, 16384
  v_mfma_f32_32x32x16_bf16 v[64:79], v[156:159], v[220:223], v[64:79]
  v_add_f32 v45, v45, v85
  v_exp_f32 v87, v87
  v_add_f32 v45, v45, v86
  s_waitcnt lgkmcnt(0)
  v_mfma_f32_32x32x16_bf16 a[0:15], v[160:163], v[28:31], a[0:15]
  v_cvt_pk_bf16_f32 v38, v84, v85
  v_add_f32 v45, v45, v87
  v_cvt_pk_bf16_f32 v39, v86, v87
  v_exp_f32 v88, v88
  v_mfma_f32_32x32x16_bf16 a[16:31], v[164:167], v[28:31], a[16:31]
  v_exp_f32 v89, v89
  v_add_f32 v45, v45, v88
  v_exp_f32 v90, v90
  v_add_f32 v45, v45, v89
  v_mfma_f32_32x32x16_bf16 a[32:47], v[168:171], v[28:31], a[32:47]
  v_max3_f32 v46, v64, v65, v66
  v_max3_f32 v46, v46, v67, v68
  v_max3_f32 v46, v46, v69, v70
  v_max3_f32 v46, v46, v71, v72
  v_max3_f32 v46, v46, v73, v74
  v_max3_f32 v46, v46, v75, v76
  v_mfma_f32_32x32x16_bf16 a[48:63], v[172:175], v[28:31], a[48:63]
  v_max3_f32 v46, v46, v77, v78
  v_max_f32 v46, v46, v79
  v_cmp_lt_f32 vcc, s46, v46
  v_exp_f32 v91, v91
  v_add_f32 v45, v45, v90
  v_mfma_f32_32x32x16_bf16 a[0:15], v[176:179], v[32:35], a[0:15]
  v_cvt_pk_bf16_f32 v40, v88, v89
  v_exp_f32 v92, v92
  v_add_f32 v45, v45, v91
  v_exp_f32 v93, v93
  v_mfma_f32_32x32x16_bf16 a[16:31], v[180:183], v[32:35], a[16:31]
  v_add_f32 v45, v45, v92
  v_cvt_pk_bf16_f32 v41, v90, v91
  v_exp_f32 v94, v94
  v_add_f32 v45, v45, v93
  v_mfma_f32_32x32x16_bf16 a[32:47], v[184:187], v[32:35], a[32:47]
  v_exp_f32 v95, v95
  v_add_f32 v45, v45, v94
  v_cvt_pk_bf16_f32 v42, v92, v93
  v_add_f32 v45, v45, v95
  v_cvt_pk_bf16_f32 v43, v94, v95
  v_mfma_f32_32x32x16_bf16 a[48:63], v[188:191], v[32:35], a[48:63]
  s_waitcnt vmcnt(9)
  s_nop 0
  s_cbranch_vccnz L_slowA6
L_slowA6_back:
  s_barrier
  v_mfma_f32_32x32x16_bf16 v[80:95], v[128:131], v[224:227], v[112:127]
  ds_read_b128 v[128:131], v10 offset:49152
  v_exp_f32 v64, v64
  v_exp_f32 v65, v65
  v_add_f32 v44, v44, v64
  v_exp_f32 v66, v66
  v_mfma_f32_32x32x16_bf16 v[80:95], v[132:135], v[228:231], v[80:95]
  ds_read_b128 v[132:135], v11 offset:49152
  v_add_f32 v44, v44, v65
  v_exp_f32 v67, v67
  v_add_f32 v44, v44, v66
  v_cvt_pk_bf16_f32 v28, v64, v65
  v_mfma_f32_32x32x16_bf16 v[80:95], v[136:139], v[232:235], v[80:95]
  ds_read_b128 v[136:139], v12 offset:49152
  v_exp_f32 v68, v68
  v_add_f32 v44, v44, v67
  v_exp_f32 v69, v69
  v_add_f32 v44, v44, v68
  v_mfma_f32_32x32x16_bf16 v[80:95], v[140:143], v[236:239], v[80:95]
  ds_read_b128 v[140:143], v13 offset:49152
  v_cvt_pk_bf16_f32 v29, v66, v67
  v_exp_f32 v70, v70
  v_add_f32 v44, v44, v69
  v_exp_f32 v71, v71
  v_mfma_f32_32x32x16_bf16 v[80:95], v[144:147], v[240:243], v[80:95]
  ds_read_b128 v[144:147], v14 offset:49152
  v_add_f32 v44, v44, v70
  v_cvt_pk_bf16_f32 v30, v68, v69
  v_add_f32 v44, v44, v71
  v_cvt_pk_bf16_f32 v31, v70, v71
  v_exp_f32 v72, v72
  v_mfma_f32_32x32x16_bf16 v[80:95], v[148:151], v[244:247], v[80:95]
  ds_read_b128 v[148:151], v15 offset:49152
  v_exp_f32 v73, v73
  v_add_f32 v44, v44, v72
  v_exp_f32 v74, v74
  v_add_f32 v44, v44, v73
  v_mfma_f32_32x32x16_bf16 v[80:95], v[152:155], v[248:251], v[80:95]
  ds_read_b128 v[152:155], v16 offset:49152
  v_exp_f32 v75, v75
  v_add_f32 v44, v44, v74
  v_cvt_pk_bf16_f32 v32, v72, v73
  v_exp_f32 v76, v76
  v_mfma_f32_32x32x16_bf16 v[80:95], v[156:159], v[252:255], v[80:95]
  ds_read_b128 v[156:159], v17 offset:49152
  v_add_f32 v44, v44, v75
  v_exp_f32 v77, v77
  v_add_f32 v44, v44, v76
  v_cvt_pk_bf16_f32 v33, v74, v75
  s_add_u32 m0, s25, 16384
  v_mfma_f32_32x32x16_bf16 a[64:79], v[160:163], v[36:39], a[64:79]
  buffer_load_dwordx4 v60, s[28:31], s40 offen lds
  v_mfma_f32_32x32x16_bf16 a[80:95], v[164:167], v[36:39], a[80:95]
  buffer_load_dwordx4 v61, s[28:31], s40 offen offset:1024 lds
  s_add_u32 s40, s40, 16384
  v_mfma_f32_32x32x16_bf16 a[96:111], v[168:171], v[36:39], a[96:111]
  buffer_load_dwordx4 v[52:55], v1, s[96:99], s49 offen
  v_mfma_f32_32x32x16_bf16 a[112:127], v[172:175], v[36:39], a[112:127]
  ds_read_b64_tr_b16 v[160:161], v18 offset:49152
  ds_read_b64_tr_b16 v[162:163], v18 offset:50176
  v_max3_f32 v46, v80, v81, v82
  v_max3_f32 v46, v46, v83, v84
  v_max3_f32 v46, v46, v85, v86
  v_max3_f32 v46, v46, v87, v88
  v_max3_f32 v46, v46, v89, v90
  v_mfma_f32_32x32x16_bf16 a[64:79], v[176:179], v[40:43], a[64:79]
  ds_read_b64_tr_b16 v[164:165], v19 offset:49152
  ds_read_b64_tr_b16 v[166:167], v19 offset:50176
  v_max3_f32 v46, v46, v91, v92
  v_max3_f32 v46, v46, v93, v94
  v_max_f32 v46, v46, v95
  v_cmp_lt_f32 vcc, s46, v46
  v_mfma_f32_32x32x16_bf16 a[80:95], v[180:183], v[40:43], a[80:95]
  ds_read_b64_tr_b16 v[168:169], v20 offset:49152
  ds_read_b64_tr_b16 v[170:171], v20 offset:50176
  v_exp_f32 v78, v78
  v_add_f32 v44, v44, v77
  v_exp_f32 v79, v79
  v_mfma_f32_32x32x16_bf16 a[96:111], v[184:187], v[40:43], a[96:111]
  ds_read_b64_tr_b16 v[172:173], v21 offset:49152
  ds_read_b64_tr_b16 v[174:175], v21 offset:50176
  v_add_f32 v44, v44, v78
  v_cvt_pk_bf16_f32 v34, v76, v77
  v_add_f32 v44, v44, v79
  v_cvt_pk_bf16_f32 v35, v78, v79
  s_waitcnt lgkmcnt(8)
  v_mfma_f32_32x32x16_bf16 a[112:127], v[188:191], v[40:43], a[112:127]
  s_cbranch_vccnz L_slowB6
L_slowB6_back:
  v_mfma_f32_32x32x16_bf16 v[64:79], v[128:131], v[192:195], v[96:111]
  ds_read_b64_tr_b16 v[176:177], v18 offset:53248
  ds_read_b64_tr_b16 v[178:179], v18 offset:54272
  v_exp_f32 v80, v80
  v_exp_f32 v81, v81
  v_mfma_f32_32x32x16_bf16 v[64:79], v[132:135], v[196:199], v[64:79]
  ds_read_b64_tr_b16 v[180:181], v19 offset:53248
  ds_read_b64_tr_b16 v[182:183], v19 offset:54272
  v_add_f32 v45, v45, v80
  v_exp_f32 v82, v82
  v_add_f32 v45, v45, v81
  v_mfma_f32_32x32x16_bf16 v[64:79], v[136:139], v[200:203], v[64:79]
  ds_read_b64_tr_b16 v[184:185], v20 offset:53248
  ds_read_b64_tr_b16 v[186:187], v20 offset:54272
  v_exp_f32 v83, v83
  v_add_f32 v45, v45, v82
  v_mfma_f32_32x32x16_bf16 v[64:79], v[140:143], v[204:207], v[64:79]
  ds_read_b64_tr_b16 v[188:189], v21 offset:53248
  ds_read_b64_tr_b16 v[190:191], v21 offset:54272
  v_cvt_pk_bf16_f32 v36, v80, v81
  v_exp_f32 v84, v84
  v_add_f32 v45, v45, v83
  v_mfma_f32_32x32x16_bf16 v[64:79], v[144:147], v[208:211], v[64:79]
  v_exp_f32 v85, v85
  v_add_f32 v45, v45, v84
  v_cvt_pk_bf16_f32 v37, v82, v83
  v_exp_f32 v86, v86
  s_add_u32 m0, s25, 81920
  v_mfma_f32_32x32x16_bf16 v[64:79], v[148:151], v[212:215], v[64:79]
  buffer_load_dwordx4 v62, s[32:35], s42 offen lds
  v_mfma_f32_32x32x16_bf16 v[64:79], v[152:155], v[216:219], v[64:79]
  buffer_load_dwordx4 v62, s[32:35], s42 offen offset:1024 lds
  s_add_u32 s42, s42, 16384
  v_mfma_f32_32x32x16_bf16 v[64:79], v[156:159], v[220:223], v[64:79]
  v_add_f32 v45, v45, v85
  v_exp_f32 v87, v87
  v_add_f32 v45, v45, v86
  s_waitcnt lgkmcnt(0)
  v_mfma_f32_32x32x16_bf16 a[0:15], v[160:163], v[28:31], a[0:15]
  v_cvt_pk_bf16_f32 v38, v84, v85
  v_add_f32 v45, v45, v87
  v_cvt_pk_bf16_f32 v39, v86, v87
  v_exp_f32 v88, v88
  v_mfma_f32_32x32x16_bf16 a[16:31], v[164:167], v[28:31], a[16:31]
  v_exp_f32 v89, v89
  v_add_f32 v45, v45, v88
  v_exp_f32 v90, v90
  v_add_f32 v45, v45, v89
  v_mfma_f32_32x32x16_bf16 a[32:47], v[168:171], v[28:31], a[32:47]
  v_max3_f32 v46, v64, v65, v66
  v_max3_f32 v46, v46, v67, v68
  v_max3_f32 v46, v46, v69, v70
  v_max3_f32 v46, v46, v71, v72
  v_max3_f32 v46, v46, v73, v74
  v_max3_f32 v46, v46, v75, v76
  v_mfma_f32_32x32x16_bf16 a[48:63], v[172:175], v[28:31], a[48:63]
  v_max3_f32 v46, v46, v77, v78
  v_max_f32 v46, v46, v79
  v_cmp_lt_f32 vcc, s47, v46
  v_exp_f32 v91, v91
  v_add_f32 v45, v45, v90
  v_mfma_f32_32x32x16_bf16 a[0:15], v[176:179], v[32:35], a[0:15]
  v_cvt_pk_bf16_f32 v40, v88, v89
  v_exp_f32 v92, v92
  v_add_f32 v45, v45, v91
  v_exp_f32 v93, v93
  v_mfma_f32_32x32x16_bf16 a[16:31], v[180:183], v[32:35], a[16:31]
  v_add_f32 v45, v45, v92
  v_cvt_pk_bf16_f32 v41, v90, v91
  v_exp_f32 v94, v94
  v_add_f32 v45, v45, v93
  v_mfma_f32_32x32x16_bf16 a[32:47], v[184:187], v[32:35], a[32:47]
  v_exp_f32 v95, v95
  v_add_f32 v45, v45, v94
  v_cvt_pk_bf16_f32 v42, v92, v93
  v_add_f32 v45, v45, v95
  v_cvt_pk_bf16_f32 v43, v94, v95
  v_mfma_f32_32x32x16_bf16 a[48:63], v[188:191], v[32:35], a[48:63]
  v_mov_b32 v48, v44
  s_cbranch_vccnz L_slowA7
L_slowA7_back:
  v_mfma_f32_32x32x16_bf16 v[80:95], v[128:131], v[224:227], v[112:127]
  ds_read_b128 v[128:131], v10 offset:57344
  v_exp_f32 v64, v64
  v_exp_f32 v65, v65
  v_add_f32 v44, v44, v64
  v_mfma_f32_32x32x16_bf16 v[80:95], v[132:135], v[228:231], v[80:95]
  ds_read_b128 v[132:135], v11 offset:57344
  v_exp_f32 v66, v66
  v_add_f32 v44, v44, v65
  v_exp_f32 v67, v67
  v_add_f32 v44, v44, v66
  v_mfma_f32_32x32x16_bf16 v[80:95], v[136:139], v[232:235], v[80:95]
  ds_read_b128 v[136:139], v12 offset:57344
  v_cvt_pk_bf16_f32 v28, v64, v65
  v_exp_f32 v68, v68
  v_add_f32 v44, v44, v67
  v_exp_f32 v69, v69
  v_mfma_f32_32x32x16_bf16 v[80:95], v[140:143], v[236:239], v[80:95]
  ds_read_b128 v[140:143], v13 offset:57344
  v_add_f32 v44, v44, v68
  v_cvt_pk_bf16_f32 v29, v66, v67
  v_exp_f32 v70, v70
  v_add_f32 v44, v44, v69
  v_mfma_f32_32x32x16_bf16 v[80:95], v[144:147], v[240:243], v[80:95]
  ds_read_b128 v[144:147], v14 offset:57344
  v_exp_f32 v71, v71
  v_add_f32 v44, v44, v70
  v_cvt_pk_bf16_f32 v30, v68, v69
  v_add_f32 v44, v44, v71
  v_mfma_f32_32x32x16_bf16 v[80:95], v[148:151], v[244:247], v[80:95]
  ds_read_b128 v[148:151], v15 offset:57344
  v_cvt_pk_bf16_f32 v31, v70, v71
  v_exp_f32 v72, v72
  v_exp_f32 v73, v73
  v_add_f32 v44, v44, v72
  v_mfma_f32_32x32x16_bf16 v[80:95], v[152:155], v[248:251], v[80:95]
  ds_read_b128 v[152:155], v16 offset:57344
  v_exp_f32 v74, v74
  v_add_f32 v44, v44, v73
  v_exp_f32 v75, v75
  v_mfma_f32_32x32x16_bf16 v[80:95], v[156:159], v[252:255], v[80:95]
  ds_read_b128 v[156:159], v17 offset:57344
  v_add_f32 v44, v44, v74
  v_cvt_pk_bf16_f32 v32, v72, v73
  v_exp_f32 v76, v76
  s_add_u32 m0, s25, 24576
  v_mfma_f32_32x32x16_bf16 a[64:79], v[160:163], v[36:39], a[64:79]
  buffer_load_dwordx4 v60, s[28:31], s41 offen lds
  v_mfma_f32_32x32x16_bf16 a[80:95], v[164:167], v[36:39], a[80:95]
  buffer_load_dwordx4 v61, s[28:31], s41 offen offset:1024 lds
  s_add_u32 s41, s41, 16384
  v_mfma_f32_32x32x16_bf16 a[96:111], v[168:171], v[36:39], a[96:111]
  v_add_f32 v44, v44, v75
  v_exp_f32 v77, v77
  v_add_f32 v44, v44, v76
  v_cvt_pk_bf16_f32 v33, v74, v75
  v_exp_f32 v78, v78
  v_mfma_f32_32x32x16_bf16 a[112:127], v[172:175], v[36:39], a[112:127]
  ds_read_b64_tr_b16 v[160:161], v18 offset:57344
  ds_read_b64_tr_b16 v[162:163], v18 offset:58368
  v_max3_f32 v46, v80, v81, v82
  v_max3_f32 v46, v46, v83, v84
  v_max3_f32 v46, v46, v85, v86
  v_max3_f32 v46, v46, v87, v88
  v_mfma_f32_32x32x16_bf16 a[64:79], v[176:179], v[40:43], a[64:79]
  ds_read_b64_tr_b16 v[164:165], v19 offset:57344
  ds_read_b64_tr_b16 v[166:167], v19 offset:58368
  v_max3_f32 v46, v46, v89, v90
  v_max3_f32 v46, v46, v91, v92
  v_max3_f32 v46, v46, v93, v94
  v_max_f32 v46, v46, v95
  v_mfma_f32_32x32x16_bf16 a[80:95], v[180:183], v[40:43], a[80:95]
  ds_read_b64_tr_b16 v[168:169], v20 offset:57344
  ds_read_b64_tr_b16 v[170:171], v20 offset:58368
  v_cmp_lt_f32 vcc, s47, v46
  v_add_f32 v44, v44, v77
  v_exp_f32 v79, v79
  v_add_f32 v44, v44, v78
  v_mfma_f32_32x32x16_bf16 a[96:111], v[184:187], v[40:43], a[96:111]
  ds_read_b64_tr_b16 v[172:173], v21 offset:57344
  ds_read_b64_tr_b16 v[174:175], v21 offset:58368
  v_cvt_pk_bf16_f32 v34, v76, v77
  v_add_f32 v44, v44, v79
  v_cvt_pk_bf16_f32 v35, v78, v79
  s_waitcnt lgkmcnt(8)
  v_mfma_f32_32x32x16_bf16 a[112:127], v[188:191], v[40:43], a[112:127]
  s_cbranch_vccnz L_slowB7
L_slowB7_back:
  s_add_u32 s48, s48, 1
  s_add_u32 s49, s49, 1024
  s_add_u32 s51, s51, 1024
  s_cmp_ge_u32 s48, 6
  s_cselect_b32 s49, 0x7fff0000, s49
  s_cmp_ge_u32 s48, 5
  s_cselect_b32 s51, 0x7fff0000, s51
  s_cmp_lt_u32 s48, 8
  s_cbranch_scc1 L_attn_loop
  s_waitcnt vmcnt(0)
  s_nop 15
  s_lshl_b32 s23, s20, 18
  s_lshl_b32 s26, s17, 14
  s_add_u32 s23, s23, s26
  v_mov_b32 v2, v48
  v_mov_b32 v3, v48
  s_nop 1
  v_permlane32_swap_b32 v2, v3
  v_add_f32 v2, v2, v3
  v_rcp_f32 v2, v2
  v_accvgpr_read_b32 v64, a0
  v_accvgpr_read_b32 v65, a1
  v_accvgpr_read_b32 v66, a2
  v_accvgpr_read_b32 v67, a3
  v_accvgpr_read_b32 v68, a4
  v_accvgpr_read_b32 v69, a5
  v_accvgpr_read_b32 v70, a6
  v_accvgpr_read_b32 v71, a7
  v_pk_mul_f32 v[64:65], v[64:65], v[2:3] op_sel_hi:[1,0]
  v_pk_mul_f32 v[66:67], v[66:67], v[2:3] op_sel_hi:[1,0]
  v_pk_mul_f32 v[68:69], v[68:69], v[2:3] op_sel_hi:[1,0]
  v_pk_mul_f32 v[70:71], v[70:71], v[2:3] op_sel_hi:[1,0]
  v_cvt_pk_bf16_f32 v80, v64, v65
  v_cvt_pk_bf16_f32 v81, v66, v67
  v_cvt_pk_bf16_f32 v82, v68, v69
  v_cvt_pk_bf16_f32 v83, v70, v71
  buffer_store_dwordx4 v[80:83], v1, s[12:15], s23 offen offset:0 sc0 sc1
  v_accvgpr_read_b32 v72, a8
  v_accvgpr_read_b32 v73, a9
  v_accvgpr_read_b32 v74, a10
  v_accvgpr_read_b32 v75, a11
  v_accvgpr_read_b32 v76, a12
  v_accvgpr_read_b32 v77, a13
  v_accvgpr_read_b32 v78, a14
  v_accvgpr_read_b32 v79, a15
  v_pk_mul_f32 v[72:73], v[72:73], v[2:3] op_sel_hi:[1,0]
  v_pk_mul_f32 v[74:75], v[74:75], v[2:3] op_sel_hi:[1,0]
  v_pk_mul_f32 v[76:77], v[76:77], v[2:3] op_sel_hi:[1,0]
  v_pk_mul_f32 v[78:79], v[78:79], v[2:3] op_sel_hi:[1,0]
  v_cvt_pk_bf16_f32 v84, v72, v73
  v_cvt_pk_bf16_f32 v85, v74, v75
  v_cvt_pk_bf16_f32 v86, v76, v77
  v_cvt_pk_bf16_f32 v87, v78, v79
  buffer_store_dwordx4 v[84:87], v1, s[12:15], s23 offen offset:1024 sc0 sc1
  v_accvgpr_read_b32 v64, a16
  v_accvgpr_read_b32 v65, a17
  v_accvgpr_read_b32 v66, a18
  v_accvgpr_read_b32 v67, a19
  v_accvgpr_read_b32 v68, a20
  v_accvgpr_read_b32 v69, a21
  v_accvgpr_read_b32 v70, a22
  v_accvgpr_read_b32 v71, a23
  v_pk_mul_f32 v[64:65], v[64:65], v[2:3] op_sel_hi:[1,0]
  v_pk_mul_f32 v[66:67], v[66:67], v[2:3] op_sel_hi:[1,0]
  v_pk_mul_f32 v[68:69], v[68:69], v[2:3] op_sel_hi:[1,0]
  v_pk_mul_f32 v[70:71], v[70:71], v[2:3] op_sel_hi:[1,0]
  v_cvt_pk_bf16_f32 v88, v64, v65
  v_cvt_pk_bf16_f32 v89, v66, v67
  v_cvt_pk_bf16_f32 v90, v68, v69
  v_cvt_pk_bf16_f32 v91, v70, v71
  buffer_store_dwordx4 v[88:91], v1, s[12:15], s23 offen offset:2048 sc0 sc1
  v_accvgpr_read_b32 v72, a24
  v_accvgpr_read_b32 v73, a25
  v_accvgpr_read_b32 v74, a26
  v_accvgpr_read_b32 v75, a27
  v_accvgpr_read_b32 v76, a28
  v_accvgpr_read_b32 v77, a29
  v_accvgpr_read_b32 v78, a30
  v_accvgpr_read_b32 v79, a31
  v_pk_mul_f32 v[72:73], v[72:73], v[2:3] op_sel_hi:[1,0]
  v_pk_mul_f32 v[74:75], v[74:75], v[2:3] op_sel_hi:[1,0]
  v_pk_mul_f32 v[76:77], v[76:77], v[2:3] op_sel_hi:[1,0]
  v_pk_mul_f32 v[78:79], v[78:79], v[2:3] op_sel_hi:[1,0]
  v_cvt_pk_bf16_f32 v92, v72, v73
  v_cvt_pk_bf16_f32 v93, v74, v75
  v_cvt_pk_bf16_f32 v94, v76, v77
  v_cvt_pk_bf16_f32 v95, v78, v79
  buffer_store_dwordx4 v[92:95], v1, s[12:15], s23 offen offset:3072 sc0 sc1
  s_add_u32 s23, s23, 4096
  v_accvgpr_read_b32 v64, a32
  v_accvgpr_read_b32 v65, a33
  v_accvgpr_read_b32 v66, a34
  v_accvgpr_read_b32 v67, a35
  v_accvgpr_read_b32 v68, a36
  v_accvgpr_read_b32 v69, a37
  v_accvgpr_read_b32 v70, a38
  v_accvgpr_read_b32 v71, a39
  v_pk_mul_f32 v[64:65], v[64:65], v[2:3] op_sel_hi:[1,0]
  v_pk_mul_f32 v[66:67], v[66:67], v[2:3] op_sel_hi:[1,0]
  v_pk_mul_f32 v[68:69], v[68:69], v[2:3] op_sel_hi:[1,0]
  v_pk_mul_f32 v[70:71], v[70:71], v[2:3] op_sel_hi:[1,0]
  v_cvt_pk_bf16_f32 v80, v64, v65
  v_cvt_pk_bf16_f32 v81, v66, v67
  v_cvt_pk_bf16_f32 v82, v68, v69
  v_cvt_pk_bf16_f32 v83, v70, v71
  buffer_store_dwordx4 v[80:83], v1, s[12:15], s23 offen offset:0 sc0 sc1
  v_accvgpr_read_b32 v72, a40
  v_accvgpr_read_b32 v73, a41
  v_accvgpr_read_b32 v74, a42
  v_accvgpr_read_b32 v75, a43
  v_accvgpr_read_b32 v76, a44
  v_accvgpr_read_b32 v77, a45
  v_accvgpr_read_b32 v78, a46
  v_accvgpr_read_b32 v79, a47
  v_pk_mul_f32 v[72:73], v[72:73], v[2:3] op_sel_hi:[1,0]
  v_pk_mul_f32 v[74:75], v[74:75], v[2:3] op_sel_hi:[1,0]
  v_pk_mul_f32 v[76:77], v[76:77], v[2:3] op_sel_hi:[1,0]
  v_pk_mul_f32 v[78:79], v[78:79], v[2:3] op_sel_hi:[1,0]
  v_cvt_pk_bf16_f32 v84, v72, v73
  v_cvt_pk_bf16_f32 v85, v74, v75
  v_cvt_pk_bf16_f32 v86, v76, v77
  v_cvt_pk_bf16_f32 v87, v78, v79
  buffer_store_dwordx4 v[84:87], v1, s[12:15], s23 offen offset:1024 sc0 sc1
  v_accvgpr_read_b32 v64, a48
  v_accvgpr_read_b32 v65, a49
  v_accvgpr_read_b32 v66, a50
  v_accvgpr_read_b32 v67, a51
  v_accvgpr_read_b32 v68, a52
  v_accvgpr_read_b32 v69, a53
  v_accvgpr_read_b32 v70, a54
  v_accvgpr_read_b32 v71, a55
  v_pk_mul_f32 v[64:65], v[64:65], v[2:3] op_sel_hi:[1,0]
  v_pk_mul_f32 v[66:67], v[66:67], v[2:3] op_sel_hi:[1,0]
  v_pk_mul_f32 v[68:69], v[68:69], v[2:3] op_sel_hi:[1,0]
  v_pk_mul_f32 v[70:71], v[70:71], v[2:3] op_sel_hi:[1,0]
  v_cvt_pk_bf16_f32 v88, v64, v65
  v_cvt_pk_bf16_f32 v89, v66, v67
  v_cvt_pk_bf16_f32 v90, v68, v69
  v_cvt_pk_bf16_f32 v91, v70, v71
  buffer_store_dwordx4 v[88:91], v1, s[12:15], s23 offen offset:2048 sc0 sc1
  v_accvgpr_read_b32 v72, a56
  v_accvgpr_read_b32 v73, a57
  v_accvgpr_read_b32 v74, a58
  v_accvgpr_read_b32 v75, a59
  v_accvgpr_read_b32 v76, a60
  v_accvgpr_read_b32 v77, a61
  v_accvgpr_read_b32 v78, a62
  v_accvgpr_read_b32 v79, a63
  v_pk_mul_f32 v[72:73], v[72:73], v[2:3] op_sel_hi:[1,0]
  v_pk_mul_f32 v[74:75], v[74:75], v[2:3] op_sel_hi:[1,0]
  v_pk_mul_f32 v[76:77], v[76:77], v[2:3] op_sel_hi:[1,0]
  v_pk_mul_f32 v[78:79], v[78:79], v[2:3] op_sel_hi:[1,0]
  v_cvt_pk_bf16_f32 v92, v72, v73
  v_cvt_pk_bf16_f32 v93, v74, v75
  v_cvt_pk_bf16_f32 v94, v76, v77
  v_cvt_pk_bf16_f32 v95, v78, v79
  buffer_store_dwordx4 v[92:95], v1, s[12:15], s23 offen offset:3072 sc0 sc1
  s_add_u32 s23, s23, 4096
  v_mov_b32 v2, v45
  v_mov_b32 v3, v45
  s_nop 1
  v_permlane32_swap_b32 v2, v3
  v_add_f32 v2, v2, v3
  v_rcp_f32 v2, v2
  v_accvgpr_read_b32 v64, a64
  v_accvgpr_read_b32 v65, a65
  v_accvgpr_read_b32 v66, a66
  v_accvgpr_read_b32 v67, a67
  v_accvgpr_read_b32 v68, a68
  v_accvgpr_read_b32 v69, a69
  v_accvgpr_read_b32 v70, a70
  v_accvgpr_read_b32 v71, a71
  v_pk_mul_f32 v[64:65], v[64:65], v[2:3] op_sel_hi:[1,0]
  v_pk_mul_f32 v[66:67], v[66:67], v[2:3] op_sel_hi:[1,0]
  v_pk_mul_f32 v[68:69], v[68:69], v[2:3] op_sel_hi:[1,0]
  v_pk_mul_f32 v[70:71], v[70:71], v[2:3] op_sel_hi:[1,0]
  v_cvt_pk_bf16_f32 v80, v64, v65
  v_cvt_pk_bf16_f32 v81, v66, v67
  v_cvt_pk_bf16_f32 v82, v68, v69
  v_cvt_pk_bf16_f32 v83, v70, v71
  buffer_store_dwordx4 v[80:83], v1, s[12:15], s23 offen offset:0 sc0 sc1
  v_accvgpr_read_b32 v72, a72
  v_accvgpr_read_b32 v73, a73
  v_accvgpr_read_b32 v74, a74
  v_accvgpr_read_b32 v75, a75
  v_accvgpr_read_b32 v76, a76
  v_accvgpr_read_b32 v77, a77
  v_accvgpr_read_b32 v78, a78
  v_accvgpr_read_b32 v79, a79
  v_pk_mul_f32 v[72:73], v[72:73], v[2:3] op_sel_hi:[1,0]
  v_pk_mul_f32 v[74:75], v[74:75], v[2:3] op_sel_hi:[1,0]
  v_pk_mul_f32 v[76:77], v[76:77], v[2:3] op_sel_hi:[1,0]
  v_pk_mul_f32 v[78:79], v[78:79], v[2:3] op_sel_hi:[1,0]
  v_cvt_pk_bf16_f32 v84, v72, v73
  v_cvt_pk_bf16_f32 v85, v74, v75
  v_cvt_pk_bf16_f32 v86, v76, v77
  v_cvt_pk_bf16_f32 v87, v78, v79
  buffer_store_dwordx4 v[84:87], v1, s[12:15], s23 offen offset:1024 sc0 sc1
  v_accvgpr_read_b32 v64, a80
  v_accvgpr_read_b32 v65, a81
  v_accvgpr_read_b32 v66, a82
  v_accvgpr_read_b32 v67, a83
  v_accvgpr_read_b32 v68, a84
  v_accvgpr_read_b32 v69, a85
  v_accvgpr_read_b32 v70, a86
  v_accvgpr_read_b32 v71, a87
  v_pk_mul_f32 v[64:65], v[64:65], v[2:3] op_sel_hi:[1,0]
  v_pk_mul_f32 v[66:67], v[66:67], v[2:3] op_sel_hi:[1,0]
  v_pk_mul_f32 v[68:69], v[68:69], v[2:3] op_sel_hi:[1,0]
  v_pk_mul_f32 v[70:71], v[70:71], v[2:3] op_sel_hi:[1,0]
  v_cvt_pk_bf16_f32 v88, v64, v65
  v_cvt_pk_bf16_f32 v89, v66, v67
  v_cvt_pk_bf16_f32 v90, v68, v69
  v_cvt_pk_bf16_f32 v91, v70, v71
  buffer_store_dwordx4 v[88:91], v1, s[12:15], s23 offen offset:2048 sc0 sc1
  v_accvgpr_read_b32 v72, a88
  v_accvgpr_read_b32 v73, a89
  v_accvgpr_read_b32 v74, a90
  v_accvgpr_read_b32 v75, a91
  v_accvgpr_read_b32 v76, a92
  v_accvgpr_read_b32 v77, a93
  v_accvgpr_read_b32 v78, a94
  v_accvgpr_read_b32 v79, a95
  v_pk_mul_f32 v[72:73], v[72:73], v[2:3] op_sel_hi:[1,0]
  v_pk_mul_f32 v[74:75], v[74:75], v[2:3] op_sel_hi:[1,0]
  v_pk_mul_f32 v[76:77], v[76:77], v[2:3] op_sel_hi:[1,0]
  v_pk_mul_f32 v[78:79], v[78:79], v[2:3] op_sel_hi:[1,0]
  v_cvt_pk_bf16_f32 v92, v72, v73
  v_cvt_pk_bf16_f32 v93, v74, v75
  v_cvt_pk_bf16_f32 v94, v76, v77
  v_cvt_pk_bf16_f32 v95, v78, v79
  buffer_store_dwordx4 v[92:95], v1, s[12:15], s23 offen offset:3072 sc0 sc1
  s_add_u32 s23, s23, 4096
  v_accvgpr_read_b32 v64, a96
  v_accvgpr_read_b32 v65, a97
  v_accvgpr_read_b32 v66, a98
  v_accvgpr_read_b32 v67, a99
  v_accvgpr_read_b32 v68, a100
  v_accvgpr_read_b32 v69, a101
  v_accvgpr_read_b32 v70, a102
  v_accvgpr_read_b32 v71, a103
  v_pk_mul_f32 v[64:65], v[64:65], v[2:3] op_sel_hi:[1,0]
  v_pk_mul_f32 v[66:67], v[66:67], v[2:3] op_sel_hi:[1,0]
  v_pk_mul_f32 v[68:69], v[68:69], v[2:3] op_sel_hi:[1,0]
  v_pk_mul_f32 v[70:71], v[70:71], v[2:3] op_sel_hi:[1,0]
  v_cvt_pk_bf16_f32 v80, v64, v65
  v_cvt_pk_bf16_f32 v81, v66, v67
  v_cvt_pk_bf16_f32 v82, v68, v69
  v_cvt_pk_bf16_f32 v83, v70, v71
  buffer_store_dwordx4 v[80:83], v1, s[12:15], s23 offen offset:0 sc0 sc1
  v_accvgpr_read_b32 v72, a104
  v_accvgpr_read_b32 v73, a105
  v_accvgpr_read_b32 v74, a106
  v_accvgpr_read_b32 v75, a107
  v_accvgpr_read_b32 v76, a108
  v_accvgpr_read_b32 v77, a109
  v_accvgpr_read_b32 v78, a110
  v_accvgpr_read_b32 v79, a111
  v_pk_mul_f32 v[72:73], v[72:73], v[2:3] op_sel_hi:[1,0]
  v_pk_mul_f32 v[74:75], v[74:75], v[2:3] op_sel_hi:[1,0]
  v_pk_mul_f32 v[76:77], v[76:77], v[2:3] op_sel_hi:[1,0]
  v_pk_mul_f32 v[78:79], v[78:79], v[2:3] op_sel_hi:[1,0]
  v_cvt_pk_bf16_f32 v84, v72, v73
  v_cvt_pk_bf16_f32 v85, v74, v75
  v_cvt_pk_bf16_f32 v86, v76, v77
  v_cvt_pk_bf16_f32 v87, v78, v79
  buffer_store_dwordx4 v[84:87], v1, s[12:15], s23 offen offset:1024 sc0 sc1
  v_accvgpr_read_b32 v64, a112
  v_accvgpr_read_b32 v65, a113
  v_accvgpr_read_b32 v66, a114
  v_accvgpr_read_b32 v67, a115
  v_accvgpr_read_b32 v68, a116
  v_accvgpr_read_b32 v69, a117
  v_accvgpr_read_b32 v70, a118
  v_accvgpr_read_b32 v71, a119
  v_pk_mul_f32 v[64:65], v[64:65], v[2:3] op_sel_hi:[1,0]
  v_pk_mul_f32 v[66:67], v[66:67], v[2:3] op_sel_hi:[1,0]
  v_pk_mul_f32 v[68:69], v[68:69], v[2:3] op_sel_hi:[1,0]
  v_pk_mul_f32 v[70:71], v[70:71], v[2:3] op_sel_hi:[1,0]
  v_cvt_pk_bf16_f32 v88, v64, v65
  v_cvt_pk_bf16_f32 v89, v66, v67
  v_cvt_pk_bf16_f32 v90, v68, v69
  v_cvt_pk_bf16_f32 v91, v70, v71
  buffer_store_dwordx4 v[88:91], v1, s[12:15], s23 offen offset:2048 sc0 sc1
  v_accvgpr_read_b32 v72, a120
  v_accvgpr_read_b32 v73, a121
  v_accvgpr_read_b32 v74, a122
  v_accvgpr_read_b32 v75, a123
  v_accvgpr_read_b32 v76, a124
  v_accvgpr_read_b32 v77, a125
  v_accvgpr_read_b32 v78, a126
  v_accvgpr_read_b32 v79, a127
  v_pk_mul_f32 v[72:73], v[72:73], v[2:3] op_sel_hi:[1,0]
  v_pk_mul_f32 v[74:75], v[74:75], v[2:3] op_sel_hi:[1,0]
  v_pk_mul_f32 v[76:77], v[76:77], v[2:3] op_sel_hi:[1,0]
  v_pk_mul_f32 v[78:79], v[78:79], v[2:3] op_sel_hi:[1,0]
  v_cvt_pk_bf16_f32 v92, v72, v73
  v_cvt_pk_bf16_f32 v93, v74, v75
  v_cvt_pk_bf16_f32 v94, v76, v77
  v_cvt_pk_bf16_f32 v95, v78, v79
  buffer_store_dwordx4 v[92:95], v1, s[12:15], s23 offen offset:3072 sc0 sc1
  s_add_u32 s23, s23, 4096
  s_endpgm
L_slowA0:
  s_nop 15
  v_mov_b32 v2, v46
  v_mov_b32 v3, v46
  s_nop 1
  v_permlane32_swap_b32 v2, v3
  v_max_f32 v2, v2, v3
  v_max_f32 v2, 0, v2
  v_sub_f32 v3, 0, v2
  v_exp_f32 v3, v3
  v_sub_f32 v64, v64, v2
  v_sub_f32 v96, v96, v2
  v_sub_f32 v65, v65, v2
  v_sub_f32 v97, v97, v2
  v_sub_f32 v66, v66, v2
  v_sub_f32 v98, v98, v2
  v_sub_f32 v67, v67, v2
  v_sub_f32 v99, v99, v2
  v_sub_f32 v68, v68, v2
  v_sub_f32 v100, v100, v2
  v_sub_f32 v69, v69, v2
  v_sub_f32 v101, v101, v2
  v_sub_f32 v70, v70, v2
  v_sub_f32 v102, v102, v2
  v_sub_f32 v71, v71, v2
  v_sub_f32 v103, v103, v2
  v_sub_f32 v72, v72, v2
  v_sub_f32 v104, v104, v2
  v_sub_f32 v73, v73, v2
  v_sub_f32 v105, v105, v2
  v_sub_f32 v74, v74, v2
  v_sub_f32 v106, v106, v2
  v_sub_f32 v75, v75, v2
  v_sub_f32 v107, v107, v2
  v_sub_f32 v76, v76, v2
  v_sub_f32 v108, v108, v2
  v_sub_f32 v77, v77, v2
  v_sub_f32 v109, v109, v2
  v_sub_f32 v78, v78, v2
  v_sub_f32 v110, v110, v2
  v_sub_f32 v79, v79, v2
  v_sub_f32 v111, v111, v2
  v_mul_f32 v44, v44, v3
  v_accvgpr_read_b32 v4, a0
  v_accvgpr_read_b32 v5, a1
  v_accvgpr_read_b32 v6, a2
  v_accvgpr_read_b32 v7, a3
  v_mul_f32 v4, v4, v3
  v_mul_f32 v5, v5, v3
  v_mul_f32 v6, v6, v3
  v_mul_f32 v7, v7, v3
  v_accvgpr_write_b32 a0, v4
  v_accvgpr_write_b32 a1, v5
  v_accvgpr_write_b32 a2, v6
  v_accvgpr_write_b32 a3, v7
  v_accvgpr_read_b32 v4, a4
  v_accvgpr_read_b32 v5, a5
  v_accvgpr_read_b32 v6, a6
  v_accvgpr_read_b32 v7, a7
  v_mul_f32 v4, v4, v3
  v_mul_f32 v5, v5, v3
  v_mul_f32 v6, v6, v3
  v_mul_f32 v7, v7, v3
  v_accvgpr_write_b32 a4, v4
  v_accvgpr_write_b32 a5, v5
  v_accvgpr_write_b32 a6, v6
  v_accvgpr_write_b32 a7, v7
  v_accvgpr_read_b32 v4, a8
  v_accvgpr_read_b32 v5, a9
  v_accvgpr_read_b32 v6, a10
  v_accvgpr_read_b32 v7, a11
  v_mul_f32 v4, v4, v3
  v_mul_f32 v5, v5, v3
  v_mul_f32 v6, v6, v3
  v_mul_f32 v7, v7, v3
  v_accvgpr_write_b32 a8, v4
  v_accvgpr_write_b32 a9, v5
  v_accvgpr_write_b32 a10, v6
  v_accvgpr_write_b32 a11, v7
  v_accvgpr_read_b32 v4, a12
  v_accvgpr_read_b32 v5, a13
  v_accvgpr_read_b32 v6, a14
  v_accvgpr_read_b32 v7, a15
  v_mul_f32 v4, v4, v3
  v_mul_f32 v5, v5, v3
  v_mul_f32 v6, v6, v3
  v_mul_f32 v7, v7, v3
  v_accvgpr_write_b32 a12, v4
  v_accvgpr_write_b32 a13, v5
  v_accvgpr_write_b32 a14, v6
  v_accvgpr_write_b32 a15, v7
  v_accvgpr_read_b32 v4, a16
  v_accvgpr_read_b32 v5, a17
  v_accvgpr_read_b32 v6, a18
  v_accvgpr_read_b32 v7, a19
  v_mul_f32 v4, v4, v3
  v_mul_f32 v5, v5, v3
  v_mul_f32 v6, v6, v3
  v_mul_f32 v7, v7, v3
  v_accvgpr_write_b32 a16, v4
  v_accvgpr_write_b32 a17, v5
  v_accvgpr_write_b32 a18, v6
  v_accvgpr_write_b32 a19, v7
  v_accvgpr_read_b32 v4, a20
  v_accvgpr_read_b32 v5, a21
  v_accvgpr_read_b32 v6, a22
  v_accvgpr_read_b32 v7, a23
  v_mul_f32 v4, v4, v3
  v_mul_f32 v5, v5, v3
  v_mul_f32 v6, v6, v3
  v_mul_f32 v7, v7, v3
  v_accvgpr_write_b32 a20, v4
  v_accvgpr_write_b32 a21, v5
  v_accvgpr_write_b32 a22, v6
  v_accvgpr_write_b32 a23, v7
  v_accvgpr_read_b32 v4, a24
  v_accvgpr_read_b32 v5, a25
  v_accvgpr_read_b32 v6, a26
  v_accvgpr_read_b32 v7, a27
  v_mul_f32 v4, v4, v3
  v_mul_f32 v5, v5, v3
  v_mul_f32 v6, v6, v3
  v_mul_f32 v7, v7, v3
  v_accvgpr_write_b32 a24, v4
  v_accvgpr_write_b32 a25, v5
  v_accvgpr_write_b32 a26, v6
  v_accvgpr_write_b32 a27, v7
  v_accvgpr_read_b32 v4, a28
  v_accvgpr_read_b32 v5, a29
  v_accvgpr_read_b32 v6, a30
  v_accvgpr_read_b32 v7, a31
  v_mul_f32 v4, v4, v3
  v_mul_f32 v5, v5, v3
  v_mul_f32 v6, v6, v3
  v_mul_f32 v7, v7, v3
  v_accvgpr_write_b32 a28, v4
  v_accvgpr_write_b32 a29, v5
  v_accvgpr_write_b32 a30, v6
  v_accvgpr_write_b32 a31, v7
  v_accvgpr_read_b32 v4, a32
  v_accvgpr_read_b32 v5, a33
  v_accvgpr_read_b32 v6, a34
  v_accvgpr_read_b32 v7, a35
  v_mul_f32 v4, v4, v3
  v_mul_f32 v5, v5, v3
  v_mul_f32 v6, v6, v3
  v_mul_f32 v7, v7, v3
  v_accvgpr_write_b32 a32, v4
  v_accvgpr_write_b32 a33, v5
  v_accvgpr_write_b32 a34, v6
  v_accvgpr_write_b32 a35, v7
  v_accvgpr_read_b32 v4, a36
  v_accvgpr_read_b32 v5, a37
  v_accvgpr_read_b32 v6, a38
  v_accvgpr_read_b32 v7, a39
  v_mul_f32 v4, v4, v3
  v_mul_f32 v5, v5, v3
  v_mul_f32 v6, v6, v3
  v_mul_f32 v7, v7, v3
  v_accvgpr_write_b32 a36, v4
  v_accvgpr_write_b32 a37, v5
  v_accvgpr_write_b32 a38, v6
  v_accvgpr_write_b32 a39, v7
  v_accvgpr_read_b32 v4, a40
  v_accvgpr_read_b32 v5, a41
  v_accvgpr_read_b32 v6, a42
  v_accvgpr_read_b32 v7, a43
  v_mul_f32 v4, v4, v3
  v_mul_f32 v5, v5, v3
  v_mul_f32 v6, v6, v3
  v_mul_f32 v7, v7, v3
  v_accvgpr_write_b32 a40, v4
  v_accvgpr_write_b32 a41, v5
  v_accvgpr_write_b32 a42, v6
  v_accvgpr_write_b32 a43, v7
  v_accvgpr_read_b32 v4, a44
  v_accvgpr_read_b32 v5, a45
  v_accvgpr_read_b32 v6, a46
  v_accvgpr_read_b32 v7, a47
  v_mul_f32 v4, v4, v3
  v_mul_f32 v5, v5, v3
  v_mul_f32 v6, v6, v3
  v_mul_f32 v7, v7, v3
  v_accvgpr_write_b32 a44, v4
  v_accvgpr_write_b32 a45, v5
  v_accvgpr_write_b32 a46, v6
  v_accvgpr_write_b32 a47, v7
  v_accvgpr_read_b32 v4, a48
  v_accvgpr_read_b32 v5, a49
  v_accvgpr_read_b32 v6, a50
  v_accvgpr_read_b32 v7, a51
  v_mul_f32 v4, v4, v3
  v_mul_f32 v5, v5, v3
  v_mul_f32 v6, v6, v3
  v_mul_f32 v7, v7, v3
  v_accvgpr_write_b32 a48, v4
  v_accvgpr_write_b32 a49, v5
  v_accvgpr_write_b32 a50, v6
  v_accvgpr_write_b32 a51, v7
  v_accvgpr_read_b32 v4, a52
  v_accvgpr_read_b32 v5, a53
  v_accvgpr_read_b32 v6, a54
  v_accvgpr_read_b32 v7, a55
  v_mul_f32 v4, v4, v3
  v_mul_f32 v5, v5, v3
  v_mul_f32 v6, v6, v3
  v_mul_f32 v7, v7, v3
  v_accvgpr_write_b32 a52, v4
  v_accvgpr_write_b32 a53, v5
  v_accvgpr_write_b32 a54, v6
  v_accvgpr_write_b32 a55, v7
  v_accvgpr_read_b32 v4, a56
  v_accvgpr_read_b32 v5, a57
  v_accvgpr_read_b32 v6, a58
  v_accvgpr_read_b32 v7, a59
  v_mul_f32 v4, v4, v3
  v_mul_f32 v5, v5, v3
  v_mul_f32 v6, v6, v3
  v_mul_f32 v7, v7, v3
  v_accvgpr_write_b32 a56, v4
  v_accvgpr_write_b32 a57, v5
  v_accvgpr_write_b32 a58, v6
  v_accvgpr_write_b32 a59, v7
  v_accvgpr_read_b32 v4, a60
  v_accvgpr_read_b32 v5, a61
  v_accvgpr_read_b32 v6, a62
  v_accvgpr_read_b32 v7, a63
  v_mul_f32 v4, v4, v3
  v_mul_f32 v5, v5, v3
  v_mul_f32 v6, v6, v3
  v_mul_f32 v7, v7, v3
  v_accvgpr_write_b32 a60, v4
  v_accvgpr_write_b32 a61, v5
  v_accvgpr_write_b32 a62, v6
  v_accvgpr_write_b32 a63, v7
  s_nop 3
  s_branch L_slowA0_back
L_slowB0:
  s_nop 15
  v_mov_b32 v2, v46
  v_mov_b32 v3, v46
  s_nop 1
  v_permlane32_swap_b32 v2, v3
  v_max_f32 v2, v2, v3
  v_max_f32 v2, 0, v2
  v_sub_f32 v3, 0, v2
  v_exp_f32 v3, v3
  v_sub_f32 v80, v80, v2
  v_sub_f32 v112, v112, v2
  v_sub_f32 v81, v81, v2
  v_sub_f32 v113, v113, v2
  v_sub_f32 v82, v82, v2
  v_sub_f32 v114, v114, v2
  v_sub_f32 v83, v83, v2
  v_sub_f32 v115, v115, v2
  v_sub_f32 v84, v84, v2
  v_sub_f32 v116, v116, v2
  v_sub_f32 v85, v85, v2
  v_sub_f32 v117, v117, v2
  v_sub_f32 v86, v86, v2
  v_sub_f32 v118, v118, v2
  v_sub_f32 v87, v87, v2
  v_sub_f32 v119, v119, v2
  v_sub_f32 v88, v88, v2
  v_sub_f32 v120, v120, v2
  v_sub_f32 v89, v89, v2
  v_sub_f32 v121, v121, v2
  v_sub_f32 v90, v90, v2
  v_sub_f32 v122, v122, v2
  v_sub_f32 v91, v91, v2
  v_sub_f32 v123, v123, v2
  v_sub_f32 v92, v92, v2
  v_sub_f32 v124, v124, v2
  v_sub_f32 v93, v93, v2
  v_sub_f32 v125, v125, v2
  v_sub_f32 v94, v94, v2
  v_sub_f32 v126, v126, v2
  v_sub_f32 v95, v95, v2
  v_sub_f32 v127, v127, v2
  v_mul_f32 v45, v45, v3
  v_accvgpr_read_b32 v4, a64
  v_accvgpr_read_b32 v5, a65
  v_accvgpr_read_b32 v6, a66
  v_accvgpr_read_b32 v7, a67
  v_mul_f32 v4, v4, v3
  v_mul_f32 v5, v5, v3
  v_mul_f32 v6, v6, v3
  v_mul_f32 v7, v7, v3
  v_accvgpr_write_b32 a64, v4
  v_accvgpr_write_b32 a65, v5
  v_accvgpr_write_b32 a66, v6
  v_accvgpr_write_b32 a67, v7
  v_accvgpr_read_b32 v4, a68
  v_accvgpr_read_b32 v5, a69
  v_accvgpr_read_b32 v6, a70
  v_accvgpr_read_b32 v7, a71
  v_mul_f32 v4, v4, v3
  v_mul_f32 v5, v5, v3
  v_mul_f32 v6, v6, v3
  v_mul_f32 v7, v7, v3
  v_accvgpr_write_b32 a68, v4
  v_accvgpr_write_b32 a69, v5
  v_accvgpr_write_b32 a70, v6
  v_accvgpr_write_b32 a71, v7
  v_accvgpr_read_b32 v4, a72
  v_accvgpr_read_b32 v5, a73
  v_accvgpr_read_b32 v6, a74
  v_accvgpr_read_b32 v7, a75
  v_mul_f32 v4, v4, v3
  v_mul_f32 v5, v5, v3
  v_mul_f32 v6, v6, v3
  v_mul_f32 v7, v7, v3
  v_accvgpr_write_b32 a72, v4
  v_accvgpr_write_b32 a73, v5
  v_accvgpr_write_b32 a74, v6
  v_accvgpr_write_b32 a75, v7
  v_accvgpr_read_b32 v4, a76
  v_accvgpr_read_b32 v5, a77
  v_accvgpr_read_b32 v6, a78
  v_accvgpr_read_b32 v7, a79
  v_mul_f32 v4, v4, v3
  v_mul_f32 v5, v5, v3
  v_mul_f32 v6, v6, v3
  v_mul_f32 v7, v7, v3
  v_accvgpr_write_b32 a76, v4
  v_accvgpr_write_b32 a77, v5
  v_accvgpr_write_b32 a78, v6
  v_accvgpr_write_b32 a79, v7
  v_accvgpr_read_b32 v4, a80
  v_accvgpr_read_b32 v5, a81
  v_accvgpr_read_b32 v6, a82
  v_accvgpr_read_b32 v7, a83
  v_mul_f32 v4, v4, v3
  v_mul_f32 v5, v5, v3
  v_mul_f32 v6, v6, v3
  v_mul_f32 v7, v7, v3
  v_accvgpr_write_b32 a80, v4
  v_accvgpr_write_b32 a81, v5
  v_accvgpr_write_b32 a82, v6
  v_accvgpr_write_b32 a83, v7
  v_accvgpr_read_b32 v4, a84
  v_accvgpr_read_b32 v5, a85
  v_accvgpr_read_b32 v6, a86
  v_accvgpr_read_b32 v7, a87
  v_mul_f32 v4, v4, v3
  v_mul_f32 v5, v5, v3
  v_mul_f32 v6, v6, v3
  v_mul_f32 v7, v7, v3
  v_accvgpr_write_b32 a84, v4
  v_accvgpr_write_b32 a85, v5
  v_accvgpr_write_b32 a86, v6
  v_accvgpr_write_b32 a87, v7
  v_accvgpr_read_b32 v4, a88
  v_accvgpr_read_b32 v5, a89
  v_accvgpr_read_b32 v6, a90
  v_accvgpr_read_b32 v7, a91
  v_mul_f32 v4, v4, v3
  v_mul_f32 v5, v5, v3
  v_mul_f32 v6, v6, v3
  v_mul_f32 v7, v7, v3
  v_accvgpr_write_b32 a88, v4
  v_accvgpr_write_b32 a89, v5
  v_accvgpr_write_b32 a90, v6
  v_accvgpr_write_b32 a91, v7
  v_accvgpr_read_b32 v4, a92
  v_accvgpr_read_b32 v5, a93
  v_accvgpr_read_b32 v6, a94
  v_accvgpr_read_b32 v7, a95
  v_mul_f32 v4, v4, v3
  v_mul_f32 v5, v5, v3
  v_mul_f32 v6, v6, v3
  v_mul_f32 v7, v7, v3
  v_accvgpr_write_b32 a92, v4
  v_accvgpr_write_b32 a93, v5
  v_accvgpr_write_b32 a94, v6
  v_accvgpr_write_b32 a95, v7
  v_accvgpr_read_b32 v4, a96
  v_accvgpr_read_b32 v5, a97
  v_accvgpr_read_b32 v6, a98
  v_accvgpr_read_b32 v7, a99
  v_mul_f32 v4, v4, v3
  v_mul_f32 v5, v5, v3
  v_mul_f32 v6, v6, v3
  v_mul_f32 v7, v7, v3
  v_accvgpr_write_b32 a96, v4
  v_accvgpr_write_b32 a97, v5
  v_accvgpr_write_b32 a98, v6
  v_accvgpr_write_b32 a99, v7
  v_accvgpr_read_b32 v4, a100
  v_accvgpr_read_b32 v5, a101
  v_accvgpr_read_b32 v6, a102
  v_accvgpr_read_b32 v7, a103
  v_mul_f32 v4, v4, v3
  v_mul_f32 v5, v5, v3
  v_mul_f32 v6, v6, v3
  v_mul_f32 v7, v7, v3
  v_accvgpr_write_b32 a100, v4
  v_accvgpr_write_b32 a101, v5
  v_accvgpr_write_b32 a102, v6
  v_accvgpr_write_b32 a103, v7
  v_accvgpr_read_b32 v4, a104
  v_accvgpr_read_b32 v5, a105
  v_accvgpr_read_b32 v6, a106
  v_accvgpr_read_b32 v7, a107
  v_mul_f32 v4, v4, v3
  v_mul_f32 v5, v5, v3
  v_mul_f32 v6, v6, v3
  v_mul_f32 v7, v7, v3
  v_accvgpr_write_b32 a104, v4
  v_accvgpr_write_b32 a105, v5
  v_accvgpr_write_b32 a106, v6
  v_accvgpr_write_b32 a107, v7
  v_accvgpr_read_b32 v4, a108
  v_accvgpr_read_b32 v5, a109
  v_accvgpr_read_b32 v6, a110
  v_accvgpr_read_b32 v7, a111
  v_mul_f32 v4, v4, v3
  v_mul_f32 v5, v5, v3
  v_mul_f32 v6, v6, v3
  v_mul_f32 v7, v7, v3
  v_accvgpr_write_b32 a108, v4
  v_accvgpr_write_b32 a109, v5
  v_accvgpr_write_b32 a110, v6
  v_accvgpr_write_b32 a111, v7
  v_accvgpr_read_b32 v4, a112
  v_accvgpr_read_b32 v5, a113
  v_accvgpr_read_b32 v6, a114
  v_accvgpr_read_b32 v7, a115
  v_mul_f32 v4, v4, v3
  v_mul_f32 v5, v5, v3
  v_mul_f32 v6, v6, v3
  v_mul_f32 v7, v7, v3
  v_accvgpr_write_b32 a112, v4
  v_accvgpr_write_b32 a113, v5
  v_accvgpr_write_b32 a114, v6
  v_accvgpr_write_b32 a115, v7
  v_accvgpr_read_b32 v4, a116
  v_accvgpr_read_b32 v5, a117
  v_accvgpr_read_b32 v6, a118
  v_accvgpr_read_b32 v7, a119
  v_mul_f32 v4, v4, v3
  v_mul_f32 v5, v5, v3
  v_mul_f32 v6, v6, v3
  v_mul_f32 v7, v7, v3
  v_accvgpr_write_b32 a116, v4
  v_accvgpr_write_b32 a117, v5
  v_accvgpr_write_b32 a118, v6
  v_accvgpr_write_b32 a119, v7
  v_accvgpr_read_b32 v4, a120
  v_accvgpr_read_b32 v5, a121
  v_accvgpr_read_b32 v6, a122
  v_accvgpr_read_b32 v7, a123
  v_mul_f32 v4, v4, v3
  v_mul_f32 v5, v5, v3
  v_mul_f32 v6, v6, v3
  v_mul_f32 v7, v7, v3
  v_accvgpr_write_b32 a120, v4
  v_accvgpr_write_b32 a121, v5
  v_accvgpr_write_b32 a122, v6
  v_accvgpr_write_b32 a123, v7
  v_accvgpr_read_b32 v4, a124
  v_accvgpr_read_b32 v5, a125
  v_accvgpr_read_b32 v6, a126
  v_accvgpr_read_b32 v7, a127
  v_mul_f32 v4, v4, v3
  v_mul_f32 v5, v5, v3
  v_mul_f32 v6, v6, v3
  v_mul_f32 v7, v7, v3
  v_accvgpr_write_b32 a124, v4
  v_accvgpr_write_b32 a125, v5
  v_accvgpr_write_b32 a126, v6
  v_accvgpr_write_b32 a127, v7
  s_nop 3
  s_branch L_slowB0_back
L_slowA1:
  s_nop 15
  v_mov_b32 v2, v46
  v_mov_b32 v3, v46
  s_nop 1
  v_permlane32_swap_b32 v2, v3
  v_max_f32 v2, v2, v3
  v_max_f32 v2, 0, v2
  v_sub_f32 v3, 0, v2
  v_exp_f32 v3, v3
  v_sub_f32 v64, v64, v2
  v_sub_f32 v96, v96, v2
  v_sub_f32 v65, v65, v2
  v_sub_f32 v97, v97, v2
  v_sub_f32 v66, v66, v2
  v_sub_f32 v98, v98, v2
  v_sub_f32 v67, v67, v2
  v_sub_f32 v99, v99, v2
  v_sub_f32 v68, v68, v2
  v_sub_f32 v100, v100, v2
  v_sub_f32 v69, v69, v2
  v_sub_f32 v101, v101, v2
  v_sub_f32 v70, v70, v2
  v_sub_f32 v102, v102, v2
  v_sub_f32 v71, v71, v2
  v_sub_f32 v103, v103, v2
  v_sub_f32 v72, v72, v2
  v_sub_f32 v104, v104, v2
  v_sub_f32 v73, v73, v2
  v_sub_f32 v105, v105, v2
  v_sub_f32 v74, v74, v2
  v_sub_f32 v106, v106, v2
  v_sub_f32 v75, v75, v2
  v_sub_f32 v107, v107, v2
  v_sub_f32 v76, v76, v2
  v_sub_f32 v108, v108, v2
  v_sub_f32 v77, v77, v2
  v_sub_f32 v109, v109, v2
  v_sub_f32 v78, v78, v2
  v_sub_f32 v110, v110, v2
  v_sub_f32 v79, v79, v2
  v_sub_f32 v111, v111, v2
  v_mul_f32 v44, v44, v3
  v_accvgpr_read_b32 v4, a0
  v_accvgpr_read_b32 v5, a1
  v_accvgpr_read_b32 v6, a2
  v_accvgpr_read_b32 v7, a3
  v_mul_f32 v4, v4, v3
  v_mul_f32 v5, v5, v3
  v_mul_f32 v6, v6, v3
  v_mul_f32 v7, v7, v3
  v_accvgpr_write_b32 a0, v4
  v_accvgpr_write_b32 a1, v5
  v_accvgpr_write_b32 a2, v6
  v_accvgpr_write_b32 a3, v7
  v_accvgpr_read_b32 v4, a4
  v_accvgpr_read_b32 v5, a5
  v_accvgpr_read_b32 v6, a6
  v_accvgpr_read_b32 v7, a7
  v_mul_f32 v4, v4, v3
  v_mul_f32 v5, v5, v3
  v_mul_f32 v6, v6, v3
  v_mul_f32 v7, v7, v3
  v_accvgpr_write_b32 a4, v4
  v_accvgpr_write_b32 a5, v5
  v_accvgpr_write_b32 a6, v6
  v_accvgpr_write_b32 a7, v7
  v_accvgpr_read_b32 v4, a8
  v_accvgpr_read_b32 v5, a9
  v_accvgpr_read_b32 v6, a10
  v_accvgpr_read_b32 v7, a11
  v_mul_f32 v4, v4, v3
  v_mul_f32 v5, v5, v3
  v_mul_f32 v6, v6, v3
  v_mul_f32 v7, v7, v3
  v_accvgpr_write_b32 a8, v4
  v_accvgpr_write_b32 a9, v5
  v_accvgpr_write_b32 a10, v6
  v_accvgpr_write_b32 a11, v7
  v_accvgpr_read_b32 v4, a12
  v_accvgpr_read_b32 v5, a13
  v_accvgpr_read_b32 v6, a14
  v_accvgpr_read_b32 v7, a15
  v_mul_f32 v4, v4, v3
  v_mul_f32 v5, v5, v3
  v_mul_f32 v6, v6, v3
  v_mul_f32 v7, v7, v3
  v_accvgpr_write_b32 a12, v4
  v_accvgpr_write_b32 a13, v5
  v_accvgpr_write_b32 a14, v6
  v_accvgpr_write_b32 a15, v7
  v_accvgpr_read_b32 v4, a16
  v_accvgpr_read_b32 v5, a17
  v_accvgpr_read_b32 v6, a18
  v_accvgpr_read_b32 v7, a19
  v_mul_f32 v4, v4, v3
  v_mul_f32 v5, v5, v3
  v_mul_f32 v6, v6, v3
  v_mul_f32 v7, v7, v3
  v_accvgpr_write_b32 a16, v4
  v_accvgpr_write_b32 a17, v5
  v_accvgpr_write_b32 a18, v6
  v_accvgpr_write_b32 a19, v7
  v_accvgpr_read_b32 v4, a20
  v_accvgpr_read_b32 v5, a21
  v_accvgpr_read_b32 v6, a22
  v_accvgpr_read_b32 v7, a23
  v_mul_f32 v4, v4, v3
  v_mul_f32 v5, v5, v3
  v_mul_f32 v6, v6, v3
  v_mul_f32 v7, v7, v3
  v_accvgpr_write_b32 a20, v4
  v_accvgpr_write_b32 a21, v5
  v_accvgpr_write_b32 a22, v6
  v_accvgpr_write_b32 a23, v7
  v_accvgpr_read_b32 v4, a24
  v_accvgpr_read_b32 v5, a25
  v_accvgpr_read_b32 v6, a26
  v_accvgpr_read_b32 v7, a27
  v_mul_f32 v4, v4, v3
  v_mul_f32 v5, v5, v3
  v_mul_f32 v6, v6, v3
  v_mul_f32 v7, v7, v3
  v_accvgpr_write_b32 a24, v4
  v_accvgpr_write_b32 a25, v5
  v_accvgpr_write_b32 a26, v6
  v_accvgpr_write_b32 a27, v7
  v_accvgpr_read_b32 v4, a28
  v_accvgpr_read_b32 v5, a29
  v_accvgpr_read_b32 v6, a30
  v_accvgpr_read_b32 v7, a31
  v_mul_f32 v4, v4, v3
  v_mul_f32 v5, v5, v3
  v_mul_f32 v6, v6, v3
  v_mul_f32 v7, v7, v3
  v_accvgpr_write_b32 a28, v4
  v_accvgpr_write_b32 a29, v5
  v_accvgpr_write_b32 a30, v6
  v_accvgpr_write_b32 a31, v7
  v_accvgpr_read_b32 v4, a32
  v_accvgpr_read_b32 v5, a33
  v_accvgpr_read_b32 v6, a34
  v_accvgpr_read_b32 v7, a35
  v_mul_f32 v4, v4, v3
  v_mul_f32 v5, v5, v3
  v_mul_f32 v6, v6, v3
  v_mul_f32 v7, v7, v3
  v_accvgpr_write_b32 a32, v4
  v_accvgpr_write_b32 a33, v5
  v_accvgpr_write_b32 a34, v6
  v_accvgpr_write_b32 a35, v7
  v_accvgpr_read_b32 v4, a36
  v_accvgpr_read_b32 v5, a37
  v_accvgpr_read_b32 v6, a38
  v_accvgpr_read_b32 v7, a39
  v_mul_f32 v4, v4, v3
  v_mul_f32 v5, v5, v3
  v_mul_f32 v6, v6, v3
  v_mul_f32 v7, v7, v3
  v_accvgpr_write_b32 a36, v4
  v_accvgpr_write_b32 a37, v5
  v_accvgpr_write_b32 a38, v6
  v_accvgpr_write_b32 a39, v7
  v_accvgpr_read_b32 v4, a40
  v_accvgpr_read_b32 v5, a41
  v_accvgpr_read_b32 v6, a42
  v_accvgpr_read_b32 v7, a43
  v_mul_f32 v4, v4, v3
  v_mul_f32 v5, v5, v3
  v_mul_f32 v6, v6, v3
  v_mul_f32 v7, v7, v3
  v_accvgpr_write_b32 a40, v4
  v_accvgpr_write_b32 a41, v5
  v_accvgpr_write_b32 a42, v6
  v_accvgpr_write_b32 a43, v7
  v_accvgpr_read_b32 v4, a44
  v_accvgpr_read_b32 v5, a45
  v_accvgpr_read_b32 v6, a46
  v_accvgpr_read_b32 v7, a47
  v_mul_f32 v4, v4, v3
  v_mul_f32 v5, v5, v3
  v_mul_f32 v6, v6, v3
  v_mul_f32 v7, v7, v3
  v_accvgpr_write_b32 a44, v4
  v_accvgpr_write_b32 a45, v5
  v_accvgpr_write_b32 a46, v6
  v_accvgpr_write_b32 a47, v7
  v_accvgpr_read_b32 v4, a48
  v_accvgpr_read_b32 v5, a49
  v_accvgpr_read_b32 v6, a50
  v_accvgpr_read_b32 v7, a51
  v_mul_f32 v4, v4, v3
  v_mul_f32 v5, v5, v3
  v_mul_f32 v6, v6, v3
  v_mul_f32 v7, v7, v3
  v_accvgpr_write_b32 a48, v4
  v_accvgpr_write_b32 a49, v5
  v_accvgpr_write_b32 a50, v6
  v_accvgpr_write_b32 a51, v7
  v_accvgpr_read_b32 v4, a52
  v_accvgpr_read_b32 v5, a53
  v_accvgpr_read_b32 v6, a54
  v_accvgpr_read_b32 v7, a55
  v_mul_f32 v4, v4, v3
  v_mul_f32 v5, v5, v3
  v_mul_f32 v6, v6, v3
  v_mul_f32 v7, v7, v3
  v_accvgpr_write_b32 a52, v4
  v_accvgpr_write_b32 a53, v5
  v_accvgpr_write_b32 a54, v6
  v_accvgpr_write_b32 a55, v7
  v_accvgpr_read_b32 v4, a56
  v_accvgpr_read_b32 v5, a57
  v_accvgpr_read_b32 v6, a58
  v_accvgpr_read_b32 v7, a59
  v_mul_f32 v4, v4, v3
  v_mul_f32 v5, v5, v3
  v_mul_f32 v6, v6, v3
  v_mul_f32 v7, v7, v3
  v_accvgpr_write_b32 a56, v4
  v_accvgpr_write_b32 a57, v5
  v_accvgpr_write_b32 a58, v6
  v_accvgpr_write_b32 a59, v7
  v_accvgpr_read_b32 v4, a60
  v_accvgpr_read_b32 v5, a61
  v_accvgpr_read_b32 v6, a62
  v_accvgpr_read_b32 v7, a63
  v_mul_f32 v4, v4, v3
  v_mul_f32 v5, v5, v3
  v_mul_f32 v6, v6, v3
  v_mul_f32 v7, v7, v3
  v_accvgpr_write_b32 a60, v4
  v_accvgpr_write_b32 a61, v5
  v_accvgpr_write_b32 a62, v6
  v_accvgpr_write_b32 a63, v7
  s_nop 3
  s_branch L_slowA1_back
L_slowB1:
  s_nop 15
  v_mov_b32 v2, v46
  v_mov_b32 v3, v46
  s_nop 1
  v_permlane32_swap_b32 v2, v3
  v_max_f32 v2, v2, v3
  v_max_f32 v2, 0, v2
  v_sub_f32 v3, 0, v2
  v_exp_f32 v3, v3
  v_sub_f32 v80, v80, v2
  v_sub_f32 v112, v112, v2
  v_sub_f32 v81, v81, v2
  v_sub_f32 v113, v113, v2
  v_sub_f32 v82, v82, v2
  v_sub_f32 v114, v114, v2
  v_sub_f32 v83, v83, v2
  v_sub_f32 v115, v115, v2
  v_sub_f32 v84, v84, v2
  v_sub_f32 v116, v116, v2
  v_sub_f32 v85, v85, v2
  v_sub_f32 v117, v117, v2
  v_sub_f32 v86, v86, v2
  v_sub_f32 v118, v118, v2
  v_sub_f32 v87, v87, v2
  v_sub_f32 v119, v119, v2
  v_sub_f32 v88, v88, v2
  v_sub_f32 v120, v120, v2
  v_sub_f32 v89, v89, v2
  v_sub_f32 v121, v121, v2
  v_sub_f32 v90, v90, v2
  v_sub_f32 v122, v122, v2
  v_sub_f32 v91, v91, v2
  v_sub_f32 v123, v123, v2
  v_sub_f32 v92, v92, v2
  v_sub_f32 v124, v124, v2
  v_sub_f32 v93, v93, v2
  v_sub_f32 v125, v125, v2
  v_sub_f32 v94, v94, v2
  v_sub_f32 v126, v126, v2
  v_sub_f32 v95, v95, v2
  v_sub_f32 v127, v127, v2
  v_mul_f32 v45, v45, v3
  v_accvgpr_read_b32 v4, a64
  v_accvgpr_read_b32 v5, a65
  v_accvgpr_read_b32 v6, a66
  v_accvgpr_read_b32 v7, a67
  v_mul_f32 v4, v4, v3
  v_mul_f32 v5, v5, v3
  v_mul_f32 v6, v6, v3
  v_mul_f32 v7, v7, v3
  v_accvgpr_write_b32 a64, v4
  v_accvgpr_write_b32 a65, v5
  v_accvgpr_write_b32 a66, v6
  v_accvgpr_write_b32 a67, v7
  v_accvgpr_read_b32 v4, a68
  v_accvgpr_read_b32 v5, a69
  v_accvgpr_read_b32 v6, a70
  v_accvgpr_read_b32 v7, a71
  v_mul_f32 v4, v4, v3
  v_mul_f32 v5, v5, v3
  v_mul_f32 v6, v6, v3
  v_mul_f32 v7, v7, v3
  v_accvgpr_write_b32 a68, v4
  v_accvgpr_write_b32 a69, v5
  v_accvgpr_write_b32 a70, v6
  v_accvgpr_write_b32 a71, v7
  v_accvgpr_read_b32 v4, a72
  v_accvgpr_read_b32 v5, a73
  v_accvgpr_read_b32 v6, a74
  v_accvgpr_read_b32 v7, a75
  v_mul_f32 v4, v4, v3
  v_mul_f32 v5, v5, v3
  v_mul_f32 v6, v6, v3
  v_mul_f32 v7, v7, v3
  v_accvgpr_write_b32 a72, v4
  v_accvgpr_write_b32 a73, v5
  v_accvgpr_write_b32 a74, v6
  v_accvgpr_write_b32 a75, v7
  v_accvgpr_read_b32 v4, a76
  v_accvgpr_read_b32 v5, a77
  v_accvgpr_read_b32 v6, a78
  v_accvgpr_read_b32 v7, a79
  v_mul_f32 v4, v4, v3
  v_mul_f32 v5, v5, v3
  v_mul_f32 v6, v6, v3
  v_mul_f32 v7, v7, v3
  v_accvgpr_write_b32 a76, v4
  v_accvgpr_write_b32 a77, v5
  v_accvgpr_write_b32 a78, v6
  v_accvgpr_write_b32 a79, v7
  v_accvgpr_read_b32 v4, a80
  v_accvgpr_read_b32 v5, a81
  v_accvgpr_read_b32 v6, a82
  v_accvgpr_read_b32 v7, a83
  v_mul_f32 v4, v4, v3
  v_mul_f32 v5, v5, v3
  v_mul_f32 v6, v6, v3
  v_mul_f32 v7, v7, v3
  v_accvgpr_write_b32 a80, v4
  v_accvgpr_write_b32 a81, v5
  v_accvgpr_write_b32 a82, v6
  v_accvgpr_write_b32 a83, v7
  v_accvgpr_read_b32 v4, a84
  v_accvgpr_read_b32 v5, a85
  v_accvgpr_read_b32 v6, a86
  v_accvgpr_read_b32 v7, a87
  v_mul_f32 v4, v4, v3
  v_mul_f32 v5, v5, v3
  v_mul_f32 v6, v6, v3
  v_mul_f32 v7, v7, v3
  v_accvgpr_write_b32 a84, v4
  v_accvgpr_write_b32 a85, v5
  v_accvgpr_write_b32 a86, v6
  v_accvgpr_write_b32 a87, v7
  v_accvgpr_read_b32 v4, a88
  v_accvgpr_read_b32 v5, a89
  v_accvgpr_read_b32 v6, a90
  v_accvgpr_read_b32 v7, a91
  v_mul_f32 v4, v4, v3
  v_mul_f32 v5, v5, v3
  v_mul_f32 v6, v6, v3
  v_mul_f32 v7, v7, v3
  v_accvgpr_write_b32 a88, v4
  v_accvgpr_write_b32 a89, v5
  v_accvgpr_write_b32 a90, v6
  v_accvgpr_write_b32 a91, v7
  v_accvgpr_read_b32 v4, a92
  v_accvgpr_read_b32 v5, a93
  v_accvgpr_read_b32 v6, a94
  v_accvgpr_read_b32 v7, a95
  v_mul_f32 v4, v4, v3
  v_mul_f32 v5, v5, v3
  v_mul_f32 v6, v6, v3
  v_mul_f32 v7, v7, v3
  v_accvgpr_write_b32 a92, v4
  v_accvgpr_write_b32 a93, v5
  v_accvgpr_write_b32 a94, v6
  v_accvgpr_write_b32 a95, v7
  v_accvgpr_read_b32 v4, a96
  v_accvgpr_read_b32 v5, a97
  v_accvgpr_read_b32 v6, a98
  v_accvgpr_read_b32 v7, a99
  v_mul_f32 v4, v4, v3
  v_mul_f32 v5, v5, v3
  v_mul_f32 v6, v6, v3
  v_mul_f32 v7, v7, v3
  v_accvgpr_write_b32 a96, v4
  v_accvgpr_write_b32 a97, v5
  v_accvgpr_write_b32 a98, v6
  v_accvgpr_write_b32 a99, v7
  v_accvgpr_read_b32 v4, a100
  v_accvgpr_read_b32 v5, a101
  v_accvgpr_read_b32 v6, a102
  v_accvgpr_read_b32 v7, a103
  v_mul_f32 v4, v4, v3
  v_mul_f32 v5, v5, v3
  v_mul_f32 v6, v6, v3
  v_mul_f32 v7, v7, v3
  v_accvgpr_write_b32 a100, v4
  v_accvgpr_write_b32 a101, v5
  v_accvgpr_write_b32 a102, v6
  v_accvgpr_write_b32 a103, v7
  v_accvgpr_read_b32 v4, a104
  v_accvgpr_read_b32 v5, a105
  v_accvgpr_read_b32 v6, a106
  v_accvgpr_read_b32 v7, a107
  v_mul_f32 v4, v4, v3
  v_mul_f32 v5, v5, v3
  v_mul_f32 v6, v6, v3
  v_mul_f32 v7, v7, v3
  v_accvgpr_write_b32 a104, v4
  v_accvgpr_write_b32 a105, v5
  v_accvgpr_write_b32 a106, v6
  v_accvgpr_write_b32 a107, v7
  v_accvgpr_read_b32 v4, a108
  v_accvgpr_read_b32 v5, a109
  v_accvgpr_read_b32 v6, a110
  v_accvgpr_read_b32 v7, a111
  v_mul_f32 v4, v4, v3
  v_mul_f32 v5, v5, v3
  v_mul_f32 v6, v6, v3
  v_mul_f32 v7, v7, v3
  v_accvgpr_write_b32 a108, v4
  v_accvgpr_write_b32 a109, v5
  v_accvgpr_write_b32 a110, v6
  v_accvgpr_write_b32 a111, v7
  v_accvgpr_read_b32 v4, a112
  v_accvgpr_read_b32 v5, a113
  v_accvgpr_read_b32 v6, a114
  v_accvgpr_read_b32 v7, a115
  v_mul_f32 v4, v4, v3
  v_mul_f32 v5, v5, v3
  v_mul_f32 v6, v6, v3
  v_mul_f32 v7, v7, v3
  v_accvgpr_write_b32 a112, v4
  v_accvgpr_write_b32 a113, v5
  v_accvgpr_write_b32 a114, v6
  v_accvgpr_write_b32 a115, v7
  v_accvgpr_read_b32 v4, a116
  v_accvgpr_read_b32 v5, a117
  v_accvgpr_read_b32 v6, a118
  v_accvgpr_read_b32 v7, a119
  v_mul_f32 v4, v4, v3
  v_mul_f32 v5, v5, v3
  v_mul_f32 v6, v6, v3
  v_mul_f32 v7, v7, v3
  v_accvgpr_write_b32 a116, v4
  v_accvgpr_write_b32 a117, v5
  v_accvgpr_write_b32 a118, v6
  v_accvgpr_write_b32 a119, v7
  v_accvgpr_read_b32 v4, a120
  v_accvgpr_read_b32 v5, a121
  v_accvgpr_read_b32 v6, a122
  v_accvgpr_read_b32 v7, a123
  v_mul_f32 v4, v4, v3
  v_mul_f32 v5, v5, v3
  v_mul_f32 v6, v6, v3
  v_mul_f32 v7, v7, v3
  v_accvgpr_write_b32 a120, v4
  v_accvgpr_write_b32 a121, v5
  v_accvgpr_write_b32 a122, v6
  v_accvgpr_write_b32 a123, v7
  v_accvgpr_read_b32 v4, a124
  v_accvgpr_read_b32 v5, a125
  v_accvgpr_read_b32 v6, a126
  v_accvgpr_read_b32 v7, a127
  v_mul_f32 v4, v4, v3
  v_mul_f32 v5, v5, v3
  v_mul_f32 v6, v6, v3
  v_mul_f32 v7, v7, v3
  v_accvgpr_write_b32 a124, v4
  v_accvgpr_write_b32 a125, v5
  v_accvgpr_write_b32 a126, v6
  v_accvgpr_write_b32 a127, v7
  s_nop 3
  s_branch L_slowB1_back
L_slowA2:
  s_nop 15
  v_mov_b32 v2, v46
  v_mov_b32 v3, v46
  s_nop 1
  v_permlane32_swap_b32 v2, v3
  v_max_f32 v2, v2, v3
  v_max_f32 v2, 0, v2
  v_sub_f32 v3, 0, v2
  v_exp_f32 v3, v3
  v_sub_f32 v64, v64, v2
  v_sub_f32 v96, v96, v2
  v_sub_f32 v65, v65, v2
  v_sub_f32 v97, v97, v2
  v_sub_f32 v66, v66, v2
  v_sub_f32 v98, v98, v2
  v_sub_f32 v67, v67, v2
  v_sub_f32 v99, v99, v2
  v_sub_f32 v68, v68, v2
  v_sub_f32 v100, v100, v2
  v_sub_f32 v69, v69, v2
  v_sub_f32 v101, v101, v2
  v_sub_f32 v70, v70, v2
  v_sub_f32 v102, v102, v2
  v_sub_f32 v71, v71, v2
  v_sub_f32 v103, v103, v2
  v_sub_f32 v72, v72, v2
  v_sub_f32 v104, v104, v2
  v_sub_f32 v73, v73, v2
  v_sub_f32 v105, v105, v2
  v_sub_f32 v74, v74, v2
  v_sub_f32 v106, v106, v2
  v_sub_f32 v75, v75, v2
  v_sub_f32 v107, v107, v2
  v_sub_f32 v76, v76, v2
  v_sub_f32 v108, v108, v2
  v_sub_f32 v77, v77, v2
  v_sub_f32 v109, v109, v2
  v_sub_f32 v78, v78, v2
  v_sub_f32 v110, v110, v2
  v_sub_f32 v79, v79, v2
  v_sub_f32 v111, v111, v2
  v_mul_f32 v44, v44, v3
  v_accvgpr_read_b32 v4, a0
  v_accvgpr_read_b32 v5, a1
  v_accvgpr_read_b32 v6, a2
  v_accvgpr_read_b32 v7, a3
  v_mul_f32 v4, v4, v3
  v_mul_f32 v5, v5, v3
  v_mul_f32 v6, v6, v3
  v_mul_f32 v7, v7, v3
  v_accvgpr_write_b32 a0, v4
  v_accvgpr_write_b32 a1, v5
  v_accvgpr_write_b32 a2, v6
  v_accvgpr_write_b32 a3, v7
  v_accvgpr_read_b32 v4, a4
  v_accvgpr_read_b32 v5, a5
  v_accvgpr_read_b32 v6, a6
  v_accvgpr_read_b32 v7, a7
  v_mul_f32 v4, v4, v3
  v_mul_f32 v5, v5, v3
  v_mul_f32 v6, v6, v3
  v_mul_f32 v7, v7, v3
  v_accvgpr_write_b32 a4, v4
  v_accvgpr_write_b32 a5, v5
  v_accvgpr_write_b32 a6, v6
  v_accvgpr_write_b32 a7, v7
  v_accvgpr_read_b32 v4, a8
  v_accvgpr_read_b32 v5, a9
  v_accvgpr_read_b32 v6, a10
  v_accvgpr_read_b32 v7, a11
  v_mul_f32 v4, v4, v3
  v_mul_f32 v5, v5, v3
  v_mul_f32 v6, v6, v3
  v_mul_f32 v7, v7, v3
  v_accvgpr_write_b32 a8, v4
  v_accvgpr_write_b32 a9, v5
  v_accvgpr_write_b32 a10, v6
  v_accvgpr_write_b32 a11, v7
  v_accvgpr_read_b32 v4, a12
  v_accvgpr_read_b32 v5, a13
  v_accvgpr_read_b32 v6, a14
  v_accvgpr_read_b32 v7, a15
  v_mul_f32 v4, v4, v3
  v_mul_f32 v5, v5, v3
  v_mul_f32 v6, v6, v3
  v_mul_f32 v7, v7, v3
  v_accvgpr_write_b32 a12, v4
  v_accvgpr_write_b32 a13, v5
  v_accvgpr_write_b32 a14, v6
  v_accvgpr_write_b32 a15, v7
  v_accvgpr_read_b32 v4, a16
  v_accvgpr_read_b32 v5, a17
  v_accvgpr_read_b32 v6, a18
  v_accvgpr_read_b32 v7, a19
  v_mul_f32 v4, v4, v3
  v_mul_f32 v5, v5, v3
  v_mul_f32 v6, v6, v3
  v_mul_f32 v7, v7, v3
  v_accvgpr_write_b32 a16, v4
  v_accvgpr_write_b32 a17, v5
  v_accvgpr_write_b32 a18, v6
  v_accvgpr_write_b32 a19, v7
  v_accvgpr_read_b32 v4, a20
  v_accvgpr_read_b32 v5, a21
  v_accvgpr_read_b32 v6, a22
  v_accvgpr_read_b32 v7, a23
  v_mul_f32 v4, v4, v3
  v_mul_f32 v5, v5, v3
  v_mul_f32 v6, v6, v3
  v_mul_f32 v7, v7, v3
  v_accvgpr_write_b32 a20, v4
  v_accvgpr_write_b32 a21, v5
  v_accvgpr_write_b32 a22, v6
  v_accvgpr_write_b32 a23, v7
  v_accvgpr_read_b32 v4, a24
  v_accvgpr_read_b32 v5, a25
  v_accvgpr_read_b32 v6, a26
  v_accvgpr_read_b32 v7, a27
  v_mul_f32 v4, v4, v3
  v_mul_f32 v5, v5, v3
  v_mul_f32 v6, v6, v3
  v_mul_f32 v7, v7, v3
  v_accvgpr_write_b32 a24, v4
  v_accvgpr_write_b32 a25, v5
  v_accvgpr_write_b32 a26, v6
  v_accvgpr_write_b32 a27, v7
  v_accvgpr_read_b32 v4, a28
  v_accvgpr_read_b32 v5, a29
  v_accvgpr_read_b32 v6, a30
  v_accvgpr_read_b32 v7, a31
  v_mul_f32 v4, v4, v3
  v_mul_f32 v5, v5, v3
  v_mul_f32 v6, v6, v3
  v_mul_f32 v7, v7, v3
  v_accvgpr_write_b32 a28, v4
  v_accvgpr_write_b32 a29, v5
  v_accvgpr_write_b32 a30, v6
  v_accvgpr_write_b32 a31, v7
  v_accvgpr_read_b32 v4, a32
  v_accvgpr_read_b32 v5, a33
  v_accvgpr_read_b32 v6, a34
  v_accvgpr_read_b32 v7, a35
  v_mul_f32 v4, v4, v3
  v_mul_f32 v5, v5, v3
  v_mul_f32 v6, v6, v3
  v_mul_f32 v7, v7, v3
  v_accvgpr_write_b32 a32, v4
  v_accvgpr_write_b32 a33, v5
  v_accvgpr_write_b32 a34, v6
  v_accvgpr_write_b32 a35, v7
  v_accvgpr_read_b32 v4, a36
  v_accvgpr_read_b32 v5, a37
  v_accvgpr_read_b32 v6, a38
  v_accvgpr_read_b32 v7, a39
  v_mul_f32 v4, v4, v3
  v_mul_f32 v5, v5, v3
  v_mul_f32 v6, v6, v3
  v_mul_f32 v7, v7, v3
  v_accvgpr_write_b32 a36, v4
  v_accvgpr_write_b32 a37, v5
  v_accvgpr_write_b32 a38, v6
  v_accvgpr_write_b32 a39, v7
  v_accvgpr_read_b32 v4, a40
  v_accvgpr_read_b32 v5, a41
  v_accvgpr_read_b32 v6, a42
  v_accvgpr_read_b32 v7, a43
  v_mul_f32 v4, v4, v3
  v_mul_f32 v5, v5, v3
  v_mul_f32 v6, v6, v3
  v_mul_f32 v7, v7, v3
  v_accvgpr_write_b32 a40, v4
  v_accvgpr_write_b32 a41, v5
  v_accvgpr_write_b32 a42, v6
  v_accvgpr_write_b32 a43, v7
  v_accvgpr_read_b32 v4, a44
  v_accvgpr_read_b32 v5, a45
  v_accvgpr_read_b32 v6, a46
  v_accvgpr_read_b32 v7, a47
  v_mul_f32 v4, v4, v3
  v_mul_f32 v5, v5, v3
  v_mul_f32 v6, v6, v3
  v_mul_f32 v7, v7, v3
  v_accvgpr_write_b32 a44, v4
  v_accvgpr_write_b32 a45, v5
  v_accvgpr_write_b32 a46, v6
  v_accvgpr_write_b32 a47, v7
  v_accvgpr_read_b32 v4, a48
  v_accvgpr_read_b32 v5, a49
  v_accvgpr_read_b32 v6, a50
  v_accvgpr_read_b32 v7, a51
  v_mul_f32 v4, v4, v3
  v_mul_f32 v5, v5, v3
  v_mul_f32 v6, v6, v3
  v_mul_f32 v7, v7, v3
  v_accvgpr_write_b32 a48, v4
  v_accvgpr_write_b32 a49, v5
  v_accvgpr_write_b32 a50, v6
  v_accvgpr_write_b32 a51, v7
  v_accvgpr_read_b32 v4, a52
  v_accvgpr_read_b32 v5, a53
  v_accvgpr_read_b32 v6, a54
  v_accvgpr_read_b32 v7, a55
  v_mul_f32 v4, v4, v3
  v_mul_f32 v5, v5, v3
  v_mul_f32 v6, v6, v3
  v_mul_f32 v7, v7, v3
  v_accvgpr_write_b32 a52, v4
  v_accvgpr_write_b32 a53, v5
  v_accvgpr_write_b32 a54, v6
  v_accvgpr_write_b32 a55, v7
  v_accvgpr_read_b32 v4, a56
  v_accvgpr_read_b32 v5, a57
  v_accvgpr_read_b32 v6, a58
  v_accvgpr_read_b32 v7, a59
  v_mul_f32 v4, v4, v3
  v_mul_f32 v5, v5, v3
  v_mul_f32 v6, v6, v3
  v_mul_f32 v7, v7, v3
  v_accvgpr_write_b32 a56, v4
  v_accvgpr_write_b32 a57, v5
  v_accvgpr_write_b32 a58, v6
  v_accvgpr_write_b32 a59, v7
  v_accvgpr_read_b32 v4, a60
  v_accvgpr_read_b32 v5, a61
  v_accvgpr_read_b32 v6, a62
  v_accvgpr_read_b32 v7, a63
  v_mul_f32 v4, v4, v3
  v_mul_f32 v5, v5, v3
  v_mul_f32 v6, v6, v3
  v_mul_f32 v7, v7, v3
  v_accvgpr_write_b32 a60, v4
  v_accvgpr_write_b32 a61, v5
  v_accvgpr_write_b32 a62, v6
  v_accvgpr_write_b32 a63, v7
  s_nop 3
  s_branch L_slowA2_back
L_slowB2:
  s_nop 15
  v_mov_b32 v2, v46
  v_mov_b32 v3, v46
  s_nop 1
  v_permlane32_swap_b32 v2, v3
  v_max_f32 v2, v2, v3
  v_max_f32 v2, 0, v2
  v_sub_f32 v3, 0, v2
  v_exp_f32 v3, v3
  v_sub_f32 v80, v80, v2
  v_sub_f32 v112, v112, v2
  v_sub_f32 v81, v81, v2
  v_sub_f32 v113, v113, v2
  v_sub_f32 v82, v82, v2
  v_sub_f32 v114, v114, v2
  v_sub_f32 v83, v83, v2
  v_sub_f32 v115, v115, v2
  v_sub_f32 v84, v84, v2
  v_sub_f32 v116, v116, v2
  v_sub_f32 v85, v85, v2
  v_sub_f32 v117, v117, v2
  v_sub_f32 v86, v86, v2
  v_sub_f32 v118, v118, v2
  v_sub_f32 v87, v87, v2
  v_sub_f32 v119, v119, v2
  v_sub_f32 v88, v88, v2
  v_sub_f32 v120, v120, v2
  v_sub_f32 v89, v89, v2
  v_sub_f32 v121, v121, v2
  v_sub_f32 v90, v90, v2
  v_sub_f32 v122, v122, v2
  v_sub_f32 v91, v91, v2
  v_sub_f32 v123, v123, v2
  v_sub_f32 v92, v92, v2
  v_sub_f32 v124, v124, v2
  v_sub_f32 v93, v93, v2
  v_sub_f32 v125, v125, v2
  v_sub_f32 v94, v94, v2
  v_sub_f32 v126, v126, v2
  v_sub_f32 v95, v95, v2
  v_sub_f32 v127, v127, v2
  v_mul_f32 v45, v45, v3
  v_accvgpr_read_b32 v4, a64
  v_accvgpr_read_b32 v5, a65
  v_accvgpr_read_b32 v6, a66
  v_accvgpr_read_b32 v7, a67
  v_mul_f32 v4, v4, v3
  v_mul_f32 v5, v5, v3
  v_mul_f32 v6, v6, v3
  v_mul_f32 v7, v7, v3
  v_accvgpr_write_b32 a64, v4
  v_accvgpr_write_b32 a65, v5
  v_accvgpr_write_b32 a66, v6
  v_accvgpr_write_b32 a67, v7
  v_accvgpr_read_b32 v4, a68
  v_accvgpr_read_b32 v5, a69
  v_accvgpr_read_b32 v6, a70
  v_accvgpr_read_b32 v7, a71
  v_mul_f32 v4, v4, v3
  v_mul_f32 v5, v5, v3
  v_mul_f32 v6, v6, v3
  v_mul_f32 v7, v7, v3
  v_accvgpr_write_b32 a68, v4
  v_accvgpr_write_b32 a69, v5
  v_accvgpr_write_b32 a70, v6
  v_accvgpr_write_b32 a71, v7
  v_accvgpr_read_b32 v4, a72
  v_accvgpr_read_b32 v5, a73
  v_accvgpr_read_b32 v6, a74
  v_accvgpr_read_b32 v7, a75
  v_mul_f32 v4, v4, v3
  v_mul_f32 v5, v5, v3
  v_mul_f32 v6, v6, v3
  v_mul_f32 v7, v7, v3
  v_accvgpr_write_b32 a72, v4
  v_accvgpr_write_b32 a73, v5
  v_accvgpr_write_b32 a74, v6
  v_accvgpr_write_b32 a75, v7
  v_accvgpr_read_b32 v4, a76
  v_accvgpr_read_b32 v5, a77
  v_accvgpr_read_b32 v6, a78
  v_accvgpr_read_b32 v7, a79
  v_mul_f32 v4, v4, v3
  v_mul_f32 v5, v5, v3
  v_mul_f32 v6, v6, v3
  v_mul_f32 v7, v7, v3
  v_accvgpr_write_b32 a76, v4
  v_accvgpr_write_b32 a77, v5
  v_accvgpr_write_b32 a78, v6
  v_accvgpr_write_b32 a79, v7
  v_accvgpr_read_b32 v4, a80
  v_accvgpr_read_b32 v5, a81
  v_accvgpr_read_b32 v6, a82
  v_accvgpr_read_b32 v7, a83
  v_mul_f32 v4, v4, v3
  v_mul_f32 v5, v5, v3
  v_mul_f32 v6, v6, v3
  v_mul_f32 v7, v7, v3
  v_accvgpr_write_b32 a80, v4
  v_accvgpr_write_b32 a81, v5
  v_accvgpr_write_b32 a82, v6
  v_accvgpr_write_b32 a83, v7
  v_accvgpr_read_b32 v4, a84
  v_accvgpr_read_b32 v5, a85
  v_accvgpr_read_b32 v6, a86
  v_accvgpr_read_b32 v7, a87
  v_mul_f32 v4, v4, v3
  v_mul_f32 v5, v5, v3
  v_mul_f32 v6, v6, v3
  v_mul_f32 v7, v7, v3
  v_accvgpr_write_b32 a84, v4
  v_accvgpr_write_b32 a85, v5
  v_accvgpr_write_b32 a86, v6
  v_accvgpr_write_b32 a87, v7
  v_accvgpr_read_b32 v4, a88
  v_accvgpr_read_b32 v5, a89
  v_accvgpr_read_b32 v6, a90
  v_accvgpr_read_b32 v7, a91
  v_mul_f32 v4, v4, v3
  v_mul_f32 v5, v5, v3
  v_mul_f32 v6, v6, v3
  v_mul_f32 v7, v7, v3
  v_accvgpr_write_b32 a88, v4
  v_accvgpr_write_b32 a89, v5
  v_accvgpr_write_b32 a90, v6
  v_accvgpr_write_b32 a91, v7
  v_accvgpr_read_b32 v4, a92
  v_accvgpr_read_b32 v5, a93
  v_accvgpr_read_b32 v6, a94
  v_accvgpr_read_b32 v7, a95
  v_mul_f32 v4, v4, v3
  v_mul_f32 v5, v5, v3
  v_mul_f32 v6, v6, v3
  v_mul_f32 v7, v7, v3
  v_accvgpr_write_b32 a92, v4
  v_accvgpr_write_b32 a93, v5
  v_accvgpr_write_b32 a94, v6
  v_accvgpr_write_b32 a95, v7
  v_accvgpr_read_b32 v4, a96
  v_accvgpr_read_b32 v5, a97
  v_accvgpr_read_b32 v6, a98
  v_accvgpr_read_b32 v7, a99
  v_mul_f32 v4, v4, v3
  v_mul_f32 v5, v5, v3
  v_mul_f32 v6, v6, v3
  v_mul_f32 v7, v7, v3
  v_accvgpr_write_b32 a96, v4
  v_accvgpr_write_b32 a97, v5
  v_accvgpr_write_b32 a98, v6
  v_accvgpr_write_b32 a99, v7
  v_accvgpr_read_b32 v4, a100
  v_accvgpr_read_b32 v5, a101
  v_accvgpr_read_b32 v6, a102
  v_accvgpr_read_b32 v7, a103
  v_mul_f32 v4, v4, v3
  v_mul_f32 v5, v5, v3
  v_mul_f32 v6, v6, v3
  v_mul_f32 v7, v7, v3
  v_accvgpr_write_b32 a100, v4
  v_accvgpr_write_b32 a101, v5
  v_accvgpr_write_b32 a102, v6
  v_accvgpr_write_b32 a103, v7
  v_accvgpr_read_b32 v4, a104
  v_accvgpr_read_b32 v5, a105
  v_accvgpr_read_b32 v6, a106
  v_accvgpr_read_b32 v7, a107
  v_mul_f32 v4, v4, v3
  v_mul_f32 v5, v5, v3
  v_mul_f32 v6, v6, v3
  v_mul_f32 v7, v7, v3
  v_accvgpr_write_b32 a104, v4
  v_accvgpr_write_b32 a105, v5
  v_accvgpr_write_b32 a106, v6
  v_accvgpr_write_b32 a107, v7
  v_accvgpr_read_b32 v4, a108
  v_accvgpr_read_b32 v5, a109
  v_accvgpr_read_b32 v6, a110
  v_accvgpr_read_b32 v7, a111
  v_mul_f32 v4, v4, v3
  v_mul_f32 v5, v5, v3
  v_mul_f32 v6, v6, v3
  v_mul_f32 v7, v7, v3
  v_accvgpr_write_b32 a108, v4
  v_accvgpr_write_b32 a109, v5
  v_accvgpr_write_b32 a110, v6
  v_accvgpr_write_b32 a111, v7
  v_accvgpr_read_b32 v4, a112
  v_accvgpr_read_b32 v5, a113
  v_accvgpr_read_b32 v6, a114
  v_accvgpr_read_b32 v7, a115
  v_mul_f32 v4, v4, v3
  v_mul_f32 v5, v5, v3
  v_mul_f32 v6, v6, v3
  v_mul_f32 v7, v7, v3
  v_accvgpr_write_b32 a112, v4
  v_accvgpr_write_b32 a113, v5
  v_accvgpr_write_b32 a114, v6
  v_accvgpr_write_b32 a115, v7
  v_accvgpr_read_b32 v4, a116
  v_accvgpr_read_b32 v5, a117
  v_accvgpr_read_b32 v6, a118
  v_accvgpr_read_b32 v7, a119
  v_mul_f32 v4, v4, v3
  v_mul_f32 v5, v5, v3
  v_mul_f32 v6, v6, v3
  v_mul_f32 v7, v7, v3
  v_accvgpr_write_b32 a116, v4
  v_accvgpr_write_b32 a117, v5
  v_accvgpr_write_b32 a118, v6
  v_accvgpr_write_b32 a119, v7
  v_accvgpr_read_b32 v4, a120
  v_accvgpr_read_b32 v5, a121
  v_accvgpr_read_b32 v6, a122
  v_accvgpr_read_b32 v7, a123
  v_mul_f32 v4, v4, v3
  v_mul_f32 v5, v5, v3
  v_mul_f32 v6, v6, v3
  v_mul_f32 v7, v7, v3
  v_accvgpr_write_b32 a120, v4
  v_accvgpr_write_b32 a121, v5
  v_accvgpr_write_b32 a122, v6
  v_accvgpr_write_b32 a123, v7
  v_accvgpr_read_b32 v4, a124
  v_accvgpr_read_b32 v5, a125
  v_accvgpr_read_b32 v6, a126
  v_accvgpr_read_b32 v7, a127
  v_mul_f32 v4, v4, v3
  v_mul_f32 v5, v5, v3
  v_mul_f32 v6, v6, v3
  v_mul_f32 v7, v7, v3
  v_accvgpr_write_b32 a124, v4
  v_accvgpr_write_b32 a125, v5
  v_accvgpr_write_b32 a126, v6
  v_accvgpr_write_b32 a127, v7
  s_nop 3
  s_branch L_slowB2_back
L_slowA3:
  s_nop 15
  v_mov_b32 v2, v46
  v_mov_b32 v3, v46
  s_nop 1
  v_permlane32_swap_b32 v2, v3
  v_max_f32 v2, v2, v3
  v_max_f32 v2, 0, v2
  v_sub_f32 v3, 0, v2
  v_exp_f32 v3, v3
  v_sub_f32 v64, v64, v2
  v_sub_f32 v96, v96, v2
  v_sub_f32 v65, v65, v2
  v_sub_f32 v97, v97, v2
  v_sub_f32 v66, v66, v2
  v_sub_f32 v98, v98, v2
  v_sub_f32 v67, v67, v2
  v_sub_f32 v99, v99, v2
  v_sub_f32 v68, v68, v2
  v_sub_f32 v100, v100, v2
  v_sub_f32 v69, v69, v2
  v_sub_f32 v101, v101, v2
  v_sub_f32 v70, v70, v2
  v_sub_f32 v102, v102, v2
  v_sub_f32 v71, v71, v2
  v_sub_f32 v103, v103, v2
  v_sub_f32 v72, v72, v2
  v_sub_f32 v104, v104, v2
  v_sub_f32 v73, v73, v2
  v_sub_f32 v105, v105, v2
  v_sub_f32 v74, v74, v2
  v_sub_f32 v106, v106, v2
  v_sub_f32 v75, v75, v2
  v_sub_f32 v107, v107, v2
  v_sub_f32 v76, v76, v2
  v_sub_f32 v108, v108, v2
  v_sub_f32 v77, v77, v2
  v_sub_f32 v109, v109, v2
  v_sub_f32 v78, v78, v2
  v_sub_f32 v110, v110, v2
  v_sub_f32 v79, v79, v2
  v_sub_f32 v111, v111, v2
  v_mul_f32 v44, v44, v3
  v_accvgpr_read_b32 v4, a0
  v_accvgpr_read_b32 v5, a1
  v_accvgpr_read_b32 v6, a2
  v_accvgpr_read_b32 v7, a3
  v_mul_f32 v4, v4, v3
  v_mul_f32 v5, v5, v3
  v_mul_f32 v6, v6, v3
  v_mul_f32 v7, v7, v3
  v_accvgpr_write_b32 a0, v4
  v_accvgpr_write_b32 a1, v5
  v_accvgpr_write_b32 a2, v6
  v_accvgpr_write_b32 a3, v7
  v_accvgpr_read_b32 v4, a4
  v_accvgpr_read_b32 v5, a5
  v_accvgpr_read_b32 v6, a6
  v_accvgpr_read_b32 v7, a7
  v_mul_f32 v4, v4, v3
  v_mul_f32 v5, v5, v3
  v_mul_f32 v6, v6, v3
  v_mul_f32 v7, v7, v3
  v_accvgpr_write_b32 a4, v4
  v_accvgpr_write_b32 a5, v5
  v_accvgpr_write_b32 a6, v6
  v_accvgpr_write_b32 a7, v7
  v_accvgpr_read_b32 v4, a8
  v_accvgpr_read_b32 v5, a9
  v_accvgpr_read_b32 v6, a10
  v_accvgpr_read_b32 v7, a11
  v_mul_f32 v4, v4, v3
  v_mul_f32 v5, v5, v3
  v_mul_f32 v6, v6, v3
  v_mul_f32 v7, v7, v3
  v_accvgpr_write_b32 a8, v4
  v_accvgpr_write_b32 a9, v5
  v_accvgpr_write_b32 a10, v6
  v_accvgpr_write_b32 a11, v7
  v_accvgpr_read_b32 v4, a12
  v_accvgpr_read_b32 v5, a13
  v_accvgpr_read_b32 v6, a14
  v_accvgpr_read_b32 v7, a15
  v_mul_f32 v4, v4, v3
  v_mul_f32 v5, v5, v3
  v_mul_f32 v6, v6, v3
  v_mul_f32 v7, v7, v3
  v_accvgpr_write_b32 a12, v4
  v_accvgpr_write_b32 a13, v5
  v_accvgpr_write_b32 a14, v6
  v_accvgpr_write_b32 a15, v7
  v_accvgpr_read_b32 v4, a16
  v_accvgpr_read_b32 v5, a17
  v_accvgpr_read_b32 v6, a18
  v_accvgpr_read_b32 v7, a19
  v_mul_f32 v4, v4, v3
  v_mul_f32 v5, v5, v3
  v_mul_f32 v6, v6, v3
  v_mul_f32 v7, v7, v3
  v_accvgpr_write_b32 a16, v4
  v_accvgpr_write_b32 a17, v5
  v_accvgpr_write_b32 a18, v6
  v_accvgpr_write_b32 a19, v7
  v_accvgpr_read_b32 v4, a20
  v_accvgpr_read_b32 v5, a21
  v_accvgpr_read_b32 v6, a22
  v_accvgpr_read_b32 v7, a23
  v_mul_f32 v4, v4, v3
  v_mul_f32 v5, v5, v3
  v_mul_f32 v6, v6, v3
  v_mul_f32 v7, v7, v3
  v_accvgpr_write_b32 a20, v4
  v_accvgpr_write_b32 a21, v5
  v_accvgpr_write_b32 a22, v6
  v_accvgpr_write_b32 a23, v7
  v_accvgpr_read_b32 v4, a24
  v_accvgpr_read_b32 v5, a25
  v_accvgpr_read_b32 v6, a26
  v_accvgpr_read_b32 v7, a27
  v_mul_f32 v4, v4, v3
  v_mul_f32 v5, v5, v3
  v_mul_f32 v6, v6, v3
  v_mul_f32 v7, v7, v3
  v_accvgpr_write_b32 a24, v4
  v_accvgpr_write_b32 a25, v5
  v_accvgpr_write_b32 a26, v6
  v_accvgpr_write_b32 a27, v7
  v_accvgpr_read_b32 v4, a28
  v_accvgpr_read_b32 v5, a29
  v_accvgpr_read_b32 v6, a30
  v_accvgpr_read_b32 v7, a31
  v_mul_f32 v4, v4, v3
  v_mul_f32 v5, v5, v3
  v_mul_f32 v6, v6, v3
  v_mul_f32 v7, v7, v3
  v_accvgpr_write_b32 a28, v4
  v_accvgpr_write_b32 a29, v5
  v_accvgpr_write_b32 a30, v6
  v_accvgpr_write_b32 a31, v7
  v_accvgpr_read_b32 v4, a32
  v_accvgpr_read_b32 v5, a33
  v_accvgpr_read_b32 v6, a34
  v_accvgpr_read_b32 v7, a35
  v_mul_f32 v4, v4, v3
  v_mul_f32 v5, v5, v3
  v_mul_f32 v6, v6, v3
  v_mul_f32 v7, v7, v3
  v_accvgpr_write_b32 a32, v4
  v_accvgpr_write_b32 a33, v5
  v_accvgpr_write_b32 a34, v6
  v_accvgpr_write_b32 a35, v7
  v_accvgpr_read_b32 v4, a36
  v_accvgpr_read_b32 v5, a37
  v_accvgpr_read_b32 v6, a38
  v_accvgpr_read_b32 v7, a39
  v_mul_f32 v4, v4, v3
  v_mul_f32 v5, v5, v3
  v_mul_f32 v6, v6, v3
  v_mul_f32 v7, v7, v3
  v_accvgpr_write_b32 a36, v4
  v_accvgpr_write_b32 a37, v5
  v_accvgpr_write_b32 a38, v6
  v_accvgpr_write_b32 a39, v7
  v_accvgpr_read_b32 v4, a40
  v_accvgpr_read_b32 v5, a41
  v_accvgpr_read_b32 v6, a42
  v_accvgpr_read_b32 v7, a43
  v_mul_f32 v4, v4, v3
  v_mul_f32 v5, v5, v3
  v_mul_f32 v6, v6, v3
  v_mul_f32 v7, v7, v3
  v_accvgpr_write_b32 a40, v4
  v_accvgpr_write_b32 a41, v5
  v_accvgpr_write_b32 a42, v6
  v_accvgpr_write_b32 a43, v7
  v_accvgpr_read_b32 v4, a44
  v_accvgpr_read_b32 v5, a45
  v_accvgpr_read_b32 v6, a46
  v_accvgpr_read_b32 v7, a47
  v_mul_f32 v4, v4, v3
  v_mul_f32 v5, v5, v3
  v_mul_f32 v6, v6, v3
  v_mul_f32 v7, v7, v3
  v_accvgpr_write_b32 a44, v4
  v_accvgpr_write_b32 a45, v5
  v_accvgpr_write_b32 a46, v6
  v_accvgpr_write_b32 a47, v7
  v_accvgpr_read_b32 v4, a48
  v_accvgpr_read_b32 v5, a49
  v_accvgpr_read_b32 v6, a50
  v_accvgpr_read_b32 v7, a51
  v_mul_f32 v4, v4, v3
  v_mul_f32 v5, v5, v3
  v_mul_f32 v6, v6, v3
  v_mul_f32 v7, v7, v3
  v_accvgpr_write_b32 a48, v4
  v_accvgpr_write_b32 a49, v5
  v_accvgpr_write_b32 a50, v6
  v_accvgpr_write_b32 a51, v7
  v_accvgpr_read_b32 v4, a52
  v_accvgpr_read_b32 v5, a53
  v_accvgpr_read_b32 v6, a54
  v_accvgpr_read_b32 v7, a55
  v_mul_f32 v4, v4, v3
  v_mul_f32 v5, v5, v3
  v_mul_f32 v6, v6, v3
  v_mul_f32 v7, v7, v3
  v_accvgpr_write_b32 a52, v4
  v_accvgpr_write_b32 a53, v5
  v_accvgpr_write_b32 a54, v6
  v_accvgpr_write_b32 a55, v7
  v_accvgpr_read_b32 v4, a56
  v_accvgpr_read_b32 v5, a57
  v_accvgpr_read_b32 v6, a58
  v_accvgpr_read_b32 v7, a59
  v_mul_f32 v4, v4, v3
  v_mul_f32 v5, v5, v3
  v_mul_f32 v6, v6, v3
  v_mul_f32 v7, v7, v3
  v_accvgpr_write_b32 a56, v4
  v_accvgpr_write_b32 a57, v5
  v_accvgpr_write_b32 a58, v6
  v_accvgpr_write_b32 a59, v7
  v_accvgpr_read_b32 v4, a60
  v_accvgpr_read_b32 v5, a61
  v_accvgpr_read_b32 v6, a62
  v_accvgpr_read_b32 v7, a63
  v_mul_f32 v4, v4, v3
  v_mul_f32 v5, v5, v3
  v_mul_f32 v6, v6, v3
  v_mul_f32 v7, v7, v3
  v_accvgpr_write_b32 a60, v4
  v_accvgpr_write_b32 a61, v5
  v_accvgpr_write_b32 a62, v6
  v_accvgpr_write_b32 a63, v7
  s_nop 3
  s_branch L_slowA3_back
L_slowB3:
  s_nop 15
  v_mov_b32 v2, v46
  v_mov_b32 v3, v46
  s_nop 1
  v_permlane32_swap_b32 v2, v3
  v_max_f32 v2, v2, v3
  v_max_f32 v2, 0, v2
  v_sub_f32 v3, 0, v2
  v_exp_f32 v3, v3
  v_sub_f32 v80, v80, v2
  v_sub_f32 v112, v112, v2
  v_sub_f32 v81, v81, v2
  v_sub_f32 v113, v113, v2
  v_sub_f32 v82, v82, v2
  v_sub_f32 v114, v114, v2
  v_sub_f32 v83, v83, v2
  v_sub_f32 v115, v115, v2
  v_sub_f32 v84, v84, v2
  v_sub_f32 v116, v116, v2
  v_sub_f32 v85, v85, v2
  v_sub_f32 v117, v117, v2
  v_sub_f32 v86, v86, v2
  v_sub_f32 v118, v118, v2
  v_sub_f32 v87, v87, v2
  v_sub_f32 v119, v119, v2
  v_sub_f32 v88, v88, v2
  v_sub_f32 v120, v120, v2
  v_sub_f32 v89, v89, v2
  v_sub_f32 v121, v121, v2
  v_sub_f32 v90, v90, v2
  v_sub_f32 v122, v122, v2
  v_sub_f32 v91, v91, v2
  v_sub_f32 v123, v123, v2
  v_sub_f32 v92, v92, v2
  v_sub_f32 v124, v124, v2
  v_sub_f32 v93, v93, v2
  v_sub_f32 v125, v125, v2
  v_sub_f32 v94, v94, v2
  v_sub_f32 v126, v126, v2
  v_sub_f32 v95, v95, v2
  v_sub_f32 v127, v127, v2
  v_mul_f32 v45, v45, v3
  v_accvgpr_read_b32 v4, a64
  v_accvgpr_read_b32 v5, a65
  v_accvgpr_read_b32 v6, a66
  v_accvgpr_read_b32 v7, a67
  v_mul_f32 v4, v4, v3
  v_mul_f32 v5, v5, v3
  v_mul_f32 v6, v6, v3
  v_mul_f32 v7, v7, v3
  v_accvgpr_write_b32 a64, v4
  v_accvgpr_write_b32 a65, v5
  v_accvgpr_write_b32 a66, v6
  v_accvgpr_write_b32 a67, v7
  v_accvgpr_read_b32 v4, a68
  v_accvgpr_read_b32 v5, a69
  v_accvgpr_read_b32 v6, a70
  v_accvgpr_read_b32 v7, a71
  v_mul_f32 v4, v4, v3
  v_mul_f32 v5, v5, v3
  v_mul_f32 v6, v6, v3
  v_mul_f32 v7, v7, v3
  v_accvgpr_write_b32 a68, v4
  v_accvgpr_write_b32 a69, v5
  v_accvgpr_write_b32 a70, v6
  v_accvgpr_write_b32 a71, v7
  v_accvgpr_read_b32 v4, a72
  v_accvgpr_read_b32 v5, a73
  v_accvgpr_read_b32 v6, a74
  v_accvgpr_read_b32 v7, a75
  v_mul_f32 v4, v4, v3
  v_mul_f32 v5, v5, v3
  v_mul_f32 v6, v6, v3
  v_mul_f32 v7, v7, v3
  v_accvgpr_write_b32 a72, v4
  v_accvgpr_write_b32 a73, v5
  v_accvgpr_write_b32 a74, v6
  v_accvgpr_write_b32 a75, v7
  v_accvgpr_read_b32 v4, a76
  v_accvgpr_read_b32 v5, a77
  v_accvgpr_read_b32 v6, a78
  v_accvgpr_read_b32 v7, a79
  v_mul_f32 v4, v4, v3
  v_mul_f32 v5, v5, v3
  v_mul_f32 v6, v6, v3
  v_mul_f32 v7, v7, v3
  v_accvgpr_write_b32 a76, v4
  v_accvgpr_write_b32 a77, v5
  v_accvgpr_write_b32 a78, v6
  v_accvgpr_write_b32 a79, v7
  v_accvgpr_read_b32 v4, a80
  v_accvgpr_read_b32 v5, a81
  v_accvgpr_read_b32 v6, a82
  v_accvgpr_read_b32 v7, a83
  v_mul_f32 v4, v4, v3
  v_mul_f32 v5, v5, v3
  v_mul_f32 v6, v6, v3
  v_mul_f32 v7, v7, v3
  v_accvgpr_write_b32 a80, v4
  v_accvgpr_write_b32 a81, v5
  v_accvgpr_write_b32 a82, v6
  v_accvgpr_write_b32 a83, v7
  v_accvgpr_read_b32 v4, a84
  v_accvgpr_read_b32 v5, a85
  v_accvgpr_read_b32 v6, a86
  v_accvgpr_read_b32 v7, a87
  v_mul_f32 v4, v4, v3
  v_mul_f32 v5, v5, v3
  v_mul_f32 v6, v6, v3
  v_mul_f32 v7, v7, v3
  v_accvgpr_write_b32 a84, v4
  v_accvgpr_write_b32 a85, v5
  v_accvgpr_write_b32 a86, v6
  v_accvgpr_write_b32 a87, v7
  v_accvgpr_read_b32 v4, a88
  v_accvgpr_read_b32 v5, a89
  v_accvgpr_read_b32 v6, a90
  v_accvgpr_read_b32 v7, a91
  v_mul_f32 v4, v4, v3
  v_mul_f32 v5, v5, v3
  v_mul_f32 v6, v6, v3
  v_mul_f32 v7, v7, v3
  v_accvgpr_write_b32 a88, v4
  v_accvgpr_write_b32 a89, v5
  v_accvgpr_write_b32 a90, v6
  v_accvgpr_write_b32 a91, v7
  v_accvgpr_read_b32 v4, a92
  v_accvgpr_read_b32 v5, a93
  v_accvgpr_read_b32 v6, a94
  v_accvgpr_read_b32 v7, a95
  v_mul_f32 v4, v4, v3
  v_mul_f32 v5, v5, v3
  v_mul_f32 v6, v6, v3
  v_mul_f32 v7, v7, v3
  v_accvgpr_write_b32 a92, v4
  v_accvgpr_write_b32 a93, v5
  v_accvgpr_write_b32 a94, v6
  v_accvgpr_write_b32 a95, v7
  v_accvgpr_read_b32 v4, a96
  v_accvgpr_read_b32 v5, a97
  v_accvgpr_read_b32 v6, a98
  v_accvgpr_read_b32 v7, a99
  v_mul_f32 v4, v4, v3
  v_mul_f32 v5, v5, v3
  v_mul_f32 v6, v6, v3
  v_mul_f32 v7, v7, v3
  v_accvgpr_write_b32 a96, v4
  v_accvgpr_write_b32 a97, v5
  v_accvgpr_write_b32 a98, v6
  v_accvgpr_write_b32 a99, v7
  v_accvgpr_read_b32 v4, a100
  v_accvgpr_read_b32 v5, a101
  v_accvgpr_read_b32 v6, a102
  v_accvgpr_read_b32 v7, a103
  v_mul_f32 v4, v4, v3
  v_mul_f32 v5, v5, v3
  v_mul_f32 v6, v6, v3
  v_mul_f32 v7, v7, v3
  v_accvgpr_write_b32 a100, v4
  v_accvgpr_write_b32 a101, v5
  v_accvgpr_write_b32 a102, v6
  v_accvgpr_write_b32 a103, v7
  v_accvgpr_read_b32 v4, a104
  v_accvgpr_read_b32 v5, a105
  v_accvgpr_read_b32 v6, a106
  v_accvgpr_read_b32 v7, a107
  v_mul_f32 v4, v4, v3
  v_mul_f32 v5, v5, v3
  v_mul_f32 v6, v6, v3
  v_mul_f32 v7, v7, v3
  v_accvgpr_write_b32 a104, v4
  v_accvgpr_write_b32 a105, v5
  v_accvgpr_write_b32 a106, v6
  v_accvgpr_write_b32 a107, v7
  v_accvgpr_read_b32 v4, a108
  v_accvgpr_read_b32 v5, a109
  v_accvgpr_read_b32 v6, a110
  v_accvgpr_read_b32 v7, a111
  v_mul_f32 v4, v4, v3
  v_mul_f32 v5, v5, v3
  v_mul_f32 v6, v6, v3
  v_mul_f32 v7, v7, v3
  v_accvgpr_write_b32 a108, v4
  v_accvgpr_write_b32 a109, v5
  v_accvgpr_write_b32 a110, v6
  v_accvgpr_write_b32 a111, v7
  v_accvgpr_read_b32 v4, a112
  v_accvgpr_read_b32 v5, a113
  v_accvgpr_read_b32 v6, a114
  v_accvgpr_read_b32 v7, a115
  v_mul_f32 v4, v4, v3
  v_mul_f32 v5, v5, v3
  v_mul_f32 v6, v6, v3
  v_mul_f32 v7, v7, v3
  v_accvgpr_write_b32 a112, v4
  v_accvgpr_write_b32 a113, v5
  v_accvgpr_write_b32 a114, v6
  v_accvgpr_write_b32 a115, v7
  v_accvgpr_read_b32 v4, a116
  v_accvgpr_read_b32 v5, a117
  v_accvgpr_read_b32 v6, a118
  v_accvgpr_read_b32 v7, a119
  v_mul_f32 v4, v4, v3
  v_mul_f32 v5, v5, v3
  v_mul_f32 v6, v6, v3
  v_mul_f32 v7, v7, v3
  v_accvgpr_write_b32 a116, v4
  v_accvgpr_write_b32 a117, v5
  v_accvgpr_write_b32 a118, v6
  v_accvgpr_write_b32 a119, v7
  v_accvgpr_read_b32 v4, a120
  v_accvgpr_read_b32 v5, a121
  v_accvgpr_read_b32 v6, a122
  v_accvgpr_read_b32 v7, a123
  v_mul_f32 v4, v4, v3
  v_mul_f32 v5, v5, v3
  v_mul_f32 v6, v6, v3
  v_mul_f32 v7, v7, v3
  v_accvgpr_write_b32 a120, v4
  v_accvgpr_write_b32 a121, v5
  v_accvgpr_write_b32 a122, v6
  v_accvgpr_write_b32 a123, v7
  v_accvgpr_read_b32 v4, a124
  v_accvgpr_read_b32 v5, a125
  v_accvgpr_read_b32 v6, a126
  v_accvgpr_read_b32 v7, a127
  v_mul_f32 v4, v4, v3
  v_mul_f32 v5, v5, v3
  v_mul_f32 v6, v6, v3
  v_mul_f32 v7, v7, v3
  v_accvgpr_write_b32 a124, v4
  v_accvgpr_write_b32 a125, v5
  v_accvgpr_write_b32 a126, v6
  v_accvgpr_write_b32 a127, v7
  s_nop 3
  s_branch L_slowB3_back
L_slowA4:
  s_nop 15
  v_mov_b32 v2, v46
  v_mov_b32 v3, v46
  s_nop 1
  v_permlane32_swap_b32 v2, v3
  v_max_f32 v2, v2, v3
  v_max_f32 v2, 0, v2
  v_sub_f32 v3, 0, v2
  v_exp_f32 v3, v3
  v_sub_f32 v64, v64, v2
  v_sub_f32 v96, v96, v2
  v_sub_f32 v65, v65, v2
  v_sub_f32 v97, v97, v2
  v_sub_f32 v66, v66, v2
  v_sub_f32 v98, v98, v2
  v_sub_f32 v67, v67, v2
  v_sub_f32 v99, v99, v2
  v_sub_f32 v68, v68, v2
  v_sub_f32 v100, v100, v2
  v_sub_f32 v69, v69, v2
  v_sub_f32 v101, v101, v2
  v_sub_f32 v70, v70, v2
  v_sub_f32 v102, v102, v2
  v_sub_f32 v71, v71, v2
  v_sub_f32 v103, v103, v2
  v_sub_f32 v72, v72, v2
  v_sub_f32 v104, v104, v2
  v_sub_f32 v73, v73, v2
  v_sub_f32 v105, v105, v2
  v_sub_f32 v74, v74, v2
  v_sub_f32 v106, v106, v2
  v_sub_f32 v75, v75, v2
  v_sub_f32 v107, v107, v2
  v_sub_f32 v76, v76, v2
  v_sub_f32 v108, v108, v2
  v_sub_f32 v77, v77, v2
  v_sub_f32 v109, v109, v2
  v_sub_f32 v78, v78, v2
  v_sub_f32 v110, v110, v2
  v_sub_f32 v79, v79, v2
  v_sub_f32 v111, v111, v2
  v_mul_f32 v44, v44, v3
  v_accvgpr_read_b32 v4, a0
  v_accvgpr_read_b32 v5, a1
  v_accvgpr_read_b32 v6, a2
  v_accvgpr_read_b32 v7, a3
  v_mul_f32 v4, v4, v3
  v_mul_f32 v5, v5, v3
  v_mul_f32 v6, v6, v3
  v_mul_f32 v7, v7, v3
  v_accvgpr_write_b32 a0, v4
  v_accvgpr_write_b32 a1, v5
  v_accvgpr_write_b32 a2, v6
  v_accvgpr_write_b32 a3, v7
  v_accvgpr_read_b32 v4, a4
  v_accvgpr_read_b32 v5, a5
  v_accvgpr_read_b32 v6, a6
  v_accvgpr_read_b32 v7, a7
  v_mul_f32 v4, v4, v3
  v_mul_f32 v5, v5, v3
  v_mul_f32 v6, v6, v3
  v_mul_f32 v7, v7, v3
  v_accvgpr_write_b32 a4, v4
  v_accvgpr_write_b32 a5, v5
  v_accvgpr_write_b32 a6, v6
  v_accvgpr_write_b32 a7, v7
  v_accvgpr_read_b32 v4, a8
  v_accvgpr_read_b32 v5, a9
  v_accvgpr_read_b32 v6, a10
  v_accvgpr_read_b32 v7, a11
  v_mul_f32 v4, v4, v3
  v_mul_f32 v5, v5, v3
  v_mul_f32 v6, v6, v3
  v_mul_f32 v7, v7, v3
  v_accvgpr_write_b32 a8, v4
  v_accvgpr_write_b32 a9, v5
  v_accvgpr_write_b32 a10, v6
  v_accvgpr_write_b32 a11, v7
  v_accvgpr_read_b32 v4, a12
  v_accvgpr_read_b32 v5, a13
  v_accvgpr_read_b32 v6, a14
  v_accvgpr_read_b32 v7, a15
  v_mul_f32 v4, v4, v3
  v_mul_f32 v5, v5, v3
  v_mul_f32 v6, v6, v3
  v_mul_f32 v7, v7, v3
  v_accvgpr_write_b32 a12, v4
  v_accvgpr_write_b32 a13, v5
  v_accvgpr_write_b32 a14, v6
  v_accvgpr_write_b32 a15, v7
  v_accvgpr_read_b32 v4, a16
  v_accvgpr_read_b32 v5, a17
  v_accvgpr_read_b32 v6, a18
  v_accvgpr_read_b32 v7, a19
  v_mul_f32 v4, v4, v3
  v_mul_f32 v5, v5, v3
  v_mul_f32 v6, v6, v3
  v_mul_f32 v7, v7, v3
  v_accvgpr_write_b32 a16, v4
  v_accvgpr_write_b32 a17, v5
  v_accvgpr_write_b32 a18, v6
  v_accvgpr_write_b32 a19, v7
  v_accvgpr_read_b32 v4, a20
  v_accvgpr_read_b32 v5, a21
  v_accvgpr_read_b32 v6, a22
  v_accvgpr_read_b32 v7, a23
  v_mul_f32 v4, v4, v3
  v_mul_f32 v5, v5, v3
  v_mul_f32 v6, v6, v3
  v_mul_f32 v7, v7, v3
  v_accvgpr_write_b32 a20, v4
  v_accvgpr_write_b32 a21, v5
  v_accvgpr_write_b32 a22, v6
  v_accvgpr_write_b32 a23, v7
  v_accvgpr_read_b32 v4, a24
  v_accvgpr_read_b32 v5, a25
  v_accvgpr_read_b32 v6, a26
  v_accvgpr_read_b32 v7, a27
  v_mul_f32 v4, v4, v3
  v_mul_f32 v5, v5, v3
  v_mul_f32 v6, v6, v3
  v_mul_f32 v7, v7, v3
  v_accvgpr_write_b32 a24, v4
  v_accvgpr_write_b32 a25, v5
  v_accvgpr_write_b32 a26, v6
  v_accvgpr_write_b32 a27, v7
  v_accvgpr_read_b32 v4, a28
  v_accvgpr_read_b32 v5, a29
  v_accvgpr_read_b32 v6, a30
  v_accvgpr_read_b32 v7, a31
  v_mul_f32 v4, v4, v3
  v_mul_f32 v5, v5, v3
  v_mul_f32 v6, v6, v3
  v_mul_f32 v7, v7, v3
  v_accvgpr_write_b32 a28, v4
  v_accvgpr_write_b32 a29, v5
  v_accvgpr_write_b32 a30, v6
  v_accvgpr_write_b32 a31, v7
  v_accvgpr_read_b32 v4, a32
  v_accvgpr_read_b32 v5, a33
  v_accvgpr_read_b32 v6, a34
  v_accvgpr_read_b32 v7, a35
  v_mul_f32 v4, v4, v3
  v_mul_f32 v5, v5, v3
  v_mul_f32 v6, v6, v3
  v_mul_f32 v7, v7, v3
  v_accvgpr_write_b32 a32, v4
  v_accvgpr_write_b32 a33, v5
  v_accvgpr_write_b32 a34, v6
  v_accvgpr_write_b32 a35, v7
  v_accvgpr_read_b32 v4, a36
  v_accvgpr_read_b32 v5, a37
  v_accvgpr_read_b32 v6, a38
  v_accvgpr_read_b32 v7, a39
  v_mul_f32 v4, v4, v3
  v_mul_f32 v5, v5, v3
  v_mul_f32 v6, v6, v3
  v_mul_f32 v7, v7, v3
  v_accvgpr_write_b32 a36, v4
  v_accvgpr_write_b32 a37, v5
  v_accvgpr_write_b32 a38, v6
  v_accvgpr_write_b32 a39, v7
  v_accvgpr_read_b32 v4, a40
  v_accvgpr_read_b32 v5, a41
  v_accvgpr_read_b32 v6, a42
  v_accvgpr_read_b32 v7, a43
  v_mul_f32 v4, v4, v3
  v_mul_f32 v5, v5, v3
  v_mul_f32 v6, v6, v3
  v_mul_f32 v7, v7, v3
  v_accvgpr_write_b32 a40, v4
  v_accvgpr_write_b32 a41, v5
  v_accvgpr_write_b32 a42, v6
  v_accvgpr_write_b32 a43, v7
  v_accvgpr_read_b32 v4, a44
  v_accvgpr_read_b32 v5, a45
  v_accvgpr_read_b32 v6, a46
  v_accvgpr_read_b32 v7, a47
  v_mul_f32 v4, v4, v3
  v_mul_f32 v5, v5, v3
  v_mul_f32 v6, v6, v3
  v_mul_f32 v7, v7, v3
  v_accvgpr_write_b32 a44, v4
  v_accvgpr_write_b32 a45, v5
  v_accvgpr_write_b32 a46, v6
  v_accvgpr_write_b32 a47, v7
  v_accvgpr_read_b32 v4, a48
  v_accvgpr_read_b32 v5, a49
  v_accvgpr_read_b32 v6, a50
  v_accvgpr_read_b32 v7, a51
  v_mul_f32 v4, v4, v3
  v_mul_f32 v5, v5, v3
  v_mul_f32 v6, v6, v3
  v_mul_f32 v7, v7, v3
  v_accvgpr_write_b32 a48, v4
  v_accvgpr_write_b32 a49, v5
  v_accvgpr_write_b32 a50, v6
  v_accvgpr_write_b32 a51, v7
  v_accvgpr_read_b32 v4, a52
  v_accvgpr_read_b32 v5, a53
  v_accvgpr_read_b32 v6, a54
  v_accvgpr_read_b32 v7, a55
  v_mul_f32 v4, v4, v3
  v_mul_f32 v5, v5, v3
  v_mul_f32 v6, v6, v3
  v_mul_f32 v7, v7, v3
  v_accvgpr_write_b32 a52, v4
  v_accvgpr_write_b32 a53, v5
  v_accvgpr_write_b32 a54, v6
  v_accvgpr_write_b32 a55, v7
  v_accvgpr_read_b32 v4, a56
  v_accvgpr_read_b32 v5, a57
  v_accvgpr_read_b32 v6, a58
  v_accvgpr_read_b32 v7, a59
  v_mul_f32 v4, v4, v3
  v_mul_f32 v5, v5, v3
  v_mul_f32 v6, v6, v3
  v_mul_f32 v7, v7, v3
  v_accvgpr_write_b32 a56, v4
  v_accvgpr_write_b32 a57, v5
  v_accvgpr_write_b32 a58, v6
  v_accvgpr_write_b32 a59, v7
  v_accvgpr_read_b32 v4, a60
  v_accvgpr_read_b32 v5, a61
  v_accvgpr_read_b32 v6, a62
  v_accvgpr_read_b32 v7, a63
  v_mul_f32 v4, v4, v3
  v_mul_f32 v5, v5, v3
  v_mul_f32 v6, v6, v3
  v_mul_f32 v7, v7, v3
  v_accvgpr_write_b32 a60, v4
  v_accvgpr_write_b32 a61, v5
  v_accvgpr_write_b32 a62, v6
  v_accvgpr_write_b32 a63, v7
  s_nop 3
  s_branch L_slowA4_back
L_slowB4:
  s_nop 15
  v_mov_b32 v2, v46
  v_mov_b32 v3, v46
  s_nop 1
  v_permlane32_swap_b32 v2, v3
  v_max_f32 v2, v2, v3
  v_max_f32 v2, 0, v2
  v_sub_f32 v3, 0, v2
  v_exp_f32 v3, v3
  v_sub_f32 v80, v80, v2
  v_sub_f32 v112, v112, v2
  v_sub_f32 v81, v81, v2
  v_sub_f32 v113, v113, v2
  v_sub_f32 v82, v82, v2
  v_sub_f32 v114, v114, v2
  v_sub_f32 v83, v83, v2
  v_sub_f32 v115, v115, v2
  v_sub_f32 v84, v84, v2
  v_sub_f32 v116, v116, v2
  v_sub_f32 v85, v85, v2
  v_sub_f32 v117, v117, v2
  v_sub_f32 v86, v86, v2
  v_sub_f32 v118, v118, v2
  v_sub_f32 v87, v87, v2
  v_sub_f32 v119, v119, v2
  v_sub_f32 v88, v88, v2
  v_sub_f32 v120, v120, v2
  v_sub_f32 v89, v89, v2
  v_sub_f32 v121, v121, v2
  v_sub_f32 v90, v90, v2
  v_sub_f32 v122, v122, v2
  v_sub_f32 v91, v91, v2
  v_sub_f32 v123, v123, v2
  v_sub_f32 v92, v92, v2
  v_sub_f32 v124, v124, v2
  v_sub_f32 v93, v93, v2
  v_sub_f32 v125, v125, v2
  v_sub_f32 v94, v94, v2
  v_sub_f32 v126, v126, v2
  v_sub_f32 v95, v95, v2
  v_sub_f32 v127, v127, v2
  v_mul_f32 v45, v45, v3
  v_accvgpr_read_b32 v4, a64
  v_accvgpr_read_b32 v5, a65
  v_accvgpr_read_b32 v6, a66
  v_accvgpr_read_b32 v7, a67
  v_mul_f32 v4, v4, v3
  v_mul_f32 v5, v5, v3
  v_mul_f32 v6, v6, v3
  v_mul_f32 v7, v7, v3
  v_accvgpr_write_b32 a64, v4
  v_accvgpr_write_b32 a65, v5
  v_accvgpr_write_b32 a66, v6
  v_accvgpr_write_b32 a67, v7
  v_accvgpr_read_b32 v4, a68
  v_accvgpr_read_b32 v5, a69
  v_accvgpr_read_b32 v6, a70
  v_accvgpr_read_b32 v7, a71
  v_mul_f32 v4, v4, v3
  v_mul_f32 v5, v5, v3
  v_mul_f32 v6, v6, v3
  v_mul_f32 v7, v7, v3
  v_accvgpr_write_b32 a68, v4
  v_accvgpr_write_b32 a69, v5
  v_accvgpr_write_b32 a70, v6
  v_accvgpr_write_b32 a71, v7
  v_accvgpr_read_b32 v4, a72
  v_accvgpr_read_b32 v5, a73
  v_accvgpr_read_b32 v6, a74
  v_accvgpr_read_b32 v7, a75
  v_mul_f32 v4, v4, v3
  v_mul_f32 v5, v5, v3
  v_mul_f32 v6, v6, v3
  v_mul_f32 v7, v7, v3
  v_accvgpr_write_b32 a72, v4
  v_accvgpr_write_b32 a73, v5
  v_accvgpr_write_b32 a74, v6
  v_accvgpr_write_b32 a75, v7
  v_accvgpr_read_b32 v4, a76
  v_accvgpr_read_b32 v5, a77
  v_accvgpr_read_b32 v6, a78
  v_accvgpr_read_b32 v7, a79
  v_mul_f32 v4, v4, v3
  v_mul_f32 v5, v5, v3
  v_mul_f32 v6, v6, v3
  v_mul_f32 v7, v7, v3
  v_accvgpr_write_b32 a76, v4
  v_accvgpr_write_b32 a77, v5
  v_accvgpr_write_b32 a78, v6
  v_accvgpr_write_b32 a79, v7
  v_accvgpr_read_b32 v4, a80
  v_accvgpr_read_b32 v5, a81
  v_accvgpr_read_b32 v6, a82
  v_accvgpr_read_b32 v7, a83
  v_mul_f32 v4, v4, v3
  v_mul_f32 v5, v5, v3
  v_mul_f32 v6, v6, v3
  v_mul_f32 v7, v7, v3
  v_accvgpr_write_b32 a80, v4
  v_accvgpr_write_b32 a81, v5
  v_accvgpr_write_b32 a82, v6
  v_accvgpr_write_b32 a83, v7
  v_accvgpr_read_b32 v4, a84
  v_accvgpr_read_b32 v5, a85
  v_accvgpr_read_b32 v6, a86
  v_accvgpr_read_b32 v7, a87
  v_mul_f32 v4, v4, v3
  v_mul_f32 v5, v5, v3
  v_mul_f32 v6, v6, v3
  v_mul_f32 v7, v7, v3
  v_accvgpr_write_b32 a84, v4
  v_accvgpr_write_b32 a85, v5
  v_accvgpr_write_b32 a86, v6
  v_accvgpr_write_b32 a87, v7
  v_accvgpr_read_b32 v4, a88
  v_accvgpr_read_b32 v5, a89
  v_accvgpr_read_b32 v6, a90
  v_accvgpr_read_b32 v7, a91
  v_mul_f32 v4, v4, v3
  v_mul_f32 v5, v5, v3
  v_mul_f32 v6, v6, v3
  v_mul_f32 v7, v7, v3
  v_accvgpr_write_b32 a88, v4
  v_accvgpr_write_b32 a89, v5
  v_accvgpr_write_b32 a90, v6
  v_accvgpr_write_b32 a91, v7
  v_accvgpr_read_b32 v4, a92
  v_accvgpr_read_b32 v5, a93
  v_accvgpr_read_b32 v6, a94
  v_accvgpr_read_b32 v7, a95
  v_mul_f32 v4, v4, v3
  v_mul_f32 v5, v5, v3
  v_mul_f32 v6, v6, v3
  v_mul_f32 v7, v7, v3
  v_accvgpr_write_b32 a92, v4
  v_accvgpr_write_b32 a93, v5
  v_accvgpr_write_b32 a94, v6
  v_accvgpr_write_b32 a95, v7
  v_accvgpr_read_b32 v4, a96
  v_accvgpr_read_b32 v5, a97
  v_accvgpr_read_b32 v6, a98
  v_accvgpr_read_b32 v7, a99
  v_mul_f32 v4, v4, v3
  v_mul_f32 v5, v5, v3
  v_mul_f32 v6, v6, v3
  v_mul_f32 v7, v7, v3
  v_accvgpr_write_b32 a96, v4
  v_accvgpr_write_b32 a97, v5
  v_accvgpr_write_b32 a98, v6
  v_accvgpr_write_b32 a99, v7
  v_accvgpr_read_b32 v4, a100
  v_accvgpr_read_b32 v5, a101
  v_accvgpr_read_b32 v6, a102
  v_accvgpr_read_b32 v7, a103
  v_mul_f32 v4, v4, v3
  v_mul_f32 v5, v5, v3
  v_mul_f32 v6, v6, v3
  v_mul_f32 v7, v7, v3
  v_accvgpr_write_b32 a100, v4
  v_accvgpr_write_b32 a101, v5
  v_accvgpr_write_b32 a102, v6
  v_accvgpr_write_b32 a103, v7
  v_accvgpr_read_b32 v4, a104
  v_accvgpr_read_b32 v5, a105
  v_accvgpr_read_b32 v6, a106
  v_accvgpr_read_b32 v7, a107
  v_mul_f32 v4, v4, v3
  v_mul_f32 v5, v5, v3
  v_mul_f32 v6, v6, v3
  v_mul_f32 v7, v7, v3
  v_accvgpr_write_b32 a104, v4
  v_accvgpr_write_b32 a105, v5
  v_accvgpr_write_b32 a106, v6
  v_accvgpr_write_b32 a107, v7
  v_accvgpr_read_b32 v4, a108
  v_accvgpr_read_b32 v5, a109
  v_accvgpr_read_b32 v6, a110
  v_accvgpr_read_b32 v7, a111
  v_mul_f32 v4, v4, v3
  v_mul_f32 v5, v5, v3
  v_mul_f32 v6, v6, v3
  v_mul_f32 v7, v7, v3
  v_accvgpr_write_b32 a108, v4
  v_accvgpr_write_b32 a109, v5
  v_accvgpr_write_b32 a110, v6
  v_accvgpr_write_b32 a111, v7
  v_accvgpr_read_b32 v4, a112
  v_accvgpr_read_b32 v5, a113
  v_accvgpr_read_b32 v6, a114
  v_accvgpr_read_b32 v7, a115
  v_mul_f32 v4, v4, v3
  v_mul_f32 v5, v5, v3
  v_mul_f32 v6, v6, v3
  v_mul_f32 v7, v7, v3
  v_accvgpr_write_b32 a112, v4
  v_accvgpr_write_b32 a113, v5
  v_accvgpr_write_b32 a114, v6
  v_accvgpr_write_b32 a115, v7
  v_accvgpr_read_b32 v4, a116
  v_accvgpr_read_b32 v5, a117
  v_accvgpr_read_b32 v6, a118
  v_accvgpr_read_b32 v7, a119
  v_mul_f32 v4, v4, v3
  v_mul_f32 v5, v5, v3
  v_mul_f32 v6, v6, v3
  v_mul_f32 v7, v7, v3
  v_accvgpr_write_b32 a116, v4
  v_accvgpr_write_b32 a117, v5
  v_accvgpr_write_b32 a118, v6
  v_accvgpr_write_b32 a119, v7
  v_accvgpr_read_b32 v4, a120
  v_accvgpr_read_b32 v5, a121
  v_accvgpr_read_b32 v6, a122
  v_accvgpr_read_b32 v7, a123
  v_mul_f32 v4, v4, v3
  v_mul_f32 v5, v5, v3
  v_mul_f32 v6, v6, v3
  v_mul_f32 v7, v7, v3
  v_accvgpr_write_b32 a120, v4
  v_accvgpr_write_b32 a121, v5
  v_accvgpr_write_b32 a122, v6
  v_accvgpr_write_b32 a123, v7
  v_accvgpr_read_b32 v4, a124
  v_accvgpr_read_b32 v5, a125
  v_accvgpr_read_b32 v6, a126
  v_accvgpr_read_b32 v7, a127
  v_mul_f32 v4, v4, v3
  v_mul_f32 v5, v5, v3
  v_mul_f32 v6, v6, v3
  v_mul_f32 v7, v7, v3
  v_accvgpr_write_b32 a124, v4
  v_accvgpr_write_b32 a125, v5
  v_accvgpr_write_b32 a126, v6
  v_accvgpr_write_b32 a127, v7
  s_nop 3
  s_branch L_slowB4_back
L_slowA5:
  s_nop 15
  v_mov_b32 v2, v46
  v_mov_b32 v3, v46
  s_nop 1
  v_permlane32_swap_b32 v2, v3
  v_max_f32 v2, v2, v3
  v_max_f32 v2, 0, v2
  v_sub_f32 v3, 0, v2
  v_exp_f32 v3, v3
  v_sub_f32 v64, v64, v2
  v_sub_f32 v96, v96, v2
  v_sub_f32 v65, v65, v2
  v_sub_f32 v97, v97, v2
  v_sub_f32 v66, v66, v2
  v_sub_f32 v98, v98, v2
  v_sub_f32 v67, v67, v2
  v_sub_f32 v99, v99, v2
  v_sub_f32 v68, v68, v2
  v_sub_f32 v100, v100, v2
  v_sub_f32 v69, v69, v2
  v_sub_f32 v101, v101, v2
  v_sub_f32 v70, v70, v2
  v_sub_f32 v102, v102, v2
  v_sub_f32 v71, v71, v2
  v_sub_f32 v103, v103, v2
  v_sub_f32 v72, v72, v2
  v_sub_f32 v104, v104, v2
  v_sub_f32 v73, v73, v2
  v_sub_f32 v105, v105, v2
  v_sub_f32 v74, v74, v2
  v_sub_f32 v106, v106, v2
  v_sub_f32 v75, v75, v2
  v_sub_f32 v107, v107, v2
  v_sub_f32 v76, v76, v2
  v_sub_f32 v108, v108, v2
  v_sub_f32 v77, v77, v2
  v_sub_f32 v109, v109, v2
  v_sub_f32 v78, v78, v2
  v_sub_f32 v110, v110, v2
  v_sub_f32 v79, v79, v2
  v_sub_f32 v111, v111, v2
  v_mul_f32 v44, v44, v3
  v_accvgpr_read_b32 v4, a0
  v_accvgpr_read_b32 v5, a1
  v_accvgpr_read_b32 v6, a2
  v_accvgpr_read_b32 v7, a3
  v_mul_f32 v4, v4, v3
  v_mul_f32 v5, v5, v3
  v_mul_f32 v6, v6, v3
  v_mul_f32 v7, v7, v3
  v_accvgpr_write_b32 a0, v4
  v_accvgpr_write_b32 a1, v5
  v_accvgpr_write_b32 a2, v6
  v_accvgpr_write_b32 a3, v7
  v_accvgpr_read_b32 v4, a4
  v_accvgpr_read_b32 v5, a5
  v_accvgpr_read_b32 v6, a6
  v_accvgpr_read_b32 v7, a7
  v_mul_f32 v4, v4, v3
  v_mul_f32 v5, v5, v3
  v_mul_f32 v6, v6, v3
  v_mul_f32 v7, v7, v3
  v_accvgpr_write_b32 a4, v4
  v_accvgpr_write_b32 a5, v5
  v_accvgpr_write_b32 a6, v6
  v_accvgpr_write_b32 a7, v7
  v_accvgpr_read_b32 v4, a8
  v_accvgpr_read_b32 v5, a9
  v_accvgpr_read_b32 v6, a10
  v_accvgpr_read_b32 v7, a11
  v_mul_f32 v4, v4, v3
  v_mul_f32 v5, v5, v3
  v_mul_f32 v6, v6, v3
  v_mul_f32 v7, v7, v3
  v_accvgpr_write_b32 a8, v4
  v_accvgpr_write_b32 a9, v5
  v_accvgpr_write_b32 a10, v6
  v_accvgpr_write_b32 a11, v7
  v_accvgpr_read_b32 v4, a12
  v_accvgpr_read_b32 v5, a13
  v_accvgpr_read_b32 v6, a14
  v_accvgpr_read_b32 v7, a15
  v_mul_f32 v4, v4, v3
  v_mul_f32 v5, v5, v3
  v_mul_f32 v6, v6, v3
  v_mul_f32 v7, v7, v3
  v_accvgpr_write_b32 a12, v4
  v_accvgpr_write_b32 a13, v5
  v_accvgpr_write_b32 a14, v6
  v_accvgpr_write_b32 a15, v7
  v_accvgpr_read_b32 v4, a16
  v_accvgpr_read_b32 v5, a17
  v_accvgpr_read_b32 v6, a18
  v_accvgpr_read_b32 v7, a19
  v_mul_f32 v4, v4, v3
  v_mul_f32 v5, v5, v3
  v_mul_f32 v6, v6, v3
  v_mul_f32 v7, v7, v3
  v_accvgpr_write_b32 a16, v4
  v_accvgpr_write_b32 a17, v5
  v_accvgpr_write_b32 a18, v6
  v_accvgpr_write_b32 a19, v7
  v_accvgpr_read_b32 v4, a20
  v_accvgpr_read_b32 v5, a21
  v_accvgpr_read_b32 v6, a22
  v_accvgpr_read_b32 v7, a23
  v_mul_f32 v4, v4, v3
  v_mul_f32 v5, v5, v3
  v_mul_f32 v6, v6, v3
  v_mul_f32 v7, v7, v3
  v_accvgpr_write_b32 a20, v4
  v_accvgpr_write_b32 a21, v5
  v_accvgpr_write_b32 a22, v6
  v_accvgpr_write_b32 a23, v7
  v_accvgpr_read_b32 v4, a24
  v_accvgpr_read_b32 v5, a25
  v_accvgpr_read_b32 v6, a26
  v_accvgpr_read_b32 v7, a27
  v_mul_f32 v4, v4, v3
  v_mul_f32 v5, v5, v3
  v_mul_f32 v6, v6, v3
  v_mul_f32 v7, v7, v3
  v_accvgpr_write_b32 a24, v4
  v_accvgpr_write_b32 a25, v5
  v_accvgpr_write_b32 a26, v6
  v_accvgpr_write_b32 a27, v7
  v_accvgpr_read_b32 v4, a28
  v_accvgpr_read_b32 v5, a29
  v_accvgpr_read_b32 v6, a30
  v_accvgpr_read_b32 v7, a31
  v_mul_f32 v4, v4, v3
  v_mul_f32 v5, v5, v3
  v_mul_f32 v6, v6, v3
  v_mul_f32 v7, v7, v3
  v_accvgpr_write_b32 a28, v4
  v_accvgpr_write_b32 a29, v5
  v_accvgpr_write_b32 a30, v6
  v_accvgpr_write_b32 a31, v7
  v_accvgpr_read_b32 v4, a32
  v_accvgpr_read_b32 v5, a33
  v_accvgpr_read_b32 v6, a34
  v_accvgpr_read_b32 v7, a35
  v_mul_f32 v4, v4, v3
  v_mul_f32 v5, v5, v3
  v_mul_f32 v6, v6, v3
  v_mul_f32 v7, v7, v3
  v_accvgpr_write_b32 a32, v4
  v_accvgpr_write_b32 a33, v5
  v_accvgpr_write_b32 a34, v6
  v_accvgpr_write_b32 a35, v7
  v_accvgpr_read_b32 v4, a36
  v_accvgpr_read_b32 v5, a37
  v_accvgpr_read_b32 v6, a38
  v_accvgpr_read_b32 v7, a39
  v_mul_f32 v4, v4, v3
  v_mul_f32 v5, v5, v3
  v_mul_f32 v6, v6, v3
  v_mul_f32 v7, v7, v3
  v_accvgpr_write_b32 a36, v4
  v_accvgpr_write_b32 a37, v5
  v_accvgpr_write_b32 a38, v6
  v_accvgpr_write_b32 a39, v7
  v_accvgpr_read_b32 v4, a40
  v_accvgpr_read_b32 v5, a41
  v_accvgpr_read_b32 v6, a42
  v_accvgpr_read_b32 v7, a43
  v_mul_f32 v4, v4, v3
  v_mul_f32 v5, v5, v3
  v_mul_f32 v6, v6, v3
  v_mul_f32 v7, v7, v3
  v_accvgpr_write_b32 a40, v4
  v_accvgpr_write_b32 a41, v5
  v_accvgpr_write_b32 a42, v6
  v_accvgpr_write_b32 a43, v7
  v_accvgpr_read_b32 v4, a44
  v_accvgpr_read_b32 v5, a45
  v_accvgpr_read_b32 v6, a46
  v_accvgpr_read_b32 v7, a47
  v_mul_f32 v4, v4, v3
  v_mul_f32 v5, v5, v3
  v_mul_f32 v6, v6, v3
  v_mul_f32 v7, v7, v3
  v_accvgpr_write_b32 a44, v4
  v_accvgpr_write_b32 a45, v5
  v_accvgpr_write_b32 a46, v6
  v_accvgpr_write_b32 a47, v7
  v_accvgpr_read_b32 v4, a48
  v_accvgpr_read_b32 v5, a49
  v_accvgpr_read_b32 v6, a50
  v_accvgpr_read_b32 v7, a51
  v_mul_f32 v4, v4, v3
  v_mul_f32 v5, v5, v3
  v_mul_f32 v6, v6, v3
  v_mul_f32 v7, v7, v3
  v_accvgpr_write_b32 a48, v4
  v_accvgpr_write_b32 a49, v5
  v_accvgpr_write_b32 a50, v6
  v_accvgpr_write_b32 a51, v7
  v_accvgpr_read_b32 v4, a52
  v_accvgpr_read_b32 v5, a53
  v_accvgpr_read_b32 v6, a54
  v_accvgpr_read_b32 v7, a55
  v_mul_f32 v4, v4, v3
  v_mul_f32 v5, v5, v3
  v_mul_f32 v6, v6, v3
  v_mul_f32 v7, v7, v3
  v_accvgpr_write_b32 a52, v4
  v_accvgpr_write_b32 a53, v5
  v_accvgpr_write_b32 a54, v6
  v_accvgpr_write_b32 a55, v7
  v_accvgpr_read_b32 v4, a56
  v_accvgpr_read_b32 v5, a57
  v_accvgpr_read_b32 v6, a58
  v_accvgpr_read_b32 v7, a59
  v_mul_f32 v4, v4, v3
  v_mul_f32 v5, v5, v3
  v_mul_f32 v6, v6, v3
  v_mul_f32 v7, v7, v3
  v_accvgpr_write_b32 a56, v4
  v_accvgpr_write_b32 a57, v5
  v_accvgpr_write_b32 a58, v6
  v_accvgpr_write_b32 a59, v7
  v_accvgpr_read_b32 v4, a60
  v_accvgpr_read_b32 v5, a61
  v_accvgpr_read_b32 v6, a62
  v_accvgpr_read_b32 v7, a63
  v_mul_f32 v4, v4, v3
  v_mul_f32 v5, v5, v3
  v_mul_f32 v6, v6, v3
  v_mul_f32 v7, v7, v3
  v_accvgpr_write_b32 a60, v4
  v_accvgpr_write_b32 a61, v5
  v_accvgpr_write_b32 a62, v6
  v_accvgpr_write_b32 a63, v7
  s_nop 3
  s_branch L_slowA5_back
L_slowB5:
  s_nop 15
  v_mov_b32 v2, v46
  v_mov_b32 v3, v46
  s_nop 1
  v_permlane32_swap_b32 v2, v3
  v_max_f32 v2, v2, v3
  v_max_f32 v2, 0, v2
  v_sub_f32 v3, 0, v2
  v_exp_f32 v3, v3
  v_sub_f32 v80, v80, v2
  v_sub_f32 v112, v112, v2
  v_sub_f32 v81, v81, v2
  v_sub_f32 v113, v113, v2
  v_sub_f32 v82, v82, v2
  v_sub_f32 v114, v114, v2
  v_sub_f32 v83, v83, v2
  v_sub_f32 v115, v115, v2
  v_sub_f32 v84, v84, v2
  v_sub_f32 v116, v116, v2
  v_sub_f32 v85, v85, v2
  v_sub_f32 v117, v117, v2
  v_sub_f32 v86, v86, v2
  v_sub_f32 v118, v118, v2
  v_sub_f32 v87, v87, v2
  v_sub_f32 v119, v119, v2
  v_sub_f32 v88, v88, v2
  v_sub_f32 v120, v120, v2
  v_sub_f32 v89, v89, v2
  v_sub_f32 v121, v121, v2
  v_sub_f32 v90, v90, v2
  v_sub_f32 v122, v122, v2
  v_sub_f32 v91, v91, v2
  v_sub_f32 v123, v123, v2
  v_sub_f32 v92, v92, v2
  v_sub_f32 v124, v124, v2
  v_sub_f32 v93, v93, v2
  v_sub_f32 v125, v125, v2
  v_sub_f32 v94, v94, v2
  v_sub_f32 v126, v126, v2
  v_sub_f32 v95, v95, v2
  v_sub_f32 v127, v127, v2
  v_mul_f32 v45, v45, v3
  v_accvgpr_read_b32 v4, a64
  v_accvgpr_read_b32 v5, a65
  v_accvgpr_read_b32 v6, a66
  v_accvgpr_read_b32 v7, a67
  v_mul_f32 v4, v4, v3
  v_mul_f32 v5, v5, v3
  v_mul_f32 v6, v6, v3
  v_mul_f32 v7, v7, v3
  v_accvgpr_write_b32 a64, v4
  v_accvgpr_write_b32 a65, v5
  v_accvgpr_write_b32 a66, v6
  v_accvgpr_write_b32 a67, v7
  v_accvgpr_read_b32 v4, a68
  v_accvgpr_read_b32 v5, a69
  v_accvgpr_read_b32 v6, a70
  v_accvgpr_read_b32 v7, a71
  v_mul_f32 v4, v4, v3
  v_mul_f32 v5, v5, v3
  v_mul_f32 v6, v6, v3
  v_mul_f32 v7, v7, v3
  v_accvgpr_write_b32 a68, v4
  v_accvgpr_write_b32 a69, v5
  v_accvgpr_write_b32 a70, v6
  v_accvgpr_write_b32 a71, v7
  v_accvgpr_read_b32 v4, a72
  v_accvgpr_read_b32 v5, a73
  v_accvgpr_read_b32 v6, a74
  v_accvgpr_read_b32 v7, a75
  v_mul_f32 v4, v4, v3
  v_mul_f32 v5, v5, v3
  v_mul_f32 v6, v6, v3
  v_mul_f32 v7, v7, v3
  v_accvgpr_write_b32 a72, v4
  v_accvgpr_write_b32 a73, v5
  v_accvgpr_write_b32 a74, v6
  v_accvgpr_write_b32 a75, v7
  v_accvgpr_read_b32 v4, a76
  v_accvgpr_read_b32 v5, a77
  v_accvgpr_read_b32 v6, a78
  v_accvgpr_read_b32 v7, a79
  v_mul_f32 v4, v4, v3
  v_mul_f32 v5, v5, v3
  v_mul_f32 v6, v6, v3
  v_mul_f32 v7, v7, v3
  v_accvgpr_write_b32 a76, v4
  v_accvgpr_write_b32 a77, v5
  v_accvgpr_write_b32 a78, v6
  v_accvgpr_write_b32 a79, v7
  v_accvgpr_read_b32 v4, a80
  v_accvgpr_read_b32 v5, a81
  v_accvgpr_read_b32 v6, a82
  v_accvgpr_read_b32 v7, a83
  v_mul_f32 v4, v4, v3
  v_mul_f32 v5, v5, v3
  v_mul_f32 v6, v6, v3
  v_mul_f32 v7, v7, v3
  v_accvgpr_write_b32 a80, v4
  v_accvgpr_write_b32 a81, v5
  v_accvgpr_write_b32 a82, v6
  v_accvgpr_write_b32 a83, v7
  v_accvgpr_read_b32 v4, a84
  v_accvgpr_read_b32 v5, a85
  v_accvgpr_read_b32 v6, a86
  v_accvgpr_read_b32 v7, a87
  v_mul_f32 v4, v4, v3
  v_mul_f32 v5, v5, v3
  v_mul_f32 v6, v6, v3
  v_mul_f32 v7, v7, v3
  v_accvgpr_write_b32 a84, v4
  v_accvgpr_write_b32 a85, v5
  v_accvgpr_write_b32 a86, v6
  v_accvgpr_write_b32 a87, v7
  v_accvgpr_read_b32 v4, a88
  v_accvgpr_read_b32 v5, a89
  v_accvgpr_read_b32 v6, a90
  v_accvgpr_read_b32 v7, a91
  v_mul_f32 v4, v4, v3
  v_mul_f32 v5, v5, v3
  v_mul_f32 v6, v6, v3
  v_mul_f32 v7, v7, v3
  v_accvgpr_write_b32 a88, v4
  v_accvgpr_write_b32 a89, v5
  v_accvgpr_write_b32 a90, v6
  v_accvgpr_write_b32 a91, v7
  v_accvgpr_read_b32 v4, a92
  v_accvgpr_read_b32 v5, a93
  v_accvgpr_read_b32 v6, a94
  v_accvgpr_read_b32 v7, a95
  v_mul_f32 v4, v4, v3
  v_mul_f32 v5, v5, v3
  v_mul_f32 v6, v6, v3
  v_mul_f32 v7, v7, v3
  v_accvgpr_write_b32 a92, v4
  v_accvgpr_write_b32 a93, v5
  v_accvgpr_write_b32 a94, v6
  v_accvgpr_write_b32 a95, v7
  v_accvgpr_read_b32 v4, a96
  v_accvgpr_read_b32 v5, a97
  v_accvgpr_read_b32 v6, a98
  v_accvgpr_read_b32 v7, a99
  v_mul_f32 v4, v4, v3
  v_mul_f32 v5, v5, v3
  v_mul_f32 v6, v6, v3
  v_mul_f32 v7, v7, v3
  v_accvgpr_write_b32 a96, v4
  v_accvgpr_write_b32 a97, v5
  v_accvgpr_write_b32 a98, v6
  v_accvgpr_write_b32 a99, v7
  v_accvgpr_read_b32 v4, a100
  v_accvgpr_read_b32 v5, a101
  v_accvgpr_read_b32 v6, a102
  v_accvgpr_read_b32 v7, a103
  v_mul_f32 v4, v4, v3
  v_mul_f32 v5, v5, v3
  v_mul_f32 v6, v6, v3
  v_mul_f32 v7, v7, v3
  v_accvgpr_write_b32 a100, v4
  v_accvgpr_write_b32 a101, v5
  v_accvgpr_write_b32 a102, v6
  v_accvgpr_write_b32 a103, v7
  v_accvgpr_read_b32 v4, a104
  v_accvgpr_read_b32 v5, a105
  v_accvgpr_read_b32 v6, a106
  v_accvgpr_read_b32 v7, a107
  v_mul_f32 v4, v4, v3
  v_mul_f32 v5, v5, v3
  v_mul_f32 v6, v6, v3
  v_mul_f32 v7, v7, v3
  v_accvgpr_write_b32 a104, v4
  v_accvgpr_write_b32 a105, v5
  v_accvgpr_write_b32 a106, v6
  v_accvgpr_write_b32 a107, v7
  v_accvgpr_read_b32 v4, a108
  v_accvgpr_read_b32 v5, a109
  v_accvgpr_read_b32 v6, a110
  v_accvgpr_read_b32 v7, a111
  v_mul_f32 v4, v4, v3
  v_mul_f32 v5, v5, v3
  v_mul_f32 v6, v6, v3
  v_mul_f32 v7, v7, v3
  v_accvgpr_write_b32 a108, v4
  v_accvgpr_write_b32 a109, v5
  v_accvgpr_write_b32 a110, v6
  v_accvgpr_write_b32 a111, v7
  v_accvgpr_read_b32 v4, a112
  v_accvgpr_read_b32 v5, a113
  v_accvgpr_read_b32 v6, a114
  v_accvgpr_read_b32 v7, a115
  v_mul_f32 v4, v4, v3
  v_mul_f32 v5, v5, v3
  v_mul_f32 v6, v6, v3
  v_mul_f32 v7, v7, v3
  v_accvgpr_write_b32 a112, v4
  v_accvgpr_write_b32 a113, v5
  v_accvgpr_write_b32 a114, v6
  v_accvgpr_write_b32 a115, v7
  v_accvgpr_read_b32 v4, a116
  v_accvgpr_read_b32 v5, a117
  v_accvgpr_read_b32 v6, a118
  v_accvgpr_read_b32 v7, a119
  v_mul_f32 v4, v4, v3
  v_mul_f32 v5, v5, v3
  v_mul_f32 v6, v6, v3
  v_mul_f32 v7, v7, v3
  v_accvgpr_write_b32 a116, v4
  v_accvgpr_write_b32 a117, v5
  v_accvgpr_write_b32 a118, v6
  v_accvgpr_write_b32 a119, v7
  v_accvgpr_read_b32 v4, a120
  v_accvgpr_read_b32 v5, a121
  v_accvgpr_read_b32 v6, a122
  v_accvgpr_read_b32 v7, a123
  v_mul_f32 v4, v4, v3
  v_mul_f32 v5, v5, v3
  v_mul_f32 v6, v6, v3
  v_mul_f32 v7, v7, v3
  v_accvgpr_write_b32 a120, v4
  v_accvgpr_write_b32 a121, v5
  v_accvgpr_write_b32 a122, v6
  v_accvgpr_write_b32 a123, v7
  v_accvgpr_read_b32 v4, a124
  v_accvgpr_read_b32 v5, a125
  v_accvgpr_read_b32 v6, a126
  v_accvgpr_read_b32 v7, a127
  v_mul_f32 v4, v4, v3
  v_mul_f32 v5, v5, v3
  v_mul_f32 v6, v6, v3
  v_mul_f32 v7, v7, v3
  v_accvgpr_write_b32 a124, v4
  v_accvgpr_write_b32 a125, v5
  v_accvgpr_write_b32 a126, v6
  v_accvgpr_write_b32 a127, v7
  s_nop 3
  s_branch L_slowB5_back
L_slowA6:
  s_nop 15
  v_mov_b32 v2, v46
  v_mov_b32 v3, v46
  s_nop 1
  v_permlane32_swap_b32 v2, v3
  v_max_f32 v2, v2, v3
  v_max_f32 v2, 0, v2
  v_sub_f32 v3, 0, v2
  v_exp_f32 v3, v3
  v_sub_f32 v64, v64, v2
  v_sub_f32 v96, v96, v2
  v_sub_f32 v65, v65, v2
  v_sub_f32 v97, v97, v2
  v_sub_f32 v66, v66, v2
  v_sub_f32 v98, v98, v2
  v_sub_f32 v67, v67, v2
  v_sub_f32 v99, v99, v2
  v_sub_f32 v68, v68, v2
  v_sub_f32 v100, v100, v2
  v_sub_f32 v69, v69, v2
  v_sub_f32 v101, v101, v2
  v_sub_f32 v70, v70, v2
  v_sub_f32 v102, v102, v2
  v_sub_f32 v71, v71, v2
  v_sub_f32 v103, v103, v2
  v_sub_f32 v72, v72, v2
  v_sub_f32 v104, v104, v2
  v_sub_f32 v73, v73, v2
  v_sub_f32 v105, v105, v2
  v_sub_f32 v74, v74, v2
  v_sub_f32 v106, v106, v2
  v_sub_f32 v75, v75, v2
  v_sub_f32 v107, v107, v2
  v_sub_f32 v76, v76, v2
  v_sub_f32 v108, v108, v2
  v_sub_f32 v77, v77, v2
  v_sub_f32 v109, v109, v2
  v_sub_f32 v78, v78, v2
  v_sub_f32 v110, v110, v2
  v_sub_f32 v79, v79, v2
  v_sub_f32 v111, v111, v2
  v_mul_f32 v44, v44, v3
  v_accvgpr_read_b32 v4, a0
  v_accvgpr_read_b32 v5, a1
  v_accvgpr_read_b32 v6, a2
  v_accvgpr_read_b32 v7, a3
  v_mul_f32 v4, v4, v3
  v_mul_f32 v5, v5, v3
  v_mul_f32 v6, v6, v3
  v_mul_f32 v7, v7, v3
  v_accvgpr_write_b32 a0, v4
  v_accvgpr_write_b32 a1, v5
  v_accvgpr_write_b32 a2, v6
  v_accvgpr_write_b32 a3, v7
  v_accvgpr_read_b32 v4, a4
  v_accvgpr_read_b32 v5, a5
  v_accvgpr_read_b32 v6, a6
  v_accvgpr_read_b32 v7, a7
  v_mul_f32 v4, v4, v3
  v_mul_f32 v5, v5, v3
  v_mul_f32 v6, v6, v3
  v_mul_f32 v7, v7, v3
  v_accvgpr_write_b32 a4, v4
  v_accvgpr_write_b32 a5, v5
  v_accvgpr_write_b32 a6, v6
  v_accvgpr_write_b32 a7, v7
  v_accvgpr_read_b32 v4, a8
  v_accvgpr_read_b32 v5, a9
  v_accvgpr_read_b32 v6, a10
  v_accvgpr_read_b32 v7, a11
  v_mul_f32 v4, v4, v3
  v_mul_f32 v5, v5, v3
  v_mul_f32 v6, v6, v3
  v_mul_f32 v7, v7, v3
  v_accvgpr_write_b32 a8, v4
  v_accvgpr_write_b32 a9, v5
  v_accvgpr_write_b32 a10, v6
  v_accvgpr_write_b32 a11, v7
  v_accvgpr_read_b32 v4, a12
  v_accvgpr_read_b32 v5, a13
  v_accvgpr_read_b32 v6, a14
  v_accvgpr_read_b32 v7, a15
  v_mul_f32 v4, v4, v3
  v_mul_f32 v5, v5, v3
  v_mul_f32 v6, v6, v3
  v_mul_f32 v7, v7, v3
  v_accvgpr_write_b32 a12, v4
  v_accvgpr_write_b32 a13, v5
  v_accvgpr_write_b32 a14, v6
  v_accvgpr_write_b32 a15, v7
  v_accvgpr_read_b32 v4, a16
  v_accvgpr_read_b32 v5, a17
  v_accvgpr_read_b32 v6, a18
  v_accvgpr_read_b32 v7, a19
  v_mul_f32 v4, v4, v3
  v_mul_f32 v5, v5, v3
  v_mul_f32 v6, v6, v3
  v_mul_f32 v7, v7, v3
  v_accvgpr_write_b32 a16, v4
  v_accvgpr_write_b32 a17, v5
  v_accvgpr_write_b32 a18, v6
  v_accvgpr_write_b32 a19, v7
  v_accvgpr_read_b32 v4, a20
  v_accvgpr_read_b32 v5, a21
  v_accvgpr_read_b32 v6, a22
  v_accvgpr_read_b32 v7, a23
  v_mul_f32 v4, v4, v3
  v_mul_f32 v5, v5, v3
  v_mul_f32 v6, v6, v3
  v_mul_f32 v7, v7, v3
  v_accvgpr_write_b32 a20, v4
  v_accvgpr_write_b32 a21, v5
  v_accvgpr_write_b32 a22, v6
  v_accvgpr_write_b32 a23, v7
  v_accvgpr_read_b32 v4, a24
  v_accvgpr_read_b32 v5, a25
  v_accvgpr_read_b32 v6, a26
  v_accvgpr_read_b32 v7, a27
  v_mul_f32 v4, v4, v3
  v_mul_f32 v5, v5, v3
  v_mul_f32 v6, v6, v3
  v_mul_f32 v7, v7, v3
  v_accvgpr_write_b32 a24, v4
  v_accvgpr_write_b32 a25, v5
  v_accvgpr_write_b32 a26, v6
  v_accvgpr_write_b32 a27, v7
  v_accvgpr_read_b32 v4, a28
  v_accvgpr_read_b32 v5, a29
  v_accvgpr_read_b32 v6, a30
  v_accvgpr_read_b32 v7, a31
  v_mul_f32 v4, v4, v3
  v_mul_f32 v5, v5, v3
  v_mul_f32 v6, v6, v3
  v_mul_f32 v7, v7, v3
  v_accvgpr_write_b32 a28, v4
  v_accvgpr_write_b32 a29, v5
  v_accvgpr_write_b32 a30, v6
  v_accvgpr_write_b32 a31, v7
  v_accvgpr_read_b32 v4, a32
  v_accvgpr_read_b32 v5, a33
  v_accvgpr_read_b32 v6, a34
  v_accvgpr_read_b32 v7, a35
  v_mul_f32 v4, v4, v3
  v_mul_f32 v5, v5, v3
  v_mul_f32 v6, v6, v3
  v_mul_f32 v7, v7, v3
  v_accvgpr_write_b32 a32, v4
  v_accvgpr_write_b32 a33, v5
  v_accvgpr_write_b32 a34, v6
  v_accvgpr_write_b32 a35, v7
  v_accvgpr_read_b32 v4, a36
  v_accvgpr_read_b32 v5, a37
  v_accvgpr_read_b32 v6, a38
  v_accvgpr_read_b32 v7, a39
  v_mul_f32 v4, v4, v3
  v_mul_f32 v5, v5, v3
  v_mul_f32 v6, v6, v3
  v_mul_f32 v7, v7, v3
  v_accvgpr_write_b32 a36, v4
  v_accvgpr_write_b32 a37, v5
  v_accvgpr_write_b32 a38, v6
  v_accvgpr_write_b32 a39, v7
  v_accvgpr_read_b32 v4, a40
  v_accvgpr_read_b32 v5, a41
  v_accvgpr_read_b32 v6, a42
  v_accvgpr_read_b32 v7, a43
  v_mul_f32 v4, v4, v3
  v_mul_f32 v5, v5, v3
  v_mul_f32 v6, v6, v3
  v_mul_f32 v7, v7, v3
  v_accvgpr_write_b32 a40, v4
  v_accvgpr_write_b32 a41, v5
  v_accvgpr_write_b32 a42, v6
  v_accvgpr_write_b32 a43, v7
  v_accvgpr_read_b32 v4, a44
  v_accvgpr_read_b32 v5, a45
  v_accvgpr_read_b32 v6, a46
  v_accvgpr_read_b32 v7, a47
  v_mul_f32 v4, v4, v3
  v_mul_f32 v5, v5, v3
  v_mul_f32 v6, v6, v3
  v_mul_f32 v7, v7, v3
  v_accvgpr_write_b32 a44, v4
  v_accvgpr_write_b32 a45, v5
  v_accvgpr_write_b32 a46, v6
  v_accvgpr_write_b32 a47, v7
  v_accvgpr_read_b32 v4, a48
  v_accvgpr_read_b32 v5, a49
  v_accvgpr_read_b32 v6, a50
  v_accvgpr_read_b32 v7, a51
  v_mul_f32 v4, v4, v3
  v_mul_f32 v5, v5, v3
  v_mul_f32 v6, v6, v3
  v_mul_f32 v7, v7, v3
  v_accvgpr_write_b32 a48, v4
  v_accvgpr_write_b32 a49, v5
  v_accvgpr_write_b32 a50, v6
  v_accvgpr_write_b32 a51, v7
  v_accvgpr_read_b32 v4, a52
  v_accvgpr_read_b32 v5, a53
  v_accvgpr_read_b32 v6, a54
  v_accvgpr_read_b32 v7, a55
  v_mul_f32 v4, v4, v3
  v_mul_f32 v5, v5, v3
  v_mul_f32 v6, v6, v3
  v_mul_f32 v7, v7, v3
  v_accvgpr_write_b32 a52, v4
  v_accvgpr_write_b32 a53, v5
  v_accvgpr_write_b32 a54, v6
  v_accvgpr_write_b32 a55, v7
  v_accvgpr_read_b32 v4, a56
  v_accvgpr_read_b32 v5, a57
  v_accvgpr_read_b32 v6, a58
  v_accvgpr_read_b32 v7, a59
  v_mul_f32 v4, v4, v3
  v_mul_f32 v5, v5, v3
  v_mul_f32 v6, v6, v3
  v_mul_f32 v7, v7, v3
  v_accvgpr_write_b32 a56, v4
  v_accvgpr_write_b32 a57, v5
  v_accvgpr_write_b32 a58, v6
  v_accvgpr_write_b32 a59, v7
  v_accvgpr_read_b32 v4, a60
  v_accvgpr_read_b32 v5, a61
  v_accvgpr_read_b32 v6, a62
  v_accvgpr_read_b32 v7, a63
  v_mul_f32 v4, v4, v3
  v_mul_f32 v5, v5, v3
  v_mul_f32 v6, v6, v3
  v_mul_f32 v7, v7, v3
  v_accvgpr_write_b32 a60, v4
  v_accvgpr_write_b32 a61, v5
  v_accvgpr_write_b32 a62, v6
  v_accvgpr_write_b32 a63, v7
  s_nop 3
  s_branch L_slowA6_back
L_slowB6:
  s_nop 15
  v_mov_b32 v2, v46
  v_mov_b32 v3, v46
  s_nop 1
  v_permlane32_swap_b32 v2, v3
  v_max_f32 v2, v2, v3
  v_max_f32 v2, 0, v2
  v_sub_f32 v3, 0, v2
  v_exp_f32 v3, v3
  v_sub_f32 v80, v80, v2
  v_sub_f32 v112, v112, v2
  v_sub_f32 v81, v81, v2
  v_sub_f32 v113, v113, v2
  v_sub_f32 v82, v82, v2
  v_sub_f32 v114, v114, v2
  v_sub_f32 v83, v83, v2
  v_sub_f32 v115, v115, v2
  v_sub_f32 v84, v84, v2
  v_sub_f32 v116, v116, v2
  v_sub_f32 v85, v85, v2
  v_sub_f32 v117, v117, v2
  v_sub_f32 v86, v86, v2
  v_sub_f32 v118, v118, v2
  v_sub_f32 v87, v87, v2
  v_sub_f32 v119, v119, v2
  v_sub_f32 v88, v88, v2
  v_sub_f32 v120, v120, v2
  v_sub_f32 v89, v89, v2
  v_sub_f32 v121, v121, v2
  v_sub_f32 v90, v90, v2
  v_sub_f32 v122, v122, v2
  v_sub_f32 v91, v91, v2
  v_sub_f32 v123, v123, v2
  v_sub_f32 v92, v92, v2
  v_sub_f32 v124, v124, v2
  v_sub_f32 v93, v93, v2
  v_sub_f32 v125, v125, v2
  v_sub_f32 v94, v94, v2
  v_sub_f32 v126, v126, v2
  v_sub_f32 v95, v95, v2
  v_sub_f32 v127, v127, v2
  v_mul_f32 v45, v45, v3
  v_accvgpr_read_b32 v4, a64
  v_accvgpr_read_b32 v5, a65
  v_accvgpr_read_b32 v6, a66
  v_accvgpr_read_b32 v7, a67
  v_mul_f32 v4, v4, v3
  v_mul_f32 v5, v5, v3
  v_mul_f32 v6, v6, v3
  v_mul_f32 v7, v7, v3
  v_accvgpr_write_b32 a64, v4
  v_accvgpr_write_b32 a65, v5
  v_accvgpr_write_b32 a66, v6
  v_accvgpr_write_b32 a67, v7
  v_accvgpr_read_b32 v4, a68
  v_accvgpr_read_b32 v5, a69
  v_accvgpr_read_b32 v6, a70
  v_accvgpr_read_b32 v7, a71
  v_mul_f32 v4, v4, v3
  v_mul_f32 v5, v5, v3
  v_mul_f32 v6, v6, v3
  v_mul_f32 v7, v7, v3
  v_accvgpr_write_b32 a68, v4
  v_accvgpr_write_b32 a69, v5
  v_accvgpr_write_b32 a70, v6
  v_accvgpr_write_b32 a71, v7
  v_accvgpr_read_b32 v4, a72
  v_accvgpr_read_b32 v5, a73
  v_accvgpr_read_b32 v6, a74
  v_accvgpr_read_b32 v7, a75
  v_mul_f32 v4, v4, v3
  v_mul_f32 v5, v5, v3
  v_mul_f32 v6, v6, v3
  v_mul_f32 v7, v7, v3
  v_accvgpr_write_b32 a72, v4
  v_accvgpr_write_b32 a73, v5
  v_accvgpr_write_b32 a74, v6
  v_accvgpr_write_b32 a75, v7
  v_accvgpr_read_b32 v4, a76
  v_accvgpr_read_b32 v5, a77
  v_accvgpr_read_b32 v6, a78
  v_accvgpr_read_b32 v7, a79
  v_mul_f32 v4, v4, v3
  v_mul_f32 v5, v5, v3
  v_mul_f32 v6, v6, v3
  v_mul_f32 v7, v7, v3
  v_accvgpr_write_b32 a76, v4
  v_accvgpr_write_b32 a77, v5
  v_accvgpr_write_b32 a78, v6
  v_accvgpr_write_b32 a79, v7
  v_accvgpr_read_b32 v4, a80
  v_accvgpr_read_b32 v5, a81
  v_accvgpr_read_b32 v6, a82
  v_accvgpr_read_b32 v7, a83
  v_mul_f32 v4, v4, v3
  v_mul_f32 v5, v5, v3
  v_mul_f32 v6, v6, v3
  v_mul_f32 v7, v7, v3
  v_accvgpr_write_b32 a80, v4
  v_accvgpr_write_b32 a81, v5
  v_accvgpr_write_b32 a82, v6
  v_accvgpr_write_b32 a83, v7
  v_accvgpr_read_b32 v4, a84
  v_accvgpr_read_b32 v5, a85
  v_accvgpr_read_b32 v6, a86
  v_accvgpr_read_b32 v7, a87
  v_mul_f32 v4, v4, v3
  v_mul_f32 v5, v5, v3
  v_mul_f32 v6, v6, v3
  v_mul_f32 v7, v7, v3
  v_accvgpr_write_b32 a84, v4
  v_accvgpr_write_b32 a85, v5
  v_accvgpr_write_b32 a86, v6
  v_accvgpr_write_b32 a87, v7
  v_accvgpr_read_b32 v4, a88
  v_accvgpr_read_b32 v5, a89
  v_accvgpr_read_b32 v6, a90
  v_accvgpr_read_b32 v7, a91
  v_mul_f32 v4, v4, v3
  v_mul_f32 v5, v5, v3
  v_mul_f32 v6, v6, v3
  v_mul_f32 v7, v7, v3
  v_accvgpr_write_b32 a88, v4
  v_accvgpr_write_b32 a89, v5
  v_accvgpr_write_b32 a90, v6
  v_accvgpr_write_b32 a91, v7
  v_accvgpr_read_b32 v4, a92
  v_accvgpr_read_b32 v5, a93
  v_accvgpr_read_b32 v6, a94
  v_accvgpr_read_b32 v7, a95
  v_mul_f32 v4, v4, v3
  v_mul_f32 v5, v5, v3
  v_mul_f32 v6, v6, v3
  v_mul_f32 v7, v7, v3
  v_accvgpr_write_b32 a92, v4
  v_accvgpr_write_b32 a93, v5
  v_accvgpr_write_b32 a94, v6
  v_accvgpr_write_b32 a95, v7
  v_accvgpr_read_b32 v4, a96
  v_accvgpr_read_b32 v5, a97
  v_accvgpr_read_b32 v6, a98
  v_accvgpr_read_b32 v7, a99
  v_mul_f32 v4, v4, v3
  v_mul_f32 v5, v5, v3
  v_mul_f32 v6, v6, v3
  v_mul_f32 v7, v7, v3
  v_accvgpr_write_b32 a96, v4
  v_accvgpr_write_b32 a97, v5
  v_accvgpr_write_b32 a98, v6
  v_accvgpr_write_b32 a99, v7
  v_accvgpr_read_b32 v4, a100
  v_accvgpr_read_b32 v5, a101
  v_accvgpr_read_b32 v6, a102
  v_accvgpr_read_b32 v7, a103
  v_mul_f32 v4, v4, v3
  v_mul_f32 v5, v5, v3
  v_mul_f32 v6, v6, v3
  v_mul_f32 v7, v7, v3
  v_accvgpr_write_b32 a100, v4
  v_accvgpr_write_b32 a101, v5
  v_accvgpr_write_b32 a102, v6
  v_accvgpr_write_b32 a103, v7
  v_accvgpr_read_b32 v4, a104
  v_accvgpr_read_b32 v5, a105
  v_accvgpr_read_b32 v6, a106
  v_accvgpr_read_b32 v7, a107
  v_mul_f32 v4, v4, v3
  v_mul_f32 v5, v5, v3
  v_mul_f32 v6, v6, v3
  v_mul_f32 v7, v7, v3
  v_accvgpr_write_b32 a104, v4
  v_accvgpr_write_b32 a105, v5
  v_accvgpr_write_b32 a106, v6
  v_accvgpr_write_b32 a107, v7
  v_accvgpr_read_b32 v4, a108
  v_accvgpr_read_b32 v5, a109
  v_accvgpr_read_b32 v6, a110
  v_accvgpr_read_b32 v7, a111
  v_mul_f32 v4, v4, v3
  v_mul_f32 v5, v5, v3
  v_mul_f32 v6, v6, v3
  v_mul_f32 v7, v7, v3
  v_accvgpr_write_b32 a108, v4
  v_accvgpr_write_b32 a109, v5
  v_accvgpr_write_b32 a110, v6
  v_accvgpr_write_b32 a111, v7
  v_accvgpr_read_b32 v4, a112
  v_accvgpr_read_b32 v5, a113
  v_accvgpr_read_b32 v6, a114
  v_accvgpr_read_b32 v7, a115
  v_mul_f32 v4, v4, v3
  v_mul_f32 v5, v5, v3
  v_mul_f32 v6, v6, v3
  v_mul_f32 v7, v7, v3
  v_accvgpr_write_b32 a112, v4
  v_accvgpr_write_b32 a113, v5
  v_accvgpr_write_b32 a114, v6
  v_accvgpr_write_b32 a115, v7
  v_accvgpr_read_b32 v4, a116
  v_accvgpr_read_b32 v5, a117
  v_accvgpr_read_b32 v6, a118
  v_accvgpr_read_b32 v7, a119
  v_mul_f32 v4, v4, v3
  v_mul_f32 v5, v5, v3
  v_mul_f32 v6, v6, v3
  v_mul_f32 v7, v7, v3
  v_accvgpr_write_b32 a116, v4
  v_accvgpr_write_b32 a117, v5
  v_accvgpr_write_b32 a118, v6
  v_accvgpr_write_b32 a119, v7
  v_accvgpr_read_b32 v4, a120
  v_accvgpr_read_b32 v5, a121
  v_accvgpr_read_b32 v6, a122
  v_accvgpr_read_b32 v7, a123
  v_mul_f32 v4, v4, v3
  v_mul_f32 v5, v5, v3
  v_mul_f32 v6, v6, v3
  v_mul_f32 v7, v7, v3
  v_accvgpr_write_b32 a120, v4
  v_accvgpr_write_b32 a121, v5
  v_accvgpr_write_b32 a122, v6
  v_accvgpr_write_b32 a123, v7
  v_accvgpr_read_b32 v4, a124
  v_accvgpr_read_b32 v5, a125
  v_accvgpr_read_b32 v6, a126
  v_accvgpr_read_b32 v7, a127
  v_mul_f32 v4, v4, v3
  v_mul_f32 v5, v5, v3
  v_mul_f32 v6, v6, v3
  v_mul_f32 v7, v7, v3
  v_accvgpr_write_b32 a124, v4
  v_accvgpr_write_b32 a125, v5
  v_accvgpr_write_b32 a126, v6
  v_accvgpr_write_b32 a127, v7
  s_nop 3
  s_branch L_slowB6_back
L_slowA7:
  s_nop 15
  v_mov_b32 v2, v46
  v_mov_b32 v3, v46
  s_nop 1
  v_permlane32_swap_b32 v2, v3
  v_max_f32 v2, v2, v3
  v_max_f32 v2, 0, v2
  v_sub_f32 v3, 0, v2
  v_exp_f32 v3, v3
  v_sub_f32 v64, v64, v2
  v_sub_f32 v96, v96, v2
  v_sub_f32 v65, v65, v2
  v_sub_f32 v97, v97, v2
  v_sub_f32 v66, v66, v2
  v_sub_f32 v98, v98, v2
  v_sub_f32 v67, v67, v2
  v_sub_f32 v99, v99, v2
  v_sub_f32 v68, v68, v2
  v_sub_f32 v100, v100, v2
  v_sub_f32 v69, v69, v2
  v_sub_f32 v101, v101, v2
  v_sub_f32 v70, v70, v2
  v_sub_f32 v102, v102, v2
  v_sub_f32 v71, v71, v2
  v_sub_f32 v103, v103, v2
  v_sub_f32 v72, v72, v2
  v_sub_f32 v104, v104, v2
  v_sub_f32 v73, v73, v2
  v_sub_f32 v105, v105, v2
  v_sub_f32 v74, v74, v2
  v_sub_f32 v106, v106, v2
  v_sub_f32 v75, v75, v2
  v_sub_f32 v107, v107, v2
  v_sub_f32 v76, v76, v2
  v_sub_f32 v108, v108, v2
  v_sub_f32 v77, v77, v2
  v_sub_f32 v109, v109, v2
  v_sub_f32 v78, v78, v2
  v_sub_f32 v110, v110, v2
  v_sub_f32 v79, v79, v2
  v_sub_f32 v111, v111, v2
  v_mul_f32 v44, v44, v3
  v_accvgpr_read_b32 v4, a0
  v_accvgpr_read_b32 v5, a1
  v_accvgpr_read_b32 v6, a2
  v_accvgpr_read_b32 v7, a3
  v_mul_f32 v4, v4, v3
  v_mul_f32 v5, v5, v3
  v_mul_f32 v6, v6, v3
  v_mul_f32 v7, v7, v3
  v_accvgpr_write_b32 a0, v4
  v_accvgpr_write_b32 a1, v5
  v_accvgpr_write_b32 a2, v6
  v_accvgpr_write_b32 a3, v7
  v_accvgpr_read_b32 v4, a4
  v_accvgpr_read_b32 v5, a5
  v_accvgpr_read_b32 v6, a6
  v_accvgpr_read_b32 v7, a7
  v_mul_f32 v4, v4, v3
  v_mul_f32 v5, v5, v3
  v_mul_f32 v6, v6, v3
  v_mul_f32 v7, v7, v3
  v_accvgpr_write_b32 a4, v4
  v_accvgpr_write_b32 a5, v5
  v_accvgpr_write_b32 a6, v6
  v_accvgpr_write_b32 a7, v7
  v_accvgpr_read_b32 v4, a8
  v_accvgpr_read_b32 v5, a9
  v_accvgpr_read_b32 v6, a10
  v_accvgpr_read_b32 v7, a11
  v_mul_f32 v4, v4, v3
  v_mul_f32 v5, v5, v3
  v_mul_f32 v6, v6, v3
  v_mul_f32 v7, v7, v3
  v_accvgpr_write_b32 a8, v4
  v_accvgpr_write_b32 a9, v5
  v_accvgpr_write_b32 a10, v6
  v_accvgpr_write_b32 a11, v7
  v_accvgpr_read_b32 v4, a12
  v_accvgpr_read_b32 v5, a13
  v_accvgpr_read_b32 v6, a14
  v_accvgpr_read_b32 v7, a15
  v_mul_f32 v4, v4, v3
  v_mul_f32 v5, v5, v3
  v_mul_f32 v6, v6, v3
  v_mul_f32 v7, v7, v3
  v_accvgpr_write_b32 a12, v4
  v_accvgpr_write_b32 a13, v5
  v_accvgpr_write_b32 a14, v6
  v_accvgpr_write_b32 a15, v7
  v_accvgpr_read_b32 v4, a16
  v_accvgpr_read_b32 v5, a17
  v_accvgpr_read_b32 v6, a18
  v_accvgpr_read_b32 v7, a19
  v_mul_f32 v4, v4, v3
  v_mul_f32 v5, v5, v3
  v_mul_f32 v6, v6, v3
  v_mul_f32 v7, v7, v3
  v_accvgpr_write_b32 a16, v4
  v_accvgpr_write_b32 a17, v5
  v_accvgpr_write_b32 a18, v6
  v_accvgpr_write_b32 a19, v7
  v_accvgpr_read_b32 v4, a20
  v_accvgpr_read_b32 v5, a21
  v_accvgpr_read_b32 v6, a22
  v_accvgpr_read_b32 v7, a23
  v_mul_f32 v4, v4, v3
  v_mul_f32 v5, v5, v3
  v_mul_f32 v6, v6, v3
  v_mul_f32 v7, v7, v3
  v_accvgpr_write_b32 a20, v4
  v_accvgpr_write_b32 a21, v5
  v_accvgpr_write_b32 a22, v6
  v_accvgpr_write_b32 a23, v7
  v_accvgpr_read_b32 v4, a24
  v_accvgpr_read_b32 v5, a25
  v_accvgpr_read_b32 v6, a26
  v_accvgpr_read_b32 v7, a27
  v_mul_f32 v4, v4, v3
  v_mul_f32 v5, v5, v3
  v_mul_f32 v6, v6, v3
  v_mul_f32 v7, v7, v3
  v_accvgpr_write_b32 a24, v4
  v_accvgpr_write_b32 a25, v5
  v_accvgpr_write_b32 a26, v6
  v_accvgpr_write_b32 a27, v7
  v_accvgpr_read_b32 v4, a28
  v_accvgpr_read_b32 v5, a29
  v_accvgpr_read_b32 v6, a30
  v_accvgpr_read_b32 v7, a31
  v_mul_f32 v4, v4, v3
  v_mul_f32 v5, v5, v3
  v_mul_f32 v6, v6, v3
  v_mul_f32 v7, v7, v3
  v_accvgpr_write_b32 a28, v4
  v_accvgpr_write_b32 a29, v5
  v_accvgpr_write_b32 a30, v6
  v_accvgpr_write_b32 a31, v7
  v_accvgpr_read_b32 v4, a32
  v_accvgpr_read_b32 v5, a33
  v_accvgpr_read_b32 v6, a34
  v_accvgpr_read_b32 v7, a35
  v_mul_f32 v4, v4, v3
  v_mul_f32 v5, v5, v3
  v_mul_f32 v6, v6, v3
  v_mul_f32 v7, v7, v3
  v_accvgpr_write_b32 a32, v4
  v_accvgpr_write_b32 a33, v5
  v_accvgpr_write_b32 a34, v6
  v_accvgpr_write_b32 a35, v7
  v_accvgpr_read_b32 v4, a36
  v_accvgpr_read_b32 v5, a37
  v_accvgpr_read_b32 v6, a38
  v_accvgpr_read_b32 v7, a39
  v_mul_f32 v4, v4, v3
  v_mul_f32 v5, v5, v3
  v_mul_f32 v6, v6, v3
  v_mul_f32 v7, v7, v3
  v_accvgpr_write_b32 a36, v4
  v_accvgpr_write_b32 a37, v5
  v_accvgpr_write_b32 a38, v6
  v_accvgpr_write_b32 a39, v7
  v_accvgpr_read_b32 v4, a40
  v_accvgpr_read_b32 v5, a41
  v_accvgpr_read_b32 v6, a42
  v_accvgpr_read_b32 v7, a43
  v_mul_f32 v4, v4, v3
  v_mul_f32 v5, v5, v3
  v_mul_f32 v6, v6, v3
  v_mul_f32 v7, v7, v3
  v_accvgpr_write_b32 a40, v4
  v_accvgpr_write_b32 a41, v5
  v_accvgpr_write_b32 a42, v6
  v_accvgpr_write_b32 a43, v7
  v_accvgpr_read_b32 v4, a44
  v_accvgpr_read_b32 v5, a45
  v_accvgpr_read_b32 v6, a46
  v_accvgpr_read_b32 v7, a47
  v_mul_f32 v4, v4, v3
  v_mul_f32 v5, v5, v3
  v_mul_f32 v6, v6, v3
  v_mul_f32 v7, v7, v3
  v_accvgpr_write_b32 a44, v4
  v_accvgpr_write_b32 a45, v5
  v_accvgpr_write_b32 a46, v6
  v_accvgpr_write_b32 a47, v7
  v_accvgpr_read_b32 v4, a48
  v_accvgpr_read_b32 v5, a49
  v_accvgpr_read_b32 v6, a50
  v_accvgpr_read_b32 v7, a51
  v_mul_f32 v4, v4, v3
  v_mul_f32 v5, v5, v3
  v_mul_f32 v6, v6, v3
  v_mul_f32 v7, v7, v3
  v_accvgpr_write_b32 a48, v4
  v_accvgpr_write_b32 a49, v5
  v_accvgpr_write_b32 a50, v6
  v_accvgpr_write_b32 a51, v7
  v_accvgpr_read_b32 v4, a52
  v_accvgpr_read_b32 v5, a53
  v_accvgpr_read_b32 v6, a54
  v_accvgpr_read_b32 v7, a55
  v_mul_f32 v4, v4, v3
  v_mul_f32 v5, v5, v3
  v_mul_f32 v6, v6, v3
  v_mul_f32 v7, v7, v3
  v_accvgpr_write_b32 a52, v4
  v_accvgpr_write_b32 a53, v5
  v_accvgpr_write_b32 a54, v6
  v_accvgpr_write_b32 a55, v7
  v_accvgpr_read_b32 v4, a56
  v_accvgpr_read_b32 v5, a57
  v_accvgpr_read_b32 v6, a58
  v_accvgpr_read_b32 v7, a59
  v_mul_f32 v4, v4, v3
  v_mul_f32 v5, v5, v3
  v_mul_f32 v6, v6, v3
  v_mul_f32 v7, v7, v3
  v_accvgpr_write_b32 a56, v4
  v_accvgpr_write_b32 a57, v5
  v_accvgpr_write_b32 a58, v6
  v_accvgpr_write_b32 a59, v7
  v_accvgpr_read_b32 v4, a60
  v_accvgpr_read_b32 v5, a61
  v_accvgpr_read_b32 v6, a62
  v_accvgpr_read_b32 v7, a63
  v_mul_f32 v4, v4, v3
  v_mul_f32 v5, v5, v3
  v_mul_f32 v6, v6, v3
  v_mul_f32 v7, v7, v3
  v_accvgpr_write_b32 a60, v4
  v_accvgpr_write_b32 a61, v5
  v_accvgpr_write_b32 a62, v6
  v_accvgpr_write_b32 a63, v7
  s_nop 3
  s_branch L_slowA7_back
L_slowB7:
  s_nop 15
  v_mov_b32 v2, v46
  v_mov_b32 v3, v46
  s_nop 1
  v_permlane32_swap_b32 v2, v3
  v_max_f32 v2, v2, v3
  v_max_f32 v2, 0, v2
  v_sub_f32 v3, 0, v2
  v_exp_f32 v3, v3
  v_sub_f32 v80, v80, v2
  v_sub_f32 v112, v112, v2
  v_sub_f32 v81, v81, v2
  v_sub_f32 v113, v113, v2
  v_sub_f32 v82, v82, v2
  v_sub_f32 v114, v114, v2
  v_sub_f32 v83, v83, v2
  v_sub_f32 v115, v115, v2
  v_sub_f32 v84, v84, v2
  v_sub_f32 v116, v116, v2
  v_sub_f32 v85, v85, v2
  v_sub_f32 v117, v117, v2
  v_sub_f32 v86, v86, v2
  v_sub_f32 v118, v118, v2
  v_sub_f32 v87, v87, v2
  v_sub_f32 v119, v119, v2
  v_sub_f32 v88, v88, v2
  v_sub_f32 v120, v120, v2
  v_sub_f32 v89, v89, v2
  v_sub_f32 v121, v121, v2
  v_sub_f32 v90, v90, v2
  v_sub_f32 v122, v122, v2
  v_sub_f32 v91, v91, v2
  v_sub_f32 v123, v123, v2
  v_sub_f32 v92, v92, v2
  v_sub_f32 v124, v124, v2
  v_sub_f32 v93, v93, v2
  v_sub_f32 v125, v125, v2
  v_sub_f32 v94, v94, v2
  v_sub_f32 v126, v126, v2
  v_sub_f32 v95, v95, v2
  v_sub_f32 v127, v127, v2
  v_mul_f32 v45, v45, v3
  v_accvgpr_read_b32 v4, a64
  v_accvgpr_read_b32 v5, a65
  v_accvgpr_read_b32 v6, a66
  v_accvgpr_read_b32 v7, a67
  v_mul_f32 v4, v4, v3
  v_mul_f32 v5, v5, v3
  v_mul_f32 v6, v6, v3
  v_mul_f32 v7, v7, v3
  v_accvgpr_write_b32 a64, v4
  v_accvgpr_write_b32 a65, v5
  v_accvgpr_write_b32 a66, v6
  v_accvgpr_write_b32 a67, v7
  v_accvgpr_read_b32 v4, a68
  v_accvgpr_read_b32 v5, a69
  v_accvgpr_read_b32 v6, a70
  v_accvgpr_read_b32 v7, a71
  v_mul_f32 v4, v4, v3
  v_mul_f32 v5, v5, v3
  v_mul_f32 v6, v6, v3
  v_mul_f32 v7, v7, v3
  v_accvgpr_write_b32 a68, v4
  v_accvgpr_write_b32 a69, v5
  v_accvgpr_write_b32 a70, v6
  v_accvgpr_write_b32 a71, v7
  v_accvgpr_read_b32 v4, a72
  v_accvgpr_read_b32 v5, a73
  v_accvgpr_read_b32 v6, a74
  v_accvgpr_read_b32 v7, a75
  v_mul_f32 v4, v4, v3
  v_mul_f32 v5, v5, v3
  v_mul_f32 v6, v6, v3
  v_mul_f32 v7, v7, v3
  v_accvgpr_write_b32 a72, v4
  v_accvgpr_write_b32 a73, v5
  v_accvgpr_write_b32 a74, v6
  v_accvgpr_write_b32 a75, v7
  v_accvgpr_read_b32 v4, a76
  v_accvgpr_read_b32 v5, a77
  v_accvgpr_read_b32 v6, a78
  v_accvgpr_read_b32 v7, a79
  v_mul_f32 v4, v4, v3
  v_mul_f32 v5, v5, v3
  v_mul_f32 v6, v6, v3
  v_mul_f32 v7, v7, v3
  v_accvgpr_write_b32 a76, v4
  v_accvgpr_write_b32 a77, v5
  v_accvgpr_write_b32 a78, v6
  v_accvgpr_write_b32 a79, v7
  v_accvgpr_read_b32 v4, a80
  v_accvgpr_read_b32 v5, a81
  v_accvgpr_read_b32 v6, a82
  v_accvgpr_read_b32 v7, a83
  v_mul_f32 v4, v4, v3
  v_mul_f32 v5, v5, v3
  v_mul_f32 v6, v6, v3
  v_mul_f32 v7, v7, v3
  v_accvgpr_write_b32 a80, v4
  v_accvgpr_write_b32 a81, v5
  v_accvgpr_write_b32 a82, v6
  v_accvgpr_write_b32 a83, v7
  v_accvgpr_read_b32 v4, a84
  v_accvgpr_read_b32 v5, a85
  v_accvgpr_read_b32 v6, a86
  v_accvgpr_read_b32 v7, a87
  v_mul_f32 v4, v4, v3
  v_mul_f32 v5, v5, v3
  v_mul_f32 v6, v6, v3
  v_mul_f32 v7, v7, v3
  v_accvgpr_write_b32 a84, v4
  v_accvgpr_write_b32 a85, v5
  v_accvgpr_write_b32 a86, v6
  v_accvgpr_write_b32 a87, v7
  v_accvgpr_read_b32 v4, a88
  v_accvgpr_read_b32 v5, a89
  v_accvgpr_read_b32 v6, a90
  v_accvgpr_read_b32 v7, a91
  v_mul_f32 v4, v4, v3
  v_mul_f32 v5, v5, v3
  v_mul_f32 v6, v6, v3
  v_mul_f32 v7, v7, v3
  v_accvgpr_write_b32 a88, v4
  v_accvgpr_write_b32 a89, v5
  v_accvgpr_write_b32 a90, v6
  v_accvgpr_write_b32 a91, v7
  v_accvgpr_read_b32 v4, a92
  v_accvgpr_read_b32 v5, a93
  v_accvgpr_read_b32 v6, a94
  v_accvgpr_read_b32 v7, a95
  v_mul_f32 v4, v4, v3
  v_mul_f32 v5, v5, v3
  v_mul_f32 v6, v6, v3
  v_mul_f32 v7, v7, v3
  v_accvgpr_write_b32 a92, v4
  v_accvgpr_write_b32 a93, v5
  v_accvgpr_write_b32 a94, v6
  v_accvgpr_write_b32 a95, v7
  v_accvgpr_read_b32 v4, a96
  v_accvgpr_read_b32 v5, a97
  v_accvgpr_read_b32 v6, a98
  v_accvgpr_read_b32 v7, a99
  v_mul_f32 v4, v4, v3
  v_mul_f32 v5, v5, v3
  v_mul_f32 v6, v6, v3
  v_mul_f32 v7, v7, v3
  v_accvgpr_write_b32 a96, v4
  v_accvgpr_write_b32 a97, v5
  v_accvgpr_write_b32 a98, v6
  v_accvgpr_write_b32 a99, v7
  v_accvgpr_read_b32 v4, a100
  v_accvgpr_read_b32 v5, a101
  v_accvgpr_read_b32 v6, a102
  v_accvgpr_read_b32 v7, a103
  v_mul_f32 v4, v4, v3
  v_mul_f32 v5, v5, v3
  v_mul_f32 v6, v6, v3
  v_mul_f32 v7, v7, v3
  v_accvgpr_write_b32 a100, v4
  v_accvgpr_write_b32 a101, v5
  v_accvgpr_write_b32 a102, v6
  v_accvgpr_write_b32 a103, v7
  v_accvgpr_read_b32 v4, a104
  v_accvgpr_read_b32 v5, a105
  v_accvgpr_read_b32 v6, a106
  v_accvgpr_read_b32 v7, a107
  v_mul_f32 v4, v4, v3
  v_mul_f32 v5, v5, v3
  v_mul_f32 v6, v6, v3
  v_mul_f32 v7, v7, v3
  v_accvgpr_write_b32 a104, v4
  v_accvgpr_write_b32 a105, v5
  v_accvgpr_write_b32 a106, v6
  v_accvgpr_write_b32 a107, v7
  v_accvgpr_read_b32 v4, a108
  v_accvgpr_read_b32 v5, a109
  v_accvgpr_read_b32 v6, a110
  v_accvgpr_read_b32 v7, a111
  v_mul_f32 v4, v4, v3
  v_mul_f32 v5, v5, v3
  v_mul_f32 v6, v6, v3
  v_mul_f32 v7, v7, v3
  v_accvgpr_write_b32 a108, v4
  v_accvgpr_write_b32 a109, v5
  v_accvgpr_write_b32 a110, v6
  v_accvgpr_write_b32 a111, v7
  v_accvgpr_read_b32 v4, a112
  v_accvgpr_read_b32 v5, a113
  v_accvgpr_read_b32 v6, a114
  v_accvgpr_read_b32 v7, a115
  v_mul_f32 v4, v4, v3
  v_mul_f32 v5, v5, v3
  v_mul_f32 v6, v6, v3
  v_mul_f32 v7, v7, v3
  v_accvgpr_write_b32 a112, v4
  v_accvgpr_write_b32 a113, v5
  v_accvgpr_write_b32 a114, v6
  v_accvgpr_write_b32 a115, v7
  v_accvgpr_read_b32 v4, a116
  v_accvgpr_read_b32 v5, a117
  v_accvgpr_read_b32 v6, a118
  v_accvgpr_read_b32 v7, a119
  v_mul_f32 v4, v4, v3
  v_mul_f32 v5, v5, v3
  v_mul_f32 v6, v6, v3
  v_mul_f32 v7, v7, v3
  v_accvgpr_write_b32 a116, v4
  v_accvgpr_write_b32 a117, v5
  v_accvgpr_write_b32 a118, v6
  v_accvgpr_write_b32 a119, v7
  v_accvgpr_read_b32 v4, a120
  v_accvgpr_read_b32 v5, a121
  v_accvgpr_read_b32 v6, a122
  v_accvgpr_read_b32 v7, a123
  v_mul_f32 v4, v4, v3
  v_mul_f32 v5, v5, v3
  v_mul_f32 v6, v6, v3
  v_mul_f32 v7, v7, v3
  v_accvgpr_write_b32 a120, v4
  v_accvgpr_write_b32 a121, v5
  v_accvgpr_write_b32 a122, v6
  v_accvgpr_write_b32 a123, v7
  v_accvgpr_read_b32 v4, a124
  v_accvgpr_read_b32 v5, a125
  v_accvgpr_read_b32 v6, a126
  v_accvgpr_read_b32 v7, a127
  v_mul_f32 v4, v4, v3
  v_mul_f32 v5, v5, v3
  v_mul_f32 v6, v6, v3
  v_mul_f32 v7, v7, v3
  v_accvgpr_write_b32 a124, v4
  v_accvgpr_write_b32 a125, v5
  v_accvgpr_write_b32 a126, v6
  v_accvgpr_write_b32 a127, v7
  s_nop 3
  s_branch L_slowB7_back
L_k2_attn_kernel_end:
  s_endpgm
.globl k3_oproj_kernel
.p2align 8
.type k3_oproj_kernel,@function
k3_oproj_kernel:
  s_cmp_ge_u32 s2, 256
  s_cbranch_scc1 L_k3_oproj_kernel_end
  s_load_dwordx2 s[4:5], s[0:1], 32
  s_mov_b32 s6, 4718592
  s_mov_b32 s7, 0x00020000
  s_load_dwordx2 s[8:9], s[0:1], 104
  s_mov_b32 s10, 16777216
  s_mov_b32 s11, 0x00020000
  s_load_dwordx2 s[12:13], s[0:1], 104
  s_mov_b32 s14, 18874368
  s_mov_b32 s15, 0x00020000
  v_lshrrev_b32 v1, 6, v0
  s_nop 0
  v_readfirstlane_b32 s16, v1
  v_and_b32 v0, 63, v0
  s_nop 3
  s_and_b32 s17, s2, 7
  s_bfe_u32 s18, s2, 0x10003
  s_lshr_b32 s19, s2, 4
  s_lshl_b32 s20, s19, 2
  s_add_u32 s20, s20, s16
  s_mul_i32 s21, s20, 262144
  s_mul_i32 s22, s17, 32768
  s_add_u32 s21, s21, s22
  s_mul_i32 s22, s17, 589824
  s_mul_i32 s23, s18, 576
  s_add_u32 s22, s22, s23
  s_mul_i32 s24, s16, 9216
  s_mul_i32 s25, s17, 2359296
  s_mul_i32 s26, s20, 36864
  s_add_u32 s25, s25, s26
  s_mul_i32 s26, s18, 18432
  s_add_u32 s25, s25, s26
  v_lshlrev_b32 v1, 4, v0
  s_waitcnt lgkmcnt(0)
  s_add_u32 s8, s8, 16777216
  s_addc_u32 s9, s9, 0
  s_add_u32 s12, s12, 33554432
  s_addc_u32 s13, s13, 0
  buffer_load_dwordx4 a[0:3], v1, s[8:11], s21 offen offset:0
  buffer_load_dwordx4 a[4:7], v1, s[8:11], s21 offen offset:1024
  buffer_load_dwordx4 a[8:11], v1, s[8:11], s21 offen offset:2048
  buffer_load_dwordx4 a[12:15], v1, s[8:11], s21 offen offset:3072
  s_add_u32 s21, s21, 4096
  buffer_load_dwordx4 a[16:19], v1, s[8:11], s21 offen offset:0
  buffer_load_dwordx4 a[20:23], v1, s[8:11], s21 offen offset:1024
  buffer_load_dwordx4 a[24:27], v1, s[8:11], s21 offen offset:2048
  buffer_load_dwordx4 a[28:31], v1, s[8:11], s21 offen offset:3072
  s_add_u32 s21, s21, 4096
  s_mul_i32 s26, s16, 576
  s_add_u32 s26, s26, 0
  v_add_u32 v2, s26, v0
  v_mul_u32_u24 v3, 1821, v2
  v_lshrrev_b32 v3, 16, v3
  v_mul_u32_u24 v5, 36, v3
  v_sub_u32 v4, v2, v5
  v_mul_u32_u24 v10, 1152, v3
  v_lshl_add_u32 v10, v4, 4, v10
  s_add_u32 m0, s24, 0
  s_nop 0
  buffer_load_dwordx4 v10, s[4:7], s22 offen lds
  s_mul_i32 s26, s16, 576
  s_add_u32 s26, s26, 64
  v_add_u32 v2, s26, v0
  v_mul_u32_u24 v3, 1821, v2
  v_lshrrev_b32 v3, 16, v3
  v_mul_u32_u24 v5, 36, v3
  v_sub_u32 v4, v2, v5
  v_mul_u32_u24 v11, 1152, v3
  v_lshl_add_u32 v11, v4, 4, v11
  s_add_u32 m0, s24, 1024
  s_nop 0
  buffer_load_dwordx4 v11, s[4:7], s22 offen lds
  s_mul_i32 s26, s16, 576
  s_add_u32 s26, s26, 128
  v_add_u32 v2, s26, v0
  v_mul_u32_u24 v3, 1821, v2
  v_lshrrev_b32 v3, 16, v3
  v_mul_u32_u24 v5, 36, v3
  v_sub_u32 v4, v2, v5
  v_mul_u32_u24 v12, 1152, v3
  v_lshl_add_u32 v12, v4, 4, v12
  s_add_u32 m0, s24, 2048
  s_nop 0
  buffer_load_dwordx4 v12, s[4:7], s22 offen lds
  s_mul_i32 s26, s16, 576
  s_add_u32 s26, s26, 192
  v_add_u32 v2, s26, v0
  v_mul_u32_u24 v3, 1821, v2
  v_lshrrev_b32 v3, 16, v3
  v_mul_u32_u24 v5, 36, v3
  v_sub_u32 v4, v2, v5
  v_mul_u32_u24 v13, 1152, v3
  v_lshl_add_u32 v13, v4, 4, v13
  s_add_u32 m0, s24, 3072
  s_nop 0
  buffer_load_dwordx4 v13, s[4:7], s22 offen lds
  s_mul_i32 s26, s16, 576
  s_add_u32 s26, s26, 256
  v_add_u32 v2, s26, v0
  v_mul_u32_u24 v3, 1821, v2
  v_lshrrev_b32 v3, 16, v3
  v_mul_u32_u24 v5, 36, v3
  v_sub_u32 v4, v2, v5
  v_mul_u32_u24 v14, 1152, v3
  v_lshl_add_u32 v14, v4, 4, v14
  s_add_u32 m0, s24, 4096
  s_nop 0
  buffer_load_dwordx4 v14, s[4:7], s22 offen lds
  s_mul_i32 s26, s16, 576
  s_add_u32 s26, s26, 320
  v_add_u32 v2, s26, v0
  v_mul_u32_u24 v3, 1821, v2
  v_lshrrev_b32 v3, 16, v3
  v_mul_u32_u24 v5, 36, v3
  v_sub_u32 v4, v2, v5
  v_mul_u32_u24 v15, 1152, v3
  v_lshl_add_u32 v15, v4, 4, v15
  s_add_u32 m0, s24, 5120
  s_nop 0
  buffer_load_dwordx4 v15, s[4:7], s22 offen lds
  s_mul_i32 s26, s16, 576
  s_add_u32 s26, s26, 384
  v_add_u32 v2, s26, v0
  v_mul_u32_u24 v3, 1821, v2
  v_lshrrev_b32 v3, 16, v3
  v_mul_u32_u24 v5, 36, v3
  v_sub_u32 v4, v2, v5
  v_mul_u32_u24 v16, 1152, v3
  v_lshl_add_u32 v16, v4, 4, v16
  s_add_u32 m0, s24, 6144
  s_nop 0
  buffer_load_dwordx4 v16, s[4:7], s22 offen lds
  s_mul_i32 s26, s16, 576
  s_add_u32 s26, s26, 448
  v_add_u32 v2, s26, v0
  v_mul_u32_u24 v3, 1821, v2
  v_lshrrev_b32 v3, 16, v3
  v_mul_u32_u24 v5, 36, v3
  v_sub_u32 v4, v2, v5
  v_mul_u32_u24 v17, 1152, v3
  v_lshl_add_u32 v17, v4, 4, v17
  s_add_u32 m0, s24, 7168
  s_nop 0
  buffer_load_dwordx4 v17, s[4:7], s22 offen lds
  s_mul_i32 s26, s16, 576
  s_add_u32 s26, s26, 512
  v_add_u32 v2, s26, v0
  v_mul_u32_u24 v3, 1821, v2
  v_lshrrev_b32 v3, 16, v3
  v_mul_u32_u24 v5, 36, v3
  v_sub_u32 v4, v2, v5
  v_mul_u32_u24 v18, 1152, v3
  v_lshl_add_u32 v18, v4, 4, v18
  s_add_u32 m0, s24, 8192
  s_nop 0
  buffer_load_dwordx4 v18, s[4:7], s22 offen lds
  s_add_u32 s22, s22, 73728
  v_lshrrev_b32 v2, 5, v0
  v_lshlrev_b32 v2, 3, v2
  v_bfe_u32 v3, v0, 2, 2
  v_add_u32 v2, v2, v3
  v_mul_u32_u24 v20, 576, v2
  v_bfe_u32 v3, v0, 4, 1
  v_mul_u32_u24 v3, 32, v3
  v_add_u32 v20, v20, v3
  v_and_b32 v3, 1, v0
  v_lshl_add_u32 v20, v3, 4, v20
  v_bfe_u32 v3, v0, 1, 1
  v_lshl_add_u32 v20, v3, 3, v20
  v_add_u32 v21, 36864, v20
  v_add_u32 v22, 73728, v20
  v_add_u32 v23, 110592, v20
  s_add_u32 m0, s24, 36864
  s_nop 0
  buffer_load_dwordx4 v10, s[4:7], s22 offen lds
  s_add_u32 m0, s24, 37888
  s_nop 0
  buffer_load_dwordx4 v11, s[4:7], s22 offen lds
  s_add_u32 m0, s24, 38912
  s_nop 0
  buffer_load_dwordx4 v12, s[4:7], s22 offen lds
  s_add_u32 m0, s24, 39936
  s_nop 0
  buffer_load_dwordx4 v13, s[4:7], s22 offen lds
  s_add_u32 m0, s24, 40960
  s_nop 0
  buffer_load_dwordx4 v14, s[4:7], s22 offen lds
  s_add_u32 m0, s24, 41984
  s_nop 0
  buffer_load_dwordx4 v15, s[4:7], s22 offen lds
  s_add_u32 m0, s24, 43008
  s_nop 0
  buffer_load_dwordx4 v16, s[4:7], s22 offen lds
  s_add_u32 m0, s24, 44032
  s_nop 0
  buffer_load_dwordx4 v17, s[4:7], s22 offen lds
  s_add_u32 m0, s24, 45056
  s_nop 0
  buffer_load_dwordx4 v18, s[4:7], s22 offen lds
  s_add_u32 s22, s22, 73728
  s_waitcnt vmcnt(9) lgkmcnt(0)
  s_barrier
  ds_read_b64_tr_b16 v[24:25], v20 offset:0
  ds_read_b64_tr_b16 v[26:27], v20 offset:2304
  ds_read_b64_tr_b16 v[28:29], v20 offset:64
  ds_read_b64_tr_b16 v[30:31], v20 offset:2368
  ds_read_b64_tr_b16 v[32:33], v20 offset:128
  ds_read_b64_tr_b16 v[34:35], v20 offset:2432
  ds_read_b64_tr_b16 v[36:37], v20 offset:192
  ds_read_b64_tr_b16 v[38:39], v20 offset:2496
  s_waitcnt lgkmcnt(6)
  v_mfma_f32_32x32x16_bf16 v[64:79], v[24:27], a[0:3], 0
  ds_read_b64_tr_b16 v[40:41], v20 offset:256
  ds_read_b64_tr_b16 v[42:43], v20 offset:2560
  buffer_load_dwordx4 a[32:35], v1, s[8:11], s21 offen offset:0
  s_waitcnt lgkmcnt(6)
  v_mfma_f32_32x32x16_bf16 v[80:95], v[28:31], a[0:3], 0
  ds_read_b64_tr_b16 v[44:45], v20 offset:320
  ds_read_b64_tr_b16 v[46:47], v20 offset:2624
  s_waitcnt lgkmcnt(6)
  v_mfma_f32_32x32x16_bf16 v[96:111], v[32:35], a[0:3], 0
  ds_read_b64_tr_b16 v[24:25], v20 offset:384
  ds_read_b64_tr_b16 v[26:27], v20 offset:2688
  buffer_load_dwordx4 a[36:39], v1, s[8:11], s21 offen offset:1024
  s_waitcnt lgkmcnt(6)
  v_mfma_f32_32x32x16_bf16 v[112:127], v[36:39], a[0:3], 0
  ds_read_b64_tr_b16 v[28:29], v20 offset:448
  ds_read_b64_tr_b16 v[30:31], v20 offset:2752
  s_waitcnt lgkmcnt(6)
  v_mfma_f32_32x32x16_bf16 v[128:143], v[40:43], a[0:3], 0
  ds_read_b64_tr_b16 v[32:33], v20 offset:512
  ds_read_b64_tr_b16 v[34:35], v20 offset:2816
  buffer_load_dwordx4 a[40:43], v1, s[8:11], s21 offen offset:2048
  s_waitcnt lgkmcnt(6)
  v_mfma_f32_32x32x16_bf16 v[144:159], v[44:47], a[0:3], 0
  ds_read_b64_tr_b16 v[36:37], v20 offset:9216
  ds_read_b64_tr_b16 v[38:39], v20 offset:11520
  s_waitcnt lgkmcnt(6)
  v_mfma_f32_32x32x16_bf16 v[160:175], v[24:27], a[0:3], 0
  ds_read_b64_tr_b16 v[40:41], v20 offset:9280
  ds_read_b64_tr_b16 v[42:43], v20 offset:11584
  buffer_load_dwordx4 a[44:47], v1, s[8:11], s21 offen offset:3072
  s_add_u32 s21, s21, 4096
  s_waitcnt lgkmcnt(6)
  v_mfma_f32_32x32x16_bf16 v[176:191], v[28:31], a[0:3], 0
  ds_read_b64_tr_b16 v[44:45], v20 offset:9344
  ds_read_b64_tr_b16 v[46:47], v20 offset:11648
  s_waitcnt lgkmcnt(6)
  v_mfma_f32_32x32x16_bf16 v[192:207], v[32:35], a[0:3], 0
  ds_read_b64_tr_b16 v[24:25], v20 offset:9408
  ds_read_b64_tr_b16 v[26:27], v20 offset:11712
  s_add_u32 m0, s24, 73728
  s_nop 0
  buffer_load_dwordx4 v10, s[4:7], s22 offen lds
  s_waitcnt lgkmcnt(6)
  v_mfma_f32_32x32x16_bf16 v[64:79], v[36:39], a[4:7], v[64:79]
  ds_read_b64_tr_b16 v[28:29], v20 offset:9472
  ds_read_b64_tr_b16 v[30:31], v20 offset:11776
  s_waitcnt lgkmcnt(6)
  v_mfma_f32_32x32x16_bf16 v[80:95], v[40:43], a[4:7], v[80:95]
  ds_read_b64_tr_b16 v[32:33], v20 offset:9536
  ds_read_b64_tr_b16 v[34:35], v20 offset:11840
  s_add_u32 m0, s24, 74752
  s_nop 0
  buffer_load_dwordx4 v11, s[4:7], s22 offen lds
  s_waitcnt lgkmcnt(6)
  v_mfma_f32_32x32x16_bf16 v[96:111], v[44:47], a[4:7], v[96:111]
  ds_read_b64_tr_b16 v[36:37], v20 offset:9600
  ds_read_b64_tr_b16 v[38:39], v20 offset:11904
  s_waitcnt lgkmcnt(6)
  v_mfma_f32_32x32x16_bf16 v[112:127], v[24:27], a[4:7], v[112:127]
  ds_read_b64_tr_b16 v[40:41], v20 offset:9664
  ds_read_b64_tr_b16 v[42:43], v20 offset:11968
  s_add_u32 m0, s24, 75776
  s_nop 0
  buffer_load_dwordx4 v12, s[4:7], s22 offen lds
  s_waitcnt lgkmcnt(6)
  v_mfma_f32_32x32x16_bf16 v[128:143], v[28:31], a[4:7], v[128:143]
  ds_read_b64_tr_b16 v[44:45], v20 offset:9728
  ds_read_b64_tr_b16 v[46:47], v20 offset:12032
  s_waitcnt lgkmcnt(6)
  v_mfma_f32_32x32x16_bf16 v[144:159], v[32:35], a[4:7], v[144:159]
  ds_read_b64_tr_b16 v[24:25], v20 offset:18432
  ds_read_b64_tr_b16 v[26:27], v20 offset:20736
  s_add_u32 m0, s24, 76800
  s_nop 0
  buffer_load_dwordx4 v13, s[4:7], s22 offen lds
  s_waitcnt lgkmcnt(6)
  v_mfma_f32_32x32x16_bf16 v[160:175], v[36:39], a[4:7], v[160:175]
  ds_read_b64_tr_b16 v[28:29], v20 offset:18496
  ds_read_b64_tr_b16 v[30:31], v20 offset:20800
  s_waitcnt lgkmcnt(6)
  v_mfma_f32_32x32x16_bf16 v[176:191], v[40:43], a[4:7], v[176:191]
  ds_read_b64_tr_b16 v[32:33], v20 offset:18560
  ds_read_b64_tr_b16 v[34:35], v20 offset:20864
  s_add_u32 m0, s24, 77824
  s_nop 0
  buffer_load_dwordx4 v14, s[4:7], s22 offen lds
  s_waitcnt lgkmcnt(6)
  v_mfma_f32_32x32x16_bf16 v[192:207], v[44:47], a[4:7], v[192:207]
  ds_read_b64_tr_b16 v[36:37], v20 offset:18624
  ds_read_b64_tr_b16 v[38:39], v20 offset:20928
  s_waitcnt lgkmcnt(6)
  v_mfma_f32_32x32x16_bf16 v[64:79], v[24:27], a[8:11], v[64:79]
  ds_read_b64_tr_b16 v[40:41], v20 offset:18688
  ds_read_b64_tr_b16 v[42:43], v20 offset:20992
  s_add_u32 m0, s24, 78848
  s_nop 0
  buffer_load_dwordx4 v15, s[4:7], s22 offen lds
  s_waitcnt lgkmcnt(6)
  v_mfma_f32_32x32x16_bf16 v[80:95], v[28:31], a[8:11], v[80:95]
  ds_read_b64_tr_b16 v[44:45], v20 offset:18752
  ds_read_b64_tr_b16 v[46:47], v20 offset:21056
  s_waitcnt lgkmcnt(6)
  v_mfma_f32_32x32x16_bf16 v[96:111], v[32:35], a[8:11], v[96:111]
  ds_read_b64_tr_b16 v[24:25], v20 offset:18816
  ds_read_b64_tr_b16 v[26:27], v20 offset:21120
  s_add_u32 m0, s24, 79872
  s_nop 0
  buffer_load_dwordx4 v16, s[4:7], s22 offen lds
  s_waitcnt lgkmcnt(6)
  v_mfma_f32_32x32x16_bf16 v[112:127], v[36:39], a[8:11], v[112:127]
  ds_read_b64_tr_b16 v[28:29], v20 offset:18880
  ds_read_b64_tr_b16 v[30:31], v20 offset:21184
  s_waitcnt lgkmcnt(6)
  v_mfma_f32_32x32x16_bf16 v[128:143], v[40:43], a[8:11], v[128:143]
  ds_read_b64_tr_b16 v[32:33], v20 offset:18944
  ds_read_b64_tr_b16 v[34:35], v20 offset:21248
  s_add_u32 m0, s24, 80896
  s_nop 0
  buffer_load_dwordx4 v17, s[4:7], s22 offen lds
  s_waitcnt lgkmcnt(6)
  v_mfma_f32_32x32x16_bf16 v[144:159], v[44:47], a[8:11], v[144:159]
  ds_read_b64_tr_b16 v[36:37], v20 offset:27648
  ds_read_b64_tr_b16 v[38:39], v20 offset:29952
  s_waitcnt lgkmcnt(6)
  v_mfma_f32_32x32x16_bf16 v[160:175], v[24:27], a[8:11], v[160:175]
  ds_read_b64_tr_b16 v[40:41], v20 offset:27712
  ds_read_b64_tr_b16 v[42:43], v20 offset:30016
  s_add_u32 m0, s24, 81920
  s_nop 0
  buffer_load_dwordx4 v18, s[4:7], s22 offen lds
  s_add_u32 s22, s22, 73728
  s_waitcnt lgkmcnt(6)
  v_mfma_f32_32x32x16_bf16 v[176:191], v[28:31], a[8:11], v[176:191]
  ds_read_b64_tr_b16 v[44:45], v20 offset:27776
  ds_read_b64_tr_b16 v[46:47], v20 offset:30080
  s_waitcnt lgkmcnt(6)
  v_mfma_f32_32x32x16_bf16 v[192:207], v[32:35], a[8:11], v[192:207]
  ds_read_b64_tr_b16 v[24:25], v20 offset:27840
  ds_read_b64_tr_b16 v[26:27], v20 offset:30144
  s_waitcnt lgkmcnt(6)
  v_mfma_f32_32x32x16_bf16 v[64:79], v[36:39], a[12:15], v[64:79]
  ds_read_b64_tr_b16 v[28:29], v20 offset:27904
  ds_read_b64_tr_b16 v[30:31], v20 offset:30208
  s_waitcnt lgkmcnt(6)
  v_mfma_f32_32x32x16_bf16 v[80:95], v[40:43], a[12:15], v[80:95]
  ds_read_b64_tr_b16 v[32:33], v20 offset:27968
  ds_read_b64_tr_b16 v[34:35], v20 offset:30272
  s_waitcnt lgkmcnt(6)
  v_mfma_f32_32x32x16_bf16 v[96:111], v[44:47], a[12:15], v[96:111]
  ds_read_b64_tr_b16 v[36:37], v20 offset:28032
  ds_read_b64_tr_b16 v[38:39], v20 offset:30336
  s_waitcnt lgkmcnt(6)
  v_mfma_f32_32x32x16_bf16 v[112:127], v[24:27], a[12:15], v[112:127]
  ds_read_b64_tr_b16 v[40:41], v20 offset:28096
  ds_read_b64_tr_b16 v[42:43], v20 offset:30400
  s_waitcnt lgkmcnt(6)
  v_mfma_f32_32x32x16_bf16 v[128:143], v[28:31], a[12:15], v[128:143]
  ds_read_b64_tr_b16 v[44:45], v20 offset:28160
  ds_read_b64_tr_b16 v[46:47], v20 offset:30464
  s_waitcnt lgkmcnt(6)
  v_mfma_f32_32x32x16_bf16 v[144:159], v[32:35], a[12:15], v[144:159]
  s_waitcnt vmcnt(13) lgkmcnt(0)
  s_barrier
  ds_read_b64_tr_b16 v[24:25], v21 offset:0
  ds_read_b64_tr_b16 v[26:27], v21 offset:2304
  v_mfma_f32_32x32x16_bf16 v[160:175], v[36:39], a[12:15], v[160:175]
  ds_read_b64_tr_b16 v[28:29], v21 offset:64
  ds_read_b64_tr_b16 v[30:31], v21 offset:2368
  v_mfma_f32_32x32x16_bf16 v[176:191], v[40:43], a[12:15], v[176:191]
  ds_read_b64_tr_b16 v[32:33], v21 offset:128
  ds_read_b64_tr_b16 v[34:35], v21 offset:2432
  v_mfma_f32_32x32x16_bf16 v[192:207], v[44:47], a[12:15], v[192:207]
  ds_read_b64_tr_b16 v[36:37], v21 offset:192
  ds_read_b64_tr_b16 v[38:39], v21 offset:2496
  s_waitcnt lgkmcnt(6)
  v_mfma_f32_32x32x16_bf16 v[64:79], v[24:27], a[16:19], v[64:79]
  ds_read_b64_tr_b16 v[40:41], v21 offset:256
  ds_read_b64_tr_b16 v[42:43], v21 offset:2560
  buffer_load_dwordx4 a[48:51], v1, s[8:11], s21 offen offset:0
  s_waitcnt lgkmcnt(6)
  v_mfma_f32_32x32x16_bf16 v[80:95], v[28:31], a[16:19], v[80:95]
  ds_read_b64_tr_b16 v[44:45], v21 offset:320
  ds_read_b64_tr_b16 v[46:47], v21 offset:2624
  s_waitcnt lgkmcnt(6)
  v_mfma_f32_32x32x16_bf16 v[96:111], v[32:35], a[16:19], v[96:111]
  ds_read_b64_tr_b16 v[24:25], v21 offset:384
  ds_read_b64_tr_b16 v[26:27], v21 offset:2688
  buffer_load_dwordx4 a[52:55], v1, s[8:11], s21 offen offset:1024
  s_waitcnt lgkmcnt(6)
  v_mfma_f32_32x32x16_bf16 v[112:127], v[36:39], a[16:19], v[112:127]
  ds_read_b64_tr_b16 v[28:29], v21 offset:448
  ds_read_b64_tr_b16 v[30:31], v21 offset:2752
  s_waitcnt lgkmcnt(6)
  v_mfma_f32_32x32x16_bf16 v[128:143], v[40:43], a[16:19], v[128:143]
  ds_read_b64_tr_b16 v[32:33], v21 offset:512
  ds_read_b64_tr_b16 v[34:35], v21 offset:2816
  buffer_load_dwordx4 a[56:59], v1, s[8:11], s21 offen offset:2048
  s_waitcnt lgkmcnt(6)
  v_mfma_f32_32x32x16_bf16 v[144:159], v[44:47], a[16:19], v[144:159]
  ds_read_b64_tr_b16 v[36:37], v21 offset:9216
  ds_read_b64_tr_b16 v[38:39], v21 offset:11520
  s_waitcnt lgkmcnt(6)
  v_mfma_f32_32x32x16_bf16 v[160:175], v[24:27], a[16:19], v[160:175]
  ds_read_b64_tr_b16 v[40:41], v21 offset:9280
  ds_read_b64_tr_b16 v[42:43], v21 offset:11584
  buffer_load_dwordx4 a[60:63], v1, s[8:11], s21 offen offset:3072
  s_add_u32 s21, s21, 4096
  s_waitcnt lgkmcnt(6)
  v_mfma_f32_32x32x16_bf16 v[176:191], v[28:31], a[16:19], v[176:191]
  ds_read_b64_tr_b16 v[44:45], v21 offset:9344
  ds_read_b64_tr_b16 v[46:47], v21 offset:11648
  s_waitcnt lgkmcnt(6)
  v_mfma_f32_32x32x16_bf16 v[192:207], v[32:35], a[16:19], v[192:207]
  ds_read_b64_tr_b16 v[24:25], v21 offset:9408
  ds_read_b64_tr_b16 v[26:27], v21 offset:11712
  s_add_u32 m0, s24, 110592
  s_nop 0
  buffer_load_dwordx4 v10, s[4:7], s22 offen lds
  s_waitcnt lgkmcnt(6)
  v_mfma_f32_32x32x16_bf16 v[64:79], v[36:39], a[20:23], v[64:79]
  ds_read_b64_tr_b16 v[28:29], v21 offset:9472
  ds_read_b64_tr_b16 v[30:31], v21 offset:11776
  s_waitcnt lgkmcnt(6)
  v_mfma_f32_32x32x16_bf16 v[80:95], v[40:43], a[20:23], v[80:95]
  ds_read_b64_tr_b16 v[32:33], v21 offset:9536
  ds_read_b64_tr_b16 v[34:35], v21 offset:11840
  s_add_u32 m0, s24, 111616
  s_nop 0
  buffer_load_dwordx4 v11, s[4:7], s22 offen lds
  s_waitcnt lgkmcnt(6)
  v_mfma_f32_32x32x16_bf16 v[96:111], v[44:47], a[20:23], v[96:111]
  ds_read_b64_tr_b16 v[36:37], v21 offset:9600
  ds_read_b64_tr_b16 v[38:39], v21 offset:11904
  s_waitcnt lgkmcnt(6)
  v_mfma_f32_32x32x16_bf16 v[112:127], v[24:27], a[20:23], v[112:127]
  ds_read_b64_tr_b16 v[40:41], v21 offset:9664
  ds_read_b64_tr_b16 v[42:43], v21 offset:11968
  s_add_u32 m0, s24, 112640
  s_nop 0
  buffer_load_dwordx4 v12, s[4:7], s22 offen lds
  s_waitcnt lgkmcnt(6)
  v_mfma_f32_32x32x16_bf16 v[128:143], v[28:31], a[20:23], v[128:143]
  ds_read_b64_tr_b16 v[44:45], v21 offset:9728
  ds_read_b64_tr_b16 v[46:47], v21 offset:12032
  s_waitcnt lgkmcnt(6)
  v_mfma_f32_32x32x16_bf16 v[144:159], v[32:35], a[20:23], v[144:159]
  ds_read_b64_tr_b16 v[24:25], v21 offset:18432
  ds_read_b64_tr_b16 v[26:27], v21 offset:20736
  s_add_u32 m0, s24, 113664
  s_nop 0
  buffer_load_dwordx4 v13, s[4:7], s22 offen lds
  s_waitcnt lgkmcnt(6)
  v_mfma_f32_32x32x16_bf16 v[160:175], v[36:39], a[20:23], v[160:175]
  ds_read_b64_tr_b16 v[28:29], v21 offset:18496
  ds_read_b64_tr_b16 v[30:31], v21 offset:20800
  s_waitcnt lgkmcnt(6)
  v_mfma_f32_32x32x16_bf16 v[176:191], v[40:43], a[20:23], v[176:191]
  ds_read_b64_tr_b16 v[32:33], v21 offset:18560
  ds_read_b64_tr_b16 v[34:35], v21 offset:20864
  s_add_u32 m0, s24, 114688
  s_nop 0
  buffer_load_dwordx4 v14, s[4:7], s22 offen lds
  s_waitcnt lgkmcnt(6)
  v_mfma_f32_32x32x16_bf16 v[192:207], v[44:47], a[20:23], v[192:207]
  ds_read_b64_tr_b16 v[36:37], v21 offset:18624
  ds_read_b64_tr_b16 v[38:39], v21 offset:20928
  s_waitcnt lgkmcnt(6)
  v_mfma_f32_32x32x16_bf16 v[64:79], v[24:27], a[24:27], v[64:79]
  ds_read_b64_tr_b16 v[40:41], v21 offset:18688
  ds_read_b64_tr_b16 v[42:43], v21 offset:20992
  s_add_u32 m0, s24, 115712
  s_nop 0
  buffer_load_dwordx4 v15, s[4:7], s22 offen lds
  s_waitcnt lgkmcnt(6)
  v_mfma_f32_32x32x16_bf16 v[80:95], v[28:31], a[24:27], v[80:95]
  ds_read_b64_tr_b16 v[44:45], v21 offset:18752
  ds_read_b64_tr_b16 v[46:47], v21 offset:21056
  s_waitcnt lgkmcnt(6)
  v_mfma_f32_32x32x16_bf16 v[96:111], v[32:35], a[24:27], v[96:111]
  ds_read_b64_tr_b16 v[24:25], v21 offset:18816
  ds_read_b64_tr_b16 v[26:27], v21 offset:21120
  s_add_u32 m0, s24, 116736
  s_nop 0
  buffer_load_dwordx4 v16, s[4:7], s22 offen lds
  s_waitcnt lgkmcnt(6)
  v_mfma_f32_32x32x16_bf16 v[112:127], v[36:39], a[24:27], v[112:127]
  ds_read_b64_tr_b16 v[28:29], v21 offset:18880
  ds_read_b64_tr_b16 v[30:31], v21 offset:21184
  s_waitcnt lgkmcnt(6)
  v_mfma_f32_32x32x16_bf16 v[128:143], v[40:43], a[24:27], v[128:143]
  ds_read_b64_tr_b16 v[32:33], v21 offset:18944
  ds_read_b64_tr_b16 v[34:35], v21 offset:21248
  s_add_u32 m0, s24, 117760
  s_nop 0
  buffer_load_dwordx4 v17, s[4:7], s22 offen lds
  s_waitcnt lgkmcnt(6)
  v_mfma_f32_32x32x16_bf16 v[144:159], v[44:47], a[24:27], v[144:159]
  ds_read_b64_tr_b16 v[36:37], v21 offset:27648
  ds_read_b64_tr_b16 v[38:39], v21 offset:29952
  s_waitcnt lgkmcnt(6)
  v_mfma_f32_32x32x16_bf16 v[160:175], v[24:27], a[24:27], v[160:175]
  ds_read_b64_tr_b16 v[40:41], v21 offset:27712
  ds_read_b64_tr_b16 v[42:43], v21 offset:30016
  s_add_u32 m0, s24, 118784
  s_nop 0
  buffer_load_dwordx4 v18, s[4:7], s22 offen lds
  s_add_u32 s22, s22, 73728
  s_waitcnt lgkmcnt(6)
  v_mfma_f32_32x32x16_bf16 v[176:191], v[28:31], a[24:27], v[176:191]
  ds_read_b64_tr_b16 v[44:45], v21 offset:27776
  ds_read_b64_tr_b16 v[46:47], v21 offset:30080
  s_waitcnt lgkmcnt(6)
  v_mfma_f32_32x32x16_bf16 v[192:207], v[32:35], a[24:27], v[192:207]
  ds_read_b64_tr_b16 v[24:25], v21 offset:27840
  ds_read_b64_tr_b16 v[26:27], v21 offset:30144
  s_waitcnt lgkmcnt(6)
  v_mfma_f32_32x32x16_bf16 v[64:79], v[36:39], a[28:31], v[64:79]
  ds_read_b64_tr_b16 v[28:29], v21 offset:27904
  ds_read_b64_tr_b16 v[30:31], v21 offset:30208
  s_waitcnt lgkmcnt(6)
  v_mfma_f32_32x32x16_bf16 v[80:95], v[40:43], a[28:31], v[80:95]
  ds_read_b64_tr_b16 v[32:33], v21 offset:27968
  ds_read_b64_tr_b16 v[34:35], v21 offset:30272
  s_waitcnt lgkmcnt(6)
  v_mfma_f32_32x32x16_bf16 v[96:111], v[44:47], a[28:31], v[96:111]
  ds_read_b64_tr_b16 v[36:37], v21 offset:28032
  ds_read_b64_tr_b16 v[38:39], v21 offset:30336
  s_waitcnt lgkmcnt(6)
  v_mfma_f32_32x32x16_bf16 v[112:127], v[24:27], a[28:31], v[112:127]
  ds_read_b64_tr_b16 v[40:41], v21 offset:28096
  ds_read_b64_tr_b16 v[42:43], v21 offset:30400
  s_waitcnt lgkmcnt(6)
  v_mfma_f32_32x32x16_bf16 v[128:143], v[28:31], a[28:31], v[128:143]
  ds_read_b64_tr_b16 v[44:45], v21 offset:28160
  ds_read_b64_tr_b16 v[46:47], v21 offset:30464
  s_waitcnt lgkmcnt(6)
  v_mfma_f32_32x32x16_bf16 v[144:159], v[32:35], a[28:31], v[144:159]
  s_waitcnt vmcnt(13) lgkmcnt(0)
  s_barrier
  ds_read_b64_tr_b16 v[24:25], v22 offset:0
  ds_read_b64_tr_b16 v[26:27], v22 offset:2304
  v_mfma_f32_32x32x16_bf16 v[160:175], v[36:39], a[28:31], v[160:175]
  ds_read_b64_tr_b16 v[28:29], v22 offset:64
  ds_read_b64_tr_b16 v[30:31], v22 offset:2368
  v_mfma_f32_32x32x16_bf16 v[176:191], v[40:43], a[28:31], v[176:191]
  ds_read_b64_tr_b16 v[32:33], v22 offset:128
  ds_read_b64_tr_b16 v[34:35], v22 offset:2432
  v_mfma_f32_32x32x16_bf16 v[192:207], v[44:47], a[28:31], v[192:207]
  ds_read_b64_tr_b16 v[36:37], v22 offset:192
  ds_read_b64_tr_b16 v[38:39], v22 offset:2496
  s_waitcnt lgkmcnt(6)
  v_mfma_f32_32x32x16_bf16 v[64:79], v[24:27], a[32:35], v[64:79]
  ds_read_b64_tr_b16 v[40:41], v22 offset:256
  ds_read_b64_tr_b16 v[42:43], v22 offset:2560
  buffer_load_dwordx4 a[64:67], v1, s[8:11], s21 offen offset:0
  s_waitcnt lgkmcnt(6)
  v_mfma_f32_32x32x16_bf16 v[80:95], v[28:31], a[32:35], v[80:95]
  ds_read_b64_tr_b16 v[44:45], v22 offset:320
  ds_read_b64_tr_b16 v[46:47], v22 offset:2624
  s_waitcnt lgkmcnt(6)
  v_mfma_f32_32x32x16_bf16 v[96:111], v[32:35], a[32:35], v[96:111]
  ds_read_b64_tr_b16 v[24:25], v22 offset:384
  ds_read_b64_tr_b16 v[26:27], v22 offset:2688
  buffer_load_dwordx4 a[68:71], v1, s[8:11], s21 offen offset:1024
  s_waitcnt lgkmcnt(6)
  v_mfma_f32_32x32x16_bf16 v[112:127], v[36:39], a[32:35], v[112:127]
  ds_read_b64_tr_b16 v[28:29], v22 offset:448
  ds_read_b64_tr_b16 v[30:31], v22 offset:2752
  s_waitcnt lgkmcnt(6)
  v_mfma_f32_32x32x16_bf16 v[128:143], v[40:43], a[32:35], v[128:143]
  ds_read_b64_tr_b16 v[32:33], v22 offset:512
  ds_read_b64_tr_b16 v[34:35], v22 offset:2816
  buffer_load_dwordx4 a[72:75], v1, s[8:11], s21 offen offset:2048
  s_waitcnt lgkmcnt(6)
  v_mfma_f32_32x32x16_bf16 v[144:159], v[44:47], a[32:35], v[144:159]
  ds_read_b64_tr_b16 v[36:37], v22 offset:9216
  ds_read_b64_tr_b16 v[38:39], v22 offset:11520
  s_waitcnt lgkmcnt(6)
  v_mfma_f32_32x32x16_bf16 v[160:175], v[24:27], a[32:35], v[160:175]
  ds_read_b64_tr_b16 v[40:41], v22 offset:9280
  ds_read_b64_tr_b16 v[42:43], v22 offset:11584
  buffer_load_dwordx4 a[76:79], v1, s[8:11], s21 offen offset:3072
  s_add_u32 s21, s21, 4096
  s_waitcnt lgkmcnt(6)
  v_mfma_f32_32x32x16_bf16 v[176:191], v[28:31], a[32:35], v[176:191]
  ds_read_b64_tr_b16 v[44:45], v22 offset:9344
  ds_read_b64_tr_b16 v[46:47], v22 offset:11648
  s_waitcnt lgkmcnt(6)
  v_mfma_f32_32x32x16_bf16 v[192:207], v[32:35], a[32:35], v[192:207]
  ds_read_b64_tr_b16 v[24:25], v22 offset:9408
  ds_read_b64_tr_b16 v[26:27], v22 offset:11712
  s_add_u32 m0, s24, 0
  s_nop 0
  buffer_load_dwordx4 v10, s[4:7], s22 offen lds
  s_waitcnt lgkmcnt(6)
  v_mfma_f32_32x32x16_bf16 v[64:79], v[36:39], a[36:39], v[64:79]
  ds_read_b64_tr_b16 v[28:29], v22 offset:9472
  ds_read_b64_tr_b16 v[30:31], v22 offset:11776
  s_waitcnt lgkmcnt(6)
  v_mfma_f32_32x32x16_bf16 v[80:95], v[40:43], a[36:39], v[80:95]
  ds_read_b64_tr_b16 v[32:33], v22 offset:9536
  ds_read_b64_tr_b16 v[34:35], v22 offset:11840
  s_add_u32 m0, s24, 1024
  s_nop 0
  buffer_load_dwordx4 v11, s[4:7], s22 offen lds
  s_waitcnt lgkmcnt(6)
  v_mfma_f32_32x32x16_bf16 v[96:111], v[44:47], a[36:39], v[96:111]
  ds_read_b64_tr_b16 v[36:37], v22 offset:9600
  ds_read_b64_tr_b16 v[38:39], v22 offset:11904
  s_waitcnt lgkmcnt(6)
  v_mfma_f32_32x32x16_bf16 v[112:127], v[24:27], a[36:39], v[112:127]
  ds_read_b64_tr_b16 v[40:41], v22 offset:9664
  ds_read_b64_tr_b16 v[42:43], v22 offset:11968
  s_add_u32 m0, s24, 2048
  s_nop 0
  buffer_load_dwordx4 v12, s[4:7], s22 offen lds
  s_waitcnt lgkmcnt(6)
  v_mfma_f32_32x32x16_bf16 v[128:143], v[28:31], a[36:39], v[128:143]
  ds_read_b64_tr_b16 v[44:45], v22 offset:9728
  ds_read_b64_tr_b16 v[46:47], v22 offset:12032
  s_waitcnt lgkmcnt(6)
  v_mfma_f32_32x32x16_bf16 v[144:159], v[32:35], a[36:39], v[144:159]
  ds_read_b64_tr_b16 v[24:25], v22 offset:18432
  ds_read_b64_tr_b16 v[26:27], v22 offset:20736
  s_add_u32 m0, s24, 3072
  s_nop 0
  buffer_load_dwordx4 v13, s[4:7], s22 offen lds
  s_waitcnt lgkmcnt(6)
  v_mfma_f32_32x32x16_bf16 v[160:175], v[36:39], a[36:39], v[160:175]
  ds_read_b64_tr_b16 v[28:29], v22 offset:18496
  ds_read_b64_tr_b16 v[30:31], v22 offset:20800
  s_waitcnt lgkmcnt(6)
  v_mfma_f32_32x32x16_bf16 v[176:191], v[40:43], a[36:39], v[176:191]
  ds_read_b64_tr_b16 v[32:33], v22 offset:18560
  ds_read_b64_tr_b16 v[34:35], v22 offset:20864
  s_add_u32 m0, s24, 4096
  s_nop 0
  buffer_load_dwordx4 v14, s[4:7], s22 offen lds
  s_waitcnt lgkmcnt(6)
  v_mfma_f32_32x32x16_bf16 v[192:207], v[44:47], a[36:39], v[192:207]
  ds_read_b64_tr_b16 v[36:37], v22 offset:18624
  ds_read_b64_tr_b16 v[38:39], v22 offset:20928
  s_waitcnt lgkmcnt(6)
  v_mfma_f32_32x32x16_bf16 v[64:79], v[24:27], a[40:43], v[64:79]
  ds_read_b64_tr_b16 v[40:41], v22 offset:18688
  ds_read_b64_tr_b16 v[42:43], v22 offset:20992
  s_add_u32 m0, s24, 5120
  s_nop 0
  buffer_load_dwordx4 v15, s[4:7], s22 offen lds
  s_waitcnt lgkmcnt(6)
  v_mfma_f32_32x32x16_bf16 v[80:95], v[28:31], a[40:43], v[80:95]
  ds_read_b64_tr_b16 v[44:45], v22 offset:18752
  ds_read_b64_tr_b16 v[46:47], v22 offset:21056
  s_waitcnt lgkmcnt(6)
  v_mfma_f32_32x32x16_bf16 v[96:111], v[32:35], a[40:43], v[96:111]
  ds_read_b64_tr_b16 v[24:25], v22 offset:18816
  ds_read_b64_tr_b16 v[26:27], v22 offset:21120
  s_add_u32 m0, s24, 6144
  s_nop 0
  buffer_load_dwordx4 v16, s[4:7], s22 offen lds
  s_waitcnt lgkmcnt(6)
  v_mfma_f32_32x32x16_bf16 v[112:127], v[36:39], a[40:43], v[112:127]
  ds_read_b64_tr_b16 v[28:29], v22 offset:18880
  ds_read_b64_tr_b16 v[30:31], v22 offset:21184
  s_waitcnt lgkmcnt(6)
  v_mfma_f32_32x32x16_bf16 v[128:143], v[40:43], a[40:43], v[128:143]
  ds_read_b64_tr_b16 v[32:33], v22 offset:18944
  ds_read_b64_tr_b16 v[34:35], v22 offset:21248
  s_add_u32 m0, s24, 7168
  s_nop 0
  buffer_load_dwordx4 v17, s[4:7], s22 offen lds
  s_waitcnt lgkmcnt(6)
  v_mfma_f32_32x32x16_bf16 v[144:159], v[44:47], a[40:43], v[144:159]
  ds_read_b64_tr_b16 v[36:37], v22 offset:27648
  ds_read_b64_tr_b16 v[38:39], v22 offset:29952
  s_waitcnt lgkmcnt(6)
  v_mfma_f32_32x32x16_bf16 v[160:175], v[24:27], a[40:43], v[160:175]
  ds_read_b64_tr_b16 v[40:41], v22 offset:27712
  ds_read_b64_tr_b16 v[42:43], v22 offset:30016
  s_add_u32 m0, s24, 8192
  s_nop 0
  buffer_load_dwordx4 v18, s[4:7], s22 offen lds
  s_add_u32 s22, s22, 73728
  s_waitcnt lgkmcnt(6)
  v_mfma_f32_32x32x16_bf16 v[176:191], v[28:31], a[40:43], v[176:191]
  ds_read_b64_tr_b16 v[44:45], v22 offset:27776
  ds_read_b64_tr_b16 v[46:47], v22 offset:30080
  s_waitcnt lgkmcnt(6)
  v_mfma_f32_32x32x16_bf16 v[192:207], v[32:35], a[40:43], v[192:207]
  ds_read_b64_tr_b16 v[24:25], v22 offset:27840
  ds_read_b64_tr_b16 v[26:27], v22 offset:30144
  s_waitcnt lgkmcnt(6)
  v_mfma_f32_32x32x16_bf16 v[64:79], v[36:39], a[44:47], v[64:79]
  ds_read_b64_tr_b16 v[28:29], v22 offset:27904
  ds_read_b64_tr_b16 v[30:31], v22 offset:30208
  s_waitcnt lgkmcnt(6)
  v_mfma_f32_32x32x16_bf16 v[80:95], v[40:43], a[44:47], v[80:95]
  ds_read_b64_tr_b16 v[32:33], v22 offset:27968
  ds_read_b64_tr_b16 v[34:35], v22 offset:30272
  s_waitcnt lgkmcnt(6)
  v_mfma_f32_32x32x16_bf16 v[96:111], v[44:47], a[44:47], v[96:111]
  ds_read_b64_tr_b16 v[36:37], v22 offset:28032
  ds_read_b64_tr_b16 v[38:39], v22 offset:30336
  s_waitcnt lgkmcnt(6)
  v_mfma_f32_32x32x16_bf16 v[112:127], v[24:27], a[44:47], v[112:127]
  ds_read_b64_tr_b16 v[40:41], v22 offset:28096
  ds_read_b64_tr_b16 v[42:43], v22 offset:30400
  s_waitcnt lgkmcnt(6)
  v_mfma_f32_32x32x16_bf16 v[128:143], v[28:31], a[44:47], v[128:143]
  ds_read_b64_tr_b16 v[44:45], v22 offset:28160
  ds_read_b64_tr_b16 v[46:47], v22 offset:30464
  s_waitcnt lgkmcnt(6)
  v_mfma_f32_32x32x16_bf16 v[144:159], v[32:35], a[44:47], v[144:159]
  s_waitcnt vmcnt(13) lgkmcnt(0)
  s_barrier
  ds_read_b64_tr_b16 v[24:25], v23 offset:0
  ds_read_b64_tr_b16 v[26:27], v23 offset:2304
  v_mfma_f32_32x32x16_bf16 v[160:175], v[36:39], a[44:47], v[160:175]
  ds_read_b64_tr_b16 v[28:29], v23 offset:64
  ds_read_b64_tr_b16 v[30:31], v23 offset:2368
  v_mfma_f32_32x32x16_bf16 v[176:191], v[40:43], a[44:47], v[176:191]
  ds_read_b64_tr_b16 v[32:33], v23 offset:128
  ds_read_b64_tr_b16 v[34:35], v23 offset:2432
  v_mfma_f32_32x32x16_bf16 v[192:207], v[44:47], a[44:47], v[192:207]
  ds_read_b64_tr_b16 v[36:37], v23 offset:192
  ds_read_b64_tr_b16 v[38:39], v23 offset:2496
  s_waitcnt lgkmcnt(6)
  v_mfma_f32_32x32x16_bf16 v[64:79], v[24:27], a[48:51], v[64:79]
  ds_read_b64_tr_b16 v[40:41], v23 offset:256
  ds_read_b64_tr_b16 v[42:43], v23 offset:2560
  buffer_load_dwordx4 a[80:83], v1, s[8:11], s21 offen offset:0
  s_waitcnt lgkmcnt(6)
  v_mfma_f32_32x32x16_bf16 v[80:95], v[28:31], a[48:51], v[80:95]
  ds_read_b64_tr_b16 v[44:45], v23 offset:320
  ds_read_b64_tr_b16 v[46:47], v23 offset:2624
  s_waitcnt lgkmcnt(6)
  v_mfma_f32_32x32x16_bf16 v[96:111], v[32:35], a[48:51], v[96:111]
  ds_read_b64_tr_b16 v[24:25], v23 offset:384
  ds_read_b64_tr_b16 v[26:27], v23 offset:2688
  buffer_load_dwordx4 a[84:87], v1, s[8:11], s21 offen offset:1024
  s_waitcnt lgkmcnt(6)
  v_mfma_f32_32x32x16_bf16 v[112:127], v[36:39], a[48:51], v[112:127]
  ds_read_b64_tr_b16 v[28:29], v23 offset:448
  ds_read_b64_tr_b16 v[30:31], v23 offset:2752
  s_waitcnt lgkmcnt(6)
  v_mfma_f32_32x32x16_bf16 v[128:143], v[40:43], a[48:51], v[128:143]
  ds_read_b64_tr_b16 v[32:33], v23 offset:512
  ds_read_b64_tr_b16 v[34:35], v23 offset:2816
  buffer_load_dwordx4 a[88:91], v1, s[8:11], s21 offen offset:2048
  s_waitcnt lgkmcnt(6)
  v_mfma_f32_32x32x16_bf16 v[144:159], v[44:47], a[48:51], v[144:159]
  ds_read_b64_tr_b16 v[36:37], v23 offset:9216
  ds_read_b64_tr_b16 v[38:39], v23 offset:11520
  s_waitcnt lgkmcnt(6)
  v_mfma_f32_32x32x16_bf16 v[160:175], v[24:27], a[48:51], v[160:175]
  ds_read_b64_tr_b16 v[40:41], v23 offset:9280
  ds_read_b64_tr_b16 v[42:43], v23 offset:11584
  buffer_load_dwordx4 a[92:95], v1, s[8:11], s21 offen offset:3072
  s_add_u32 s21, s21, 4096
  s_waitcnt lgkmcnt(6)
  v_mfma_f32_32x32x16_bf16 v[176:191], v[28:31], a[48:51], v[176:191]
  ds_read_b64_tr_b16 v[44:45], v23 offset:9344
  ds_read_b64_tr_b16 v[46:47], v23 offset:11648
  s_waitcnt lgkmcnt(6)
  v_mfma_f32_32x32x16_bf16 v[192:207], v[32:35], a[48:51], v[192:207]
  ds_read_b64_tr_b16 v[24:25], v23 offset:9408
  ds_read_b64_tr_b16 v[26:27], v23 offset:11712
  s_add_u32 m0, s24, 36864
  s_nop 0
  buffer_load_dwordx4 v10, s[4:7], s22 offen lds
  s_waitcnt lgkmcnt(6)
  v_mfma_f32_32x32x16_bf16 v[64:79], v[36:39], a[52:55], v[64:79]
  ds_read_b64_tr_b16 v[28:29], v23 offset:9472
  ds_read_b64_tr_b16 v[30:31], v23 offset:11776
  s_waitcnt lgkmcnt(6)
  v_mfma_f32_32x32x16_bf16 v[80:95], v[40:43], a[52:55], v[80:95]
  ds_read_b64_tr_b16 v[32:33], v23 offset:9536
  ds_read_b64_tr_b16 v[34:35], v23 offset:11840
  s_add_u32 m0, s24, 37888
  s_nop 0
  buffer_load_dwordx4 v11, s[4:7], s22 offen lds
  s_waitcnt lgkmcnt(6)
  v_mfma_f32_32x32x16_bf16 v[96:111], v[44:47], a[52:55], v[96:111]
  ds_read_b64_tr_b16 v[36:37], v23 offset:9600
  ds_read_b64_tr_b16 v[38:39], v23 offset:11904
  s_waitcnt lgkmcnt(6)
  v_mfma_f32_32x32x16_bf16 v[112:127], v[24:27], a[52:55], v[112:127]
  ds_read_b64_tr_b16 v[40:41], v23 offset:9664
  ds_read_b64_tr_b16 v[42:43], v23 offset:11968
  s_add_u32 m0, s24, 38912
  s_nop 0
  buffer_load_dwordx4 v12, s[4:7], s22 offen lds
  s_waitcnt lgkmcnt(6)
  v_mfma_f32_32x32x16_bf16 v[128:143], v[28:31], a[52:55], v[128:143]
  ds_read_b64_tr_b16 v[44:45], v23 offset:9728
  ds_read_b64_tr_b16 v[46:47], v23 offset:12032
  s_waitcnt lgkmcnt(6)
  v_mfma_f32_32x32x16_bf16 v[144:159], v[32:35], a[52:55], v[144:159]
  ds_read_b64_tr_b16 v[24:25], v23 offset:18432
  ds_read_b64_tr_b16 v[26:27], v23 offset:20736
  s_add_u32 m0, s24, 39936
  s_nop 0
  buffer_load_dwordx4 v13, s[4:7], s22 offen lds
  s_waitcnt lgkmcnt(6)
  v_mfma_f32_32x32x16_bf16 v[160:175], v[36:39], a[52:55], v[160:175]
  ds_read_b64_tr_b16 v[28:29], v23 offset:18496
  ds_read_b64_tr_b16 v[30:31], v23 offset:20800
  s_waitcnt lgkmcnt(6)
  v_mfma_f32_32x32x16_bf16 v[176:191], v[40:43], a[52:55], v[176:191]
  ds_read_b64_tr_b16 v[32:33], v23 offset:18560
  ds_read_b64_tr_b16 v[34:35], v23 offset:20864
  s_add_u32 m0, s24, 40960
  s_nop 0
  buffer_load_dwordx4 v14, s[4:7], s22 offen lds
  s_waitcnt lgkmcnt(6)
  v_mfma_f32_32x32x16_bf16 v[192:207], v[44:47], a[52:55], v[192:207]
  ds_read_b64_tr_b16 v[36:37], v23 offset:18624
  ds_read_b64_tr_b16 v[38:39], v23 offset:20928
  s_waitcnt lgkmcnt(6)
  v_mfma_f32_32x32x16_bf16 v[64:79], v[24:27], a[56:59], v[64:79]
  ds_read_b64_tr_b16 v[40:41], v23 offset:18688
  ds_read_b64_tr_b16 v[42:43], v23 offset:20992
  s_add_u32 m0, s24, 41984
  s_nop 0
  buffer_load_dwordx4 v15, s[4:7], s22 offen lds
  s_waitcnt lgkmcnt(6)
  v_mfma_f32_32x32x16_bf16 v[80:95], v[28:31], a[56:59], v[80:95]
  ds_read_b64_tr_b16 v[44:45], v23 offset:18752
  ds_read_b64_tr_b16 v[46:47], v23 offset:21056
  s_waitcnt lgkmcnt(6)
  v_mfma_f32_32x32x16_bf16 v[96:111], v[32:35], a[56:59], v[96:111]
  ds_read_b64_tr_b16 v[24:25], v23 offset:18816
  ds_read_b64_tr_b16 v[26:27], v23 offset:21120
  s_add_u32 m0, s24, 43008
  s_nop 0
  buffer_load_dwordx4 v16, s[4:7], s22 offen lds
  s_waitcnt lgkmcnt(6)
  v_mfma_f32_32x32x16_bf16 v[112:127], v[36:39], a[56:59], v[112:127]
  ds_read_b64_tr_b16 v[28:29], v23 offset:18880
  ds_read_b64_tr_b16 v[30:31], v23 offset:21184
  s_waitcnt lgkmcnt(6)
  v_mfma_f32_32x32x16_bf16 v[128:143], v[40:43], a[56:59], v[128:143]
  ds_read_b64_tr_b16 v[32:33], v23 offset:18944
  ds_read_b64_tr_b16 v[34:35], v23 offset:21248
  s_add_u32 m0, s24, 44032
  s_nop 0
  buffer_load_dwordx4 v17, s[4:7], s22 offen lds
  s_waitcnt lgkmcnt(6)
  v_mfma_f32_32x32x16_bf16 v[144:159], v[44:47], a[56:59], v[144:159]
  ds_read_b64_tr_b16 v[36:37], v23 offset:27648
  ds_read_b64_tr_b16 v[38:39], v23 offset:29952
  s_waitcnt lgkmcnt(6)
  v_mfma_f32_32x32x16_bf16 v[160:175], v[24:27], a[56:59], v[160:175]
  ds_read_b64_tr_b16 v[40:41], v23 offset:27712
  ds_read_b64_tr_b16 v[42:43], v23 offset:30016
  s_add_u32 m0, s24, 45056
  s_nop 0
  buffer_load_dwordx4 v18, s[4:7], s22 offen lds
  s_add_u32 s22, s22, 73728
  s_waitcnt lgkmcnt(6)
  v_mfma_f32_32x32x16_bf16 v[176:191], v[28:31], a[56:59], v[176:191]
  ds_read_b64_tr_b16 v[44:45], v23 offset:27776
  ds_read_b64_tr_b16 v[46:47], v23 offset:30080
  s_waitcnt lgkmcnt(6)
  v_mfma_f32_32x32x16_bf16 v[192:207], v[32:35], a[56:59], v[192:207]
  ds_read_b64_tr_b16 v[24:25], v23 offset:27840
  ds_read_b64_tr_b16 v[26:27], v23 offset:30144
  s_waitcnt lgkmcnt(6)
  v_mfma_f32_32x32x16_bf16 v[64:79], v[36:39], a[60:63], v[64:79]
  ds_read_b64_tr_b16 v[28:29], v23 offset:27904
  ds_read_b64_tr_b16 v[30:31], v23 offset:30208
  s_waitcnt lgkmcnt(6)
  v_mfma_f32_32x32x16_bf16 v[80:95], v[40:43], a[60:63], v[80:95]
  ds_read_b64_tr_b16 v[32:33], v23 offset:27968
  ds_read_b64_tr_b16 v[34:35], v23 offset:30272
  s_waitcnt lgkmcnt(6)
  v_mfma_f32_32x32x16_bf16 v[96:111], v[44:47], a[60:63], v[96:111]
  ds_read_b64_tr_b16 v[36:37], v23 offset:28032
  ds_read_b64_tr_b16 v[38:39], v23 offset:30336
  s_waitcnt lgkmcnt(6)
  v_mfma_f32_32x32x16_bf16 v[112:127], v[24:27], a[60:63], v[112:127]
  ds_read_b64_tr_b16 v[40:41], v23 offset:28096
  ds_read_b64_tr_b16 v[42:43], v23 offset:30400
  s_waitcnt lgkmcnt(6)
  v_mfma_f32_32x32x16_bf16 v[128:143], v[28:31], a[60:63], v[128:143]
  ds_read_b64_tr_b16 v[44:45], v23 offset:28160
  ds_read_b64_tr_b16 v[46:47], v23 offset:30464
  s_waitcnt lgkmcnt(6)
  v_mfma_f32_32x32x16_bf16 v[144:159], v[32:35], a[60:63], v[144:159]
  s_waitcnt vmcnt(13) lgkmcnt(0)
  s_barrier
  ds_read_b64_tr_b16 v[24:25], v20 offset:0
  ds_read_b64_tr_b16 v[26:27], v20 offset:2304
  v_mfma_f32_32x32x16_bf16 v[160:175], v[36:39], a[60:63], v[160:175]
  ds_read_b64_tr_b16 v[28:29], v20 offset:64
  ds_read_b64_tr_b16 v[30:31], v20 offset:2368
  v_mfma_f32_32x32x16_bf16 v[176:191], v[40:43], a[60:63], v[176:191]
  ds_read_b64_tr_b16 v[32:33], v20 offset:128
  ds_read_b64_tr_b16 v[34:35], v20 offset:2432
  v_mfma_f32_32x32x16_bf16 v[192:207], v[44:47], a[60:63], v[192:207]
  ds_read_b64_tr_b16 v[36:37], v20 offset:192
  ds_read_b64_tr_b16 v[38:39], v20 offset:2496
  s_waitcnt lgkmcnt(6)
  v_mfma_f32_32x32x16_bf16 v[64:79], v[24:27], a[64:67], v[64:79]
  ds_read_b64_tr_b16 v[40:41], v20 offset:256
  ds_read_b64_tr_b16 v[42:43], v20 offset:2560
  buffer_load_dwordx4 a[96:99], v1, s[8:11], s21 offen offset:0
  s_waitcnt lgkmcnt(6)
  v_mfma_f32_32x32x16_bf16 v[80:95], v[28:31], a[64:67], v[80:95]
  ds_read_b64_tr_b16 v[44:45], v20 offset:320
  ds_read_b64_tr_b16 v[46:47], v20 offset:2624
  s_waitcnt lgkmcnt(6)
  v_mfma_f32_32x32x16_bf16 v[96:111], v[32:35], a[64:67], v[96:111]
  ds_read_b64_tr_b16 v[24:25], v20 offset:384
  ds_read_b64_tr_b16 v[26:27], v20 offset:2688
  buffer_load_dwordx4 a[100:103], v1, s[8:11], s21 offen offset:1024
  s_waitcnt lgkmcnt(6)
  v_mfma_f32_32x32x16_bf16 v[112:127], v[36:39], a[64:67], v[112:127]
  ds_read_b64_tr_b16 v[28:29], v20 offset:448
  ds_read_b64_tr_b16 v[30:31], v20 offset:2752
  s_waitcnt lgkmcnt(6)
  v_mfma_f32_32x32x16_bf16 v[128:143], v[40:43], a[64:67], v[128:143]
  ds_read_b64_tr_b16 v[32:33], v20 offset:512
  ds_read_b64_tr_b16 v[34:35], v20 offset:2816
  buffer_load_dwordx4 a[104:107], v1, s[8:11], s21 offen offset:2048
  s_waitcnt lgkmcnt(6)
  v_mfma_f32_32x32x16_bf16 v[144:159], v[44:47], a[64:67], v[144:159]
  ds_read_b64_tr_b16 v[36:37], v20 offset:9216
  ds_read_b64_tr_b16 v[38:39], v20 offset:11520
  s_waitcnt lgkmcnt(6)
  v_mfma_f32_32x32x16_bf16 v[160:175], v[24:27], a[64:67], v[160:175]
  ds_read_b64_tr_b16 v[40:41], v20 offset:9280
  ds_read_b64_tr_b16 v[42:43], v20 offset:11584
  buffer_load_dwordx4 a[108:111], v1, s[8:11], s21 offen offset:3072
  s_add_u32 s21, s21, 4096
  s_waitcnt lgkmcnt(6)
  v_mfma_f32_32x32x16_bf16 v[176:191], v[28:31], a[64:67], v[176:191]
  ds_read_b64_tr_b16 v[44:45], v20 offset:9344
  ds_read_b64_tr_b16 v[46:47], v20 offset:11648
  s_waitcnt lgkmcnt(6)
  v_mfma_f32_32x32x16_bf16 v[192:207], v[32:35], a[64:67], v[192:207]
  ds_read_b64_tr_b16 v[24:25], v20 offset:9408
  ds_read_b64_tr_b16 v[26:27], v20 offset:11712
  s_add_u32 m0, s24, 73728
  s_nop 0
  buffer_load_dwordx4 v10, s[4:7], s22 offen lds
  s_waitcnt lgkmcnt(6)
  v_mfma_f32_32x32x16_bf16 v[64:79], v[36:39], a[68:71], v[64:79]
  ds_read_b64_tr_b16 v[28:29], v20 offset:9472
  ds_read_b64_tr_b16 v[30:31], v20 offset:11776
  s_waitcnt lgkmcnt(6)
  v_mfma_f32_32x32x16_bf16 v[80:95], v[40:43], a[68:71], v[80:95]
  ds_read_b64_tr_b16 v[32:33], v20 offset:9536
  ds_read_b64_tr_b16 v[34:35], v20 offset:11840
  s_add_u32 m0, s24, 74752
  s_nop 0
  buffer_load_dwordx4 v11, s[4:7], s22 offen lds
  s_waitcnt lgkmcnt(6)
  v_mfma_f32_32x32x16_bf16 v[96:111], v[44:47], a[68:71], v[96:111]
  ds_read_b64_tr_b16 v[36:37], v20 offset:9600
  ds_read_b64_tr_b16 v[38:39], v20 offset:11904
  s_waitcnt lgkmcnt(6)
  v_mfma_f32_32x32x16_bf16 v[112:127], v[24:27], a[68:71], v[112:127]
  ds_read_b64_tr_b16 v[40:41], v20 offset:9664
  ds_read_b64_tr_b16 v[42:43], v20 offset:11968
  s_add_u32 m0, s24, 75776
  s_nop 0
  buffer_load_dwordx4 v12, s[4:7], s22 offen lds
  s_waitcnt lgkmcnt(6)
  v_mfma_f32_32x32x16_bf16 v[128:143], v[28:31], a[68:71], v[128:143]
  ds_read_b64_tr_b16 v[44:45], v20 offset:9728
  ds_read_b64_tr_b16 v[46:47], v20 offset:12032
  s_waitcnt lgkmcnt(6)
  v_mfma_f32_32x32x16_bf16 v[144:159], v[32:35], a[68:71], v[144:159]
  ds_read_b64_tr_b16 v[24:25], v20 offset:18432
  ds_read_b64_tr_b16 v[26:27], v20 offset:20736
  s_add_u32 m0, s24, 76800
  s_nop 0
  buffer_load_dwordx4 v13, s[4:7], s22 offen lds
  s_waitcnt lgkmcnt(6)
  v_mfma_f32_32x32x16_bf16 v[160:175], v[36:39], a[68:71], v[160:175]
  ds_read_b64_tr_b16 v[28:29], v20 offset:18496
  ds_read_b64_tr_b16 v[30:31], v20 offset:20800
  s_waitcnt lgkmcnt(6)
  v_mfma_f32_32x32x16_bf16 v[176:191], v[40:43], a[68:71], v[176:191]
  ds_read_b64_tr_b16 v[32:33], v20 offset:18560
  ds_read_b64_tr_b16 v[34:35], v20 offset:20864
  s_add_u32 m0, s24, 77824
  s_nop 0
  buffer_load_dwordx4 v14, s[4:7], s22 offen lds
  s_waitcnt lgkmcnt(6)
  v_mfma_f32_32x32x16_bf16 v[192:207], v[44:47], a[68:71], v[192:207]
  ds_read_b64_tr_b16 v[36:37], v20 offset:18624
  ds_read_b64_tr_b16 v[38:39], v20 offset:20928
  s_waitcnt lgkmcnt(6)
  v_mfma_f32_32x32x16_bf16 v[64:79], v[24:27], a[72:75], v[64:79]
  ds_read_b64_tr_b16 v[40:41], v20 offset:18688
  ds_read_b64_tr_b16 v[42:43], v20 offset:20992
  s_add_u32 m0, s24, 78848
  s_nop 0
  buffer_load_dwordx4 v15, s[4:7], s22 offen lds
  s_waitcnt lgkmcnt(6)
  v_mfma_f32_32x32x16_bf16 v[80:95], v[28:31], a[72:75], v[80:95]
  ds_read_b64_tr_b16 v[44:45], v20 offset:18752
  ds_read_b64_tr_b16 v[46:47], v20 offset:21056
  s_waitcnt lgkmcnt(6)
  v_mfma_f32_32x32x16_bf16 v[96:111], v[32:35], a[72:75], v[96:111]
  ds_read_b64_tr_b16 v[24:25], v20 offset:18816
  ds_read_b64_tr_b16 v[26:27], v20 offset:21120
  s_add_u32 m0, s24, 79872
  s_nop 0
  buffer_load_dwordx4 v16, s[4:7], s22 offen lds
  s_waitcnt lgkmcnt(6)
  v_mfma_f32_32x32x16_bf16 v[112:127], v[36:39], a[72:75], v[112:127]
  ds_read_b64_tr_b16 v[28:29], v20 offset:18880
  ds_read_b64_tr_b16 v[30:31], v20 offset:21184
  s_waitcnt lgkmcnt(6)
  v_mfma_f32_32x32x16_bf16 v[128:143], v[40:43], a[72:75], v[128:143]
  ds_read_b64_tr_b16 v[32:33], v20 offset:18944
  ds_read_b64_tr_b16 v[34:35], v20 offset:21248
  s_add_u32 m0, s24, 80896
  s_nop 0
  buffer_load_dwordx4 v17, s[4:7], s22 offen lds
  s_waitcnt lgkmcnt(6)
  v_mfma_f32_32x32x16_bf16 v[144:159], v[44:47], a[72:75], v[144:159]
  ds_read_b64_tr_b16 v[36:37], v20 offset:27648
  ds_read_b64_tr_b16 v[38:39], v20 offset:29952
  s_waitcnt lgkmcnt(6)
  v_mfma_f32_32x32x16_bf16 v[160:175], v[24:27], a[72:75], v[160:175]
  ds_read_b64_tr_b16 v[40:41], v20 offset:27712
  ds_read_b64_tr_b16 v[42:43], v20 offset:30016
  s_add_u32 m0, s24, 81920
  s_nop 0
  buffer_load_dwordx4 v18, s[4:7], s22 offen lds
  s_add_u32 s22, s22, 73728
  s_waitcnt lgkmcnt(6)
  v_mfma_f32_32x32x16_bf16 v[176:191], v[28:31], a[72:75], v[176:191]
  ds_read_b64_tr_b16 v[44:45], v20 offset:27776
  ds_read_b64_tr_b16 v[46:47], v20 offset:30080
  s_waitcnt lgkmcnt(6)
  v_mfma_f32_32x32x16_bf16 v[192:207], v[32:35], a[72:75], v[192:207]
  ds_read_b64_tr_b16 v[24:25], v20 offset:27840
  ds_read_b64_tr_b16 v[26:27], v20 offset:30144
  s_waitcnt lgkmcnt(6)
  v_mfma_f32_32x32x16_bf16 v[64:79], v[36:39], a[76:79], v[64:79]
  ds_read_b64_tr_b16 v[28:29], v20 offset:27904
  ds_read_b64_tr_b16 v[30:31], v20 offset:30208
  s_waitcnt lgkmcnt(6)
  v_mfma_f32_32x32x16_bf16 v[80:95], v[40:43], a[76:79], v[80:95]
  ds_read_b64_tr_b16 v[32:33], v20 offset:27968
  ds_read_b64_tr_b16 v[34:35], v20 offset:30272
  s_waitcnt lgkmcnt(6)
  v_mfma_f32_32x32x16_bf16 v[96:111], v[44:47], a[76:79], v[96:111]
  ds_read_b64_tr_b16 v[36:37], v20 offset:28032
  ds_read_b64_tr_b16 v[38:39], v20 offset:30336
  s_waitcnt lgkmcnt(6)
  v_mfma_f32_32x32x16_bf16 v[112:127], v[24:27], a[76:79], v[112:127]
  ds_read_b64_tr_b16 v[40:41], v20 offset:28096
  ds_read_b64_tr_b16 v[42:43], v20 offset:30400
  s_waitcnt lgkmcnt(6)
  v_mfma_f32_32x32x16_bf16 v[128:143], v[28:31], a[76:79], v[128:143]
  ds_read_b64_tr_b16 v[44:45], v20 offset:28160
  ds_read_b64_tr_b16 v[46:47], v20 offset:30464
  s_waitcnt lgkmcnt(6)
  v_mfma_f32_32x32x16_bf16 v[144:159], v[32:35], a[76:79], v[144:159]
  s_waitcnt vmcnt(13) lgkmcnt(0)
  s_barrier
  ds_read_b64_tr_b16 v[24:25], v21 offset:0
  ds_read_b64_tr_b16 v[26:27], v21 offset:2304
  v_mfma_f32_32x32x16_bf16 v[160:175], v[36:39], a[76:79], v[160:175]
  ds_read_b64_tr_b16 v[28:29], v21 offset:64
  ds_read_b64_tr_b16 v[30:31], v21 offset:2368
  v_mfma_f32_32x32x16_bf16 v[176:191], v[40:43], a[76:79], v[176:191]
  ds_read_b64_tr_b16 v[32:33], v21 offset:128
  ds_read_b64_tr_b16 v[34:35], v21 offset:2432
  v_mfma_f32_32x32x16_bf16 v[192:207], v[44:47], a[76:79], v[192:207]
  ds_read_b64_tr_b16 v[36:37], v21 offset:192
  ds_read_b64_tr_b16 v[38:39], v21 offset:2496
  s_waitcnt lgkmcnt(6)
  v_mfma_f32_32x32x16_bf16 v[64:79], v[24:27], a[80:83], v[64:79]
  ds_read_b64_tr_b16 v[40:41], v21 offset:256
  ds_read_b64_tr_b16 v[42:43], v21 offset:2560
  buffer_load_dwordx4 a[112:115], v1, s[8:11], s21 offen offset:0
  s_waitcnt lgkmcnt(6)
  v_mfma_f32_32x32x16_bf16 v[80:95], v[28:31], a[80:83], v[80:95]
  ds_read_b64_tr_b16 v[44:45], v21 offset:320
  ds_read_b64_tr_b16 v[46:47], v21 offset:2624
  s_waitcnt lgkmcnt(6)
  v_mfma_f32_32x32x16_bf16 v[96:111], v[32:35], a[80:83], v[96:111]
  ds_read_b64_tr_b16 v[24:25], v21 offset:384
  ds_read_b64_tr_b16 v[26:27], v21 offset:2688
  buffer_load_dwordx4 a[116:119], v1, s[8:11], s21 offen offset:1024
  s_waitcnt lgkmcnt(6)
  v_mfma_f32_32x32x16_bf16 v[112:127], v[36:39], a[80:83], v[112:127]
  ds_read_b64_tr_b16 v[28:29], v21 offset:448
  ds_read_b64_tr_b16 v[30:31], v21 offset:2752
  s_waitcnt lgkmcnt(6)
  v_mfma_f32_32x32x16_bf16 v[128:143], v[40:43], a[80:83], v[128:143]
  ds_read_b64_tr_b16 v[32:33], v21 offset:512
  ds_read_b64_tr_b16 v[34:35], v21 offset:2816
  buffer_load_dwordx4 a[120:123], v1, s[8:11], s21 offen offset:2048
  s_waitcnt lgkmcnt(6)
  v_mfma_f32_32x32x16_bf16 v[144:159], v[44:47], a[80:83], v[144:159]
  ds_read_b64_tr_b16 v[36:37], v21 offset:9216
  ds_read_b64_tr_b16 v[38:39], v21 offset:11520
  s_waitcnt lgkmcnt(6)
  v_mfma_f32_32x32x16_bf16 v[160:175], v[24:27], a[80:83], v[160:175]
  ds_read_b64_tr_b16 v[40:41], v21 offset:9280
  ds_read_b64_tr_b16 v[42:43], v21 offset:11584
  buffer_load_dwordx4 a[124:127], v1, s[8:11], s21 offen offset:3072
  s_add_u32 s21, s21, 4096
  s_waitcnt lgkmcnt(6)
  v_mfma_f32_32x32x16_bf16 v[176:191], v[28:31], a[80:83], v[176:191]
  ds_read_b64_tr_b16 v[44:45], v21 offset:9344
  ds_read_b64_tr_b16 v[46:47], v21 offset:11648
  s_waitcnt lgkmcnt(6)
  v_mfma_f32_32x32x16_bf16 v[192:207], v[32:35], a[80:83], v[192:207]
  ds_read_b64_tr_b16 v[24:25], v21 offset:9408
  ds_read_b64_tr_b16 v[26:27], v21 offset:11712
  s_add_u32 m0, s24, 110592
  s_nop 0
  buffer_load_dwordx4 v10, s[4:7], s22 offen lds
  s_waitcnt lgkmcnt(6)
  v_mfma_f32_32x32x16_bf16 v[64:79], v[36:39], a[84:87], v[64:79]
  ds_read_b64_tr_b16 v[28:29], v21 offset:9472
  ds_read_b64_tr_b16 v[30:31], v21 offset:11776
  s_waitcnt lgkmcnt(6)
  v_mfma_f32_32x32x16_bf16 v[80:95], v[40:43], a[84:87], v[80:95]
  ds_read_b64_tr_b16 v[32:33], v21 offset:9536
  ds_read_b64_tr_b16 v[34:35], v21 offset:11840
  s_add_u32 m0, s24, 111616
  s_nop 0
  buffer_load_dwordx4 v11, s[4:7], s22 offen lds
  s_waitcnt lgkmcnt(6)
  v_mfma_f32_32x32x16_bf16 v[96:111], v[44:47], a[84:87], v[96:111]
  ds_read_b64_tr_b16 v[36:37], v21 offset:9600
  ds_read_b64_tr_b16 v[38:39], v21 offset:11904
  s_waitcnt lgkmcnt(6)
  v_mfma_f32_32x32x16_bf16 v[112:127], v[24:27], a[84:87], v[112:127]
  ds_read_b64_tr_b16 v[40:41], v21 offset:9664
  ds_read_b64_tr_b16 v[42:43], v21 offset:11968
  s_add_u32 m0, s24, 112640
  s_nop 0
  buffer_load_dwordx4 v12, s[4:7], s22 offen lds
  s_waitcnt lgkmcnt(6)
  v_mfma_f32_32x32x16_bf16 v[128:143], v[28:31], a[84:87], v[128:143]
  ds_read_b64_tr_b16 v[44:45], v21 offset:9728
  ds_read_b64_tr_b16 v[46:47], v21 offset:12032
  s_waitcnt lgkmcnt(6)
  v_mfma_f32_32x32x16_bf16 v[144:159], v[32:35], a[84:87], v[144:159]
  ds_read_b64_tr_b16 v[24:25], v21 offset:18432
  ds_read_b64_tr_b16 v[26:27], v21 offset:20736
  s_add_u32 m0, s24, 113664
  s_nop 0
  buffer_load_dwordx4 v13, s[4:7], s22 offen lds
  s_waitcnt lgkmcnt(6)
  v_mfma_f32_32x32x16_bf16 v[160:175], v[36:39], a[84:87], v[160:175]
  ds_read_b64_tr_b16 v[28:29], v21 offset:18496
  ds_read_b64_tr_b16 v[30:31], v21 offset:20800
  s_waitcnt lgkmcnt(6)
  v_mfma_f32_32x32x16_bf16 v[176:191], v[40:43], a[84:87], v[176:191]
  ds_read_b64_tr_b16 v[32:33], v21 offset:18560
  ds_read_b64_tr_b16 v[34:35], v21 offset:20864
  s_add_u32 m0, s24, 114688
  s_nop 0
  buffer_load_dwordx4 v14, s[4:7], s22 offen lds
  s_waitcnt lgkmcnt(6)
  v_mfma_f32_32x32x16_bf16 v[192:207], v[44:47], a[84:87], v[192:207]
  ds_read_b64_tr_b16 v[36:37], v21 offset:18624
  ds_read_b64_tr_b16 v[38:39], v21 offset:20928
  s_waitcnt lgkmcnt(6)
  v_mfma_f32_32x32x16_bf16 v[64:79], v[24:27], a[88:91], v[64:79]
  ds_read_b64_tr_b16 v[40:41], v21 offset:18688
  ds_read_b64_tr_b16 v[42:43], v21 offset:20992
  s_add_u32 m0, s24, 115712
  s_nop 0
  buffer_load_dwordx4 v15, s[4:7], s22 offen lds
  s_waitcnt lgkmcnt(6)
  v_mfma_f32_32x32x16_bf16 v[80:95], v[28:31], a[88:91], v[80:95]
  ds_read_b64_tr_b16 v[44:45], v21 offset:18752
  ds_read_b64_tr_b16 v[46:47], v21 offset:21056
  s_waitcnt lgkmcnt(6)
  v_mfma_f32_32x32x16_bf16 v[96:111], v[32:35], a[88:91], v[96:111]
  ds_read_b64_tr_b16 v[24:25], v21 offset:18816
  ds_read_b64_tr_b16 v[26:27], v21 offset:21120
  s_add_u32 m0, s24, 116736
  s_nop 0
  buffer_load_dwordx4 v16, s[4:7], s22 offen lds
  s_waitcnt lgkmcnt(6)
  v_mfma_f32_32x32x16_bf16 v[112:127], v[36:39], a[88:91], v[112:127]
  ds_read_b64_tr_b16 v[28:29], v21 offset:18880
  ds_read_b64_tr_b16 v[30:31], v21 offset:21184
  s_waitcnt lgkmcnt(6)
  v_mfma_f32_32x32x16_bf16 v[128:143], v[40:43], a[88:91], v[128:143]
  ds_read_b64_tr_b16 v[32:33], v21 offset:18944
  ds_read_b64_tr_b16 v[34:35], v21 offset:21248
  s_add_u32 m0, s24, 117760
  s_nop 0
  buffer_load_dwordx4 v17, s[4:7], s22 offen lds
  s_waitcnt lgkmcnt(6)
  v_mfma_f32_32x32x16_bf16 v[144:159], v[44:47], a[88:91], v[144:159]
  ds_read_b64_tr_b16 v[36:37], v21 offset:27648
  ds_read_b64_tr_b16 v[38:39], v21 offset:29952
  s_waitcnt lgkmcnt(6)
  v_mfma_f32_32x32x16_bf16 v[160:175], v[24:27], a[88:91], v[160:175]
  ds_read_b64_tr_b16 v[40:41], v21 offset:27712
  ds_read_b64_tr_b16 v[42:43], v21 offset:30016
  s_add_u32 m0, s24, 118784
  s_nop 0
  buffer_load_dwordx4 v18, s[4:7], s22 offen lds
  s_add_u32 s22, s22, 73728
  s_sub_u32 s22, s22, 589248
  s_waitcnt lgkmcnt(6)
  v_mfma_f32_32x32x16_bf16 v[176:191], v[28:31], a[88:91], v[176:191]
  ds_read_b64_tr_b16 v[44:45], v21 offset:27776
  ds_read_b64_tr_b16 v[46:47], v21 offset:30080
  s_waitcnt lgkmcnt(6)
  v_mfma_f32_32x32x16_bf16 v[192:207], v[32:35], a[88:91], v[192:207]
  ds_read_b64_tr_b16 v[24:25], v21 offset:27840
  ds_read_b64_tr_b16 v[26:27], v21 offset:30144
  s_waitcnt lgkmcnt(6)
  v_mfma_f32_32x32x16_bf16 v[64:79], v[36:39], a[92:95], v[64:79]
  ds_read_b64_tr_b16 v[28:29], v21 offset:27904
  ds_read_b64_tr_b16 v[30:31], v21 offset:30208
  s_waitcnt lgkmcnt(6)
  v_mfma_f32_32x32x16_bf16 v[80:95], v[40:43], a[92:95], v[80:95]
  ds_read_b64_tr_b16 v[32:33], v21 offset:27968
  ds_read_b64_tr_b16 v[34:35], v21 offset:30272
  s_waitcnt lgkmcnt(6)
  v_mfma_f32_32x32x16_bf16 v[96:111], v[44:47], a[92:95], v[96:111]
  ds_read_b64_tr_b16 v[36:37], v21 offset:28032
  ds_read_b64_tr_b16 v[38:39], v21 offset:30336
  s_waitcnt lgkmcnt(6)
  v_mfma_f32_32x32x16_bf16 v[112:127], v[24:27], a[92:95], v[112:127]
  ds_read_b64_tr_b16 v[40:41], v21 offset:28096
  ds_read_b64_tr_b16 v[42:43], v21 offset:30400
  s_waitcnt lgkmcnt(6)
  v_mfma_f32_32x32x16_bf16 v[128:143], v[28:31], a[92:95], v[128:143]
  ds_read_b64_tr_b16 v[44:45], v21 offset:28160
  ds_read_b64_tr_b16 v[46:47], v21 offset:30464
  s_waitcnt lgkmcnt(6)
  v_mfma_f32_32x32x16_bf16 v[144:159], v[32:35], a[92:95], v[144:159]
  s_waitcnt vmcnt(13) lgkmcnt(0)
  s_barrier
  ds_read_b64_tr_b16 v[24:25], v22 offset:0
  ds_read_b64_tr_b16 v[26:27], v22 offset:2304
  v_mfma_f32_32x32x16_bf16 v[160:175], v[36:39], a[92:95], v[160:175]
  ds_read_b64_tr_b16 v[28:29], v22 offset:9216
  ds_read_b64_tr_b16 v[30:31], v22 offset:11520
  v_mfma_f32_32x32x16_bf16 v[176:191], v[40:43], a[92:95], v[176:191]
  ds_read_b64_tr_b16 v[32:33], v22 offset:18432
  ds_read_b64_tr_b16 v[34:35], v22 offset:20736
  v_mfma_f32_32x32x16_bf16 v[192:207], v[44:47], a[92:95], v[192:207]
  ds_read_b64_tr_b16 v[36:37], v22 offset:27648
  ds_read_b64_tr_b16 v[38:39], v22 offset:29952
  s_waitcnt lgkmcnt(6)
  v_mfma_f32_32x32x16_bf16 v[64:79], v[24:27], a[96:99], v[64:79]
  s_waitcnt vmcnt(0) lgkmcnt(0)
  s_barrier
  ds_read_b64_tr_b16 v[40:41], v23 offset:0
  ds_read_b64_tr_b16 v[42:43], v23 offset:2304
  v_mfma_f32_32x32x16_bf16 v[64:79], v[28:31], a[100:103], v[64:79]
  ds_read_b64_tr_b16 v[44:45], v23 offset:9216
  ds_read_b64_tr_b16 v[46:47], v23 offset:11520
  v_mfma_f32_32x32x16_bf16 v[64:79], v[32:35], a[104:107], v[64:79]
  ds_read_b64_tr_b16 v[24:25], v23 offset:18432
  ds_read_b64_tr_b16 v[26:27], v23 offset:20736
  v_mfma_f32_32x32x16_bf16 v[64:79], v[36:39], a[108:111], v[64:79]
  ds_read_b64_tr_b16 v[28:29], v23 offset:27648
  ds_read_b64_tr_b16 v[30:31], v23 offset:29952
  s_waitcnt lgkmcnt(6)
  v_mfma_f32_32x32x16_bf16 v[64:79], v[40:43], a[112:115], v[64:79]
  ds_read_b64_tr_b16 v[32:33], v22 offset:64
  ds_read_b64_tr_b16 v[34:35], v22 offset:2368
  s_waitcnt lgkmcnt(6)
  v_mfma_f32_32x32x16_bf16 v[64:79], v[44:47], a[116:119], v[64:79]
  ds_read_b64_tr_b16 v[36:37], v22 offset:9280
  ds_read_b64_tr_b16 v[38:39], v22 offset:11584
  s_waitcnt lgkmcnt(6)
  v_mfma_f32_32x32x16_bf16 v[64:79], v[24:27], a[120:123], v[64:79]
  ds_read_b64_tr_b16 v[40:41], v22 offset:18496
  ds_read_b64_tr_b16 v[42:43], v22 offset:20800
  s_waitcnt lgkmcnt(6)
  v_mfma_f32_32x32x16_bf16 v[64:79], v[28:31], a[124:127], v[64:79]
  ds_read_b64_tr_b16 v[44:45], v22 offset:27712
  ds_read_b64_tr_b16 v[46:47], v22 offset:30016
  s_waitcnt lgkmcnt(6)
  v_mfma_f32_32x32x16_bf16 v[80:95], v[32:35], a[96:99], v[80:95]
  ds_read_b64_tr_b16 v[24:25], v23 offset:64
  ds_read_b64_tr_b16 v[26:27], v23 offset:2368
  s_waitcnt lgkmcnt(6)
  v_mfma_f32_32x32x16_bf16 v[80:95], v[36:39], a[100:103], v[80:95]
  ds_read_b64_tr_b16 v[28:29], v23 offset:9280
  ds_read_b64_tr_b16 v[30:31], v23 offset:11584
  s_waitcnt lgkmcnt(6)
  v_mfma_f32_32x32x16_bf16 v[80:95], v[40:43], a[104:107], v[80:95]
  ds_read_b64_tr_b16 v[32:33], v23 offset:18496
  ds_read_b64_tr_b16 v[34:35], v23 offset:20800
  v_cvt_pk_bf16_f32 v48, v64, v65
  v_cvt_pk_bf16_f32 v49, v66, v67
  s_waitcnt lgkmcnt(6)
  v_mfma_f32_32x32x16_bf16 v[80:95], v[44:47], a[108:111], v[80:95]
  ds_read_b64_tr_b16 v[36:37], v23 offset:27712
  ds_read_b64_tr_b16 v[38:39], v23 offset:30016
  v_cvt_pk_bf16_f32 v50, v68, v69
  v_cvt_pk_bf16_f32 v51, v70, v71
  s_waitcnt lgkmcnt(6)
  v_mfma_f32_32x32x16_bf16 v[80:95], v[24:27], a[112:115], v[80:95]
  ds_read_b64_tr_b16 v[40:41], v22 offset:128
  ds_read_b64_tr_b16 v[42:43], v22 offset:2432
  buffer_store_dwordx4 v[48:51], v1, s[12:15], s25 offen offset:0 sc0 sc1
  v_cvt_pk_bf16_f32 v52, v72, v73
  s_waitcnt lgkmcnt(6)
  v_mfma_f32_32x32x16_bf16 v[80:95], v[28:31], a[116:119], v[80:95]
  ds_read_b64_tr_b16 v[44:45], v22 offset:9344
  ds_read_b64_tr_b16 v[46:47], v22 offset:11648
  v_cvt_pk_bf16_f32 v53, v74, v75
  v_cvt_pk_bf16_f32 v54, v76, v77
  s_waitcnt lgkmcnt(6)
  v_mfma_f32_32x32x16_bf16 v[80:95], v[32:35], a[120:123], v[80:95]
  ds_read_b64_tr_b16 v[24:25], v22 offset:18560
  ds_read_b64_tr_b16 v[26:27], v22 offset:20864
  v_cvt_pk_bf16_f32 v55, v78, v79
  buffer_store_dwordx4 v[52:55], v1, s[12:15], s25 offen offset:1024 sc0 sc1
  s_waitcnt lgkmcnt(6)
  v_mfma_f32_32x32x16_bf16 v[80:95], v[36:39], a[124:127], v[80:95]
  ds_read_b64_tr_b16 v[28:29], v22 offset:27776
  ds_read_b64_tr_b16 v[30:31], v22 offset:30080
  s_waitcnt lgkmcnt(6)
  v_mfma_f32_32x32x16_bf16 v[96:111], v[40:43], a[96:99], v[96:111]
  ds_read_b64_tr_b16 v[32:33], v23 offset:128
  ds_read_b64_tr_b16 v[34:35], v23 offset:2432
  s_waitcnt lgkmcnt(6)
  v_mfma_f32_32x32x16_bf16 v[96:111], v[44:47], a[100:103], v[96:111]
  ds_read_b64_tr_b16 v[36:37], v23 offset:9344
  ds_read_b64_tr_b16 v[38:39], v23 offset:11648
  s_waitcnt lgkmcnt(6)
  v_mfma_f32_32x32x16_bf16 v[96:111], v[24:27], a[104:107], v[96:111]
  ds_read_b64_tr_b16 v[40:41], v23 offset:18560
  ds_read_b64_tr_b16 v[42:43], v23 offset:20864
  v_cvt_pk_bf16_f32 v56, v80, v81
  v_cvt_pk_bf16_f32 v57, v82, v83
  s_waitcnt lgkmcnt(6)
  v_mfma_f32_32x32x16_bf16 v[96:111], v[28:31], a[108:111], v[96:111]
  ds_read_b64_tr_b16 v[44:45], v23 offset:27776
  ds_read_b64_tr_b16 v[46:47], v23 offset:30080
  v_cvt_pk_bf16_f32 v58, v84, v85
  v_cvt_pk_bf16_f32 v59, v86, v87
  s_waitcnt lgkmcnt(6)
  v_mfma_f32_32x32x16_bf16 v[96:111], v[32:35], a[112:115], v[96:111]
  ds_read_b64_tr_b16 v[24:25], v22 offset:192
  ds_read_b64_tr_b16 v[26:27], v22 offset:2496
  buffer_store_dwordx4 v[56:59], v1, s[12:15], s25 offen offset:2048 sc0 sc1
  v_cvt_pk_bf16_f32 v60, v88, v89
  s_waitcnt lgkmcnt(6)
  v_mfma_f32_32x32x16_bf16 v[96:111], v[36:39], a[116:119], v[96:111]
  ds_read_b64_tr_b16 v[28:29], v22 offset:9408
  ds_read_b64_tr_b16 v[30:31], v22 offset:11712
  v_cvt_pk_bf16_f32 v61, v90, v91
  v_cvt_pk_bf16_f32 v62, v92, v93
  s_waitcnt lgkmcnt(6)
  v_mfma_f32_32x32x16_bf16 v[96:111], v[40:43], a[120:123], v[96:111]
  ds_read_b64_tr_b16 v[32:33], v22 offset:18624
  ds_read_b64_tr_b16 v[34:35], v22 offset:20928
  v_cvt_pk_bf16_f32 v63, v94, v95
  buffer_store_dwordx4 v[60:63], v1, s[12:15], s25 offen offset:3072 sc0 sc1
  s_waitcnt lgkmcnt(6)
  v_mfma_f32_32x32x16_bf16 v[96:111], v[44:47], a[124:127], v[96:111]
  ds_read_b64_tr_b16 v[36:37], v22 offset:27840
  ds_read_b64_tr_b16 v[38:39], v22 offset:30144
  s_waitcnt lgkmcnt(6)
  v_mfma_f32_32x32x16_bf16 v[112:127], v[24:27], a[96:99], v[112:127]
  ds_read_b64_tr_b16 v[40:41], v23 offset:192
  ds_read_b64_tr_b16 v[42:43], v23 offset:2496
  s_waitcnt lgkmcnt(6)
  v_mfma_f32_32x32x16_bf16 v[112:127], v[28:31], a[100:103], v[112:127]
  ds_read_b64_tr_b16 v[44:45], v23 offset:9408
  ds_read_b64_tr_b16 v[46:47], v23 offset:11712
  s_waitcnt lgkmcnt(6)
  v_mfma_f32_32x32x16_bf16 v[112:127], v[32:35], a[104:107], v[112:127]
  ds_read_b64_tr_b16 v[24:25], v23 offset:18624
  ds_read_b64_tr_b16 v[26:27], v23 offset:20928
  v_cvt_pk_bf16_f32 v48, v96, v97
  v_cvt_pk_bf16_f32 v49, v98, v99
  s_waitcnt lgkmcnt(6)
  v_mfma_f32_32x32x16_bf16 v[112:127], v[36:39], a[108:111], v[112:127]
  ds_read_b64_tr_b16 v[28:29], v23 offset:27840
  ds_read_b64_tr_b16 v[30:31], v23 offset:30144
  v_cvt_pk_bf16_f32 v50, v100, v101
  v_cvt_pk_bf16_f32 v51, v102, v103
  s_waitcnt lgkmcnt(6)
  v_mfma_f32_32x32x16_bf16 v[112:127], v[40:43], a[112:115], v[112:127]
  ds_read_b64_tr_b16 v[32:33], v22 offset:256
  ds_read_b64_tr_b16 v[34:35], v22 offset:2560
  s_add_u32 s25, s25, 4096
  buffer_store_dwordx4 v[48:51], v1, s[12:15], s25 offen offset:0 sc0 sc1
  s_waitcnt lgkmcnt(6)
  v_mfma_f32_32x32x16_bf16 v[112:127], v[44:47], a[116:119], v[112:127]
  ds_read_b64_tr_b16 v[36:37], v22 offset:9472
  ds_read_b64_tr_b16 v[38:39], v22 offset:11776
  v_cvt_pk_bf16_f32 v52, v104, v105
  v_cvt_pk_bf16_f32 v53, v106, v107
  s_waitcnt lgkmcnt(6)
  v_mfma_f32_32x32x16_bf16 v[112:127], v[24:27], a[120:123], v[112:127]
  ds_read_b64_tr_b16 v[40:41], v22 offset:18688
  ds_read_b64_tr_b16 v[42:43], v22 offset:20992
  v_cvt_pk_bf16_f32 v54, v108, v109
  v_cvt_pk_bf16_f32 v55, v110, v111
  s_waitcnt lgkmcnt(6)
  v_mfma_f32_32x32x16_bf16 v[112:127], v[28:31], a[124:127], v[112:127]
  ds_read_b64_tr_b16 v[44:45], v22 offset:27904
  ds_read_b64_tr_b16 v[46:47], v22 offset:30208
  buffer_store_dwordx4 v[52:55], v1, s[12:15], s25 offen offset:1024 sc0 sc1
  s_waitcnt lgkmcnt(6)
  v_mfma_f32_32x32x16_bf16 v[128:143], v[32:35], a[96:99], v[128:143]
  ds_read_b64_tr_b16 v[24:25], v23 offset:256
  ds_read_b64_tr_b16 v[26:27], v23 offset:2560
  s_waitcnt lgkmcnt(6)
  v_mfma_f32_32x32x16_bf16 v[128:143], v[36:39], a[100:103], v[128:143]
  ds_read_b64_tr_b16 v[28:29], v23 offset:9472
  ds_read_b64_tr_b16 v[30:31], v23 offset:11776
  s_waitcnt lgkmcnt(6)
  v_mfma_f32_32x32x16_bf16 v[128:143], v[40:43], a[104:107], v[128:143]
  ds_read_b64_tr_b16 v[32:33], v23 offset:18688
  ds_read_b64_tr_b16 v[34:35], v23 offset:20992
  v_cvt_pk_bf16_f32 v56, v112, v113
  v_cvt_pk_bf16_f32 v57, v114, v115
  s_waitcnt lgkmcnt(6)
  v_mfma_f32_32x32x16_bf16 v[128:143], v[44:47], a[108:111], v[128:143]
  ds_read_b64_tr_b16 v[36:37], v23 offset:27904
  ds_read_b64_tr_b16 v[38:39], v23 offset:30208
  v_cvt_pk_bf16_f32 v58, v116, v117
  v_cvt_pk_bf16_f32 v59, v118, v119
  s_waitcnt lgkmcnt(6)
  v_mfma_f32_32x32x16_bf16 v[128:143], v[24:27], a[112:115], v[128:143]
  ds_read_b64_tr_b16 v[40:41], v22 offset:320
  ds_read_b64_tr_b16 v[42:43], v22 offset:2624
  buffer_store_dwordx4 v[56:59], v1, s[12:15], s25 offen offset:2048 sc0 sc1
  v_cvt_pk_bf16_f32 v60, v120, v121
  s_waitcnt lgkmcnt(6)
  v_mfma_f32_32x32x16_bf16 v[128:143], v[28:31], a[116:119], v[128:143]
  ds_read_b64_tr_b16 v[44:45], v22 offset:9536
  ds_read_b64_tr_b16 v[46:47], v22 offset:11840
  v_cvt_pk_bf16_f32 v61, v122, v123
  v_cvt_pk_bf16_f32 v62, v124, v125
  s_waitcnt lgkmcnt(6)
  v_mfma_f32_32x32x16_bf16 v[128:143], v[32:35], a[120:123], v[128:143]
  ds_read_b64_tr_b16 v[24:25], v22 offset:18752
  ds_read_b64_tr_b16 v[26:27], v22 offset:21056
  v_cvt_pk_bf16_f32 v63, v126, v127
  buffer_store_dwordx4 v[60:63], v1, s[12:15], s25 offen offset:3072 sc0 sc1
  s_waitcnt lgkmcnt(6)
  v_mfma_f32_32x32x16_bf16 v[128:143], v[36:39], a[124:127], v[128:143]
  ds_read_b64_tr_b16 v[28:29], v22 offset:27968
  ds_read_b64_tr_b16 v[30:31], v22 offset:30272
  s_waitcnt lgkmcnt(6)
  v_mfma_f32_32x32x16_bf16 v[144:159], v[40:43], a[96:99], v[144:159]
  ds_read_b64_tr_b16 v[32:33], v23 offset:320
  ds_read_b64_tr_b16 v[34:35], v23 offset:2624
  s_waitcnt lgkmcnt(6)
  v_mfma_f32_32x32x16_bf16 v[144:159], v[44:47], a[100:103], v[144:159]
  ds_read_b64_tr_b16 v[36:37], v23 offset:9536
  ds_read_b64_tr_b16 v[38:39], v23 offset:11840
  s_waitcnt lgkmcnt(6)
  v_mfma_f32_32x32x16_bf16 v[144:159], v[24:27], a[104:107], v[144:159]
  ds_read_b64_tr_b16 v[40:41], v23 offset:18752
  ds_read_b64_tr_b16 v[42:43], v23 offset:21056
  v_cvt_pk_bf16_f32 v48, v128, v129
  v_cvt_pk_bf16_f32 v49, v130, v131
  s_waitcnt lgkmcnt(6)
  v_mfma_f32_32x32x16_bf16 v[144:159], v[28:31], a[108:111], v[144:159]
  ds_read_b64_tr_b16 v[44:45], v23 offset:27968
  ds_read_b64_tr_b16 v[46:47], v23 offset:30272
  v_cvt_pk_bf16_f32 v50, v132, v133
  v_cvt_pk_bf16_f32 v51, v134, v135
  s_waitcnt lgkmcnt(6)
  v_mfma_f32_32x32x16_bf16 v[144:159], v[32:35], a[112:115], v[144:159]
  ds_read_b64_tr_b16 v[24:25], v22 offset:384
  ds_read_b64_tr_b16 v[26:27], v22 offset:2688
  s_add_u32 s25, s25, 4096
  buffer_store_dwordx4 v[48:51], v1, s[12:15], s25 offen offset:0 sc0 sc1
  s_waitcnt lgkmcnt(6)
  v_mfma_f32_32x32x16_bf16 v[144:159], v[36:39], a[116:119], v[144:159]
  ds_read_b64_tr_b16 v[28:29], v22 offset:9600
  ds_read_b64_tr_b16 v[30:31], v22 offset:11904
  v_cvt_pk_bf16_f32 v52, v136, v137
  v_cvt_pk_bf16_f32 v53, v138, v139
  s_waitcnt lgkmcnt(6)
  v_mfma_f32_32x32x16_bf16 v[144:159], v[40:43], a[120:123], v[144:159]
  ds_read_b64_tr_b16 v[32:33], v22 offset:18816
  ds_read_b64_tr_b16 v[34:35], v22 offset:21120
  v_cvt_pk_bf16_f32 v54, v140, v141
  v_cvt_pk_bf16_f32 v55, v142, v143
  s_waitcnt lgkmcnt(6)
  v_mfma_f32_32x32x16_bf16 v[144:159], v[44:47], a[124:127], v[144:159]
  ds_read_b64_tr_b16 v[36:37], v22 offset:28032
  ds_read_b64_tr_b16 v[38:39], v22 offset:30336
  buffer_store_dwordx4 v[52:55], v1, s[12:15], s25 offen offset:1024 sc0 sc1
  s_waitcnt lgkmcnt(6)
  v_mfma_f32_32x32x16_bf16 v[160:175], v[24:27], a[96:99], v[160:175]
  ds_read_b64_tr_b16 v[40:41], v23 offset:384
  ds_read_b64_tr_b16 v[42:43], v23 offset:2688
  s_waitcnt lgkmcnt(6)
  v_mfma_f32_32x32x16_bf16 v[160:175], v[28:31], a[100:103], v[160:175]
  ds_read_b64_tr_b16 v[44:45], v23 offset:9600
  ds_read_b64_tr_b16 v[46:47], v23 offset:11904
  s_waitcnt lgkmcnt(6)
  v_mfma_f32_32x32x16_bf16 v[160:175], v[32:35], a[104:107], v[160:175]
  ds_read_b64_tr_b16 v[24:25], v23 offset:18816
  ds_read_b64_tr_b16 v[26:27], v23 offset:21120
  v_cvt_pk_bf16_f32 v56, v144, v145
  v_cvt_pk_bf16_f32 v57, v146, v147
  s_waitcnt lgkmcnt(6)
  v_mfma_f32_32x32x16_bf16 v[160:175], v[36:39], a[108:111], v[160:175]
  ds_read_b64_tr_b16 v[28:29], v23 offset:28032
  ds_read_b64_tr_b16 v[30:31], v23 offset:30336
  v_cvt_pk_bf16_f32 v58, v148, v149
  v_cvt_pk_bf16_f32 v59, v150, v151
  s_waitcnt lgkmcnt(6)
  v_mfma_f32_32x32x16_bf16 v[160:175], v[40:43], a[112:115], v[160:175]
  ds_read_b64_tr_b16 v[32:33], v22 offset:448
  ds_read_b64_tr_b16 v[34:35], v22 offset:2752
  buffer_store_dwordx4 v[56:59], v1, s[12:15], s25 offen offset:2048 sc0 sc1
  v_cvt_pk_bf16_f32 v60, v152, v153
  s_waitcnt lgkmcnt(6)
  v_mfma_f32_32x32x16_bf16 v[160:175], v[44:47], a[116:119], v[160:175]
  ds_read_b64_tr_b16 v[36:37], v22 offset:9664
  ds_read_b64_tr_b16 v[38:39], v22 offset:11968
  v_cvt_pk_bf16_f32 v61, v154, v155
  v_cvt_pk_bf16_f32 v62, v156, v157
  s_waitcnt lgkmcnt(6)
  v_mfma_f32_32x32x16_bf16 v[160:175], v[24:27], a[120:123], v[160:175]
  ds_read_b64_tr_b16 v[40:41], v22 offset:18880
  ds_read_b64_tr_b16 v[42:43], v22 offset:21184
  v_cvt_pk_bf16_f32 v63, v158, v159
  buffer_store_dwordx4 v[60:63], v1, s[12:15], s25 offen offset:3072 sc0 sc1
  s_waitcnt lgkmcnt(6)
  v_mfma_f32_32x32x16_bf16 v[160:175], v[28:31], a[124:127], v[160:175]
  ds_read_b64_tr_b16 v[44:45], v22 offset:28096
  ds_read_b64_tr_b16 v[46:47], v22 offset:30400
  s_waitcnt lgkmcnt(6)
  v_mfma_f32_32x32x16_bf16 v[176:191], v[32:35], a[96:99], v[176:191]
  ds_read_b64_tr_b16 v[24:25], v23 offset:448
  ds_read_b64_tr_b16 v[26:27], v23 offset:2752
  s_waitcnt lgkmcnt(6)
  v_mfma_f32_32x32x16_bf16 v[176:191], v[36:39], a[100:103], v[176:191]
  ds_read_b64_tr_b16 v[28:29], v23 offset:9664
  ds_read_b64_tr_b16 v[30:31], v23 offset:11968
  s_waitcnt lgkmcnt(6)
  v_mfma_f32_32x32x16_bf16 v[176:191], v[40:43], a[104:107], v[176:191]
  ds_read_b64_tr_b16 v[32:33], v23 offset:18880
  ds_read_b64_tr_b16 v[34:35], v23 offset:21184
  v_cvt_pk_bf16_f32 v48, v160, v161
  v_cvt_pk_bf16_f32 v49, v162, v163
  s_waitcnt lgkmcnt(6)
  v_mfma_f32_32x32x16_bf16 v[176:191], v[44:47], a[108:111], v[176:191]
  ds_read_b64_tr_b16 v[36:37], v23 offset:28096
  ds_read_b64_tr_b16 v[38:39], v23 offset:30400
  v_cvt_pk_bf16_f32 v50, v164, v165
  v_cvt_pk_bf16_f32 v51, v166, v167
  s_waitcnt lgkmcnt(6)
  v_mfma_f32_32x32x16_bf16 v[176:191], v[24:27], a[112:115], v[176:191]
  ds_read_b64_tr_b16 v[40:41], v22 offset:512
  ds_read_b64_tr_b16 v[42:43], v22 offset:2816
  s_add_u32 s25, s25, 4096
  buffer_store_dwordx4 v[48:51], v1, s[12:15], s25 offen offset:0 sc0 sc1
  s_waitcnt lgkmcnt(6)
  v_mfma_f32_32x32x16_bf16 v[176:191], v[28:31], a[116:119], v[176:191]
  ds_read_b64_tr_b16 v[44:45], v22 offset:9728
  ds_read_b64_tr_b16 v[46:47], v22 offset:12032
  v_cvt_pk_bf16_f32 v52, v168, v169
  v_cvt_pk_bf16_f32 v53, v170, v171
  s_waitcnt lgkmcnt(6)
  v_mfma_f32_32x32x16_bf16 v[176:191], v[32:35], a[120:123], v[176:191]
  ds_read_b64_tr_b16 v[24:25], v22 offset:18944
  ds_read_b64_tr_b16 v[26:27], v22 offset:21248
  v_cvt_pk_bf16_f32 v54, v172, v173
  v_cvt_pk_bf16_f32 v55, v174, v175
  s_waitcnt lgkmcnt(6)
  v_mfma_f32_32x32x16_bf16 v[176:191], v[36:39], a[124:127], v[176:191]
  ds_read_b64_tr_b16 v[28:29], v22 offset:28160
  ds_read_b64_tr_b16 v[30:31], v22 offset:30464
  buffer_store_dwordx4 v[52:55], v1, s[12:15], s25 offen offset:1024 sc0 sc1
  s_waitcnt lgkmcnt(6)
  v_mfma_f32_32x32x16_bf16 v[192:207], v[40:43], a[96:99], v[192:207]
  ds_read_b64_tr_b16 v[32:33], v23 offset:512
  ds_read_b64_tr_b16 v[34:35], v23 offset:2816
  s_waitcnt lgkmcnt(6)
  v_mfma_f32_32x32x16_bf16 v[192:207], v[44:47], a[100:103], v[192:207]
  ds_read_b64_tr_b16 v[36:37], v23 offset:9728
  ds_read_b64_tr_b16 v[38:39], v23 offset:12032
  s_waitcnt lgkmcnt(6)
  v_mfma_f32_32x32x16_bf16 v[192:207], v[24:27], a[104:107], v[192:207]
  ds_read_b64_tr_b16 v[40:41], v23 offset:18944
  ds_read_b64_tr_b16 v[42:43], v23 offset:21248
  v_cvt_pk_bf16_f32 v56, v176, v177
  v_cvt_pk_bf16_f32 v57, v178, v179
  s_waitcnt lgkmcnt(6)
  v_mfma_f32_32x32x16_bf16 v[192:207], v[28:31], a[108:111], v[192:207]
  ds_read_b64_tr_b16 v[44:45], v23 offset:28160
  ds_read_b64_tr_b16 v[46:47], v23 offset:30464
  v_cvt_pk_bf16_f32 v58, v180, v181
  v_cvt_pk_bf16_f32 v59, v182, v183
  s_waitcnt lgkmcnt(6)
  v_mfma_f32_32x32x16_bf16 v[192:207], v[32:35], a[112:115], v[192:207]
  buffer_store_dwordx4 v[56:59], v1, s[12:15], s25 offen offset:2048 sc0 sc1
  v_cvt_pk_bf16_f32 v60, v184, v185
  s_waitcnt lgkmcnt(4)
  v_mfma_f32_32x32x16_bf16 v[192:207], v[36:39], a[116:119], v[192:207]
  v_cvt_pk_bf16_f32 v61, v186, v187
  v_cvt_pk_bf16_f32 v62, v188, v189
  s_waitcnt lgkmcnt(2)
  v_mfma_f32_32x32x16_bf16 v[192:207], v[40:43], a[120:123], v[192:207]
  v_cvt_pk_bf16_f32 v63, v190, v191
  buffer_store_dwordx4 v[60:63], v1, s[12:15], s25 offen offset:3072 sc0 sc1
  s_waitcnt lgkmcnt(0)
  v_mfma_f32_32x32x16_bf16 v[192:207], v[44:47], a[124:127], v[192:207]
  s_nop 11
  v_cvt_pk_bf16_f32 v48, v192, v193
  v_cvt_pk_bf16_f32 v49, v194, v195
  v_cvt_pk_bf16_f32 v50, v196, v197
  v_cvt_pk_bf16_f32 v51, v198, v199
  s_add_u32 s25, s25, 4096
  buffer_store_dwordx4 v[48:51], v1, s[12:15], s25 offen offset:0 sc0 sc1
  v_cvt_pk_bf16_f32 v52, v200, v201
  v_cvt_pk_bf16_f32 v53, v202, v203
  v_cvt_pk_bf16_f32 v54, v204, v205
  v_cvt_pk_bf16_f32 v55, v206, v207
  buffer_store_dwordx4 v[52:55], v1, s[12:15], s25 offen offset:1024 sc0 sc1
L_k3_oproj_kernel_end:
  s_endpgm
.globl k4_red_kernel
.p2align 8
.type k4_red_kernel,@function
k4_red_kernel:
  s_cmp_ge_u32 s2, 256
  s_cbranch_scc1 L_k4_red_kernel_end
  s_load_dwordx2 s[4:5], s[0:1], 0
  s_mov_b32 s6, 2359296
  s_mov_b32 s7, 0x00020000
  s_load_dwordx2 s[8:9], s[0:1], 104
  s_mov_b32 s10, 13824
  s_mov_b32 s11, 0x00020000
  s_load_dwordx2 s[12:13], s[0:1], 104
  s_mov_b32 s14, 18874368
  s_mov_b32 s15, 0x00020000
  s_load_dwordx2 s[16:17], s[0:1], 104
  s_mov_b32 s18, 2359296
  s_mov_b32 s19, 0x00020000
  s_load_dwordx2 s[20:21], s[0:1], 104
  s_mov_b32 s22, 2359296
  s_mov_b32 s23, 0x00020000
  s_mov_b32 s24, 0xffff0000
  v_and_b32 v1, 7, v0
  v_bfe_u32 v2, v0, 3, 1
  v_lshrrev_b32 v3, 4, v0
  s_lshl_b32 s25, s2, 3
  v_add_u32 v4, s25, v1
  v_mul_u32_u24 v4, 1152, v4
  v_lshl_add_u32 v4, v3, 5, v4
  v_lshl_add_u32 v4, v2, 4, v4
  s_lshr_b32 s26, s2, 2
  s_mul_i32 s26, s26, 36864
  s_and_b32 s27, s2, 3
  s_lshl_b32 s27, s27, 7
  s_add_u32 s26, s26, s27
  v_lshlrev_b32 v5, 10, v3
  v_lshl_add_u32 v5, v2, 9, v5
  v_lshl_add_u32 v5, v1, 4, v5
  v_add_u32 v5, s26, v5
  v_lshlrev_b32 v6, 6, v3
  v_lshl_add_u32 v6, v2, 5, v6
  v_lshlrev_b32 v7, 2, v0
  v_lshlrev_b32 v8, 2, v1
  s_waitcnt lgkmcnt(0)
  s_add_u32 s12, s12, 33554432
  s_addc_u32 s13, s13, 0
  s_add_u32 s16, s16, 7340032
  s_addc_u32 s17, s17, 0
  s_add_u32 s20, s20, 4194304
  s_addc_u32 s21, s21, 0
  buffer_load_dwordx4 v[10:13], v4, s[4:7], 0 offen
  s_mov_b32 s28, 0
  buffer_load_dwordx4 v[80:83], v5, s[12:15], s28 offen
  s_mov_b32 s28, 2359296
  buffer_load_dwordx4 v[84:87], v5, s[12:15], s28 offen
  s_mov_b32 s28, 4718592
  buffer_load_dwordx4 v[88:91], v5, s[12:15], s28 offen
  s_mov_b32 s28, 7077888
  buffer_load_dwordx4 v[92:95], v5, s[12:15], s28 offen
  s_mov_b32 s28, 9437184
  buffer_load_dwordx4 v[96:99], v5, s[12:15], s28 offen
  s_mov_b32 s28, 11796480
  buffer_load_dwordx4 v[100:103], v5, s[12:15], s28 offen
  s_mov_b32 s28, 14155776
  buffer_load_dwordx4 v[104:107], v5, s[12:15], s28 offen
  s_mov_b32 s28, 16515072
  buffer_load_dwordx4 v[108:111], v5, s[12:15], s28 offen
  s_mov_b32 s28, 4608
  buffer_load_dwordx4 v[40:43], v6, s[8:11], s28 offen
  buffer_load_dwordx4 v[44:47], v6, s[8:11], s28 offen offset:16
  s_mov_b32 s28, 6912
  buffer_load_dwordx4 v[48:51], v6, s[8:11], s28 offen
  buffer_load_dwordx4 v[52:55], v6, s[8:11], s28 offen offset:16
  s_mov_b32 s28, 9216
  buffer_load_dwordx4 v[56:59], v6, s[8:11], s28 offen
  buffer_load_dwordx4 v[60:63], v6, s[8:11], s28 offen offset:16
  s_waitcnt vmcnt(14)
  v_lshlrev_b32 v20, 16, v10
  v_and_b32 v21, s24, v10
  v_lshlrev_b32 v22, 16, v11
  v_and_b32 v23, s24, v11
  v_lshlrev_b32 v24, 16, v12
  v_and_b32 v25, s24, v12
  v_lshlrev_b32 v26, 16, v13
  v_and_b32 v27, s24, v13
  s_waitcnt vmcnt(13)
  v_lshlrev_b32 v30, 16, v80
  v_and_b32 v31, s24, v80
  v_lshlrev_b32 v32, 16, v81
  v_and_b32 v33, s24, v81
  v_lshlrev_b32 v34, 16, v82
  v_and_b32 v35, s24, v82
  v_lshlrev_b32 v36, 16, v83
  v_and_b32 v37, s24, v83
  s_waitcnt vmcnt(12)
  v_lshlrev_b32 v64, 16, v84
  v_and_b32 v65, s24, v84
  v_lshlrev_b32 v66, 16, v85
  v_and_b32 v67, s24, v85
  v_lshlrev_b32 v68, 16, v86
  v_and_b32 v69, s24, v86
  v_lshlrev_b32 v70, 16, v87
  v_and_b32 v71, s24, v87
  v_add_f32 v30, v30, v64
  v_add_f32 v31, v31, v65
  v_add_f32 v32, v32, v66
  v_add_f32 v33, v33, v67
  v_add_f32 v34, v34, v68
  v_add_f32 v35, v35, v69
  v_add_f32 v36, v36, v70
  v_add_f32 v37, v37, v71
  s_waitcnt vmcnt(11)
  v_lshlrev_b32 v64, 16, v88
  v_and_b32 v65, s24, v88
  v_lshlrev_b32 v66, 16, v89
  v_and_b32 v67, s24, v89
  v_lshlrev_b32 v68, 16, v90
  v_and_b32 v69, s24, v90
  v_lshlrev_b32 v70, 16, v91
  v_and_b32 v71, s24, v91
  v_add_f32 v30, v30, v64
  v_add_f32 v31, v31, v65
  v_add_f32 v32, v32, v66
  v_add_f32 v33, v33, v67
  v_add_f32 v34, v34, v68
  v_add_f32 v35, v35, v69
  v_add_f32 v36, v36, v70
  v_add_f32 v37, v37, v71
  s_waitcnt vmcnt(10)
  v_lshlrev_b32 v64, 16, v92
  v_and_b32 v65, s24, v92
  v_lshlrev_b32 v66, 16, v93
  v_and_b32 v67, s24, v93
  v_lshlrev_b32 v68, 16, v94
  v_and_b32 v69, s24, v94
  v_lshlrev_b32 v70, 16, v95
  v_and_b32 v71, s24, v95
  v_add_f32 v30, v30, v64
  v_add_f32 v31, v31, v65
  v_add_f32 v32, v32, v66
  v_add_f32 v33, v33, v67
  v_add_f32 v34, v34, v68
  v_add_f32 v35, v35, v69
  v_add_f32 v36, v36, v70
  v_add_f32 v37, v37, v71
  s_waitcnt vmcnt(9)
  v_lshlrev_b32 v64, 16, v96
  v_and_b32 v65, s24, v96
  v_lshlrev_b32 v66, 16, v97
  v_and_b32 v67, s24, v97
  v_lshlrev_b32 v68, 16, v98
  v_and_b32 v69, s24, v98
  v_lshlrev_b32 v70, 16, v99
  v_and_b32 v71, s24, v99
  v_add_f32 v30, v30, v64
  v_add_f32 v31, v31, v65
  v_add_f32 v32, v32, v66
  v_add_f32 v33, v33, v67
  v_add_f32 v34, v34, v68
  v_add_f32 v35, v35, v69
  v_add_f32 v36, v36, v70
  v_add_f32 v37, v37, v71
  s_waitcnt vmcnt(8)
  v_lshlrev_b32 v64, 16, v100
  v_and_b32 v65, s24, v100
  v_lshlrev_b32 v66, 16, v101
  v_and_b32 v67, s24, v101
  v_lshlrev_b32 v68, 16, v102
  v_and_b32 v69, s24, v102
  v_lshlrev_b32 v70, 16, v103
  v_and_b32 v71, s24, v103
  v_add_f32 v30, v30, v64
  v_add_f32 v31, v31, v65
  v_add_f32 v32, v32, v66
  v_add_f32 v33, v33, v67
  v_add_f32 v34, v34, v68
  v_add_f32 v35, v35, v69
  v_add_f32 v36, v36, v70
  v_add_f32 v37, v37, v71
  s_waitcnt vmcnt(7)
  v_lshlrev_b32 v64, 16, v104
  v_and_b32 v65, s24, v104
  v_lshlrev_b32 v66, 16, v105
  v_and_b32 v67, s24, v105
  v_lshlrev_b32 v68, 16, v106
  v_and_b32 v69, s24, v106
  v_lshlrev_b32 v70, 16, v107
  v_and_b32 v71, s24, v107
  v_add_f32 v30, v30, v64
  v_add_f32 v31, v31, v65
  v_add_f32 v32, v32, v66
  v_add_f32 v33, v33, v67
  v_add_f32 v34, v34, v68
  v_add_f32 v35, v35, v69
  v_add_f32 v36, v36, v70
  v_add_f32 v37, v37, v71
  s_waitcnt vmcnt(6)
  v_lshlrev_b32 v64, 16, v108
  v_and_b32 v65, s24, v108
  v_lshlrev_b32 v66, 16, v109
  v_and_b32 v67, s24, v109
  v_lshlrev_b32 v68, 16, v110
  v_and_b32 v69, s24, v110
  v_lshlrev_b32 v70, 16, v111
  v_and_b32 v71, s24, v111
  v_add_f32 v30, v30, v64
  v_add_f32 v31, v31, v65
  v_add_f32 v32, v32, v66
  v_add_f32 v33, v33, v67
  v_add_f32 v34, v34, v68
  v_add_f32 v35, v35, v69
  v_add_f32 v36, v36, v70
  v_add_f32 v37, v37, v71
  s_waitcnt vmcnt(0)
  v_cvt_pk_bf16_f32 v64, v30, v31
  v_cvt_pk_bf16_f32 v65, v32, v33
  v_cvt_pk_bf16_f32 v66, v34, v35
  v_cvt_pk_bf16_f32 v67, v36, v37
  v_lshlrev_b32 v30, 16, v64
  v_and_b32 v31, s24, v64
  v_lshlrev_b32 v32, 16, v65
  v_and_b32 v33, s24, v65
  v_lshlrev_b32 v34, 16, v66
  v_and_b32 v35, s24, v66
  v_lshlrev_b32 v36, 16, v67
  v_and_b32 v37, s24, v67
  v_mul_f32 v30, v30, v40
  v_mul_f32 v31, v31, v41
  v_mul_f32 v32, v32, v42
  v_mul_f32 v33, v33, v43
  v_mul_f32 v34, v34, v44
  v_mul_f32 v35, v35, v45
  v_mul_f32 v36, v36, v46
  v_mul_f32 v37, v37, v47
  v_cvt_pk_bf16_f32 v64, v30, v31
  v_cvt_pk_bf16_f32 v65, v32, v33
  v_cvt_pk_bf16_f32 v66, v34, v35
  v_cvt_pk_bf16_f32 v67, v36, v37
  v_lshlrev_b32 v30, 16, v64
  v_and_b32 v31, s24, v64
  v_lshlrev_b32 v32, 16, v65
  v_and_b32 v33, s24, v65
  v_lshlrev_b32 v34, 16, v66
  v_and_b32 v35, s24, v66
  v_lshlrev_b32 v36, 16, v67
  v_and_b32 v37, s24, v67
  v_add_f32 v20, v20, v30
  v_add_f32 v21, v21, v31
  v_add_f32 v22, v22, v32
  v_add_f32 v23, v23, v33
  v_add_f32 v24, v24, v34
  v_add_f32 v25, v25, v35
  v_add_f32 v26, v26, v36
  v_add_f32 v27, v27, v37
  v_cvt_pk_bf16_f32 v64, v20, v21
  v_cvt_pk_bf16_f32 v65, v22, v23
  v_cvt_pk_bf16_f32 v66, v24, v25
  v_cvt_pk_bf16_f32 v67, v26, v27
  buffer_store_dwordx4 v[64:67], v4, s[20:23], 0 offen sc0 sc1
  v_lshlrev_b32 v20, 16, v64
  v_and_b32 v21, s24, v64
  v_lshlrev_b32 v22, 16, v65
  v_and_b32 v23, s24, v65
  v_lshlrev_b32 v24, 16, v66
  v_and_b32 v25, s24, v66
  v_lshlrev_b32 v26, 16, v67
  v_and_b32 v27, s24, v67
  v_add_f32 v9, v20, v21
  v_add_f32 v9, v9, v22
  v_add_f32 v9, v9, v23
  v_add_f32 v9, v9, v24
  v_add_f32 v9, v9, v25
  v_add_f32 v9, v9, v26
  v_add_f32 v9, v9, v27
  s_nop 1
  v_add_f32_dpp v9, v9, v9 row_ror:8 row_mask:0xf bank_mask:0xf
  v_mov_b32 v14, v9
  v_mov_b32 v15, v9
  s_nop 1
  v_permlane16_swap_b32 v14, v15
  v_add_f32 v9, v14, v15
  v_mov_b32 v14, v9
  v_mov_b32 v15, v9
  s_nop 1
  v_permlane32_swap_b32 v14, v15
  v_add_f32 v9, v14, v15
  ds_write_b32 v7, v9 offset:0
  s_waitcnt lgkmcnt(0)
  s_barrier
  ds_read_b32 v70, v8 offset:0
  ds_read_b32 v71, v8 offset:256
  ds_read_b32 v72, v8 offset:512
  ds_read_b32 v73, v8 offset:768
  ds_read_b32 v74, v8 offset:1024
  ds_read_b32 v75, v8 offset:1280
  ds_read_b32 v76, v8 offset:1536
  ds_read_b32 v77, v8 offset:1792
  ds_read_b32 v78, v8 offset:2048
  s_waitcnt lgkmcnt(7)
  v_add_f32 v9, v70, v71
  s_waitcnt lgkmcnt(6)
  v_add_f32 v9, v9, v72
  s_waitcnt lgkmcnt(5)
  v_add_f32 v9, v9, v73
  s_waitcnt lgkmcnt(4)
  v_add_f32 v9, v9, v74
  s_waitcnt lgkmcnt(3)
  v_add_f32 v9, v9, v75
  s_waitcnt lgkmcnt(2)
  v_add_f32 v9, v9, v76
  s_waitcnt lgkmcnt(1)
  v_add_f32 v9, v9, v77
  s_waitcnt lgkmcnt(0)
  v_add_f32 v9, v9, v78
  v_mul_f32 v9, 0x3ae38e39, v9
  v_sub_f32 v20, v20, v9
  v_sub_f32 v21, v21, v9
  v_sub_f32 v22, v22, v9
  v_sub_f32 v23, v23, v9
  v_sub_f32 v24, v24, v9
  v_sub_f32 v25, v25, v9
  v_sub_f32 v26, v26, v9
  v_sub_f32 v27, v27, v9
  v_mul_f32 v9, v20, v20
  v_fmac_f32 v9, v21, v21
  v_fmac_f32 v9, v22, v22
  v_fmac_f32 v9, v23, v23
  v_fmac_f32 v9, v24, v24
  v_fmac_f32 v9, v25, v25
  v_fmac_f32 v9, v26, v26
  v_fmac_f32 v9, v27, v27
  s_nop 1
  v_add_f32_dpp v9, v9, v9 row_ror:8 row_mask:0xf bank_mask:0xf
  v_mov_b32 v14, v9
  v_mov_b32 v15, v9
  s_nop 1
  v_permlane16_swap_b32 v14, v15
  v_add_f32 v9, v14, v15
  v_mov_b32 v14, v9
  v_mov_b32 v15, v9
  s_nop 1
  v_permlane32_swap_b32 v14, v15
  v_add_f32 v9, v14, v15
  ds_write_b32 v7, v9 offset:4096
  s_waitcnt lgkmcnt(0)
  s_barrier
  ds_read_b32 v70, v8 offset:4096
  ds_read_b32 v71, v8 offset:4352
  ds_read_b32 v72, v8 offset:4608
  ds_read_b32 v73, v8 offset:4864
  ds_read_b32 v74, v8 offset:5120
  ds_read_b32 v75, v8 offset:5376
  ds_read_b32 v76, v8 offset:5632
  ds_read_b32 v77, v8 offset:5888
  ds_read_b32 v78, v8 offset:6144
  s_waitcnt lgkmcnt(7)
  v_add_f32 v9, v70, v71
  s_waitcnt lgkmcnt(6)
  v_add_f32 v9, v9, v72
  s_waitcnt lgkmcnt(5)
  v_add_f32 v9, v9, v73
  s_waitcnt lgkmcnt(4)
  v_add_f32 v9, v9, v74
  s_waitcnt lgkmcnt(3)
  v_add_f32 v9, v9, v75
  s_waitcnt lgkmcnt(2)
  v_add_f32 v9, v9, v76
  s_waitcnt lgkmcnt(1)
  v_add_f32 v9, v9, v77
  s_waitcnt lgkmcnt(0)
  v_add_f32 v9, v9, v78
  v_mul_f32 v9, 0x3ae38e39, v9
  v_add_f32 v9, 0x3727c5ac, v9
  v_rsq_f32 v9, v9
  s_nop 0
  v_mul_f32 v20, v20, v9
  v_add_f32 v56, 1.0, v56
  v_mul_f32 v21, v21, v9
  v_add_f32 v57, 1.0, v57
  v_mul_f32 v22, v22, v9
  v_add_f32 v58, 1.0, v58
  v_mul_f32 v23, v23, v9
  v_add_f32 v59, 1.0, v59
  v_mul_f32 v24, v24, v9
  v_add_f32 v60, 1.0, v60
  v_mul_f32 v25, v25, v9
  v_add_f32 v61, 1.0, v61
  v_mul_f32 v26, v26, v9
  v_add_f32 v62, 1.0, v62
  v_mul_f32 v27, v27, v9
  v_add_f32 v63, 1.0, v63
  v_fma_f32 v20, v20, v56, v48
  v_fma_f32 v21, v21, v57, v49
  v_fma_f32 v22, v22, v58, v50
  v_fma_f32 v23, v23, v59, v51
  v_fma_f32 v24, v24, v60, v52
  v_fma_f32 v25, v25, v61, v53
  v_fma_f32 v26, v26, v62, v54
  v_fma_f32 v27, v27, v63, v55
  v_cvt_pk_bf16_f32 v68, v20, v21
  v_cvt_pk_bf16_f32 v69, v22, v23
  v_cvt_pk_bf16_f32 v70, v24, v25
  v_cvt_pk_bf16_f32 v71, v26, v27
  buffer_store_dwordx4 v[68:71], v5, s[16:19], 0 offen sc0 sc1
L_k4_red_kernel_end:
  s_endpgm
.globl k5_gateup_kernel
.p2align 8
.type k5_gateup_kernel,@function
k5_gateup_kernel:
  s_cmp_ge_u32 s2, 256
  s_cbranch_scc1 L_k5_gateup_kernel_end
  s_load_dwordx2 s[4:5], s[0:1], 48
  s_mov_b32 s6, 5308416
  s_mov_b32 s7, 0x00020000
  s_load_dwordx2 s[28:29], s[0:1], 56
  s_mov_b32 s30, 5308416
  s_mov_b32 s31, 0x00020000
  s_load_dwordx2 s[8:9], s[0:1], 104
  s_mov_b32 s10, 2359296
  s_mov_b32 s11, 0x00020000
  s_load_dwordx2 s[12:13], s[0:1], 104
  s_mov_b32 s14, 18874368
  s_mov_b32 s15, 0x00020000
  v_lshrrev_b32 v1, 6, v0
  s_nop 0
  v_readfirstlane_b32 s16, v1
  v_and_b32 v0, 63, v0
  s_nop 3
  s_and_b32 s17, s2, 7
  s_bfe_u32 s18, s2, 0x10003
  s_lshl_b32 s17, s17, 1
  s_add_u32 s18, s18, s17
  s_lshr_b32 s19, s2, 4
  s_lshl_b32 s20, s19, 2
  s_add_u32 s20, s20, s16
  s_mul_i32 s21, s20, 36864
  s_mul_i32 s22, s18, 576
  s_and_b32 s26, s16, 1
  s_mul_i32 s24, s26, 9216
  s_lshr_b32 s27, s16, 1
  s_mul_i32 s27, s27, 18560
  s_add_u32 s24, s24, s27
  s_mul_i32 s25, s20, 294912
  s_mul_i32 s27, s18, 18432
  s_add_u32 s25, s25, s27
  v_lshlrev_b32 v1, 4, v0
  s_waitcnt lgkmcnt(0)
  s_add_u32 s8, s8, 7340032
  s_addc_u32 s9, s9, 0
  s_add_u32 s12, s12, 14680064
  s_addc_u32 s13, s13, 0
  s_cmp_ge_u32 s16, 2
  s_cselect_b32 s4, s28, s4
  s_cselect_b32 s5, s29, s5
  buffer_load_dwordx4 a[0:3], v1, s[8:11], s21 offen offset:0
  buffer_load_dwordx4 a[4:7], v1, s[8:11], s21 offen offset:1024
  buffer_load_dwordx4 a[8:11], v1, s[8:11], s21 offen offset:2048
  buffer_load_dwordx4 a[12:15], v1, s[8:11], s21 offen offset:3072
  s_add_u32 s21, s21, 4096
  buffer_load_dwordx4 a[16:19], v1, s[8:11], s21 offen offset:0
  buffer_load_dwordx4 a[20:23], v1, s[8:11], s21 offen offset:1024
  buffer_load_dwordx4 a[24:27], v1, s[8:11], s21 offen offset:2048
  buffer_load_dwordx4 a[28:31], v1, s[8:11], s21 offen offset:3072
  s_add_u32 s21, s21, 4096
  s_mul_i32 s27, s26, 576
  s_add_u32 s27, s27, 0
  v_add_u32 v2, s27, v0
  v_mul_u32_u24 v3, 3641, v2
  v_lshrrev_b32 v3, 16, v3
  v_mul_u32_u24 v5, 18, v3
  v_sub_u32 v4, v2, v5
  v_mul_u32_u24 v10, 9216, v3
  v_lshl_add_u32 v10, v4, 4, v10
  s_add_u32 m0, s24, 0
  s_nop 0
  buffer_load_dwordx4 v10, s[4:7], s22 offen lds
  s_mul_i32 s27, s26, 576
  s_add_u32 s27, s27, 64
  v_add_u32 v2, s27, v0
  v_mul_u32_u24 v3, 3641, v2
  v_lshrrev_b32 v3, 16, v3
  v_mul_u32_u24 v5, 18, v3
  v_sub_u32 v4, v2, v5
  v_mul_u32_u24 v11, 9216, v3
  v_lshl_add_u32 v11, v4, 4, v11
  s_add_u32 m0, s24, 1024
  s_nop 0
  buffer_load_dwordx4 v11, s[4:7], s22 offen lds
  s_mul_i32 s27, s26, 576
  s_add_u32 s27, s27, 128
  v_add_u32 v2, s27, v0
  v_mul_u32_u24 v3, 3641, v2
  v_lshrrev_b32 v3, 16, v3
  v_mul_u32_u24 v5, 18, v3
  v_sub_u32 v4, v2, v5
  v_mul_u32_u24 v12, 9216, v3
  v_lshl_add_u32 v12, v4, 4, v12
  s_add_u32 m0, s24, 2048
  s_nop 0
  buffer_load_dwordx4 v12, s[4:7], s22 offen lds
  s_mul_i32 s27, s26, 576
  s_add_u32 s27, s27, 192
  v_add_u32 v2, s27, v0
  v_mul_u32_u24 v3, 3641, v2
  v_lshrrev_b32 v3, 16, v3
  v_mul_u32_u24 v5, 18, v3
  v_sub_u32 v4, v2, v5
  v_mul_u32_u24 v13, 9216, v3
  v_lshl_add_u32 v13, v4, 4, v13
  s_add_u32 m0, s24, 3072
  s_nop 0
  buffer_load_dwordx4 v13, s[4:7], s22 offen lds
  s_mul_i32 s27, s26, 576
  s_add_u32 s27, s27, 256
  v_add_u32 v2, s27, v0
  v_mul_u32_u24 v3, 3641, v2
  v_lshrrev_b32 v3, 16, v3
  v_mul_u32_u24 v5, 18, v3
  v_sub_u32 v4, v2, v5
  v_mul_u32_u24 v14, 9216, v3
  v_lshl_add_u32 v14, v4, 4, v14
  s_add_u32 m0, s24, 4096
  s_nop 0
  buffer_load_dwordx4 v14, s[4:7], s22 offen lds
  s_mul_i32 s27, s26, 576
  s_add_u32 s27, s27, 320
  v_add_u32 v2, s27, v0
  v_mul_u32_u24 v3, 3641, v2
  v_lshrrev_b32 v3, 16, v3
  v_mul_u32_u24 v5, 18, v3
  v_sub_u32 v4, v2, v5
  v_mul_u32_u24 v15, 9216, v3
  v_lshl_add_u32 v15, v4, 4, v15
  s_add_u32 m0, s24, 5120
  s_nop 0
  buffer_load_dwordx4 v15, s[4:7], s22 offen lds
  s_mul_i32 s27, s26, 576
  s_add_u32 s27, s27, 384
  v_add_u32 v2, s27, v0
  v_mul_u32_u24 v3, 3641, v2
  v_lshrrev_b32 v3, 16, v3
  v_mul_u32_u24 v5, 18, v3
  v_sub_u32 v4, v2, v5
  v_mul_u32_u24 v16, 9216, v3
  v_lshl_add_u32 v16, v4, 4, v16
  s_add_u32 m0, s24, 6144
  s_nop 0
  buffer_load_dwordx4 v16, s[4:7], s22 offen lds
  s_mul_i32 s27, s26, 576
  s_add_u32 s27, s27, 448
  v_add_u32 v2, s27, v0
  v_mul_u32_u24 v3, 3641, v2
  v_lshrrev_b32 v3, 16, v3
  v_mul_u32_u24 v5, 18, v3
  v_sub_u32 v4, v2, v5
  v_mul_u32_u24 v17, 9216, v3
  v_lshl_add_u32 v17, v4, 4, v17
  s_add_u32 m0, s24, 7168
  s_nop 0
  buffer_load_dwordx4 v17, s[4:7], s22 offen lds
  s_mul_i32 s27, s26, 576
  s_add_u32 s27, s27, 512
  v_add_u32 v2, s27, v0
  v_mul_u32_u24 v3, 3641, v2
  v_lshrrev_b32 v3, 16, v3
  v_mul_u32_u24 v5, 18, v3
  v_sub_u32 v4, v2, v5
  v_mul_u32_u24 v18, 9216, v3
  v_lshl_add_u32 v18, v4, 4, v18
  s_add_u32 m0, s24, 8192
  s_nop 0
  buffer_load_dwordx4 v18, s[4:7], s22 offen lds
  s_add_u32 s22, s22, 589824
  v_lshrrev_b32 v2, 5, v0
  v_lshlrev_b32 v2, 3, v2
  v_bfe_u32 v3, v0, 2, 2
  v_add_u32 v2, v2, v3
  v_mul_u32_u24 v20, 288, v2
  v_bfe_u32 v3, v0, 4, 1
  v_mul_u32_u24 v3, 18560, v3
  v_add_u32 v20, v20, v3
  v_and_b32 v3, 1, v0
  v_lshl_add_u32 v20, v3, 4, v20
  v_bfe_u32 v3, v0, 1, 1
  v_lshl_add_u32 v20, v3, 3, v20
  v_add_u32 v21, 74240, v20
  s_add_u32 m0, s24, 37120
  s_nop 0
  buffer_load_dwordx4 v10, s[4:7], s22 offen lds
  s_add_u32 m0, s24, 38144
  s_nop 0
  buffer_load_dwordx4 v11, s[4:7], s22 offen lds
  s_add_u32 m0, s24, 39168
  s_nop 0
  buffer_load_dwordx4 v12, s[4:7], s22 offen lds
  s_add_u32 m0, s24, 40192
  s_nop 0
  buffer_load_dwordx4 v13, s[4:7], s22 offen lds
  s_add_u32 m0, s24, 41216
  s_nop 0
  buffer_load_dwordx4 v14, s[4:7], s22 offen lds
  s_add_u32 m0, s24, 42240
  s_nop 0
  buffer_load_dwordx4 v15, s[4:7], s22 offen lds
  s_add_u32 m0, s24, 43264
  s_nop 0
  buffer_load_dwordx4 v16, s[4:7], s22 offen lds
  s_add_u32 m0, s24, 44288
  s_nop 0
  buffer_load_dwordx4 v17, s[4:7], s22 offen lds
  s_add_u32 m0, s24, 45312
  s_nop 0
  buffer_load_dwordx4 v18, s[4:7], s22 offen lds
  s_add_u32 s22, s22, 589824
  s_waitcnt vmcnt(9) lgkmcnt(0)
  s_barrier
  ds_read_b64_tr_b16 v[24:25], v20 offset:0
  ds_read_b64_tr_b16 v[26:27], v20 offset:1152
  ds_read_b64_tr_b16 v[28:29], v20 offset:32
  ds_read_b64_tr_b16 v[30:31], v20 offset:1184
  ds_read_b64_tr_b16 v[32:33], v20 offset:64
  ds_read_b64_tr_b16 v[34:35], v20 offset:1216
  ds_read_b64_tr_b16 v[36:37], v20 offset:96
  ds_read_b64_tr_b16 v[38:39], v20 offset:1248
  s_waitcnt lgkmcnt(6)
  v_mfma_f32_32x32x16_bf16 v[64:79], v[24:27], a[0:3], 0
  ds_read_b64_tr_b16 v[40:41], v20 offset:128
  ds_read_b64_tr_b16 v[42:43], v20 offset:1280
  buffer_load_dwordx4 a[32:35], v1, s[8:11], s21 offen offset:0
  s_waitcnt lgkmcnt(6)
  v_mfma_f32_32x32x16_bf16 v[80:95], v[28:31], a[0:3], 0
  ds_read_b64_tr_b16 v[44:45], v20 offset:160
  ds_read_b64_tr_b16 v[46:47], v20 offset:1312
  s_waitcnt lgkmcnt(6)
  v_mfma_f32_32x32x16_bf16 v[96:111], v[32:35], a[0:3], 0
  ds_read_b64_tr_b16 v[24:25], v20 offset:192
  ds_read_b64_tr_b16 v[26:27], v20 offset:1344
  buffer_load_dwordx4 a[36:39], v1, s[8:11], s21 offen offset:1024
  s_waitcnt lgkmcnt(6)
  v_mfma_f32_32x32x16_bf16 v[112:127], v[36:39], a[0:3], 0
  ds_read_b64_tr_b16 v[28:29], v20 offset:224
  ds_read_b64_tr_b16 v[30:31], v20 offset:1376
  s_waitcnt lgkmcnt(6)
  v_mfma_f32_32x32x16_bf16 v[128:143], v[40:43], a[0:3], 0
  ds_read_b64_tr_b16 v[32:33], v20 offset:256
  ds_read_b64_tr_b16 v[34:35], v20 offset:1408
  buffer_load_dwordx4 a[40:43], v1, s[8:11], s21 offen offset:2048
  s_waitcnt lgkmcnt(6)
  v_mfma_f32_32x32x16_bf16 v[144:159], v[44:47], a[0:3], 0
  ds_read_b64_tr_b16 v[36:37], v20 offset:4608
  ds_read_b64_tr_b16 v[38:39], v20 offset:5760
  s_waitcnt lgkmcnt(6)
  v_mfma_f32_32x32x16_bf16 v[160:175], v[24:27], a[0:3], 0
  ds_read_b64_tr_b16 v[40:41], v20 offset:4640
  ds_read_b64_tr_b16 v[42:43], v20 offset:5792
  buffer_load_dwordx4 a[44:47], v1, s[8:11], s21 offen offset:3072
  s_add_u32 s21, s21, 4096
  s_waitcnt lgkmcnt(6)
  v_mfma_f32_32x32x16_bf16 v[176:191], v[28:31], a[0:3], 0
  ds_read_b64_tr_b16 v[44:45], v20 offset:4672
  ds_read_b64_tr_b16 v[46:47], v20 offset:5824
  s_waitcnt lgkmcnt(6)
  v_mfma_f32_32x32x16_bf16 v[192:207], v[32:35], a[0:3], 0
  ds_read_b64_tr_b16 v[24:25], v20 offset:4704
  ds_read_b64_tr_b16 v[26:27], v20 offset:5856
  s_add_u32 m0, s24, 74240
  s_nop 0
  buffer_load_dwordx4 v10, s[4:7], s22 offen lds
  s_waitcnt lgkmcnt(6)
  v_mfma_f32_32x32x16_bf16 v[64:79], v[36:39], a[4:7], v[64:79]
  ds_read_b64_tr_b16 v[28:29], v20 offset:4736
  ds_read_b64_tr_b16 v[30:31], v20 offset:5888
  s_waitcnt lgkmcnt(6)
  v_mfma_f32_32x32x16_bf16 v[80:95], v[40:43], a[4:7], v[80:95]
  ds_read_b64_tr_b16 v[32:33], v20 offset:4768
  ds_read_b64_tr_b16 v[34:35], v20 offset:5920
  s_add_u32 m0, s24, 75264
  s_nop 0
  buffer_load_dwordx4 v11, s[4:7], s22 offen lds
  s_waitcnt lgkmcnt(6)
  v_mfma_f32_32x32x16_bf16 v[96:111], v[44:47], a[4:7], v[96:111]
  ds_read_b64_tr_b16 v[36:37], v20 offset:4800
  ds_read_b64_tr_b16 v[38:39], v20 offset:5952
  s_waitcnt lgkmcnt(6)
  v_mfma_f32_32x32x16_bf16 v[112:127], v[24:27], a[4:7], v[112:127]
  ds_read_b64_tr_b16 v[40:41], v20 offset:4832
  ds_read_b64_tr_b16 v[42:43], v20 offset:5984
  s_add_u32 m0, s24, 76288
  s_nop 0
  buffer_load_dwordx4 v12, s[4:7], s22 offen lds
  s_waitcnt lgkmcnt(6)
  v_mfma_f32_32x32x16_bf16 v[128:143], v[28:31], a[4:7], v[128:143]
  ds_read_b64_tr_b16 v[44:45], v20 offset:4864
  ds_read_b64_tr_b16 v[46:47], v20 offset:6016
  s_waitcnt lgkmcnt(6)
  v_mfma_f32_32x32x16_bf16 v[144:159], v[32:35], a[4:7], v[144:159]
  ds_read_b64_tr_b16 v[24:25], v20 offset:9216
  ds_read_b64_tr_b16 v[26:27], v20 offset:10368
  s_add_u32 m0, s24, 77312
  s_nop 0
  buffer_load_dwordx4 v13, s[4:7], s22 offen lds
  s_waitcnt lgkmcnt(6)
  v_mfma_f32_32x32x16_bf16 v[160:175], v[36:39], a[4:7], v[160:175]
  ds_read_b64_tr_b16 v[28:29], v20 offset:9248
  ds_read_b64_tr_b16 v[30:31], v20 offset:10400
  s_waitcnt lgkmcnt(6)
  v_mfma_f32_32x32x16_bf16 v[176:191], v[40:43], a[4:7], v[176:191]
  ds_read_b64_tr_b16 v[32:33], v20 offset:9280
  ds_read_b64_tr_b16 v[34:35], v20 offset:10432
  s_add_u32 m0, s24, 78336
  s_nop 0
  buffer_load_dwordx4 v14, s[4:7], s22 offen lds
  s_waitcnt lgkmcnt(6)
  v_mfma_f32_32x32x16_bf16 v[192:207], v[44:47], a[4:7], v[192:207]
  ds_read_b64_tr_b16 v[36:37], v20 offset:9312
  ds_read_b64_tr_b16 v[38:39], v20 offset:10464
  s_waitcnt lgkmcnt(6)
  v_mfma_f32_32x32x16_bf16 v[64:79], v[24:27], a[8:11], v[64:79]
  ds_read_b64_tr_b16 v[40:41], v20 offset:9344
  ds_read_b64_tr_b16 v[42:43], v20 offset:10496
  s_add_u32 m0, s24, 79360
  s_nop 0
  buffer_load_dwordx4 v15, s[4:7], s22 offen lds
  s_waitcnt lgkmcnt(6)
  v_mfma_f32_32x32x16_bf16 v[80:95], v[28:31], a[8:11], v[80:95]
  ds_read_b64_tr_b16 v[44:45], v20 offset:9376
  ds_read_b64_tr_b16 v[46:47], v20 offset:10528
  s_waitcnt lgkmcnt(6)
  v_mfma_f32_32x32x16_bf16 v[96:111], v[32:35], a[8:11], v[96:111]
  ds_read_b64_tr_b16 v[24:25], v20 offset:9408
  ds_read_b64_tr_b16 v[26:27], v20 offset:10560
  s_add_u32 m0, s24, 80384
  s_nop 0
  buffer_load_dwordx4 v16, s[4:7], s22 offen lds
  s_waitcnt lgkmcnt(6)
  v_mfma_f32_32x32x16_bf16 v[112:127], v[36:39], a[8:11], v[112:127]
  ds_read_b64_tr_b16 v[28:29], v20 offset:9440
  ds_read_b64_tr_b16 v[30:31], v20 offset:10592
  s_waitcnt lgkmcnt(6)
  v_mfma_f32_32x32x16_bf16 v[128:143], v[40:43], a[8:11], v[128:143]
  ds_read_b64_tr_b16 v[32:33], v20 offset:9472
  ds_read_b64_tr_b16 v[34:35], v20 offset:10624
  s_add_u32 m0, s24, 81408
  s_nop 0
  buffer_load_dwordx4 v17, s[4:7], s22 offen lds
  s_waitcnt lgkmcnt(6)
  v_mfma_f32_32x32x16_bf16 v[144:159], v[44:47], a[8:11], v[144:159]
  ds_read_b64_tr_b16 v[36:37], v20 offset:13824
  ds_read_b64_tr_b16 v[38:39], v20 offset:14976
  s_waitcnt lgkmcnt(6)
  v_mfma_f32_32x32x16_bf16 v[160:175], v[24:27], a[8:11], v[160:175]
  ds_read_b64_tr_b16 v[40:41], v20 offset:13856
  ds_read_b64_tr_b16 v[42:43], v20 offset:15008
  s_add_u32 m0, s24, 82432
  s_nop 0
  buffer_load_dwordx4 v18, s[4:7], s22 offen lds
  s_add_u32 s22, s22, 589824
  s_waitcnt lgkmcnt(6)
  v_mfma_f32_32x32x16_bf16 v[176:191], v[28:31], a[8:11], v[176:191]
  ds_read_b64_tr_b16 v[44:45], v20 offset:13888
  ds_read_b64_tr_b16 v[46:47], v20 offset:15040
  s_waitcnt lgkmcnt(6)
  v_mfma_f32_32x32x16_bf16 v[192:207], v[32:35], a[8:11], v[192:207]
  ds_read_b64_tr_b16 v[24:25], v20 offset:13920
  ds_read_b64_tr_b16 v[26:27], v20 offset:15072
  s_waitcnt lgkmcnt(6)
  v_mfma_f32_32x32x16_bf16 v[64:79], v[36:39], a[12:15], v[64:79]
  ds_read_b64_tr_b16 v[28:29], v20 offset:13952
  ds_read_b64_tr_b16 v[30:31], v20 offset:15104
  s_waitcnt lgkmcnt(6)
  v_mfma_f32_32x32x16_bf16 v[80:95], v[40:43], a[12:15], v[80:95]
  ds_read_b64_tr_b16 v[32:33], v20 offset:13984
  ds_read_b64_tr_b16 v[34:35], v20 offset:15136
  s_waitcnt lgkmcnt(6)
  v_mfma_f32_32x32x16_bf16 v[96:111], v[44:47], a[12:15], v[96:111]
  ds_read_b64_tr_b16 v[36:37], v20 offset:14016
  ds_read_b64_tr_b16 v[38:39], v20 offset:15168
  s_waitcnt lgkmcnt(6)
  v_mfma_f32_32x32x16_bf16 v[112:127], v[24:27], a[12:15], v[112:127]
  ds_read_b64_tr_b16 v[40:41], v20 offset:14048
  ds_read_b64_tr_b16 v[42:43], v20 offset:15200
  s_waitcnt lgkmcnt(6)
  v_mfma_f32_32x32x16_bf16 v[128:143], v[28:31], a[12:15], v[128:143]
  ds_read_b64_tr_b16 v[44:45], v20 offset:14080
  ds_read_b64_tr_b16 v[46:47], v20 offset:15232
  s_waitcnt lgkmcnt(6)
  v_mfma_f32_32x32x16_bf16 v[144:159], v[32:35], a[12:15], v[144:159]
  s_waitcnt vmcnt(13) lgkmcnt(0)
  s_barrier
  ds_read_b64_tr_b16 v[24:25], v20 offset:37120
  ds_read_b64_tr_b16 v[26:27], v20 offset:38272
  v_mfma_f32_32x32x16_bf16 v[160:175], v[36:39], a[12:15], v[160:175]
  ds_read_b64_tr_b16 v[28:29], v20 offset:37152
  ds_read_b64_tr_b16 v[30:31], v20 offset:38304
  v_mfma_f32_32x32x16_bf16 v[176:191], v[40:43], a[12:15], v[176:191]
  ds_read_b64_tr_b16 v[32:33], v20 offset:37184
  ds_read_b64_tr_b16 v[34:35], v20 offset:38336
  v_mfma_f32_32x32x16_bf16 v[192:207], v[44:47], a[12:15], v[192:207]
  ds_read_b64_tr_b16 v[36:37], v20 offset:37216
  ds_read_b64_tr_b16 v[38:39], v20 offset:38368
  s_waitcnt lgkmcnt(6)
  v_mfma_f32_32x32x16_bf16 v[64:79], v[24:27], a[16:19], v[64:79]
  ds_read_b64_tr_b16 v[40:41], v20 offset:37248
  ds_read_b64_tr_b16 v[42:43], v20 offset:38400
  buffer_load_dwordx4 a[48:51], v1, s[8:11], s21 offen offset:0
  s_waitcnt lgkmcnt(6)
  v_mfma_f32_32x32x16_bf16 v[80:95], v[28:31], a[16:19], v[80:95]
  ds_read_b64_tr_b16 v[44:45], v20 offset:37280
  ds_read_b64_tr_b16 v[46:47], v20 offset:38432
  s_waitcnt lgkmcnt(6)
  v_mfma_f32_32x32x16_bf16 v[96:111], v[32:35], a[16:19], v[96:111]
  ds_read_b64_tr_b16 v[24:25], v20 offset:37312
  ds_read_b64_tr_b16 v[26:27], v20 offset:38464
  buffer_load_dwordx4 a[52:55], v1, s[8:11], s21 offen offset:1024
  s_waitcnt lgkmcnt(6)
  v_mfma_f32_32x32x16_bf16 v[112:127], v[36:39], a[16:19], v[112:127]
  ds_read_b64_tr_b16 v[28:29], v20 offset:37344
  ds_read_b64_tr_b16 v[30:31], v20 offset:38496
  s_waitcnt lgkmcnt(6)
  v_mfma_f32_32x32x16_bf16 v[128:143], v[40:43], a[16:19], v[128:143]
  ds_read_b64_tr_b16 v[32:33], v20 offset:37376
  ds_read_b64_tr_b16 v[34:35], v20 offset:38528
  buffer_load_dwordx4 a[56:59], v1, s[8:11], s21 offen offset:2048
  s_waitcnt lgkmcnt(6)
  v_mfma_f32_32x32x16_bf16 v[144:159], v[44:47], a[16:19], v[144:159]
  ds_read_b64_tr_b16 v[36:37], v20 offset:41728
  ds_read_b64_tr_b16 v[38:39], v20 offset:42880
  s_waitcnt lgkmcnt(6)
  v_mfma_f32_32x32x16_bf16 v[160:175], v[24:27], a[16:19], v[160:175]
  ds_read_b64_tr_b16 v[40:41], v20 offset:41760
  ds_read_b64_tr_b16 v[42:43], v20 offset:42912
  buffer_load_dwordx4 a[60:63], v1, s[8:11], s21 offen offset:3072
  s_add_u32 s21, s21, 4096
  s_waitcnt lgkmcnt(6)
  v_mfma_f32_32x32x16_bf16 v[176:191], v[28:31], a[16:19], v[176:191]
  ds_read_b64_tr_b16 v[44:45], v20 offset:41792
  ds_read_b64_tr_b16 v[46:47], v20 offset:42944
  s_waitcnt lgkmcnt(6)
  v_mfma_f32_32x32x16_bf16 v[192:207], v[32:35], a[16:19], v[192:207]
  ds_read_b64_tr_b16 v[24:25], v20 offset:41824
  ds_read_b64_tr_b16 v[26:27], v20 offset:42976
  s_add_u32 m0, s24, 111360
  s_nop 0
  buffer_load_dwordx4 v10, s[4:7], s22 offen lds
  s_waitcnt lgkmcnt(6)
  v_mfma_f32_32x32x16_bf16 v[64:79], v[36:39], a[20:23], v[64:79]
  ds_read_b64_tr_b16 v[28:29], v20 offset:41856
  ds_read_b64_tr_b16 v[30:31], v20 offset:43008
  s_waitcnt lgkmcnt(6)
  v_mfma_f32_32x32x16_bf16 v[80:95], v[40:43], a[20:23], v[80:95]
  ds_read_b64_tr_b16 v[32:33], v20 offset:41888
  ds_read_b64_tr_b16 v[34:35], v20 offset:43040
  s_add_u32 m0, s24, 112384
  s_nop 0
  buffer_load_dwordx4 v11, s[4:7], s22 offen lds
  s_waitcnt lgkmcnt(6)
  v_mfma_f32_32x32x16_bf16 v[96:111], v[44:47], a[20:23], v[96:111]
  ds_read_b64_tr_b16 v[36:37], v20 offset:41920
  ds_read_b64_tr_b16 v[38:39], v20 offset:43072
  s_waitcnt lgkmcnt(6)
  v_mfma_f32_32x32x16_bf16 v[112:127], v[24:27], a[20:23], v[112:127]
  ds_read_b64_tr_b16 v[40:41], v20 offset:41952
  ds_read_b64_tr_b16 v[42:43], v20 offset:43104
  s_add_u32 m0, s24, 113408
  s_nop 0
  buffer_load_dwordx4 v12, s[4:7], s22 offen lds
  s_waitcnt lgkmcnt(6)
  v_mfma_f32_32x32x16_bf16 v[128:143], v[28:31], a[20:23], v[128:143]
  ds_read_b64_tr_b16 v[44:45], v20 offset:41984
  ds_read_b64_tr_b16 v[46:47], v20 offset:43136
  s_waitcnt lgkmcnt(6)
  v_mfma_f32_32x32x16_bf16 v[144:159], v[32:35], a[20:23], v[144:159]
  ds_read_b64_tr_b16 v[24:25], v20 offset:46336
  ds_read_b64_tr_b16 v[26:27], v20 offset:47488
  s_add_u32 m0, s24, 114432
  s_nop 0
  buffer_load_dwordx4 v13, s[4:7], s22 offen lds
  s_waitcnt lgkmcnt(6)
  v_mfma_f32_32x32x16_bf16 v[160:175], v[36:39], a[20:23], v[160:175]
  ds_read_b64_tr_b16 v[28:29], v20 offset:46368
  ds_read_b64_tr_b16 v[30:31], v20 offset:47520
  s_waitcnt lgkmcnt(6)
  v_mfma_f32_32x32x16_bf16 v[176:191], v[40:43], a[20:23], v[176:191]
  ds_read_b64_tr_b16 v[32:33], v20 offset:46400
  ds_read_b64_tr_b16 v[34:35], v20 offset:47552
  s_add_u32 m0, s24, 115456
  s_nop 0
  buffer_load_dwordx4 v14, s[4:7], s22 offen lds
  s_waitcnt lgkmcnt(6)
  v_mfma_f32_32x32x16_bf16 v[192:207], v[44:47], a[20:23], v[192:207]
  ds_read_b64_tr_b16 v[36:37], v20 offset:46432
  ds_read_b64_tr_b16 v[38:39], v20 offset:47584
  s_waitcnt lgkmcnt(6)
  v_mfma_f32_32x32x16_bf16 v[64:79], v[24:27], a[24:27], v[64:79]
  ds_read_b64_tr_b16 v[40:41], v20 offset:46464
  ds_read_b64_tr_b16 v[42:43], v20 offset:47616
  s_add_u32 m0, s24, 116480
  s_nop 0
  buffer_load_dwordx4 v15, s[4:7], s22 offen lds
  s_waitcnt lgkmcnt(6)
  v_mfma_f32_32x32x16_bf16 v[80:95], v[28:31], a[24:27], v[80:95]
  ds_read_b64_tr_b16 v[44:45], v20 offset:46496
  ds_read_b64_tr_b16 v[46:47], v20 offset:47648
  s_waitcnt lgkmcnt(6)
  v_mfma_f32_32x32x16_bf16 v[96:111], v[32:35], a[24:27], v[96:111]
  ds_read_b64_tr_b16 v[24:25], v20 offset:46528
  ds_read_b64_tr_b16 v[26:27], v20 offset:47680
  s_add_u32 m0, s24, 117504
  s_nop 0
  buffer_load_dwordx4 v16, s[4:7], s22 offen lds
  s_waitcnt lgkmcnt(6)
  v_mfma_f32_32x32x16_bf16 v[112:127], v[36:39], a[24:27], v[112:127]
  ds_read_b64_tr_b16 v[28:29], v20 offset:46560
  ds_read_b64_tr_b16 v[30:31], v20 offset:47712
  s_waitcnt lgkmcnt(6)
  v_mfma_f32_32x32x16_bf16 v[128:143], v[40:43], a[24:27], v[128:143]
  ds_read_b64_tr_b16 v[32:33], v20 offset:46592
  ds_read_b64_tr_b16 v[34:35], v20 offset:47744
  s_add_u32 m0, s24, 118528
  s_nop 0
  buffer_load_dwordx4 v17, s[4:7], s22 offen lds
  s_waitcnt lgkmcnt(6)
  v_mfma_f32_32x32x16_bf16 v[144:159], v[44:47], a[24:27], v[144:159]
  ds_read_b64_tr_b16 v[36:37], v20 offset:50944
  ds_read_b64_tr_b16 v[38:39], v20 offset:52096
  s_waitcnt lgkmcnt(6)
  v_mfma_f32_32x32x16_bf16 v[160:175], v[24:27], a[24:27], v[160:175]
  ds_read_b64_tr_b16 v[40:41], v20 offset:50976
  ds_read_b64_tr_b16 v[42:43], v20 offset:52128
  s_add_u32 m0, s24, 119552
  s_nop 0
  buffer_load_dwordx4 v18, s[4:7], s22 offen lds
  s_add_u32 s22, s22, 589824
  s_waitcnt lgkmcnt(6)
  v_mfma_f32_32x32x16_bf16 v[176:191], v[28:31], a[24:27], v[176:191]
  ds_read_b64_tr_b16 v[44:45], v20 offset:51008
  ds_read_b64_tr_b16 v[46:47], v20 offset:52160
  s_waitcnt lgkmcnt(6)
  v_mfma_f32_32x32x16_bf16 v[192:207], v[32:35], a[24:27], v[192:207]
  ds_read_b64_tr_b16 v[24:25], v20 offset:51040
  ds_read_b64_tr_b16 v[26:27], v20 offset:52192
  s_waitcnt lgkmcnt(6)
  v_mfma_f32_32x32x16_bf16 v[64:79], v[36:39], a[28:31], v[64:79]
  ds_read_b64_tr_b16 v[28:29], v20 offset:51072
  ds_read_b64_tr_b16 v[30:31], v20 offset:52224
  s_waitcnt lgkmcnt(6)
  v_mfma_f32_32x32x16_bf16 v[80:95], v[40:43], a[28:31], v[80:95]
  ds_read_b64_tr_b16 v[32:33], v20 offset:51104
  ds_read_b64_tr_b16 v[34:35], v20 offset:52256
  s_waitcnt lgkmcnt(6)
  v_mfma_f32_32x32x16_bf16 v[96:111], v[44:47], a[28:31], v[96:111]
  ds_read_b64_tr_b16 v[36:37], v20 offset:51136
  ds_read_b64_tr_b16 v[38:39], v20 offset:52288
  s_waitcnt lgkmcnt(6)
  v_mfma_f32_32x32x16_bf16 v[112:127], v[24:27], a[28:31], v[112:127]
  ds_read_b64_tr_b16 v[40:41], v20 offset:51168
  ds_read_b64_tr_b16 v[42:43], v20 offset:52320
  s_waitcnt lgkmcnt(6)
  v_mfma_f32_32x32x16_bf16 v[128:143], v[28:31], a[28:31], v[128:143]
  ds_read_b64_tr_b16 v[44:45], v20 offset:51200
  ds_read_b64_tr_b16 v[46:47], v20 offset:52352
  s_waitcnt lgkmcnt(6)
  v_mfma_f32_32x32x16_bf16 v[144:159], v[32:35], a[28:31], v[144:159]
  s_waitcnt vmcnt(13) lgkmcnt(0)
  s_barrier
  ds_read_b64_tr_b16 v[24:25], v21 offset:0
  ds_read_b64_tr_b16 v[26:27], v21 offset:1152
  v_mfma_f32_32x32x16_bf16 v[160:175], v[36:39], a[28:31], v[160:175]
  ds_read_b64_tr_b16 v[28:29], v21 offset:32
  ds_read_b64_tr_b16 v[30:31], v21 offset:1184
  v_mfma_f32_32x32x16_bf16 v[176:191], v[40:43], a[28:31], v[176:191]
  ds_read_b64_tr_b16 v[32:33], v21 offset:64
  ds_read_b64_tr_b16 v[34:35], v21 offset:1216
  v_mfma_f32_32x32x16_bf16 v[192:207], v[44:47], a[28:31], v[192:207]
  ds_read_b64_tr_b16 v[36:37], v21 offset:96
  ds_read_b64_tr_b16 v[38:39], v21 offset:1248
  s_waitcnt lgkmcnt(6)
  v_mfma_f32_32x32x16_bf16 v[64:79], v[24:27], a[32:35], v[64:79]
  ds_read_b64_tr_b16 v[40:41], v21 offset:128
  ds_read_b64_tr_b16 v[42:43], v21 offset:1280
  buffer_load_dwordx4 a[64:67], v1, s[8:11], s21 offen offset:0
  s_waitcnt lgkmcnt(6)
  v_mfma_f32_32x32x16_bf16 v[80:95], v[28:31], a[32:35], v[80:95]
  ds_read_b64_tr_b16 v[44:45], v21 offset:160
  ds_read_b64_tr_b16 v[46:47], v21 offset:1312
  s_waitcnt lgkmcnt(6)
  v_mfma_f32_32x32x16_bf16 v[96:111], v[32:35], a[32:35], v[96:111]
  ds_read_b64_tr_b16 v[24:25], v21 offset:192
  ds_read_b64_tr_b16 v[26:27], v21 offset:1344
  buffer_load_dwordx4 a[68:71], v1, s[8:11], s21 offen offset:1024
  s_waitcnt lgkmcnt(6)
  v_mfma_f32_32x32x16_bf16 v[112:127], v[36:39], a[32:35], v[112:127]
  ds_read_b64_tr_b16 v[28:29], v21 offset:224
  ds_read_b64_tr_b16 v[30:31], v21 offset:1376
  s_waitcnt lgkmcnt(6)
  v_mfma_f32_32x32x16_bf16 v[128:143], v[40:43], a[32:35], v[128:143]
  ds_read_b64_tr_b16 v[32:33], v21 offset:256
  ds_read_b64_tr_b16 v[34:35], v21 offset:1408
  buffer_load_dwordx4 a[72:75], v1, s[8:11], s21 offen offset:2048
  s_waitcnt lgkmcnt(6)
  v_mfma_f32_32x32x16_bf16 v[144:159], v[44:47], a[32:35], v[144:159]
  ds_read_b64_tr_b16 v[36:37], v21 offset:4608
  ds_read_b64_tr_b16 v[38:39], v21 offset:5760
  s_waitcnt lgkmcnt(6)
  v_mfma_f32_32x32x16_bf16 v[160:175], v[24:27], a[32:35], v[160:175]
  ds_read_b64_tr_b16 v[40:41], v21 offset:4640
  ds_read_b64_tr_b16 v[42:43], v21 offset:5792
  buffer_load_dwordx4 a[76:79], v1, s[8:11], s21 offen offset:3072
  s_add_u32 s21, s21, 4096
  s_waitcnt lgkmcnt(6)
  v_mfma_f32_32x32x16_bf16 v[176:191], v[28:31], a[32:35], v[176:191]
  ds_read_b64_tr_b16 v[44:45], v21 offset:4672
  ds_read_b64_tr_b16 v[46:47], v21 offset:5824
  s_waitcnt lgkmcnt(6)
  v_mfma_f32_32x32x16_bf16 v[192:207], v[32:35], a[32:35], v[192:207]
  ds_read_b64_tr_b16 v[24:25], v21 offset:4704
  ds_read_b64_tr_b16 v[26:27], v21 offset:5856
  s_add_u32 m0, s24, 0
  s_nop 0
  buffer_load_dwordx4 v10, s[4:7], s22 offen lds
  s_waitcnt lgkmcnt(6)
  v_mfma_f32_32x32x16_bf16 v[64:79], v[36:39], a[36:39], v[64:79]
  ds_read_b64_tr_b16 v[28:29], v21 offset:4736
  ds_read_b64_tr_b16 v[30:31], v21 offset:5888
  s_waitcnt lgkmcnt(6)
  v_mfma_f32_32x32x16_bf16 v[80:95], v[40:43], a[36:39], v[80:95]
  ds_read_b64_tr_b16 v[32:33], v21 offset:4768
  ds_read_b64_tr_b16 v[34:35], v21 offset:5920
  s_add_u32 m0, s24, 1024
  s_nop 0
  buffer_load_dwordx4 v11, s[4:7], s22 offen lds
  s_waitcnt lgkmcnt(6)
  v_mfma_f32_32x32x16_bf16 v[96:111], v[44:47], a[36:39], v[96:111]
  ds_read_b64_tr_b16 v[36:37], v21 offset:4800
  ds_read_b64_tr_b16 v[38:39], v21 offset:5952
  s_waitcnt lgkmcnt(6)
  v_mfma_f32_32x32x16_bf16 v[112:127], v[24:27], a[36:39], v[112:127]
  ds_read_b64_tr_b16 v[40:41], v21 offset:4832
  ds_read_b64_tr_b16 v[42:43], v21 offset:5984
  s_add_u32 m0, s24, 2048
  s_nop 0
  buffer_load_dwordx4 v12, s[4:7], s22 offen lds
  s_waitcnt lgkmcnt(6)
  v_mfma_f32_32x32x16_bf16 v[128:143], v[28:31], a[36:39], v[128:143]
  ds_read_b64_tr_b16 v[44:45], v21 offset:4864
  ds_read_b64_tr_b16 v[46:47], v21 offset:6016
  s_waitcnt lgkmcnt(6)
  v_mfma_f32_32x32x16_bf16 v[144:159], v[32:35], a[36:39], v[144:159]
  ds_read_b64_tr_b16 v[24:25], v21 offset:9216
  ds_read_b64_tr_b16 v[26:27], v21 offset:10368
  s_add_u32 m0, s24, 3072
  s_nop 0
  buffer_load_dwordx4 v13, s[4:7], s22 offen lds
  s_waitcnt lgkmcnt(6)
  v_mfma_f32_32x32x16_bf16 v[160:175], v[36:39], a[36:39], v[160:175]
  ds_read_b64_tr_b16 v[28:29], v21 offset:9248
  ds_read_b64_tr_b16 v[30:31], v21 offset:10400
  s_waitcnt lgkmcnt(6)
  v_mfma_f32_32x32x16_bf16 v[176:191], v[40:43], a[36:39], v[176:191]
  ds_read_b64_tr_b16 v[32:33], v21 offset:9280
  ds_read_b64_tr_b16 v[34:35], v21 offset:10432
  s_add_u32 m0, s24, 4096
  s_nop 0
  buffer_load_dwordx4 v14, s[4:7], s22 offen lds
  s_waitcnt lgkmcnt(6)
  v_mfma_f32_32x32x16_bf16 v[192:207], v[44:47], a[36:39], v[192:207]
  ds_read_b64_tr_b16 v[36:37], v21 offset:9312
  ds_read_b64_tr_b16 v[38:39], v21 offset:10464
  s_waitcnt lgkmcnt(6)
  v_mfma_f32_32x32x16_bf16 v[64:79], v[24:27], a[40:43], v[64:79]
  ds_read_b64_tr_b16 v[40:41], v21 offset:9344
  ds_read_b64_tr_b16 v[42:43], v21 offset:10496
  s_add_u32 m0, s24, 5120
  s_nop 0
  buffer_load_dwordx4 v15, s[4:7], s22 offen lds
  s_waitcnt lgkmcnt(6)
  v_mfma_f32_32x32x16_bf16 v[80:95], v[28:31], a[40:43], v[80:95]
  ds_read_b64_tr_b16 v[44:45], v21 offset:9376
  ds_read_b64_tr_b16 v[46:47], v21 offset:10528
  s_waitcnt lgkmcnt(6)
  v_mfma_f32_32x32x16_bf16 v[96:111], v[32:35], a[40:43], v[96:111]
  ds_read_b64_tr_b16 v[24:25], v21 offset:9408
  ds_read_b64_tr_b16 v[26:27], v21 offset:10560
  s_add_u32 m0, s24, 6144
  s_nop 0
  buffer_load_dwordx4 v16, s[4:7], s22 offen lds
  s_waitcnt lgkmcnt(6)
  v_mfma_f32_32x32x16_bf16 v[112:127], v[36:39], a[40:43], v[112:127]
  ds_read_b64_tr_b16 v[28:29], v21 offset:9440
  ds_read_b64_tr_b16 v[30:31], v21 offset:10592
  s_waitcnt lgkmcnt(6)
  v_mfma_f32_32x32x16_bf16 v[128:143], v[40:43], a[40:43], v[128:143]
  ds_read_b64_tr_b16 v[32:33], v21 offset:9472
  ds_read_b64_tr_b16 v[34:35], v21 offset:10624
  s_add_u32 m0, s24, 7168
  s_nop 0
  buffer_load_dwordx4 v17, s[4:7], s22 offen lds
  s_waitcnt lgkmcnt(6)
  v_mfma_f32_32x32x16_bf16 v[144:159], v[44:47], a[40:43], v[144:159]
  ds_read_b64_tr_b16 v[36:37], v21 offset:13824
  ds_read_b64_tr_b16 v[38:39], v21 offset:14976
  s_waitcnt lgkmcnt(6)
  v_mfma_f32_32x32x16_bf16 v[160:175], v[24:27], a[40:43], v[160:175]
  ds_read_b64_tr_b16 v[40:41], v21 offset:13856
  ds_read_b64_tr_b16 v[42:43], v21 offset:15008
  s_add_u32 m0, s24, 8192
  s_nop 0
  buffer_load_dwordx4 v18, s[4:7], s22 offen lds
  s_add_u32 s22, s22, 589824
  s_waitcnt lgkmcnt(6)
  v_mfma_f32_32x32x16_bf16 v[176:191], v[28:31], a[40:43], v[176:191]
  ds_read_b64_tr_b16 v[44:45], v21 offset:13888
  ds_read_b64_tr_b16 v[46:47], v21 offset:15040
  s_waitcnt lgkmcnt(6)
  v_mfma_f32_32x32x16_bf16 v[192:207], v[32:35], a[40:43], v[192:207]
  ds_read_b64_tr_b16 v[24:25], v21 offset:13920
  ds_read_b64_tr_b16 v[26:27], v21 offset:15072
  s_waitcnt lgkmcnt(6)
  v_mfma_f32_32x32x16_bf16 v[64:79], v[36:39], a[44:47], v[64:79]
  ds_read_b64_tr_b16 v[28:29], v21 offset:13952
  ds_read_b64_tr_b16 v[30:31], v21 offset:15104
  s_waitcnt lgkmcnt(6)
  v_mfma_f32_32x32x16_bf16 v[80:95], v[40:43], a[44:47], v[80:95]
  ds_read_b64_tr_b16 v[32:33], v21 offset:13984
  ds_read_b64_tr_b16 v[34:35], v21 offset:15136
  s_waitcnt lgkmcnt(6)
  v_mfma_f32_32x32x16_bf16 v[96:111], v[44:47], a[44:47], v[96:111]
  ds_read_b64_tr_b16 v[36:37], v21 offset:14016
  ds_read_b64_tr_b16 v[38:39], v21 offset:15168
  s_waitcnt lgkmcnt(6)
  v_mfma_f32_32x32x16_bf16 v[112:127], v[24:27], a[44:47], v[112:127]
  ds_read_b64_tr_b16 v[40:41], v21 offset:14048
  ds_read_b64_tr_b16 v[42:43], v21 offset:15200
  s_waitcnt lgkmcnt(6)
  v_mfma_f32_32x32x16_bf16 v[128:143], v[28:31], a[44:47], v[128:143]
  ds_read_b64_tr_b16 v[44:45], v21 offset:14080
  ds_read_b64_tr_b16 v[46:47], v21 offset:15232
  s_waitcnt lgkmcnt(6)
  v_mfma_f32_32x32x16_bf16 v[144:159], v[32:35], a[44:47], v[144:159]
  s_waitcnt vmcnt(13) lgkmcnt(0)
  s_barrier
  ds_read_b64_tr_b16 v[24:25], v21 offset:37120
  ds_read_b64_tr_b16 v[26:27], v21 offset:38272
  v_mfma_f32_32x32x16_bf16 v[160:175], v[36:39], a[44:47], v[160:175]
  ds_read_b64_tr_b16 v[28:29], v21 offset:37152
  ds_read_b64_tr_b16 v[30:31], v21 offset:38304
  v_mfma_f32_32x32x16_bf16 v[176:191], v[40:43], a[44:47], v[176:191]
  ds_read_b64_tr_b16 v[32:33], v21 offset:37184
  ds_read_b64_tr_b16 v[34:35], v21 offset:38336
  v_mfma_f32_32x32x16_bf16 v[192:207], v[44:47], a[44:47], v[192:207]
  ds_read_b64_tr_b16 v[36:37], v21 offset:37216
  ds_read_b64_tr_b16 v[38:39], v21 offset:38368
  s_waitcnt lgkmcnt(6)
  v_mfma_f32_32x32x16_bf16 v[64:79], v[24:27], a[48:51], v[64:79]
  ds_read_b64_tr_b16 v[40:41], v21 offset:37248
  ds_read_b64_tr_b16 v[42:43], v21 offset:38400
  buffer_load_dwordx4 a[80:83], v1, s[8:11], s21 offen offset:0
  s_waitcnt lgkmcnt(6)
  v_mfma_f32_32x32x16_bf16 v[80:95], v[28:31], a[48:51], v[80:95]
  ds_read_b64_tr_b16 v[44:45], v21 offset:37280
  ds_read_b64_tr_b16 v[46:47], v21 offset:38432
  s_waitcnt lgkmcnt(6)
  v_mfma_f32_32x32x16_bf16 v[96:111], v[32:35], a[48:51], v[96:111]
  ds_read_b64_tr_b16 v[24:25], v21 offset:37312
  ds_read_b64_tr_b16 v[26:27], v21 offset:38464
  buffer_load_dwordx4 a[84:87], v1, s[8:11], s21 offen offset:1024
  s_waitcnt lgkmcnt(6)
  v_mfma_f32_32x32x16_bf16 v[112:127], v[36:39], a[48:51], v[112:127]
  ds_read_b64_tr_b16 v[28:29], v21 offset:37344
  ds_read_b64_tr_b16 v[30:31], v21 offset:38496
  s_waitcnt lgkmcnt(6)
  v_mfma_f32_32x32x16_bf16 v[128:143], v[40:43], a[48:51], v[128:143]
  ds_read_b64_tr_b16 v[32:33], v21 offset:37376
  ds_read_b64_tr_b16 v[34:35], v21 offset:38528
  buffer_load_dwordx4 a[88:91], v1, s[8:11], s21 offen offset:2048
  s_waitcnt lgkmcnt(6)
  v_mfma_f32_32x32x16_bf16 v[144:159], v[44:47], a[48:51], v[144:159]
  ds_read_b64_tr_b16 v[36:37], v21 offset:41728
  ds_read_b64_tr_b16 v[38:39], v21 offset:42880
  s_waitcnt lgkmcnt(6)
  v_mfma_f32_32x32x16_bf16 v[160:175], v[24:27], a[48:51], v[160:175]
  ds_read_b64_tr_b16 v[40:41], v21 offset:41760
  ds_read_b64_tr_b16 v[42:43], v21 offset:42912
  buffer_load_dwordx4 a[92:95], v1, s[8:11], s21 offen offset:3072
  s_add_u32 s21, s21, 4096
  s_waitcnt lgkmcnt(6)
  v_mfma_f32_32x32x16_bf16 v[176:191], v[28:31], a[48:51], v[176:191]
  ds_read_b64_tr_b16 v[44:45], v21 offset:41792
  ds_read_b64_tr_b16 v[46:47], v21 offset:42944
  s_waitcnt lgkmcnt(6)
  v_mfma_f32_32x32x16_bf16 v[192:207], v[32:35], a[48:51], v[192:207]
  ds_read_b64_tr_b16 v[24:25], v21 offset:41824
  ds_read_b64_tr_b16 v[26:27], v21 offset:42976
  s_add_u32 m0, s24, 37120
  s_nop 0
  buffer_load_dwordx4 v10, s[4:7], s22 offen lds
  s_waitcnt lgkmcnt(6)
  v_mfma_f32_32x32x16_bf16 v[64:79], v[36:39], a[52:55], v[64:79]
  ds_read_b64_tr_b16 v[28:29], v21 offset:41856
  ds_read_b64_tr_b16 v[30:31], v21 offset:43008
  s_waitcnt lgkmcnt(6)
  v_mfma_f32_32x32x16_bf16 v[80:95], v[40:43], a[52:55], v[80:95]
  ds_read_b64_tr_b16 v[32:33], v21 offset:41888
  ds_read_b64_tr_b16 v[34:35], v21 offset:43040
  s_add_u32 m0, s24, 38144
  s_nop 0
  buffer_load_dwordx4 v11, s[4:7], s22 offen lds
  s_waitcnt lgkmcnt(6)
  v_mfma_f32_32x32x16_bf16 v[96:111], v[44:47], a[52:55], v[96:111]
  ds_read_b64_tr_b16 v[36:37], v21 offset:41920
  ds_read_b64_tr_b16 v[38:39], v21 offset:43072
  s_waitcnt lgkmcnt(6)
  v_mfma_f32_32x32x16_bf16 v[112:127], v[24:27], a[52:55], v[112:127]
  ds_read_b64_tr_b16 v[40:41], v21 offset:41952
  ds_read_b64_tr_b16 v[42:43], v21 offset:43104
  s_add_u32 m0, s24, 39168
  s_nop 0
  buffer_load_dwordx4 v12, s[4:7], s22 offen lds
  s_waitcnt lgkmcnt(6)
  v_mfma_f32_32x32x16_bf16 v[128:143], v[28:31], a[52:55], v[128:143]
  ds_read_b64_tr_b16 v[44:45], v21 offset:41984
  ds_read_b64_tr_b16 v[46:47], v21 offset:43136
  s_waitcnt lgkmcnt(6)
  v_mfma_f32_32x32x16_bf16 v[144:159], v[32:35], a[52:55], v[144:159]
  ds_read_b64_tr_b16 v[24:25], v21 offset:46336
  ds_read_b64_tr_b16 v[26:27], v21 offset:47488
  s_add_u32 m0, s24, 40192
  s_nop 0
  buffer_load_dwordx4 v13, s[4:7], s22 offen lds
  s_waitcnt lgkmcnt(6)
  v_mfma_f32_32x32x16_bf16 v[160:175], v[36:39], a[52:55], v[160:175]
  ds_read_b64_tr_b16 v[28:29], v21 offset:46368
  ds_read_b64_tr_b16 v[30:31], v21 offset:47520
  s_waitcnt lgkmcnt(6)
  v_mfma_f32_32x32x16_bf16 v[176:191], v[40:43], a[52:55], v[176:191]
  ds_read_b64_tr_b16 v[32:33], v21 offset:46400
  ds_read_b64_tr_b16 v[34:35], v21 offset:47552
  s_add_u32 m0, s24, 41216
  s_nop 0
  buffer_load_dwordx4 v14, s[4:7], s22 offen lds
  s_waitcnt lgkmcnt(6)
  v_mfma_f32_32x32x16_bf16 v[192:207], v[44:47], a[52:55], v[192:207]
  ds_read_b64_tr_b16 v[36:37], v21 offset:46432
  ds_read_b64_tr_b16 v[38:39], v21 offset:47584
  s_waitcnt lgkmcnt(6)
  v_mfma_f32_32x32x16_bf16 v[64:79], v[24:27], a[56:59], v[64:79]
  ds_read_b64_tr_b16 v[40:41], v21 offset:46464
  ds_read_b64_tr_b16 v[42:43], v21 offset:47616
  s_add_u32 m0, s24, 42240
  s_nop 0
  buffer_load_dwordx4 v15, s[4:7], s22 offen lds
  s_waitcnt lgkmcnt(6)
  v_mfma_f32_32x32x16_bf16 v[80:95], v[28:31], a[56:59], v[80:95]
  ds_read_b64_tr_b16 v[44:45], v21 offset:46496
  ds_read_b64_tr_b16 v[46:47], v21 offset:47648
  s_waitcnt lgkmcnt(6)
  v_mfma_f32_32x32x16_bf16 v[96:111], v[32:35], a[56:59], v[96:111]
  ds_read_b64_tr_b16 v[24:25], v21 offset:46528
  ds_read_b64_tr_b16 v[26:27], v21 offset:47680
  s_add_u32 m0, s24, 43264
  s_nop 0
  buffer_load_dwordx4 v16, s[4:7], s22 offen lds
  s_waitcnt lgkmcnt(6)
  v_mfma_f32_32x32x16_bf16 v[112:127], v[36:39], a[56:59], v[112:127]
  ds_read_b64_tr_b16 v[28:29], v21 offset:46560
  ds_read_b64_tr_b16 v[30:31], v21 offset:47712
  s_waitcnt lgkmcnt(6)
  v_mfma_f32_32x32x16_bf16 v[128:143], v[40:43], a[56:59], v[128:143]
  ds_read_b64_tr_b16 v[32:33], v21 offset:46592
  ds_read_b64_tr_b16 v[34:35], v21 offset:47744
  s_add_u32 m0, s24, 44288
  s_nop 0
  buffer_load_dwordx4 v17, s[4:7], s22 offen lds
  s_waitcnt lgkmcnt(6)
  v_mfma_f32_32x32x16_bf16 v[144:159], v[44:47], a[56:59], v[144:159]
  ds_read_b64_tr_b16 v[36:37], v21 offset:50944
  ds_read_b64_tr_b16 v[38:39], v21 offset:52096
  s_waitcnt lgkmcnt(6)
  v_mfma_f32_32x32x16_bf16 v[160:175], v[24:27], a[56:59], v[160:175]
  ds_read_b64_tr_b16 v[40:41], v21 offset:50976
  ds_read_b64_tr_b16 v[42:43], v21 offset:52128
  s_add_u32 m0, s24, 45312
  s_nop 0
  buffer_load_dwordx4 v18, s[4:7], s22 offen lds
  s_add_u32 s22, s22, 589824
  s_waitcnt lgkmcnt(6)
  v_mfma_f32_32x32x16_bf16 v[176:191], v[28:31], a[56:59], v[176:191]
  ds_read_b64_tr_b16 v[44:45], v21 offset:51008
  ds_read_b64_tr_b16 v[46:47], v21 offset:52160
  s_waitcnt lgkmcnt(6)
  v_mfma_f32_32x32x16_bf16 v[192:207], v[32:35], a[56:59], v[192:207]
  ds_read_b64_tr_b16 v[24:25], v21 offset:51040
  ds_read_b64_tr_b16 v[26:27], v21 offset:52192
  s_waitcnt lgkmcnt(6)
  v_mfma_f32_32x32x16_bf16 v[64:79], v[36:39], a[60:63], v[64:79]
  ds_read_b64_tr_b16 v[28:29], v21 offset:51072
  ds_read_b64_tr_b16 v[30:31], v21 offset:52224
  s_waitcnt lgkmcnt(6)
  v_mfma_f32_32x32x16_bf16 v[80:95], v[40:43], a[60:63], v[80:95]
  ds_read_b64_tr_b16 v[32:33], v21 offset:51104
  ds_read_b64_tr_b16 v[34:35], v21 offset:52256
  s_waitcnt lgkmcnt(6)
  v_mfma_f32_32x32x16_bf16 v[96:111], v[44:47], a[60:63], v[96:111]
  ds_read_b64_tr_b16 v[36:37], v21 offset:51136
  ds_read_b64_tr_b16 v[38:39], v21 offset:52288
  s_waitcnt lgkmcnt(6)
  v_mfma_f32_32x32x16_bf16 v[112:127], v[24:27], a[60:63], v[112:127]
  ds_read_b64_tr_b16 v[40:41], v21 offset:51168
  ds_read_b64_tr_b16 v[42:43], v21 offset:52320
  s_waitcnt lgkmcnt(6)
  v_mfma_f32_32x32x16_bf16 v[128:143], v[28:31], a[60:63], v[128:143]
  ds_read_b64_tr_b16 v[44:45], v21 offset:51200
  ds_read_b64_tr_b16 v[46:47], v21 offset:52352
  s_waitcnt lgkmcnt(6)
  v_mfma_f32_32x32x16_bf16 v[144:159], v[32:35], a[60:63], v[144:159]
  s_waitcnt vmcnt(13) lgkmcnt(0)
  s_barrier
  ds_read_b64_tr_b16 v[24:25], v20 offset:0
  ds_read_b64_tr_b16 v[26:27], v20 offset:1152
  v_mfma_f32_32x32x16_bf16 v[160:175], v[36:39], a[60:63], v[160:175]
  ds_read_b64_tr_b16 v[28:29], v20 offset:32
  ds_read_b64_tr_b16 v[30:31], v20 offset:1184
  v_mfma_f32_32x32x16_bf16 v[176:191], v[40:43], a[60:63], v[176:191]
  ds_read_b64_tr_b16 v[32:33], v20 offset:64
  ds_read_b64_tr_b16 v[34:35], v20 offset:1216
  v_mfma_f32_32x32x16_bf16 v[192:207], v[44:47], a[60:63], v[192:207]
  ds_read_b64_tr_b16 v[36:37], v20 offset:96
  ds_read_b64_tr_b16 v[38:39], v20 offset:1248
  s_waitcnt lgkmcnt(6)
  v_mfma_f32_32x32x16_bf16 v[64:79], v[24:27], a[64:67], v[64:79]
  ds_read_b64_tr_b16 v[40:41], v20 offset:128
  ds_read_b64_tr_b16 v[42:43], v20 offset:1280
  buffer_load_dwordx4 a[96:99], v1, s[8:11], s21 offen offset:0
  s_waitcnt lgkmcnt(6)
  v_mfma_f32_32x32x16_bf16 v[80:95], v[28:31], a[64:67], v[80:95]
  ds_read_b64_tr_b16 v[44:45], v20 offset:160
  ds_read_b64_tr_b16 v[46:47], v20 offset:1312
  s_waitcnt lgkmcnt(6)
  v_mfma_f32_32x32x16_bf16 v[96:111], v[32:35], a[64:67], v[96:111]
  ds_read_b64_tr_b16 v[24:25], v20 offset:192
  ds_read_b64_tr_b16 v[26:27], v20 offset:1344
  buffer_load_dwordx4 a[100:103], v1, s[8:11], s21 offen offset:1024
  s_waitcnt lgkmcnt(6)
  v_mfma_f32_32x32x16_bf16 v[112:127], v[36:39], a[64:67], v[112:127]
  ds_read_b64_tr_b16 v[28:29], v20 offset:224
  ds_read_b64_tr_b16 v[30:31], v20 offset:1376
  s_waitcnt lgkmcnt(6)
  v_mfma_f32_32x32x16_bf16 v[128:143], v[40:43], a[64:67], v[128:143]
  ds_read_b64_tr_b16 v[32:33], v20 offset:256
  ds_read_b64_tr_b16 v[34:35], v20 offset:1408
  buffer_load_dwordx4 a[104:107], v1, s[8:11], s21 offen offset:2048
  s_waitcnt lgkmcnt(6)
  v_mfma_f32_32x32x16_bf16 v[144:159], v[44:47], a[64:67], v[144:159]
  ds_read_b64_tr_b16 v[36:37], v20 offset:4608
  ds_read_b64_tr_b16 v[38:39], v20 offset:5760
  s_waitcnt lgkmcnt(6)
  v_mfma_f32_32x32x16_bf16 v[160:175], v[24:27], a[64:67], v[160:175]
  ds_read_b64_tr_b16 v[40:41], v20 offset:4640
  ds_read_b64_tr_b16 v[42:43], v20 offset:5792
  buffer_load_dwordx4 a[108:111], v1, s[8:11], s21 offen offset:3072
  s_add_u32 s21, s21, 4096
  s_waitcnt lgkmcnt(6)
  v_mfma_f32_32x32x16_bf16 v[176:191], v[28:31], a[64:67], v[176:191]
  ds_read_b64_tr_b16 v[44:45], v20 offset:4672
  ds_read_b64_tr_b16 v[46:47], v20 offset:5824
  s_waitcnt lgkmcnt(6)
  v_mfma_f32_32x32x16_bf16 v[192:207], v[32:35], a[64:67], v[192:207]
  ds_read_b64_tr_b16 v[24:25], v20 offset:4704
  ds_read_b64_tr_b16 v[26:27], v20 offset:5856
  s_add_u32 m0, s24, 74240
  s_nop 0
  buffer_load_dwordx4 v10, s[4:7], s22 offen lds
  s_waitcnt lgkmcnt(6)
  v_mfma_f32_32x32x16_bf16 v[64:79], v[36:39], a[68:71], v[64:79]
  ds_read_b64_tr_b16 v[28:29], v20 offset:4736
  ds_read_b64_tr_b16 v[30:31], v20 offset:5888
  s_waitcnt lgkmcnt(6)
  v_mfma_f32_32x32x16_bf16 v[80:95], v[40:43], a[68:71], v[80:95]
  ds_read_b64_tr_b16 v[32:33], v20 offset:4768
  ds_read_b64_tr_b16 v[34:35], v20 offset:5920
  s_add_u32 m0, s24, 75264
  s_nop 0
  buffer_load_dwordx4 v11, s[4:7], s22 offen lds
  s_waitcnt lgkmcnt(6)
  v_mfma_f32_32x32x16_bf16 v[96:111], v[44:47], a[68:71], v[96:111]
  ds_read_b64_tr_b16 v[36:37], v20 offset:4800
  ds_read_b64_tr_b16 v[38:39], v20 offset:5952
  s_waitcnt lgkmcnt(6)
  v_mfma_f32_32x32x16_bf16 v[112:127], v[24:27], a[68:71], v[112:127]
  ds_read_b64_tr_b16 v[40:41], v20 offset:4832
  ds_read_b64_tr_b16 v[42:43], v20 offset:5984
  s_add_u32 m0, s24, 76288
  s_nop 0
  buffer_load_dwordx4 v12, s[4:7], s22 offen lds
  s_waitcnt lgkmcnt(6)
  v_mfma_f32_32x32x16_bf16 v[128:143], v[28:31], a[68:71], v[128:143]
  ds_read_b64_tr_b16 v[44:45], v20 offset:4864
  ds_read_b64_tr_b16 v[46:47], v20 offset:6016
  s_waitcnt lgkmcnt(6)
  v_mfma_f32_32x32x16_bf16 v[144:159], v[32:35], a[68:71], v[144:159]
  ds_read_b64_tr_b16 v[24:25], v20 offset:9216
  ds_read_b64_tr_b16 v[26:27], v20 offset:10368
  s_add_u32 m0, s24, 77312
  s_nop 0
  buffer_load_dwordx4 v13, s[4:7], s22 offen lds
  s_waitcnt lgkmcnt(6)
  v_mfma_f32_32x32x16_bf16 v[160:175], v[36:39], a[68:71], v[160:175]
  ds_read_b64_tr_b16 v[28:29], v20 offset:9248
  ds_read_b64_tr_b16 v[30:31], v20 offset:10400
  s_waitcnt lgkmcnt(6)
  v_mfma_f32_32x32x16_bf16 v[176:191], v[40:43], a[68:71], v[176:191]
  ds_read_b64_tr_b16 v[32:33], v20 offset:9280
  ds_read_b64_tr_b16 v[34:35], v20 offset:10432
  s_add_u32 m0, s24, 78336
  s_nop 0
  buffer_load_dwordx4 v14, s[4:7], s22 offen lds
  s_waitcnt lgkmcnt(6)
  v_mfma_f32_32x32x16_bf16 v[192:207], v[44:47], a[68:71], v[192:207]
  ds_read_b64_tr_b16 v[36:37], v20 offset:9312
  ds_read_b64_tr_b16 v[38:39], v20 offset:10464
  s_waitcnt lgkmcnt(6)
  v_mfma_f32_32x32x16_bf16 v[64:79], v[24:27], a[72:75], v[64:79]
  ds_read_b64_tr_b16 v[40:41], v20 offset:9344
  ds_read_b64_tr_b16 v[42:43], v20 offset:10496
  s_add_u32 m0, s24, 79360
  s_nop 0
  buffer_load_dwordx4 v15, s[4:7], s22 offen lds
  s_waitcnt lgkmcnt(6)
  v_mfma_f32_32x32x16_bf16 v[80:95], v[28:31], a[72:75], v[80:95]
  ds_read_b64_tr_b16 v[44:45], v20 offset:9376
  ds_read_b64_tr_b16 v[46:47], v20 offset:10528
  s_waitcnt lgkmcnt(6)
  v_mfma_f32_32x32x16_bf16 v[96:111], v[32:35], a[72:75], v[96:111]
  ds_read_b64_tr_b16 v[24:25], v20 offset:9408
  ds_read_b64_tr_b16 v[26:27], v20 offset:10560
  s_add_u32 m0, s24, 80384
  s_nop 0
  buffer_load_dwordx4 v16, s[4:7], s22 offen lds
  s_waitcnt lgkmcnt(6)
  v_mfma_f32_32x32x16_bf16 v[112:127], v[36:39], a[72:75], v[112:127]
  ds_read_b64_tr_b16 v[28:29], v20 offset:9440
  ds_read_b64_tr_b16 v[30:31], v20 offset:10592
  s_waitcnt lgkmcnt(6)
  v_mfma_f32_32x32x16_bf16 v[128:143], v[40:43], a[72:75], v[128:143]
  ds_read_b64_tr_b16 v[32:33], v20 offset:9472
  ds_read_b64_tr_b16 v[34:35], v20 offset:10624
  s_add_u32 m0, s24, 81408
  s_nop 0
  buffer_load_dwordx4 v17, s[4:7], s22 offen lds
  s_waitcnt lgkmcnt(6)
  v_mfma_f32_32x32x16_bf16 v[144:159], v[44:47], a[72:75], v[144:159]
  ds_read_b64_tr_b16 v[36:37], v20 offset:13824
  ds_read_b64_tr_b16 v[38:39], v20 offset:14976
  s_waitcnt lgkmcnt(6)
  v_mfma_f32_32x32x16_bf16 v[160:175], v[24:27], a[72:75], v[160:175]
  ds_read_b64_tr_b16 v[40:41], v20 offset:13856
  ds_read_b64_tr_b16 v[42:43], v20 offset:15008
  s_add_u32 m0, s24, 82432
  s_nop 0
  buffer_load_dwordx4 v18, s[4:7], s22 offen lds
  s_add_u32 s22, s22, 589824
  s_waitcnt lgkmcnt(6)
  v_mfma_f32_32x32x16_bf16 v[176:191], v[28:31], a[72:75], v[176:191]
  ds_read_b64_tr_b16 v[44:45], v20 offset:13888
  ds_read_b64_tr_b16 v[46:47], v20 offset:15040
  s_waitcnt lgkmcnt(6)
  v_mfma_f32_32x32x16_bf16 v[192:207], v[32:35], a[72:75], v[192:207]
  ds_read_b64_tr_b16 v[24:25], v20 offset:13920
  ds_read_b64_tr_b16 v[26:27], v20 offset:15072
  s_waitcnt lgkmcnt(6)
  v_mfma_f32_32x32x16_bf16 v[64:79], v[36:39], a[76:79], v[64:79]
  ds_read_b64_tr_b16 v[28:29], v20 offset:13952
  ds_read_b64_tr_b16 v[30:31], v20 offset:15104
  s_waitcnt lgkmcnt(6)
  v_mfma_f32_32x32x16_bf16 v[80:95], v[40:43], a[76:79], v[80:95]
  ds_read_b64_tr_b16 v[32:33], v20 offset:13984
  ds_read_b64_tr_b16 v[34:35], v20 offset:15136
  s_waitcnt lgkmcnt(6)
  v_mfma_f32_32x32x16_bf16 v[96:111], v[44:47], a[76:79], v[96:111]
  ds_read_b64_tr_b16 v[36:37], v20 offset:14016
  ds_read_b64_tr_b16 v[38:39], v20 offset:15168
  s_waitcnt lgkmcnt(6)
  v_mfma_f32_32x32x16_bf16 v[112:127], v[24:27], a[76:79], v[112:127]
  ds_read_b64_tr_b16 v[40:41], v20 offset:14048
  ds_read_b64_tr_b16 v[42:43], v20 offset:15200
  s_waitcnt lgkmcnt(6)
  v_mfma_f32_32x32x16_bf16 v[128:143], v[28:31], a[76:79], v[128:143]
  ds_read_b64_tr_b16 v[44:45], v20 offset:14080
  ds_read_b64_tr_b16 v[46:47], v20 offset:15232
  s_waitcnt lgkmcnt(6)
  v_mfma_f32_32x32x16_bf16 v[144:159], v[32:35], a[76:79], v[144:159]
  s_waitcnt vmcnt(13) lgkmcnt(0)
  s_barrier
  ds_read_b64_tr_b16 v[24:25], v20 offset:37120
  ds_read_b64_tr_b16 v[26:27], v20 offset:38272
  v_mfma_f32_32x32x16_bf16 v[160:175], v[36:39], a[76:79], v[160:175]
  ds_read_b64_tr_b16 v[28:29], v20 offset:37152
  ds_read_b64_tr_b16 v[30:31], v20 offset:38304
  v_mfma_f32_32x32x16_bf16 v[176:191], v[40:43], a[76:79], v[176:191]
  ds_read_b64_tr_b16 v[32:33], v20 offset:37184
  ds_read_b64_tr_b16 v[34:35], v20 offset:38336
  v_mfma_f32_32x32x16_bf16 v[192:207], v[44:47], a[76:79], v[192:207]
  ds_read_b64_tr_b16 v[36:37], v20 offset:37216
  ds_read_b64_tr_b16 v[38:39], v20 offset:38368
  s_waitcnt lgkmcnt(6)
  v_mfma_f32_32x32x16_bf16 v[64:79], v[24:27], a[80:83], v[64:79]
  ds_read_b64_tr_b16 v[40:41], v20 offset:37248
  ds_read_b64_tr_b16 v[42:43], v20 offset:38400
  buffer_load_dwordx4 a[112:115], v1, s[8:11], s21 offen offset:0
  s_waitcnt lgkmcnt(6)
  v_mfma_f32_32x32x16_bf16 v[80:95], v[28:31], a[80:83], v[80:95]
  ds_read_b64_tr_b16 v[44:45], v20 offset:37280
  ds_read_b64_tr_b16 v[46:47], v20 offset:38432
  s_waitcnt lgkmcnt(6)
  v_mfma_f32_32x32x16_bf16 v[96:111], v[32:35], a[80:83], v[96:111]
  ds_read_b64_tr_b16 v[24:25], v20 offset:37312
  ds_read_b64_tr_b16 v[26:27], v20 offset:38464
  buffer_load_dwordx4 a[116:119], v1, s[8:11], s21 offen offset:1024
  s_waitcnt lgkmcnt(6)
  v_mfma_f32_32x32x16_bf16 v[112:127], v[36:39], a[80:83], v[112:127]
  ds_read_b64_tr_b16 v[28:29], v20 offset:37344
  ds_read_b64_tr_b16 v[30:31], v20 offset:38496
  s_waitcnt lgkmcnt(6)
  v_mfma_f32_32x32x16_bf16 v[128:143], v[40:43], a[80:83], v[128:143]
  ds_read_b64_tr_b16 v[32:33], v20 offset:37376
  ds_read_b64_tr_b16 v[34:35], v20 offset:38528
  buffer_load_dwordx4 a[120:123], v1, s[8:11], s21 offen offset:2048
  s_waitcnt lgkmcnt(6)
  v_mfma_f32_32x32x16_bf16 v[144:159], v[44:47], a[80:83], v[144:159]
  ds_read_b64_tr_b16 v[36:37], v20 offset:41728
  ds_read_b64_tr_b16 v[38:39], v20 offset:42880
  s_waitcnt lgkmcnt(6)
  v_mfma_f32_32x32x16_bf16 v[160:175], v[24:27], a[80:83], v[160:175]
  ds_read_b64_tr_b16 v[40:41], v20 offset:41760
  ds_read_b64_tr_b16 v[42:43], v20 offset:42912
  buffer_load_dwordx4 a[124:127], v1, s[8:11], s21 offen offset:3072
  s_add_u32 s21, s21, 4096
  s_waitcnt lgkmcnt(6)
  v_mfma_f32_32x32x16_bf16 v[176:191], v[28:31], a[80:83], v[176:191]
  ds_read_b64_tr_b16 v[44:45], v20 offset:41792
  ds_read_b64_tr_b16 v[46:47], v20 offset:42944
  s_waitcnt lgkmcnt(6)
  v_mfma_f32_32x32x16_bf16 v[192:207], v[32:35], a[80:83], v[192:207]
  ds_read_b64_tr_b16 v[24:25], v20 offset:41824
  ds_read_b64_tr_b16 v[26:27], v20 offset:42976
  s_add_u32 m0, s24, 111360
  s_nop 0
  buffer_load_dwordx4 v10, s[4:7], s22 offen lds
  s_waitcnt lgkmcnt(6)
  v_mfma_f32_32x32x16_bf16 v[64:79], v[36:39], a[84:87], v[64:79]
  ds_read_b64_tr_b16 v[28:29], v20 offset:41856
  ds_read_b64_tr_b16 v[30:31], v20 offset:43008
  s_waitcnt lgkmcnt(6)
  v_mfma_f32_32x32x16_bf16 v[80:95], v[40:43], a[84:87], v[80:95]
  ds_read_b64_tr_b16 v[32:33], v20 offset:41888
  ds_read_b64_tr_b16 v[34:35], v20 offset:43040
  s_add_u32 m0, s24, 112384
  s_nop 0
  buffer_load_dwordx4 v11, s[4:7], s22 offen lds
  s_waitcnt lgkmcnt(6)
  v_mfma_f32_32x32x16_bf16 v[96:111], v[44:47], a[84:87], v[96:111]
  ds_read_b64_tr_b16 v[36:37], v20 offset:41920
  ds_read_b64_tr_b16 v[38:39], v20 offset:43072
  s_waitcnt lgkmcnt(6)
  v_mfma_f32_32x32x16_bf16 v[112:127], v[24:27], a[84:87], v[112:127]
  ds_read_b64_tr_b16 v[40:41], v20 offset:41952
  ds_read_b64_tr_b16 v[42:43], v20 offset:43104
  s_add_u32 m0, s24, 113408
  s_nop 0
  buffer_load_dwordx4 v12, s[4:7], s22 offen lds
  s_waitcnt lgkmcnt(6)
  v_mfma_f32_32x32x16_bf16 v[128:143], v[28:31], a[84:87], v[128:143]
  ds_read_b64_tr_b16 v[44:45], v20 offset:41984
  ds_read_b64_tr_b16 v[46:47], v20 offset:43136
  s_waitcnt lgkmcnt(6)
  v_mfma_f32_32x32x16_bf16 v[144:159], v[32:35], a[84:87], v[144:159]
  ds_read_b64_tr_b16 v[24:25], v20 offset:46336
  ds_read_b64_tr_b16 v[26:27], v20 offset:47488
  s_add_u32 m0, s24, 114432
  s_nop 0
  buffer_load_dwordx4 v13, s[4:7], s22 offen lds
  s_waitcnt lgkmcnt(6)
  v_mfma_f32_32x32x16_bf16 v[160:175], v[36:39], a[84:87], v[160:175]
  ds_read_b64_tr_b16 v[28:29], v20 offset:46368
  ds_read_b64_tr_b16 v[30:31], v20 offset:47520
  s_waitcnt lgkmcnt(6)
  v_mfma_f32_32x32x16_bf16 v[176:191], v[40:43], a[84:87], v[176:191]
  ds_read_b64_tr_b16 v[32:33], v20 offset:46400
  ds_read_b64_tr_b16 v[34:35], v20 offset:47552
  s_add_u32 m0, s24, 115456
  s_nop 0
  buffer_load_dwordx4 v14, s[4:7], s22 offen lds
  s_waitcnt lgkmcnt(6)
  v_mfma_f32_32x32x16_bf16 v[192:207], v[44:47], a[84:87], v[192:207]
  ds_read_b64_tr_b16 v[36:37], v20 offset:46432
  ds_read_b64_tr_b16 v[38:39], v20 offset:47584
  s_waitcnt lgkmcnt(6)
  v_mfma_f32_32x32x16_bf16 v[64:79], v[24:27], a[88:91], v[64:79]
  ds_read_b64_tr_b16 v[40:41], v20 offset:46464
  ds_read_b64_tr_b16 v[42:43], v20 offset:47616
  s_add_u32 m0, s24, 116480
  s_nop 0
  buffer_load_dwordx4 v15, s[4:7], s22 offen lds
  s_waitcnt lgkmcnt(6)
  v_mfma_f32_32x32x16_bf16 v[80:95], v[28:31], a[88:91], v[80:95]
  ds_read_b64_tr_b16 v[44:45], v20 offset:46496
  ds_read_b64_tr_b16 v[46:47], v20 offset:47648
  s_waitcnt lgkmcnt(6)
  v_mfma_f32_32x32x16_bf16 v[96:111], v[32:35], a[88:91], v[96:111]
  ds_read_b64_tr_b16 v[24:25], v20 offset:46528
  ds_read_b64_tr_b16 v[26:27], v20 offset:47680
  s_add_u32 m0, s24, 117504
  s_nop 0
  buffer_load_dwordx4 v16, s[4:7], s22 offen lds
  s_waitcnt lgkmcnt(6)
  v_mfma_f32_32x32x16_bf16 v[112:127], v[36:39], a[88:91], v[112:127]
  ds_read_b64_tr_b16 v[28:29], v20 offset:46560
  ds_read_b64_tr_b16 v[30:31], v20 offset:47712
  s_waitcnt lgkmcnt(6)
  v_mfma_f32_32x32x16_bf16 v[128:143], v[40:43], a[88:91], v[128:143]
  ds_read_b64_tr_b16 v[32:33], v20 offset:46592
  ds_read_b64_tr_b16 v[34:35], v20 offset:47744
  s_add_u32 m0, s24, 118528
  s_nop 0
  buffer_load_dwordx4 v17, s[4:7], s22 offen lds
  s_waitcnt lgkmcnt(6)
  v_mfma_f32_32x32x16_bf16 v[144:159], v[44:47], a[88:91], v[144:159]
  ds_read_b64_tr_b16 v[36:37], v20 offset:50944
  ds_read_b64_tr_b16 v[38:39], v20 offset:52096
  s_waitcnt lgkmcnt(6)
  v_mfma_f32_32x32x16_bf16 v[160:175], v[24:27], a[88:91], v[160:175]
  ds_read_b64_tr_b16 v[40:41], v20 offset:50976
  ds_read_b64_tr_b16 v[42:43], v20 offset:52128
  s_add_u32 m0, s24, 119552
  s_nop 0
  buffer_load_dwordx4 v18, s[4:7], s22 offen lds
  s_add_u32 s22, s22, 589824
  s_waitcnt lgkmcnt(6)
  v_mfma_f32_32x32x16_bf16 v[176:191], v[28:31], a[88:91], v[176:191]
  ds_read_b64_tr_b16 v[44:45], v20 offset:51008
  ds_read_b64_tr_b16 v[46:47], v20 offset:52160
  s_waitcnt lgkmcnt(6)
  v_mfma_f32_32x32x16_bf16 v[192:207], v[32:35], a[88:91], v[192:207]
  ds_read_b64_tr_b16 v[24:25], v20 offset:51040
  ds_read_b64_tr_b16 v[26:27], v20 offset:52192
  s_waitcnt lgkmcnt(6)
  v_mfma_f32_32x32x16_bf16 v[64:79], v[36:39], a[92:95], v[64:79]
  ds_read_b64_tr_b16 v[28:29], v20 offset:51072
  ds_read_b64_tr_b16 v[30:31], v20 offset:52224
  s_waitcnt lgkmcnt(6)
  v_mfma_f32_32x32x16_bf16 v[80:95], v[40:43], a[92:95], v[80:95]
  ds_read_b64_tr_b16 v[32:33], v20 offset:51104
  ds_read_b64_tr_b16 v[34:35], v20 offset:52256
  s_waitcnt lgkmcnt(6)
  v_mfma_f32_32x32x16_bf16 v[96:111], v[44:47], a[92:95], v[96:111]
  ds_read_b64_tr_b16 v[36:37], v20 offset:51136
  ds_read_b64_tr_b16 v[38:39], v20 offset:52288
  s_waitcnt lgkmcnt(6)
  v_mfma_f32_32x32x16_bf16 v[112:127], v[24:27], a[92:95], v[112:127]
  ds_read_b64_tr_b16 v[40:41], v20 offset:51168
  ds_read_b64_tr_b16 v[42:43], v20 offset:52320
  s_waitcnt lgkmcnt(6)
  v_mfma_f32_32x32x16_bf16 v[128:143], v[28:31], a[92:95], v[128:143]
  ds_read_b64_tr_b16 v[44:45], v20 offset:51200
  ds_read_b64_tr_b16 v[46:47], v20 offset:52352
  s_waitcnt lgkmcnt(6)
  v_mfma_f32_32x32x16_bf16 v[144:159], v[32:35], a[92:95], v[144:159]
  s_waitcnt vmcnt(13) lgkmcnt(0)
  s_barrier
  ds_read_b64_tr_b16 v[24:25], v21 offset:0
  ds_read_b64_tr_b16 v[26:27], v21 offset:1152
  v_mfma_f32_32x32x16_bf16 v[160:175], v[36:39], a[92:95], v[160:175]
  ds_read_b64_tr_b16 v[28:29], v21 offset:32
  ds_read_b64_tr_b16 v[30:31], v21 offset:1184
  v_mfma_f32_32x32x16_bf16 v[176:191], v[40:43], a[92:95], v[176:191]
  ds_read_b64_tr_b16 v[32:33], v21 offset:64
  ds_read_b64_tr_b16 v[34:35], v21 offset:1216
  v_mfma_f32_32x32x16_bf16 v[192:207], v[44:47], a[92:95], v[192:207]
  ds_read_b64_tr_b16 v[36:37], v21 offset:96
  ds_read_b64_tr_b16 v[38:39], v21 offset:1248
  s_waitcnt lgkmcnt(6)
  v_mfma_f32_32x32x16_bf16 v[64:79], v[24:27], a[96:99], v[64:79]
  ds_read_b64_tr_b16 v[40:41], v21 offset:128
  ds_read_b64_tr_b16 v[42:43], v21 offset:1280
  buffer_load_dwordx4 a[128:131], v1, s[8:11], s21 offen offset:0
  s_waitcnt lgkmcnt(6)
  v_mfma_f32_32x32x16_bf16 v[80:95], v[28:31], a[96:99], v[80:95]
  ds_read_b64_tr_b16 v[44:45], v21 offset:160
  ds_read_b64_tr_b16 v[46:47], v21 offset:1312
  s_waitcnt lgkmcnt(6)
  v_mfma_f32_32x32x16_bf16 v[96:111], v[32:35], a[96:99], v[96:111]
  ds_read_b64_tr_b16 v[24:25], v21 offset:192
  ds_read_b64_tr_b16 v[26:27], v21 offset:1344
  buffer_load_dwordx4 a[132:135], v1, s[8:11], s21 offen offset:1024
  s_waitcnt lgkmcnt(6)
  v_mfma_f32_32x32x16_bf16 v[112:127], v[36:39], a[96:99], v[112:127]
  ds_read_b64_tr_b16 v[28:29], v21 offset:224
  ds_read_b64_tr_b16 v[30:31], v21 offset:1376
  s_waitcnt lgkmcnt(6)
  v_mfma_f32_32x32x16_bf16 v[128:143], v[40:43], a[96:99], v[128:143]
  ds_read_b64_tr_b16 v[32:33], v21 offset:256
  ds_read_b64_tr_b16 v[34:35], v21 offset:1408
  buffer_load_dwordx4 a[136:139], v1, s[8:11], s21 offen offset:2048
  s_waitcnt lgkmcnt(6)
  v_mfma_f32_32x32x16_bf16 v[144:159], v[44:47], a[96:99], v[144:159]
  ds_read_b64_tr_b16 v[36:37], v21 offset:4608
  ds_read_b64_tr_b16 v[38:39], v21 offset:5760
  s_waitcnt lgkmcnt(6)
  v_mfma_f32_32x32x16_bf16 v[160:175], v[24:27], a[96:99], v[160:175]
  ds_read_b64_tr_b16 v[40:41], v21 offset:4640
  ds_read_b64_tr_b16 v[42:43], v21 offset:5792
  buffer_load_dwordx4 a[140:143], v1, s[8:11], s21 offen offset:3072
  s_add_u32 s21, s21, 4096
  s_waitcnt lgkmcnt(6)
  v_mfma_f32_32x32x16_bf16 v[176:191], v[28:31], a[96:99], v[176:191]
  ds_read_b64_tr_b16 v[44:45], v21 offset:4672
  ds_read_b64_tr_b16 v[46:47], v21 offset:5824
  s_waitcnt lgkmcnt(6)
  v_mfma_f32_32x32x16_bf16 v[192:207], v[32:35], a[96:99], v[192:207]
  ds_read_b64_tr_b16 v[24:25], v21 offset:4704
  ds_read_b64_tr_b16 v[26:27], v21 offset:5856
  s_add_u32 m0, s24, 0
  s_nop 0
  buffer_load_dwordx4 v10, s[4:7], s22 offen lds
  s_waitcnt lgkmcnt(6)
  v_mfma_f32_32x32x16_bf16 v[64:79], v[36:39], a[100:103], v[64:79]
  ds_read_b64_tr_b16 v[28:29], v21 offset:4736
  ds_read_b64_tr_b16 v[30:31], v21 offset:5888
  s_waitcnt lgkmcnt(6)
  v_mfma_f32_32x32x16_bf16 v[80:95], v[40:43], a[100:103], v[80:95]
  ds_read_b64_tr_b16 v[32:33], v21 offset:4768
  ds_read_b64_tr_b16 v[34:35], v21 offset:5920
  s_add_u32 m0, s24, 1024
  s_nop 0
  buffer_load_dwordx4 v11, s[4:7], s22 offen lds
  s_waitcnt lgkmcnt(6)
  v_mfma_f32_32x32x16_bf16 v[96:111], v[44:47], a[100:103], v[96:111]
  ds_read_b64_tr_b16 v[36:37], v21 offset:4800
  ds_read_b64_tr_b16 v[38:39], v21 offset:5952
  s_waitcnt lgkmcnt(6)
  v_mfma_f32_32x32x16_bf16 v[112:127], v[24:27], a[100:103], v[112:127]
  ds_read_b64_tr_b16 v[40:41], v21 offset:4832
  ds_read_b64_tr_b16 v[42:43], v21 offset:5984
  s_add_u32 m0, s24, 2048
  s_nop 0
  buffer_load_dwordx4 v12, s[4:7], s22 offen lds
  s_waitcnt lgkmcnt(6)
  v_mfma_f32_32x32x16_bf16 v[128:143], v[28:31], a[100:103], v[128:143]
  ds_read_b64_tr_b16 v[44:45], v21 offset:4864
  ds_read_b64_tr_b16 v[46:47], v21 offset:6016
  s_waitcnt lgkmcnt(6)
  v_mfma_f32_32x32x16_bf16 v[144:159], v[32:35], a[100:103], v[144:159]
  ds_read_b64_tr_b16 v[24:25], v21 offset:9216
  ds_read_b64_tr_b16 v[26:27], v21 offset:10368
  s_add_u32 m0, s24, 3072
  s_nop 0
  buffer_load_dwordx4 v13, s[4:7], s22 offen lds
  s_waitcnt lgkmcnt(6)
  v_mfma_f32_32x32x16_bf16 v[160:175], v[36:39], a[100:103], v[160:175]
  ds_read_b64_tr_b16 v[28:29], v21 offset:9248
  ds_read_b64_tr_b16 v[30:31], v21 offset:10400
  s_waitcnt lgkmcnt(6)
  v_mfma_f32_32x32x16_bf16 v[176:191], v[40:43], a[100:103], v[176:191]
  ds_read_b64_tr_b16 v[32:33], v21 offset:9280
  ds_read_b64_tr_b16 v[34:35], v21 offset:10432
  s_add_u32 m0, s24, 4096
  s_nop 0
  buffer_load_dwordx4 v14, s[4:7], s22 offen lds
  s_waitcnt lgkmcnt(6)
  v_mfma_f32_32x32x16_bf16 v[192:207], v[44:47], a[100:103], v[192:207]
  ds_read_b64_tr_b16 v[36:37], v21 offset:9312
  ds_read_b64_tr_b16 v[38:39], v21 offset:10464
  s_waitcnt lgkmcnt(6)
  v_mfma_f32_32x32x16_bf16 v[64:79], v[24:27], a[104:107], v[64:79]
  ds_read_b64_tr_b16 v[40:41], v21 offset:9344
  ds_read_b64_tr_b16 v[42:43], v21 offset:10496
  s_add_u32 m0, s24, 5120
  s_nop 0
  buffer_load_dwordx4 v15, s[4:7], s22 offen lds
  s_waitcnt lgkmcnt(6)
  v_mfma_f32_32x32x16_bf16 v[80:95], v[28:31], a[104:107], v[80:95]
  ds_read_b64_tr_b16 v[44:45], v21 offset:9376
  ds_read_b64_tr_b16 v[46:47], v21 offset:10528
  s_waitcnt lgkmcnt(6)
  v_mfma_f32_32x32x16_bf16 v[96:111], v[32:35], a[104:107], v[96:111]
  ds_read_b64_tr_b16 v[24:25], v21 offset:9408
  ds_read_b64_tr_b16 v[26:27], v21 offset:10560
  s_add_u32 m0, s24, 6144
  s_nop 0
  buffer_load_dwordx4 v16, s[4:7], s22 offen lds
  s_waitcnt lgkmcnt(6)
  v_mfma_f32_32x32x16_bf16 v[112:127], v[36:39], a[104:107], v[112:127]
  ds_read_b64_tr_b16 v[28:29], v21 offset:9440
  ds_read_b64_tr_b16 v[30:31], v21 offset:10592
  s_waitcnt lgkmcnt(6)
  v_mfma_f32_32x32x16_bf16 v[128:143], v[40:43], a[104:107], v[128:143]
  ds_read_b64_tr_b16 v[32:33], v21 offset:9472
  ds_read_b64_tr_b16 v[34:35], v21 offset:10624
  s_add_u32 m0, s24, 7168
  s_nop 0
  buffer_load_dwordx4 v17, s[4:7], s22 offen lds
  s_waitcnt lgkmcnt(6)
  v_mfma_f32_32x32x16_bf16 v[144:159], v[44:47], a[104:107], v[144:159]
  ds_read_b64_tr_b16 v[36:37], v21 offset:13824
  ds_read_b64_tr_b16 v[38:39], v21 offset:14976
  s_waitcnt lgkmcnt(6)
  v_mfma_f32_32x32x16_bf16 v[160:175], v[24:27], a[104:107], v[160:175]
  ds_read_b64_tr_b16 v[40:41], v21 offset:13856
  ds_read_b64_tr_b16 v[42:43], v21 offset:15008
  s_add_u32 m0, s24, 8192
  s_nop 0
  buffer_load_dwordx4 v18, s[4:7], s22 offen lds
  s_add_u32 s22, s22, 589824
  s_sub_u32 s22, s22, 5308128
  s_waitcnt lgkmcnt(6)
  v_mfma_f32_32x32x16_bf16 v[176:191], v[28:31], a[104:107], v[176:191]
  ds_read_b64_tr_b16 v[44:45], v21 offset:13888
  ds_read_b64_tr_b16 v[46:47], v21 offset:15040
  s_waitcnt lgkmcnt(6)
  v_mfma_f32_32x32x16_bf16 v[192:207], v[32:35], a[104:107], v[192:207]
  ds_read_b64_tr_b16 v[24:25], v21 offset:13920
  ds_read_b64_tr_b16 v[26:27], v21 offset:15072
  s_waitcnt lgkmcnt(6)
  v_mfma_f32_32x32x16_bf16 v[64:79], v[36:39], a[108:111], v[64:79]
  ds_read_b64_tr_b16 v[28:29], v21 offset:13952
  ds_read_b64_tr_b16 v[30:31], v21 offset:15104
  s_waitcnt lgkmcnt(6)
  v_mfma_f32_32x32x16_bf16 v[80:95], v[40:43], a[108:111], v[80:95]
  ds_read_b64_tr_b16 v[32:33], v21 offset:13984
  ds_read_b64_tr_b16 v[34:35], v21 offset:15136
  s_waitcnt lgkmcnt(6)
  v_mfma_f32_32x32x16_bf16 v[96:111], v[44:47], a[108:111], v[96:111]
  ds_read_b64_tr_b16 v[36:37], v21 offset:14016
  ds_read_b64_tr_b16 v[38:39], v21 offset:15168
  s_waitcnt lgkmcnt(6)
  v_mfma_f32_32x32x16_bf16 v[112:127], v[24:27], a[108:111], v[112:127]
  ds_read_b64_tr_b16 v[40:41], v21 offset:14048
  ds_read_b64_tr_b16 v[42:43], v21 offset:15200
  s_waitcnt lgkmcnt(6)
  v_mfma_f32_32x32x16_bf16 v[128:143], v[28:31], a[108:111], v[128:143]
  ds_read_b64_tr_b16 v[44:45], v21 offset:14080
  ds_read_b64_tr_b16 v[46:47], v21 offset:15232
  s_waitcnt lgkmcnt(6)
  v_mfma_f32_32x32x16_bf16 v[144:159], v[32:35], a[108:111], v[144:159]
  s_waitcnt vmcnt(13) lgkmcnt(0)
  s_barrier
  ds_read_b64_tr_b16 v[24:25], v21 offset:37120
  ds_read_b64_tr_b16 v[26:27], v21 offset:38272
  v_mfma_f32_32x32x16_bf16 v[160:175], v[36:39], a[108:111], v[160:175]
  ds_read_b64_tr_b16 v[28:29], v21 offset:37152
  ds_read_b64_tr_b16 v[30:31], v21 offset:38304
  v_mfma_f32_32x32x16_bf16 v[176:191], v[40:43], a[108:111], v[176:191]
  ds_read_b64_tr_b16 v[32:33], v21 offset:37184
  ds_read_b64_tr_b16 v[34:35], v21 offset:38336
  v_mfma_f32_32x32x16_bf16 v[192:207], v[44:47], a[108:111], v[192:207]
  ds_read_b64_tr_b16 v[36:37], v21 offset:37216
  ds_read_b64_tr_b16 v[38:39], v21 offset:38368
  s_waitcnt lgkmcnt(6)
  v_mfma_f32_32x32x16_bf16 v[64:79], v[24:27], a[112:115], v[64:79]
  ds_read_b64_tr_b16 v[40:41], v21 offset:37248
  ds_read_b64_tr_b16 v[42:43], v21 offset:38400
  s_add_u32 m0, s24, 37120
  s_nop 0
  buffer_load_dwordx4 v10, s[4:7], s22 offen lds
  s_waitcnt lgkmcnt(6)
  v_mfma_f32_32x32x16_bf16 v[80:95], v[28:31], a[112:115], v[80:95]
  ds_read_b64_tr_b16 v[44:45], v21 offset:37280
  ds_read_b64_tr_b16 v[46:47], v21 offset:38432
  s_waitcnt lgkmcnt(6)
  v_mfma_f32_32x32x16_bf16 v[96:111], v[32:35], a[112:115], v[96:111]
  ds_read_b64_tr_b16 v[24:25], v21 offset:37312
  ds_read_b64_tr_b16 v[26:27], v21 offset:38464
  s_add_u32 m0, s24, 38144
  s_nop 0
  buffer_load_dwordx4 v11, s[4:7], s22 offen lds
  s_waitcnt lgkmcnt(6)
  v_mfma_f32_32x32x16_bf16 v[112:127], v[36:39], a[112:115], v[112:127]
  ds_read_b64_tr_b16 v[28:29], v21 offset:37344
  ds_read_b64_tr_b16 v[30:31], v21 offset:38496
  s_waitcnt lgkmcnt(6)
  v_mfma_f32_32x32x16_bf16 v[128:143], v[40:43], a[112:115], v[128:143]
  ds_read_b64_tr_b16 v[32:33], v21 offset:37376
  ds_read_b64_tr_b16 v[34:35], v21 offset:38528
  s_add_u32 m0, s24, 39168
  s_nop 0
  buffer_load_dwordx4 v12, s[4:7], s22 offen lds
  s_waitcnt lgkmcnt(6)
  v_mfma_f32_32x32x16_bf16 v[144:159], v[44:47], a[112:115], v[144:159]
  ds_read_b64_tr_b16 v[36:37], v21 offset:41728
  ds_read_b64_tr_b16 v[38:39], v21 offset:42880
  s_waitcnt lgkmcnt(6)
  v_mfma_f32_32x32x16_bf16 v[160:175], v[24:27], a[112:115], v[160:175]
  ds_read_b64_tr_b16 v[40:41], v21 offset:41760
  ds_read_b64_tr_b16 v[42:43], v21 offset:42912
  s_add_u32 m0, s24, 40192
  s_nop 0
  buffer_load_dwordx4 v13, s[4:7], s22 offen lds
  s_waitcnt lgkmcnt(6)
  v_mfma_f32_32x32x16_bf16 v[176:191], v[28:31], a[112:115], v[176:191]
  ds_read_b64_tr_b16 v[44:45], v21 offset:41792
  ds_read_b64_tr_b16 v[46:47], v21 offset:42944
  s_waitcnt lgkmcnt(6)
  v_mfma_f32_32x32x16_bf16 v[192:207], v[32:35], a[112:115], v[192:207]
  ds_read_b64_tr_b16 v[24:25], v21 offset:41824
  ds_read_b64_tr_b16 v[26:27], v21 offset:42976
  s_add_u32 m0, s24, 41216
  s_nop 0
  buffer_load_dwordx4 v14, s[4:7], s22 offen lds
  s_waitcnt lgkmcnt(6)
  v_mfma_f32_32x32x16_bf16 v[64:79], v[36:39], a[116:119], v[64:79]
  ds_read_b64_tr_b16 v[28:29], v21 offset:41856
  ds_read_b64_tr_b16 v[30:31], v21 offset:43008
  s_waitcnt lgkmcnt(6)
  v_mfma_f32_32x32x16_bf16 v[80:95], v[40:43], a[116:119], v[80:95]
  ds_read_b64_tr_b16 v[32:33], v21 offset:41888
  ds_read_b64_tr_b16 v[34:35], v21 offset:43040
  s_add_u32 m0, s24, 42240
  s_nop 0
  buffer_load_dwordx4 v15, s[4:7], s22 offen lds
  s_waitcnt lgkmcnt(6)
  v_mfma_f32_32x32x16_bf16 v[96:111], v[44:47], a[116:119], v[96:111]
  ds_read_b64_tr_b16 v[36:37], v21 offset:41920
  ds_read_b64_tr_b16 v[38:39], v21 offset:43072
  s_waitcnt lgkmcnt(6)
  v_mfma_f32_32x32x16_bf16 v[112:127], v[24:27], a[116:119], v[112:127]
  ds_read_b64_tr_b16 v[40:41], v21 offset:41952
  ds_read_b64_tr_b16 v[42:43], v21 offset:43104
  s_add_u32 m0, s24, 43264
  s_nop 0
  buffer_load_dwordx4 v16, s[4:7], s22 offen lds
  s_waitcnt lgkmcnt(6)
  v_mfma_f32_32x32x16_bf16 v[128:143], v[28:31], a[116:119], v[128:143]
  ds_read_b64_tr_b16 v[44:45], v21 offset:41984
  ds_read_b64_tr_b16 v[46:47], v21 offset:43136
  s_waitcnt lgkmcnt(6)
  v_mfma_f32_32x32x16_bf16 v[144:159], v[32:35], a[116:119], v[144:159]
  ds_read_b64_tr_b16 v[24:25], v21 offset:46336
  ds_read_b64_tr_b16 v[26:27], v21 offset:47488
  s_add_u32 m0, s24, 44288
  s_nop 0
  buffer_load_dwordx4 v17, s[4:7], s22 offen lds
  s_waitcnt lgkmcnt(6)
  v_mfma_f32_32x32x16_bf16 v[160:175], v[36:39], a[116:119], v[160:175]
  ds_read_b64_tr_b16 v[28:29], v21 offset:46368
  ds_read_b64_tr_b16 v[30:31], v21 offset:47520
  s_waitcnt lgkmcnt(6)
  v_mfma_f32_32x32x16_bf16 v[176:191], v[40:43], a[116:119], v[176:191]
  ds_read_b64_tr_b16 v[32:33], v21 offset:46400
  ds_read_b64_tr_b16 v[34:35], v21 offset:47552
  s_add_u32 m0, s24, 45312
  s_nop 0
  buffer_load_dwordx4 v18, s[4:7], s22 offen lds
  s_add_u32 s22, s22, 589824
  s_waitcnt lgkmcnt(6)
  v_mfma_f32_32x32x16_bf16 v[192:207], v[44:47], a[116:119], v[192:207]
  ds_read_b64_tr_b16 v[36:37], v21 offset:46432
  ds_read_b64_tr_b16 v[38:39], v21 offset:47584
  s_waitcnt lgkmcnt(6)
  v_mfma_f32_32x32x16_bf16 v[64:79], v[24:27], a[120:123], v[64:79]
  ds_read_b64_tr_b16 v[40:41], v21 offset:46464
  ds_read_b64_tr_b16 v[42:43], v21 offset:47616
  s_waitcnt lgkmcnt(6)
  v_mfma_f32_32x32x16_bf16 v[80:95], v[28:31], a[120:123], v[80:95]
  ds_read_b64_tr_b16 v[44:45], v21 offset:46496
  ds_read_b64_tr_b16 v[46:47], v21 offset:47648
  s_waitcnt lgkmcnt(6)
  v_mfma_f32_32x32x16_bf16 v[96:111], v[32:35], a[120:123], v[96:111]
  ds_read_b64_tr_b16 v[24:25], v21 offset:46528
  ds_read_b64_tr_b16 v[26:27], v21 offset:47680
  s_waitcnt lgkmcnt(6)
  v_mfma_f32_32x32x16_bf16 v[112:127], v[36:39], a[120:123], v[112:127]
  ds_read_b64_tr_b16 v[28:29], v21 offset:46560
  ds_read_b64_tr_b16 v[30:31], v21 offset:47712
  s_waitcnt lgkmcnt(6)
  v_mfma_f32_32x32x16_bf16 v[128:143], v[40:43], a[120:123], v[128:143]
  ds_read_b64_tr_b16 v[32:33], v21 offset:46592
  ds_read_b64_tr_b16 v[34:35], v21 offset:47744
  s_waitcnt lgkmcnt(6)
  v_mfma_f32_32x32x16_bf16 v[144:159], v[44:47], a[120:123], v[144:159]
  ds_read_b64_tr_b16 v[36:37], v21 offset:50944
  ds_read_b64_tr_b16 v[38:39], v21 offset:52096
  s_waitcnt lgkmcnt(6)
  v_mfma_f32_32x32x16_bf16 v[160:175], v[24:27], a[120:123], v[160:175]
  ds_read_b64_tr_b16 v[40:41], v21 offset:50976
  ds_read_b64_tr_b16 v[42:43], v21 offset:52128
  s_waitcnt lgkmcnt(6)
  v_mfma_f32_32x32x16_bf16 v[176:191], v[28:31], a[120:123], v[176:191]
  ds_read_b64_tr_b16 v[44:45], v21 offset:51008
  ds_read_b64_tr_b16 v[46:47], v21 offset:52160
  s_waitcnt lgkmcnt(6)
  v_mfma_f32_32x32x16_bf16 v[192:207], v[32:35], a[120:123], v[192:207]
  ds_read_b64_tr_b16 v[24:25], v21 offset:51040
  ds_read_b64_tr_b16 v[26:27], v21 offset:52192
  s_waitcnt lgkmcnt(6)
  v_mfma_f32_32x32x16_bf16 v[64:79], v[36:39], a[124:127], v[64:79]
  ds_read_b64_tr_b16 v[28:29], v21 offset:51072
  ds_read_b64_tr_b16 v[30:31], v21 offset:52224
  s_waitcnt lgkmcnt(6)
  v_mfma_f32_32x32x16_bf16 v[80:95], v[40:43], a[124:127], v[80:95]
  ds_read_b64_tr_b16 v[32:33], v21 offset:51104
  ds_read_b64_tr_b16 v[34:35], v21 offset:52256
  s_waitcnt lgkmcnt(6)
  v_mfma_f32_32x32x16_bf16 v[96:111], v[44:47], a[124:127], v[96:111]
  ds_read_b64_tr_b16 v[36:37], v21 offset:51136
  ds_read_b64_tr_b16 v[38:39], v21 offset:52288
  s_waitcnt lgkmcnt(6)
  v_mfma_f32_32x32x16_bf16 v[112:127], v[24:27], a[124:127], v[112:127]
  ds_read_b64_tr_b16 v[40:41], v21 offset:51168
  ds_read_b64_tr_b16 v[42:43], v21 offset:52320
  s_waitcnt lgkmcnt(6)
  v_mfma_f32_32x32x16_bf16 v[128:143], v[28:31], a[124:127], v[128:143]
  ds_read_b64_tr_b16 v[44:45], v21 offset:51200
  ds_read_b64_tr_b16 v[46:47], v21 offset:52352
  s_waitcnt lgkmcnt(6)
  v_mfma_f32_32x32x16_bf16 v[144:159], v[32:35], a[124:127], v[144:159]
  s_waitcnt vmcnt(9) lgkmcnt(0)
  s_barrier
  ds_read_b64_tr_b16 v[24:25], v20 offset:0
  ds_read_b64_tr_b16 v[26:27], v20 offset:1152
  v_mfma_f32_32x32x16_bf16 v[160:175], v[36:39], a[124:127], v[160:175]
  ds_read_b64_tr_b16 v[28:29], v20 offset:32
  ds_read_b64_tr_b16 v[30:31], v20 offset:1184
  v_mfma_f32_32x32x16_bf16 v[176:191], v[40:43], a[124:127], v[176:191]
  ds_read_b64_tr_b16 v[32:33], v20 offset:64
  ds_read_b64_tr_b16 v[34:35], v20 offset:1216
  v_mfma_f32_32x32x16_bf16 v[192:207], v[44:47], a[124:127], v[192:207]
  ds_read_b64_tr_b16 v[36:37], v20 offset:96
  ds_read_b64_tr_b16 v[38:39], v20 offset:1248
  s_waitcnt lgkmcnt(6)
  v_mfma_f32_32x32x16_bf16 v[64:79], v[24:27], a[128:131], v[64:79]
  ds_read_b64_tr_b16 v[40:41], v20 offset:128
  ds_read_b64_tr_b16 v[42:43], v20 offset:1280
  s_add_u32 m0, s24, 74240
  s_nop 0
  buffer_load_dwordx4 v10, s[4:7], s22 offen lds
  s_waitcnt lgkmcnt(6)
  v_mfma_f32_32x32x16_bf16 v[80:95], v[28:31], a[128:131], v[80:95]
  ds_read_b64_tr_b16 v[44:45], v20 offset:160
  ds_read_b64_tr_b16 v[46:47], v20 offset:1312
  s_waitcnt lgkmcnt(6)
  v_mfma_f32_32x32x16_bf16 v[96:111], v[32:35], a[128:131], v[96:111]
  ds_read_b64_tr_b16 v[24:25], v20 offset:192
  ds_read_b64_tr_b16 v[26:27], v20 offset:1344
  s_add_u32 m0, s24, 75264
  s_nop 0
  buffer_load_dwordx4 v11, s[4:7], s22 offen lds
  s_waitcnt lgkmcnt(6)
  v_mfma_f32_32x32x16_bf16 v[112:127], v[36:39], a[128:131], v[112:127]
  ds_read_b64_tr_b16 v[28:29], v20 offset:224
  ds_read_b64_tr_b16 v[30:31], v20 offset:1376
  s_waitcnt lgkmcnt(6)
  v_mfma_f32_32x32x16_bf16 v[128:143], v[40:43], a[128:131], v[128:143]
  ds_read_b64_tr_b16 v[32:33], v20 offset:256
  ds_read_b64_tr_b16 v[34:35], v20 offset:1408
  s_add_u32 m0, s24, 76288
  s_nop 0
  buffer_load_dwordx4 v12, s[4:7], s22 offen lds
  s_waitcnt lgkmcnt(6)
  v_mfma_f32_32x32x16_bf16 v[144:159], v[44:47], a[128:131], v[144:159]
  ds_read_b64_tr_b16 v[36:37], v20 offset:4608
  ds_read_b64_tr_b16 v[38:39], v20 offset:5760
  s_waitcnt lgkmcnt(6)
  v_mfma_f32_32x32x16_bf16 v[160:175], v[24:27], a[128:131], v[160:175]
  ds_read_b64_tr_b16 v[40:41], v20 offset:4640
  ds_read_b64_tr_b16 v[42:43], v20 offset:5792
  s_add_u32 m0, s24, 77312
  s_nop 0
  buffer_load_dwordx4 v13, s[4:7], s22 offen lds
  s_waitcnt lgkmcnt(6)
  v_mfma_f32_32x32x16_bf16 v[176:191], v[28:31], a[128:131], v[176:191]
  ds_read_b64_tr_b16 v[44:45], v20 offset:4672
  ds_read_b64_tr_b16 v[46:47], v20 offset:5824
  s_waitcnt lgkmcnt(6)
  v_mfma_f32_32x32x16_bf16 v[192:207], v[32:35], a[128:131], v[192:207]
  ds_read_b64_tr_b16 v[24:25], v20 offset:4704
  ds_read_b64_tr_b16 v[26:27], v20 offset:5856
  s_add_u32 m0, s24, 78336
  s_nop 0
  buffer_load_dwordx4 v14, s[4:7], s22 offen lds
  s_waitcnt lgkmcnt(6)
  v_mfma_f32_32x32x16_bf16 v[64:79], v[36:39], a[132:135], v[64:79]
  ds_read_b64_tr_b16 v[28:29], v20 offset:4736
  ds_read_b64_tr_b16 v[30:31], v20 offset:5888
  s_waitcnt lgkmcnt(6)
  v_mfma_f32_32x32x16_bf16 v[80:95], v[40:43], a[132:135], v[80:95]
  ds_read_b64_tr_b16 v[32:33], v20 offset:4768
  ds_read_b64_tr_b16 v[34:35], v20 offset:5920
  s_add_u32 m0, s24, 79360
  s_nop 0
  buffer_load_dwordx4 v15, s[4:7], s22 offen lds
  s_waitcnt lgkmcnt(6)
  v_mfma_f32_32x32x16_bf16 v[96:111], v[44:47], a[132:135], v[96:111]
  ds_read_b64_tr_b16 v[36:37], v20 offset:4800
  ds_read_b64_tr_b16 v[38:39], v20 offset:5952
  s_waitcnt lgkmcnt(6)
  v_mfma_f32_32x32x16_bf16 v[112:127], v[24:27], a[132:135], v[112:127]
  ds_read_b64_tr_b16 v[40:41], v20 offset:4832
  ds_read_b64_tr_b16 v[42:43], v20 offset:5984
  s_add_u32 m0, s24, 80384
  s_nop 0
  buffer_load_dwordx4 v16, s[4:7], s22 offen lds
  s_waitcnt lgkmcnt(6)
  v_mfma_f32_32x32x16_bf16 v[128:143], v[28:31], a[132:135], v[128:143]
  ds_read_b64_tr_b16 v[44:45], v20 offset:4864
  ds_read_b64_tr_b16 v[46:47], v20 offset:6016
  s_waitcnt lgkmcnt(6)
  v_mfma_f32_32x32x16_bf16 v[144:159], v[32:35], a[132:135], v[144:159]
  ds_read_b64_tr_b16 v[24:25], v20 offset:9216
  ds_read_b64_tr_b16 v[26:27], v20 offset:10368
  s_add_u32 m0, s24, 81408
  s_nop 0
  buffer_load_dwordx4 v17, s[4:7], s22 offen lds
  s_waitcnt lgkmcnt(6)
  v_mfma_f32_32x32x16_bf16 v[160:175], v[36:39], a[132:135], v[160:175]
  ds_read_b64_tr_b16 v[28:29], v20 offset:9248
  ds_read_b64_tr_b16 v[30:31], v20 offset:10400
  s_waitcnt lgkmcnt(6)
  v_mfma_f32_32x32x16_bf16 v[176:191], v[40:43], a[132:135], v[176:191]
  ds_read_b64_tr_b16 v[32:33], v20 offset:9280
  ds_read_b64_tr_b16 v[34:35], v20 offset:10432
  s_add_u32 m0, s24, 82432
  s_nop 0
  buffer_load_dwordx4 v18, s[4:7], s22 offen lds
  s_add_u32 s22, s22, 589824
  s_waitcnt lgkmcnt(6)
  v_mfma_f32_32x32x16_bf16 v[192:207], v[44:47], a[132:135], v[192:207]
  ds_read_b64_tr_b16 v[36:37], v20 offset:9312
  ds_read_b64_tr_b16 v[38:39], v20 offset:10464
  s_waitcnt lgkmcnt(6)
  v_mfma_f32_32x32x16_bf16 v[64:79], v[24:27], a[136:139], v[64:79]
  ds_read_b64_tr_b16 v[40:41], v20 offset:9344
  ds_read_b64_tr_b16 v[42:43], v20 offset:10496
  s_waitcnt lgkmcnt(6)
  v_mfma_f32_32x32x16_bf16 v[80:95], v[28:31], a[136:139], v[80:95]
  ds_read_b64_tr_b16 v[44:45], v20 offset:9376
  ds_read_b64_tr_b16 v[46:47], v20 offset:10528
  s_waitcnt lgkmcnt(6)
  v_mfma_f32_32x32x16_bf16 v[96:111], v[32:35], a[136:139], v[96:111]
  ds_read_b64_tr_b16 v[24:25], v20 offset:9408
  ds_read_b64_tr_b16 v[26:27], v20 offset:10560
  s_waitcnt lgkmcnt(6)
  v_mfma_f32_32x32x16_bf16 v[112:127], v[36:39], a[136:139], v[112:127]
  ds_read_b64_tr_b16 v[28:29], v20 offset:9440
  ds_read_b64_tr_b16 v[30:31], v20 offset:10592
  s_waitcnt lgkmcnt(6)
  v_mfma_f32_32x32x16_bf16 v[128:143], v[40:43], a[136:139], v[128:143]
  ds_read_b64_tr_b16 v[32:33], v20 offset:9472
  ds_read_b64_tr_b16 v[34:35], v20 offset:10624
  s_waitcnt lgkmcnt(6)
  v_mfma_f32_32x32x16_bf16 v[144:159], v[44:47], a[136:139], v[144:159]
  ds_read_b64_tr_b16 v[36:37], v20 offset:13824
  ds_read_b64_tr_b16 v[38:39], v20 offset:14976
  s_waitcnt lgkmcnt(6)
  v_mfma_f32_32x32x16_bf16 v[160:175], v[24:27], a[136:139], v[160:175]
  ds_read_b64_tr_b16 v[40:41], v20 offset:13856
  ds_read_b64_tr_b16 v[42:43], v20 offset:15008
  s_waitcnt lgkmcnt(6)
  v_mfma_f32_32x32x16_bf16 v[176:191], v[28:31], a[136:139], v[176:191]
  ds_read_b64_tr_b16 v[44:45], v20 offset:13888
  ds_read_b64_tr_b16 v[46:47], v20 offset:15040
  s_waitcnt lgkmcnt(6)
  v_mfma_f32_32x32x16_bf16 v[192:207], v[32:35], a[136:139], v[192:207]
  ds_read_b64_tr_b16 v[24:25], v20 offset:13920
  ds_read_b64_tr_b16 v[26:27], v20 offset:15072
  s_waitcnt lgkmcnt(6)
  v_mfma_f32_32x32x16_bf16 v[64:79], v[36:39], a[140:143], v[64:79]
  ds_read_b64_tr_b16 v[28:29], v20 offset:13952
  ds_read_b64_tr_b16 v[30:31], v20 offset:15104
  s_waitcnt lgkmcnt(6)
  v_mfma_f32_32x32x16_bf16 v[80:95], v[40:43], a[140:143], v[80:95]
  ds_read_b64_tr_b16 v[32:33], v20 offset:13984
  ds_read_b64_tr_b16 v[34:35], v20 offset:15136
  s_waitcnt lgkmcnt(6)
  v_mfma_f32_32x32x16_bf16 v[96:111], v[44:47], a[140:143], v[96:111]
  ds_read_b64_tr_b16 v[36:37], v20 offset:14016
  ds_read_b64_tr_b16 v[38:39], v20 offset:15168
  s_waitcnt lgkmcnt(6)
  v_mfma_f32_32x32x16_bf16 v[112:127], v[24:27], a[140:143], v[112:127]
  ds_read_b64_tr_b16 v[40:41], v20 offset:14048
  ds_read_b64_tr_b16 v[42:43], v20 offset:15200
  s_waitcnt lgkmcnt(6)
  v_mfma_f32_32x32x16_bf16 v[128:143], v[28:31], a[140:143], v[128:143]
  ds_read_b64_tr_b16 v[44:45], v20 offset:14080
  ds_read_b64_tr_b16 v[46:47], v20 offset:15232
  s_waitcnt lgkmcnt(6)
  v_mfma_f32_32x32x16_bf16 v[144:159], v[32:35], a[140:143], v[144:159]
  s_waitcnt lgkmcnt(4)
  v_mfma_f32_32x32x16_bf16 v[160:175], v[36:39], a[140:143], v[160:175]
  s_waitcnt lgkmcnt(2)
  v_mfma_f32_32x32x16_bf16 v[176:191], v[40:43], a[140:143], v[176:191]
  s_waitcnt lgkmcnt(0)
  v_mfma_f32_32x32x16_bf16 v[192:207], v[44:47], a[140:143], v[192:207]
  s_waitcnt vmcnt(9) lgkmcnt(0)
  s_barrier
  ds_read_b64_tr_b16 v[24:25], v20 offset:37120
  ds_read_b64_tr_b16 v[26:27], v20 offset:38272
  ds_read_b64_tr_b16 v[28:29], v20 offset:37152
  ds_read_b64_tr_b16 v[30:31], v20 offset:38304
  ds_read_b64_tr_b16 v[32:33], v20 offset:37184
  ds_read_b64_tr_b16 v[34:35], v20 offset:38336
  ds_read_b64_tr_b16 v[36:37], v20 offset:37216
  ds_read_b64_tr_b16 v[38:39], v20 offset:38368
  s_waitcnt lgkmcnt(6)
  v_mfma_f32_32x32x16_bf16 a[144:159], v[24:27], a[0:3], 0
  ds_read_b64_tr_b16 v[40:41], v20 offset:37248
  ds_read_b64_tr_b16 v[42:43], v20 offset:38400
  s_add_u32 m0, s24, 111360
  s_nop 0
  buffer_load_dwordx4 v10, s[4:7], s22 offen lds
  v_mul_f32 v56, 0xbfb8aa3b, v64
  v_mul_f32 v57, 0xbfb8aa3b, v65
  s_waitcnt lgkmcnt(6)
  v_mfma_f32_32x32x16_bf16 a[160:175], v[28:31], a[0:3], 0
  ds_read_b64_tr_b16 v[44:45], v20 offset:37280
  ds_read_b64_tr_b16 v[46:47], v20 offset:38432
  v_exp_f32 v56, v56
  v_exp_f32 v57, v57
  s_waitcnt lgkmcnt(6)
  v_mfma_f32_32x32x16_bf16 a[176:191], v[32:35], a[0:3], 0
  ds_read_b64_tr_b16 v[24:25], v20 offset:37312
  ds_read_b64_tr_b16 v[26:27], v20 offset:38464
  s_add_u32 m0, s24, 112384
  s_nop 0
  buffer_load_dwordx4 v11, s[4:7], s22 offen lds
  v_mul_f32 v72, v64, v72
  v_mul_f32 v73, v65, v73
  s_waitcnt lgkmcnt(6)
  v_mfma_f32_32x32x16_bf16 a[192:207], v[36:39], a[0:3], 0
  ds_read_b64_tr_b16 v[28:29], v20 offset:37344
  ds_read_b64_tr_b16 v[30:31], v20 offset:38496
  v_add_f32 v56, 1.0, v56
  v_add_f32 v57, 1.0, v57
  s_waitcnt lgkmcnt(6)
  v_mfma_f32_32x32x16_bf16 a[208:223], v[40:43], a[0:3], 0
  ds_read_b64_tr_b16 v[32:33], v20 offset:37376
  ds_read_b64_tr_b16 v[34:35], v20 offset:38528
  s_add_u32 m0, s24, 113408
  s_nop 0
  buffer_load_dwordx4 v12, s[4:7], s22 offen lds
  v_rcp_f32 v56, v56
  v_rcp_f32 v57, v57
  s_waitcnt lgkmcnt(6)
  v_mfma_f32_32x32x16_bf16 a[224:239], v[44:47], a[0:3], 0
  ds_read_b64_tr_b16 v[36:37], v20 offset:41728
  ds_read_b64_tr_b16 v[38:39], v20 offset:42880
  v_mul_f32 v64, v72, v56
  v_mul_f32 v65, v73, v57
  s_waitcnt lgkmcnt(6)
  v_mfma_f32_32x32x16_bf16 a[240:255], v[24:27], a[0:3], 0
  ds_read_b64_tr_b16 v[40:41], v20 offset:41760
  ds_read_b64_tr_b16 v[42:43], v20 offset:42912
  s_add_u32 m0, s24, 114432
  s_nop 0
  buffer_load_dwordx4 v13, s[4:7], s22 offen lds
  v_cvt_pk_bf16_f32 v48, v64, v65
  v_mul_f32 v58, 0xbfb8aa3b, v66
  s_waitcnt lgkmcnt(6)
  v_mfma_f32_32x32x16_bf16 v[208:223], v[28:31], a[0:3], 0
  ds_read_b64_tr_b16 v[44:45], v20 offset:41792
  ds_read_b64_tr_b16 v[46:47], v20 offset:42944
  v_mul_f32 v59, 0xbfb8aa3b, v67
  v_exp_f32 v58, v58
  s_waitcnt lgkmcnt(6)
  v_mfma_f32_32x32x16_bf16 v[224:239], v[32:35], a[0:3], 0
  ds_read_b64_tr_b16 v[24:25], v20 offset:41824
  ds_read_b64_tr_b16 v[26:27], v20 offset:42976
  s_add_u32 m0, s24, 115456
  s_nop 0
  buffer_load_dwordx4 v14, s[4:7], s22 offen lds
  v_exp_f32 v59, v59
  v_mul_f32 v74, v66, v74
  s_waitcnt lgkmcnt(6)
  v_mfma_f32_32x32x16_bf16 a[144:159], v[36:39], a[4:7], a[144:159]
  ds_read_b64_tr_b16 v[28:29], v20 offset:41856
  ds_read_b64_tr_b16 v[30:31], v20 offset:43008
  v_mul_f32 v75, v67, v75
  v_add_f32 v58, 1.0, v58
  s_waitcnt lgkmcnt(6)
  v_mfma_f32_32x32x16_bf16 a[160:175], v[40:43], a[4:7], a[160:175]
  ds_read_b64_tr_b16 v[32:33], v20 offset:41888
  ds_read_b64_tr_b16 v[34:35], v20 offset:43040
  s_add_u32 m0, s24, 116480
  s_nop 0
  buffer_load_dwordx4 v15, s[4:7], s22 offen lds
  v_add_f32 v59, 1.0, v59
  v_rcp_f32 v58, v58
  s_waitcnt lgkmcnt(6)
  v_mfma_f32_32x32x16_bf16 a[176:191], v[44:47], a[4:7], a[176:191]
  ds_read_b64_tr_b16 v[36:37], v20 offset:41920
  ds_read_b64_tr_b16 v[38:39], v20 offset:43072
  v_rcp_f32 v59, v59
  v_mul_f32 v66, v74, v58
  s_waitcnt lgkmcnt(6)
  v_mfma_f32_32x32x16_bf16 a[192:207], v[24:27], a[4:7], a[192:207]
  ds_read_b64_tr_b16 v[40:41], v20 offset:41952
  ds_read_b64_tr_b16 v[42:43], v20 offset:43104
  s_add_u32 m0, s24, 117504
  s_nop 0
  buffer_load_dwordx4 v16, s[4:7], s22 offen lds
  v_mul_f32 v67, v75, v59
  v_cvt_pk_bf16_f32 v49, v66, v67
  s_waitcnt lgkmcnt(6)
  v_mfma_f32_32x32x16_bf16 a[208:223], v[28:31], a[4:7], a[208:223]
  ds_read_b64_tr_b16 v[44:45], v20 offset:41984
  ds_read_b64_tr_b16 v[46:47], v20 offset:43136
  v_mul_f32 v56, 0xbfb8aa3b, v68
  v_mul_f32 v57, 0xbfb8aa3b, v69
  s_waitcnt lgkmcnt(6)
  v_mfma_f32_32x32x16_bf16 a[224:239], v[32:35], a[4:7], a[224:239]
  ds_read_b64_tr_b16 v[24:25], v20 offset:46336
  ds_read_b64_tr_b16 v[26:27], v20 offset:47488
  s_add_u32 m0, s24, 118528
  s_nop 0
  buffer_load_dwordx4 v17, s[4:7], s22 offen lds
  v_exp_f32 v56, v56
  v_exp_f32 v57, v57
  s_waitcnt lgkmcnt(6)
  v_mfma_f32_32x32x16_bf16 a[240:255], v[36:39], a[4:7], a[240:255]
  ds_read_b64_tr_b16 v[28:29], v20 offset:46368
  ds_read_b64_tr_b16 v[30:31], v20 offset:47520
  v_mul_f32 v76, v68, v76
  v_mul_f32 v77, v69, v77
  s_waitcnt lgkmcnt(6)
  v_mfma_f32_32x32x16_bf16 v[208:223], v[40:43], a[4:7], v[208:223]
  ds_read_b64_tr_b16 v[32:33], v20 offset:46400
  ds_read_b64_tr_b16 v[34:35], v20 offset:47552
  s_add_u32 m0, s24, 119552
  s_nop 0
  buffer_load_dwordx4 v18, s[4:7], s22 offen lds
  s_add_u32 s22, s22, 589824
  v_add_f32 v56, 1.0, v56
  v_add_f32 v57, 1.0, v57
  s_waitcnt lgkmcnt(6)
  v_mfma_f32_32x32x16_bf16 v[224:239], v[44:47], a[4:7], v[224:239]
  ds_read_b64_tr_b16 v[36:37], v20 offset:46432
  ds_read_b64_tr_b16 v[38:39], v20 offset:47584
  v_rcp_f32 v56, v56
  v_rcp_f32 v57, v57
  s_waitcnt lgkmcnt(6)
  v_mfma_f32_32x32x16_bf16 a[144:159], v[24:27], a[8:11], a[144:159]
  ds_read_b64_tr_b16 v[40:41], v20 offset:46464
  ds_read_b64_tr_b16 v[42:43], v20 offset:47616
  v_mul_f32 v68, v76, v56
  v_mul_f32 v69, v77, v57
  s_waitcnt lgkmcnt(6)
  v_mfma_f32_32x32x16_bf16 a[160:175], v[28:31], a[8:11], a[160:175]
  ds_read_b64_tr_b16 v[44:45], v20 offset:46496
  ds_read_b64_tr_b16 v[46:47], v20 offset:47648
  v_cvt_pk_bf16_f32 v50, v68, v69
  v_mul_f32 v58, 0xbfb8aa3b, v70
  s_waitcnt lgkmcnt(6)
  v_mfma_f32_32x32x16_bf16 a[176:191], v[32:35], a[8:11], a[176:191]
  ds_read_b64_tr_b16 v[24:25], v20 offset:46528
  ds_read_b64_tr_b16 v[26:27], v20 offset:47680
  v_mul_f32 v59, 0xbfb8aa3b, v71
  v_exp_f32 v58, v58
  s_waitcnt lgkmcnt(6)
  v_mfma_f32_32x32x16_bf16 a[192:207], v[36:39], a[8:11], a[192:207]
  ds_read_b64_tr_b16 v[28:29], v20 offset:46560
  ds_read_b64_tr_b16 v[30:31], v20 offset:47712
  v_exp_f32 v59, v59
  v_mul_f32 v78, v70, v78
  s_waitcnt lgkmcnt(6)
  v_mfma_f32_32x32x16_bf16 a[208:223], v[40:43], a[8:11], a[208:223]
  ds_read_b64_tr_b16 v[32:33], v20 offset:46592
  ds_read_b64_tr_b16 v[34:35], v20 offset:47744
  v_mul_f32 v79, v71, v79
  v_add_f32 v58, 1.0, v58
  s_waitcnt lgkmcnt(6)
  v_mfma_f32_32x32x16_bf16 a[224:239], v[44:47], a[8:11], a[224:239]
  ds_read_b64_tr_b16 v[36:37], v20 offset:50944
  ds_read_b64_tr_b16 v[38:39], v20 offset:52096
  v_add_f32 v59, 1.0, v59
  v_rcp_f32 v58, v58
  s_waitcnt lgkmcnt(6)
  v_mfma_f32_32x32x16_bf16 a[240:255], v[24:27], a[8:11], a[240:255]
  ds_read_b64_tr_b16 v[40:41], v20 offset:50976
  ds_read_b64_tr_b16 v[42:43], v20 offset:52128
  v_rcp_f32 v59, v59
  v_mul_f32 v70, v78, v58
  s_waitcnt lgkmcnt(6)
  v_mfma_f32_32x32x16_bf16 v[208:223], v[28:31], a[8:11], v[208:223]
  ds_read_b64_tr_b16 v[44:45], v20 offset:51008
  ds_read_b64_tr_b16 v[46:47], v20 offset:52160
  v_mul_f32 v71, v79, v59
  v_cvt_pk_bf16_f32 v51, v70, v71
  s_waitcnt lgkmcnt(6)
  v_mfma_f32_32x32x16_bf16 v[224:239], v[32:35], a[8:11], v[224:239]
  ds_read_b64_tr_b16 v[24:25], v20 offset:51040
  ds_read_b64_tr_b16 v[26:27], v20 offset:52192
  buffer_store_dwordx4 v[48:51], v1, s[12:15], s25 offen offset:0 sc0 sc1
  v_mul_f32 v56, 0xbfb8aa3b, v80
  s_waitcnt lgkmcnt(6)
  v_mfma_f32_32x32x16_bf16 a[144:159], v[36:39], a[12:15], a[144:159]
  ds_read_b64_tr_b16 v[28:29], v20 offset:51072
  ds_read_b64_tr_b16 v[30:31], v20 offset:52224
  v_mul_f32 v57, 0xbfb8aa3b, v81
  v_exp_f32 v56, v56
  s_waitcnt lgkmcnt(6)
  v_mfma_f32_32x32x16_bf16 a[160:175], v[40:43], a[12:15], a[160:175]
  ds_read_b64_tr_b16 v[32:33], v20 offset:51104
  ds_read_b64_tr_b16 v[34:35], v20 offset:52256
  v_exp_f32 v57, v57
  v_mul_f32 v88, v80, v88
  s_waitcnt lgkmcnt(6)
  v_mfma_f32_32x32x16_bf16 a[176:191], v[44:47], a[12:15], a[176:191]
  ds_read_b64_tr_b16 v[36:37], v20 offset:51136
  ds_read_b64_tr_b16 v[38:39], v20 offset:52288
  v_mul_f32 v89, v81, v89
  v_add_f32 v56, 1.0, v56
  s_waitcnt lgkmcnt(6)
  v_mfma_f32_32x32x16_bf16 a[192:207], v[24:27], a[12:15], a[192:207]
  ds_read_b64_tr_b16 v[40:41], v20 offset:51168
  ds_read_b64_tr_b16 v[42:43], v20 offset:52320
  v_add_f32 v57, 1.0, v57
  v_rcp_f32 v56, v56
  s_waitcnt lgkmcnt(6)
  v_mfma_f32_32x32x16_bf16 a[208:223], v[28:31], a[12:15], a[208:223]
  ds_read_b64_tr_b16 v[44:45], v20 offset:51200
  ds_read_b64_tr_b16 v[46:47], v20 offset:52352
  v_rcp_f32 v57, v57
  v_mul_f32 v80, v88, v56
  s_waitcnt lgkmcnt(6)
  v_mfma_f32_32x32x16_bf16 a[224:239], v[32:35], a[12:15], a[224:239]
  s_waitcnt vmcnt(10) lgkmcnt(0)
  s_barrier
  ds_read_b64_tr_b16 v[24:25], v21 offset:0
  ds_read_b64_tr_b16 v[26:27], v21 offset:1152
  v_mul_f32 v81, v89, v57
  v_cvt_pk_bf16_f32 v52, v80, v81
  v_mfma_f32_32x32x16_bf16 a[240:255], v[36:39], a[12:15], a[240:255]
  ds_read_b64_tr_b16 v[28:29], v21 offset:32
  ds_read_b64_tr_b16 v[30:31], v21 offset:1184
  v_mul_f32 v58, 0xbfb8aa3b, v82
  v_mul_f32 v59, 0xbfb8aa3b, v83
  v_mfma_f32_32x32x16_bf16 v[208:223], v[40:43], a[12:15], v[208:223]
  ds_read_b64_tr_b16 v[32:33], v21 offset:64
  ds_read_b64_tr_b16 v[34:35], v21 offset:1216
  v_exp_f32 v58, v58
  v_exp_f32 v59, v59
  v_mfma_f32_32x32x16_bf16 v[224:239], v[44:47], a[12:15], v[224:239]
  ds_read_b64_tr_b16 v[36:37], v21 offset:96
  ds_read_b64_tr_b16 v[38:39], v21 offset:1248
  v_mul_f32 v90, v82, v90
  v_mul_f32 v91, v83, v91
  s_waitcnt lgkmcnt(6)
  v_mfma_f32_32x32x16_bf16 a[144:159], v[24:27], a[16:19], a[144:159]
  ds_read_b64_tr_b16 v[40:41], v21 offset:128
  ds_read_b64_tr_b16 v[42:43], v21 offset:1280
  s_add_u32 m0, s24, 0
  s_nop 0
  buffer_load_dwordx4 v10, s[4:7], s22 offen lds
  v_add_f32 v58, 1.0, v58
  v_add_f32 v59, 1.0, v59
  s_waitcnt lgkmcnt(6)
  v_mfma_f32_32x32x16_bf16 a[160:175], v[28:31], a[16:19], a[160:175]
  ds_read_b64_tr_b16 v[44:45], v21 offset:160
  ds_read_b64_tr_b16 v[46:47], v21 offset:1312
  v_rcp_f32 v58, v58
  v_rcp_f32 v59, v59
  s_waitcnt lgkmcnt(6)
  v_mfma_f32_32x32x16_bf16 a[176:191], v[32:35], a[16:19], a[176:191]
  ds_read_b64_tr_b16 v[24:25], v21 offset:192
  ds_read_b64_tr_b16 v[26:27], v21 offset:1344
  s_add_u32 m0, s24, 1024
  s_nop 0
  buffer_load_dwordx4 v11, s[4:7], s22 offen lds
  v_mul_f32 v82, v90, v58
  v_mul_f32 v83, v91, v59
  s_waitcnt lgkmcnt(6)
  v_mfma_f32_32x32x16_bf16 a[192:207], v[36:39], a[16:19], a[192:207]
  ds_read_b64_tr_b16 v[28:29], v21 offset:224
  ds_read_b64_tr_b16 v[30:31], v21 offset:1376
  v_cvt_pk_bf16_f32 v53, v82, v83
  v_mul_f32 v56, 0xbfb8aa3b, v84
  s_waitcnt lgkmcnt(6)
  v_mfma_f32_32x32x16_bf16 a[208:223], v[40:43], a[16:19], a[208:223]
  ds_read_b64_tr_b16 v[32:33], v21 offset:256
  ds_read_b64_tr_b16 v[34:35], v21 offset:1408
  s_add_u32 m0, s24, 2048
  s_nop 0
  buffer_load_dwordx4 v12, s[4:7], s22 offen lds
  v_mul_f32 v57, 0xbfb8aa3b, v85
  s_waitcnt lgkmcnt(6)
  v_mfma_f32_32x32x16_bf16 a[224:239], v[44:47], a[16:19], a[224:239]
  ds_read_b64_tr_b16 v[36:37], v21 offset:4608
  ds_read_b64_tr_b16 v[38:39], v21 offset:5760
  v_exp_f32 v56, v56
  v_exp_f32 v57, v57
  s_waitcnt lgkmcnt(6)
  v_mfma_f32_32x32x16_bf16 a[240:255], v[24:27], a[16:19], a[240:255]
  ds_read_b64_tr_b16 v[40:41], v21 offset:4640
  ds_read_b64_tr_b16 v[42:43], v21 offset:5792
  s_add_u32 m0, s24, 3072
  s_nop 0
  buffer_load_dwordx4 v13, s[4:7], s22 offen lds
  v_mul_f32 v92, v84, v92
  v_mul_f32 v93, v85, v93
  s_waitcnt lgkmcnt(6)
  v_mfma_f32_32x32x16_bf16 v[208:223], v[28:31], a[16:19], v[208:223]
  ds_read_b64_tr_b16 v[44:45], v21 offset:4672
  ds_read_b64_tr_b16 v[46:47], v21 offset:5824
  v_add_f32 v56, 1.0, v56
  v_add_f32 v57, 1.0, v57
  s_waitcnt lgkmcnt(6)
  v_mfma_f32_32x32x16_bf16 v[224:239], v[32:35], a[16:19], v[224:239]
  ds_read_b64_tr_b16 v[24:25], v21 offset:4704
  ds_read_b64_tr_b16 v[26:27], v21 offset:5856
  s_add_u32 m0, s24, 4096
  s_nop 0
  buffer_load_dwordx4 v14, s[4:7], s22 offen lds
  v_rcp_f32 v56, v56
  v_rcp_f32 v57, v57
  s_waitcnt lgkmcnt(6)
  v_mfma_f32_32x32x16_bf16 a[144:159], v[36:39], a[20:23], a[144:159]
  ds_read_b64_tr_b16 v[28:29], v21 offset:4736
  ds_read_b64_tr_b16 v[30:31], v21 offset:5888
  v_mul_f32 v84, v92, v56
  v_mul_f32 v85, v93, v57
  s_waitcnt lgkmcnt(6)
  v_mfma_f32_32x32x16_bf16 a[160:175], v[40:43], a[20:23], a[160:175]
  ds_read_b64_tr_b16 v[32:33], v21 offset:4768
  ds_read_b64_tr_b16 v[34:35], v21 offset:5920
  s_add_u32 m0, s24, 5120
  s_nop 0
  buffer_load_dwordx4 v15, s[4:7], s22 offen lds
  v_cvt_pk_bf16_f32 v54, v84, v85
  v_mul_f32 v58, 0xbfb8aa3b, v86
  s_waitcnt lgkmcnt(6)
  v_mfma_f32_32x32x16_bf16 a[176:191], v[44:47], a[20:23], a[176:191]
  ds_read_b64_tr_b16 v[36:37], v21 offset:4800
  ds_read_b64_tr_b16 v[38:39], v21 offset:5952
  v_mul_f32 v59, 0xbfb8aa3b, v87
  v_exp_f32 v58, v58
  s_waitcnt lgkmcnt(6)
  v_mfma_f32_32x32x16_bf16 a[192:207], v[24:27], a[20:23], a[192:207]
  ds_read_b64_tr_b16 v[40:41], v21 offset:4832
  ds_read_b64_tr_b16 v[42:43], v21 offset:5984
  s_add_u32 m0, s24, 6144
  s_nop 0
  buffer_load_dwordx4 v16, s[4:7], s22 offen lds
  v_exp_f32 v59, v59
  v_mul_f32 v94, v86, v94
  s_waitcnt lgkmcnt(6)
  v_mfma_f32_32x32x16_bf16 a[208:223], v[28:31], a[20:23], a[208:223]
  ds_read_b64_tr_b16 v[44:45], v21 offset:4864
  ds_read_b64_tr_b16 v[46:47], v21 offset:6016
  v_mul_f32 v95, v87, v95
  v_add_f32 v58, 1.0, v58
  s_waitcnt lgkmcnt(6)
  v_mfma_f32_32x32x16_bf16 a[224:239], v[32:35], a[20:23], a[224:239]
  ds_read_b64_tr_b16 v[24:25], v21 offset:9216
  ds_read_b64_tr_b16 v[26:27], v21 offset:10368
  s_add_u32 m0, s24, 7168
  s_nop 0
  buffer_load_dwordx4 v17, s[4:7], s22 offen lds
  v_add_f32 v59, 1.0, v59
  v_rcp_f32 v58, v58
  s_waitcnt lgkmcnt(6)
  v_mfma_f32_32x32x16_bf16 a[240:255], v[36:39], a[20:23], a[240:255]
  ds_read_b64_tr_b16 v[28:29], v21 offset:9248
  ds_read_b64_tr_b16 v[30:31], v21 offset:10400
  v_rcp_f32 v59, v59
  v_mul_f32 v86, v94, v58
  s_waitcnt lgkmcnt(6)
  v_mfma_f32_32x32x16_bf16 v[208:223], v[40:43], a[20:23], v[208:223]
  ds_read_b64_tr_b16 v[32:33], v21 offset:9280
  ds_read_b64_tr_b16 v[34:35], v21 offset:10432
  s_add_u32 m0, s24, 8192
  s_nop 0
  buffer_load_dwordx4 v18, s[4:7], s22 offen lds
  s_add_u32 s22, s22, 589824
  v_mul_f32 v87, v95, v59
  v_cvt_pk_bf16_f32 v55, v86, v87
  s_waitcnt lgkmcnt(6)
  v_mfma_f32_32x32x16_bf16 v[224:239], v[44:47], a[20:23], v[224:239]
  ds_read_b64_tr_b16 v[36:37], v21 offset:9312
  ds_read_b64_tr_b16 v[38:39], v21 offset:10464
  buffer_store_dwordx4 v[52:55], v1, s[12:15], s25 offen offset:1024 sc0 sc1
  v_mul_f32 v56, 0xbfb8aa3b, v96
  s_waitcnt lgkmcnt(6)
  v_mfma_f32_32x32x16_bf16 a[144:159], v[24:27], a[24:27], a[144:159]
  ds_read_b64_tr_b16 v[40:41], v21 offset:9344
  ds_read_b64_tr_b16 v[42:43], v21 offset:10496
  v_mul_f32 v57, 0xbfb8aa3b, v97
  v_exp_f32 v56, v56
  s_waitcnt lgkmcnt(6)
  v_mfma_f32_32x32x16_bf16 a[160:175], v[28:31], a[24:27], a[160:175]
  ds_read_b64_tr_b16 v[44:45], v21 offset:9376
  ds_read_b64_tr_b16 v[46:47], v21 offset:10528
  v_exp_f32 v57, v57
  v_mul_f32 v104, v96, v104
  s_waitcnt lgkmcnt(6)
  v_mfma_f32_32x32x16_bf16 a[176:191], v[32:35], a[24:27], a[176:191]
  ds_read_b64_tr_b16 v[24:25], v21 offset:9408
  ds_read_b64_tr_b16 v[26:27], v21 offset:10560
  v_mul_f32 v105, v97, v105
  v_add_f32 v56, 1.0, v56
  s_waitcnt lgkmcnt(6)
  v_mfma_f32_32x32x16_bf16 a[192:207], v[36:39], a[24:27], a[192:207]
  ds_read_b64_tr_b16 v[28:29], v21 offset:9440
  ds_read_b64_tr_b16 v[30:31], v21 offset:10592
  v_add_f32 v57, 1.0, v57
  v_rcp_f32 v56, v56
  s_waitcnt lgkmcnt(6)
  v_mfma_f32_32x32x16_bf16 a[208:223], v[40:43], a[24:27], a[208:223]
  ds_read_b64_tr_b16 v[32:33], v21 offset:9472
  ds_read_b64_tr_b16 v[34:35], v21 offset:10624
  v_rcp_f32 v57, v57
  v_mul_f32 v96, v104, v56
  s_waitcnt lgkmcnt(6)
  v_mfma_f32_32x32x16_bf16 a[224:239], v[44:47], a[24:27], a[224:239]
  ds_read_b64_tr_b16 v[36:37], v21 offset:13824
  ds_read_b64_tr_b16 v[38:39], v21 offset:14976
  v_mul_f32 v97, v105, v57
  v_cvt_pk_bf16_f32 v48, v96, v97
  s_waitcnt lgkmcnt(6)
  v_mfma_f32_32x32x16_bf16 a[240:255], v[24:27], a[24:27], a[240:255]
  ds_read_b64_tr_b16 v[40:41], v21 offset:13856
  ds_read_b64_tr_b16 v[42:43], v21 offset:15008
  v_mul_f32 v58, 0xbfb8aa3b, v98
  v_mul_f32 v59, 0xbfb8aa3b, v99
  s_waitcnt lgkmcnt(6)
  v_mfma_f32_32x32x16_bf16 v[208:223], v[28:31], a[24:27], v[208:223]
  ds_read_b64_tr_b16 v[44:45], v21 offset:13888
  ds_read_b64_tr_b16 v[46:47], v21 offset:15040
  v_exp_f32 v58, v58
  v_exp_f32 v59, v59
  s_waitcnt lgkmcnt(6)
  v_mfma_f32_32x32x16_bf16 v[224:239], v[32:35], a[24:27], v[224:239]
  ds_read_b64_tr_b16 v[24:25], v21 offset:13920
  ds_read_b64_tr_b16 v[26:27], v21 offset:15072
  v_mul_f32 v106, v98, v106
  v_mul_f32 v107, v99, v107
  s_waitcnt lgkmcnt(6)
  v_mfma_f32_32x32x16_bf16 a[144:159], v[36:39], a[28:31], a[144:159]
  ds_read_b64_tr_b16 v[28:29], v21 offset:13952
  ds_read_b64_tr_b16 v[30:31], v21 offset:15104
  v_add_f32 v58, 1.0, v58
  v_add_f32 v59, 1.0, v59
  s_waitcnt lgkmcnt(6)
  v_mfma_f32_32x32x16_bf16 a[160:175], v[40:43], a[28:31], a[160:175]
  ds_read_b64_tr_b16 v[32:33], v21 offset:13984
  ds_read_b64_tr_b16 v[34:35], v21 offset:15136
  v_rcp_f32 v58, v58
  v_rcp_f32 v59, v59
  s_waitcnt lgkmcnt(6)
  v_mfma_f32_32x32x16_bf16 a[176:191], v[44:47], a[28:31], a[176:191]
  ds_read_b64_tr_b16 v[36:37], v21 offset:14016
  ds_read_b64_tr_b16 v[38:39], v21 offset:15168
  v_mul_f32 v98, v106, v58
  v_mul_f32 v99, v107, v59
  s_waitcnt lgkmcnt(6)
  v_mfma_f32_32x32x16_bf16 a[192:207], v[24:27], a[28:31], a[192:207]
  ds_read_b64_tr_b16 v[40:41], v21 offset:14048
  ds_read_b64_tr_b16 v[42:43], v21 offset:15200
  v_cvt_pk_bf16_f32 v49, v98, v99
  v_mul_f32 v56, 0xbfb8aa3b, v100
  s_waitcnt lgkmcnt(6)
  v_mfma_f32_32x32x16_bf16 a[208:223], v[28:31], a[28:31], a[208:223]
  ds_read_b64_tr_b16 v[44:45], v21 offset:14080
  ds_read_b64_tr_b16 v[46:47], v21 offset:15232
  v_mul_f32 v57, 0xbfb8aa3b, v101
  v_exp_f32 v56, v56
  s_waitcnt lgkmcnt(6)
  v_mfma_f32_32x32x16_bf16 a[224:239], v[32:35], a[28:31], a[224:239]
  s_waitcnt vmcnt(11) lgkmcnt(0)
  s_barrier
  ds_read_b64_tr_b16 v[24:25], v21 offset:37120
  ds_read_b64_tr_b16 v[26:27], v21 offset:38272
  v_exp_f32 v57, v57
  v_mul_f32 v108, v100, v108
  v_mfma_f32_32x32x16_bf16 a[240:255], v[36:39], a[28:31], a[240:255]
  ds_read_b64_tr_b16 v[28:29], v21 offset:37152
  ds_read_b64_tr_b16 v[30:31], v21 offset:38304
  v_mul_f32 v109, v101, v109
  v_add_f32 v56, 1.0, v56
  v_mfma_f32_32x32x16_bf16 v[208:223], v[40:43], a[28:31], v[208:223]
  ds_read_b64_tr_b16 v[32:33], v21 offset:37184
  ds_read_b64_tr_b16 v[34:35], v21 offset:38336
  v_add_f32 v57, 1.0, v57
  v_rcp_f32 v56, v56
  v_mfma_f32_32x32x16_bf16 v[224:239], v[44:47], a[28:31], v[224:239]
  ds_read_b64_tr_b16 v[36:37], v21 offset:37216
  ds_read_b64_tr_b16 v[38:39], v21 offset:38368
  v_rcp_f32 v57, v57
  v_mul_f32 v100, v108, v56
  s_waitcnt lgkmcnt(6)
  v_mfma_f32_32x32x16_bf16 a[144:159], v[24:27], a[32:35], a[144:159]
  ds_read_b64_tr_b16 v[40:41], v21 offset:37248
  ds_read_b64_tr_b16 v[42:43], v21 offset:38400
  s_add_u32 m0, s24, 37120
  s_nop 0
  buffer_load_dwordx4 v10, s[4:7], s22 offen lds
  v_mul_f32 v101, v109, v57
  v_cvt_pk_bf16_f32 v50, v100, v101
  s_waitcnt lgkmcnt(6)
  v_mfma_f32_32x32x16_bf16 a[160:175], v[28:31], a[32:35], a[160:175]
  ds_read_b64_tr_b16 v[44:45], v21 offset:37280
  ds_read_b64_tr_b16 v[46:47], v21 offset:38432
  v_mul_f32 v58, 0xbfb8aa3b, v102
  v_mul_f32 v59, 0xbfb8aa3b, v103
  s_waitcnt lgkmcnt(6)
  v_mfma_f32_32x32x16_bf16 a[176:191], v[32:35], a[32:35], a[176:191]
  ds_read_b64_tr_b16 v[24:25], v21 offset:37312
  ds_read_b64_tr_b16 v[26:27], v21 offset:38464
  s_add_u32 m0, s24, 38144
  s_nop 0
  buffer_load_dwordx4 v11, s[4:7], s22 offen lds
  v_exp_f32 v58, v58
  v_exp_f32 v59, v59
  s_waitcnt lgkmcnt(6)
  v_mfma_f32_32x32x16_bf16 a[192:207], v[36:39], a[32:35], a[192:207]
  ds_read_b64_tr_b16 v[28:29], v21 offset:37344
  ds_read_b64_tr_b16 v[30:31], v21 offset:38496
  v_mul_f32 v110, v102, v110
  v_mul_f32 v111, v103, v111
  s_waitcnt lgkmcnt(6)
  v_mfma_f32_32x32x16_bf16 a[208:223], v[40:43], a[32:35], a[208:223]
  ds_read_b64_tr_b16 v[32:33], v21 offset:37376
  ds_read_b64_tr_b16 v[34:35], v21 offset:38528
  s_add_u32 m0, s24, 39168
  s_nop 0
  buffer_load_dwordx4 v12, s[4:7], s22 offen lds
  v_add_f32 v58, 1.0, v58
  v_add_f32 v59, 1.0, v59
  s_waitcnt lgkmcnt(6)
  v_mfma_f32_32x32x16_bf16 a[224:239], v[44:47], a[32:35], a[224:239]
  ds_read_b64_tr_b16 v[36:37], v21 offset:41728
  ds_read_b64_tr_b16 v[38:39], v21 offset:42880
  v_rcp_f32 v58, v58
  v_rcp_f32 v59, v59
  s_waitcnt lgkmcnt(6)
  v_mfma_f32_32x32x16_bf16 a[240:255], v[24:27], a[32:35], a[240:255]
  ds_read_b64_tr_b16 v[40:41], v21 offset:41760
  ds_read_b64_tr_b16 v[42:43], v21 offset:42912
  s_add_u32 m0, s24, 40192
  s_nop 0
  buffer_load_dwordx4 v13, s[4:7], s22 offen lds
  v_mul_f32 v102, v110, v58
  v_mul_f32 v103, v111, v59
  s_waitcnt lgkmcnt(6)
  v_mfma_f32_32x32x16_bf16 v[208:223], v[28:31], a[32:35], v[208:223]
  ds_read_b64_tr_b16 v[44:45], v21 offset:41792
  ds_read_b64_tr_b16 v[46:47], v21 offset:42944
  v_cvt_pk_bf16_f32 v51, v102, v103
  buffer_store_dwordx4 v[48:51], v1, s[12:15], s25 offen offset:2048 sc0 sc1
  s_waitcnt lgkmcnt(6)
  v_mfma_f32_32x32x16_bf16 v[224:239], v[32:35], a[32:35], v[224:239]
  ds_read_b64_tr_b16 v[24:25], v21 offset:41824
  ds_read_b64_tr_b16 v[26:27], v21 offset:42976
  s_add_u32 m0, s24, 41216
  s_nop 0
  buffer_load_dwordx4 v14, s[4:7], s22 offen lds
  v_mul_f32 v56, 0xbfb8aa3b, v112
  s_waitcnt lgkmcnt(6)
  v_mfma_f32_32x32x16_bf16 a[144:159], v[36:39], a[36:39], a[144:159]
  ds_read_b64_tr_b16 v[28:29], v21 offset:41856
  ds_read_b64_tr_b16 v[30:31], v21 offset:43008
  v_mul_f32 v57, 0xbfb8aa3b, v113
  v_exp_f32 v56, v56
  s_waitcnt lgkmcnt(6)
  v_mfma_f32_32x32x16_bf16 a[160:175], v[40:43], a[36:39], a[160:175]
  ds_read_b64_tr_b16 v[32:33], v21 offset:41888
  ds_read_b64_tr_b16 v[34:35], v21 offset:43040
  s_add_u32 m0, s24, 42240
  s_nop 0
  buffer_load_dwordx4 v15, s[4:7], s22 offen lds
  v_exp_f32 v57, v57
  v_mul_f32 v120, v112, v120
  s_waitcnt lgkmcnt(6)
  v_mfma_f32_32x32x16_bf16 a[176:191], v[44:47], a[36:39], a[176:191]
  ds_read_b64_tr_b16 v[36:37], v21 offset:41920
  ds_read_b64_tr_b16 v[38:39], v21 offset:43072
  v_mul_f32 v121, v113, v121
  v_add_f32 v56, 1.0, v56
  s_waitcnt lgkmcnt(6)
  v_mfma_f32_32x32x16_bf16 a[192:207], v[24:27], a[36:39], a[192:207]
  ds_read_b64_tr_b16 v[40:41], v21 offset:41952
  ds_read_b64_tr_b16 v[42:43], v21 offset:43104
  s_add_u32 m0, s24, 43264
  s_nop 0
  buffer_load_dwordx4 v16, s[4:7], s22 offen lds
  v_add_f32 v57, 1.0, v57
  v_rcp_f32 v56, v56
  s_waitcnt lgkmcnt(6)
  v_mfma_f32_32x32x16_bf16 a[208:223], v[28:31], a[36:39], a[208:223]
  ds_read_b64_tr_b16 v[44:45], v21 offset:41984
  ds_read_b64_tr_b16 v[46:47], v21 offset:43136
  v_rcp_f32 v57, v57
  v_mul_f32 v112, v120, v56
  s_waitcnt lgkmcnt(6)
  v_mfma_f32_32x32x16_bf16 a[224:239], v[32:35], a[36:39], a[224:239]
  ds_read_b64_tr_b16 v[24:25], v21 offset:46336
  ds_read_b64_tr_b16 v[26:27], v21 offset:47488
  s_add_u32 m0, s24, 44288
  s_nop 0
  buffer_load_dwordx4 v17, s[4:7], s22 offen lds
  v_mul_f32 v113, v121, v57
  v_cvt_pk_bf16_f32 v52, v112, v113
  s_waitcnt lgkmcnt(6)
  v_mfma_f32_32x32x16_bf16 a[240:255], v[36:39], a[36:39], a[240:255]
  ds_read_b64_tr_b16 v[28:29], v21 offset:46368
  ds_read_b64_tr_b16 v[30:31], v21 offset:47520
  v_mul_f32 v58, 0xbfb8aa3b, v114
  v_mul_f32 v59, 0xbfb8aa3b, v115
  s_waitcnt lgkmcnt(6)
  v_mfma_f32_32x32x16_bf16 v[208:223], v[40:43], a[36:39], v[208:223]
  ds_read_b64_tr_b16 v[32:33], v21 offset:46400
  ds_read_b64_tr_b16 v[34:35], v21 offset:47552
  s_add_u32 m0, s24, 45312
  s_nop 0
  buffer_load_dwordx4 v18, s[4:7], s22 offen lds
  s_add_u32 s22, s22, 589824
  v_exp_f32 v58, v58
  v_exp_f32 v59, v59
  s_waitcnt lgkmcnt(6)
  v_mfma_f32_32x32x16_bf16 v[224:239], v[44:47], a[36:39], v[224:239]
  ds_read_b64_tr_b16 v[36:37], v21 offset:46432
  ds_read_b64_tr_b16 v[38:39], v21 offset:47584
  v_mul_f32 v122, v114, v122
  v_mul_f32 v123, v115, v123
  s_waitcnt lgkmcnt(6)
  v_mfma_f32_32x32x16_bf16 a[144:159], v[24:27], a[40:43], a[144:159]
  ds_read_b64_tr_b16 v[40:41], v21 offset:46464
  ds_read_b64_tr_b16 v[42:43], v21 offset:47616
  v_add_f32 v58, 1.0, v58
  v_add_f32 v59, 1.0, v59
  s_waitcnt lgkmcnt(6)
  v_mfma_f32_32x32x16_bf16 a[160:175], v[28:31], a[40:43], a[160:175]
  ds_read_b64_tr_b16 v[44:45], v21 offset:46496
  ds_read_b64_tr_b16 v[46:47], v21 offset:47648
  v_rcp_f32 v58, v58
  v_rcp_f32 v59, v59
  s_waitcnt lgkmcnt(6)
  v_mfma_f32_32x32x16_bf16 a[176:191], v[32:35], a[40:43], a[176:191]
  ds_read_b64_tr_b16 v[24:25], v21 offset:46528
  ds_read_b64_tr_b16 v[26:27], v21 offset:47680
  v_mul_f32 v114, v122, v58
  v_mul_f32 v115, v123, v59
  s_waitcnt lgkmcnt(6)
  v_mfma_f32_32x32x16_bf16 a[192:207], v[36:39], a[40:43], a[192:207]
  ds_read_b64_tr_b16 v[28:29], v21 offset:46560
  ds_read_b64_tr_b16 v[30:31], v21 offset:47712
  v_cvt_pk_bf16_f32 v53, v114, v115
  v_mul_f32 v56, 0xbfb8aa3b, v116
  s_waitcnt lgkmcnt(6)
  v_mfma_f32_32x32x16_bf16 a[208:223], v[40:43], a[40:43], a[208:223]
  ds_read_b64_tr_b16 v[32:33], v21 offset:46592
  ds_read_b64_tr_b16 v[34:35], v21 offset:47744
  v_mul_f32 v57, 0xbfb8aa3b, v117
  v_exp_f32 v56, v56
  s_waitcnt lgkmcnt(6)
  v_mfma_f32_32x32x16_bf16 a[224:239], v[44:47], a[40:43], a[224:239]
  ds_read_b64_tr_b16 v[36:37], v21 offset:50944
  ds_read_b64_tr_b16 v[38:39], v21 offset:52096
  v_exp_f32 v57, v57
  v_mul_f32 v124, v116, v124
  s_waitcnt lgkmcnt(6)
  v_mfma_f32_32x32x16_bf16 a[240:255], v[24:27], a[40:43], a[240:255]
  ds_read_b64_tr_b16 v[40:41], v21 offset:50976
  ds_read_b64_tr_b16 v[42:43], v21 offset:52128
  v_mul_f32 v125, v117, v125
  v_add_f32 v56, 1.0, v56
  s_waitcnt lgkmcnt(6)
  v_mfma_f32_32x32x16_bf16 v[208:223], v[28:31], a[40:43], v[208:223]
  ds_read_b64_tr_b16 v[44:45], v21 offset:51008
  ds_read_b64_tr_b16 v[46:47], v21 offset:52160
  v_add_f32 v57, 1.0, v57
  v_rcp_f32 v56, v56
  s_waitcnt lgkmcnt(6)
  v_mfma_f32_32x32x16_bf16 v[224:239], v[32:35], a[40:43], v[224:239]
  ds_read_b64_tr_b16 v[24:25], v21 offset:51040
  ds_read_b64_tr_b16 v[26:27], v21 offset:52192
  v_rcp_f32 v57, v57
  v_mul_f32 v116, v124, v56
  s_waitcnt lgkmcnt(6)
  v_mfma_f32_32x32x16_bf16 a[144:159], v[36:39], a[44:47], a[144:159]
  ds_read_b64_tr_b16 v[28:29], v21 offset:51072
  ds_read_b64_tr_b16 v[30:31], v21 offset:52224
  v_mul_f32 v117, v125, v57
  v_cvt_pk_bf16_f32 v54, v116, v117
  s_waitcnt lgkmcnt(6)
  v_mfma_f32_32x32x16_bf16 a[160:175], v[40:43], a[44:47], a[160:175]
  ds_read_b64_tr_b16 v[32:33], v21 offset:51104
  ds_read_b64_tr_b16 v[34:35], v21 offset:52256
  v_mul_f32 v58, 0xbfb8aa3b, v118
  v_mul_f32 v59, 0xbfb8aa3b, v119
  s_waitcnt lgkmcnt(6)
  v_mfma_f32_32x32x16_bf16 a[176:191], v[44:47], a[44:47], a[176:191]
  ds_read_b64_tr_b16 v[36:37], v21 offset:51136
  ds_read_b64_tr_b16 v[38:39], v21 offset:52288
  v_exp_f32 v58, v58
  v_exp_f32 v59, v59
  s_waitcnt lgkmcnt(6)
  v_mfma_f32_32x32x16_bf16 a[192:207], v[24:27], a[44:47], a[192:207]
  ds_read_b64_tr_b16 v[40:41], v21 offset:51168
  ds_read_b64_tr_b16 v[42:43], v21 offset:52320
  v_mul_f32 v126, v118, v126
  v_mul_f32 v127, v119, v127
  s_waitcnt lgkmcnt(6)
  v_mfma_f32_32x32x16_bf16 a[208:223], v[28:31], a[44:47], a[208:223]
  ds_read_b64_tr_b16 v[44:45], v21 offset:51200
  ds_read_b64_tr_b16 v[46:47], v21 offset:52352
  v_add_f32 v58, 1.0, v58
  v_add_f32 v59, 1.0, v59
  s_waitcnt lgkmcnt(6)
  v_mfma_f32_32x32x16_bf16 a[224:239], v[32:35], a[44:47], a[224:239]
  s_waitcnt vmcnt(11) lgkmcnt(0)
  s_barrier
  ds_read_b64_tr_b16 v[24:25], v20 offset:0
  ds_read_b64_tr_b16 v[26:27], v20 offset:1152
  v_rcp_f32 v58, v58
  v_rcp_f32 v59, v59
  v_mfma_f32_32x32x16_bf16 a[240:255], v[36:39], a[44:47], a[240:255]
  ds_read_b64_tr_b16 v[28:29], v20 offset:32
  ds_read_b64_tr_b16 v[30:31], v20 offset:1184
  v_mul_f32 v118, v126, v58
  v_mul_f32 v119, v127, v59
  v_mfma_f32_32x32x16_bf16 v[208:223], v[40:43], a[44:47], v[208:223]
  ds_read_b64_tr_b16 v[32:33], v20 offset:64
  ds_read_b64_tr_b16 v[34:35], v20 offset:1216
  v_cvt_pk_bf16_f32 v55, v118, v119
  buffer_store_dwordx4 v[52:55], v1, s[12:15], s25 offen offset:3072 sc0 sc1
  v_mfma_f32_32x32x16_bf16 v[224:239], v[44:47], a[44:47], v[224:239]
  ds_read_b64_tr_b16 v[36:37], v20 offset:96
  ds_read_b64_tr_b16 v[38:39], v20 offset:1248
  s_add_u32 s25, s25, 4096
  v_mul_f32 v56, 0xbfb8aa3b, v128
  s_waitcnt lgkmcnt(6)
  v_mfma_f32_32x32x16_bf16 a[144:159], v[24:27], a[48:51], a[144:159]
  ds_read_b64_tr_b16 v[40:41], v20 offset:128
  ds_read_b64_tr_b16 v[42:43], v20 offset:1280
  s_add_u32 m0, s24, 74240
  s_nop 0
  buffer_load_dwordx4 v10, s[4:7], s22 offen lds
  v_mul_f32 v57, 0xbfb8aa3b, v129
  v_exp_f32 v56, v56
  s_waitcnt lgkmcnt(6)
  v_mfma_f32_32x32x16_bf16 a[160:175], v[28:31], a[48:51], a[160:175]
  ds_read_b64_tr_b16 v[44:45], v20 offset:160
  ds_read_b64_tr_b16 v[46:47], v20 offset:1312
  v_exp_f32 v57, v57
  v_mul_f32 v136, v128, v136
  s_waitcnt lgkmcnt(6)
  v_mfma_f32_32x32x16_bf16 a[176:191], v[32:35], a[48:51], a[176:191]
  ds_read_b64_tr_b16 v[24:25], v20 offset:192
  ds_read_b64_tr_b16 v[26:27], v20 offset:1344
  s_add_u32 m0, s24, 75264
  s_nop 0
  buffer_load_dwordx4 v11, s[4:7], s22 offen lds
  v_mul_f32 v137, v129, v137
  v_add_f32 v56, 1.0, v56
  s_waitcnt lgkmcnt(6)
  v_mfma_f32_32x32x16_bf16 a[192:207], v[36:39], a[48:51], a[192:207]
  ds_read_b64_tr_b16 v[28:29], v20 offset:224
  ds_read_b64_tr_b16 v[30:31], v20 offset:1376
  v_add_f32 v57, 1.0, v57
  v_rcp_f32 v56, v56
  s_waitcnt lgkmcnt(6)
  v_mfma_f32_32x32x16_bf16 a[208:223], v[40:43], a[48:51], a[208:223]
  ds_read_b64_tr_b16 v[32:33], v20 offset:256
  ds_read_b64_tr_b16 v[34:35], v20 offset:1408
  s_add_u32 m0, s24, 76288
  s_nop 0
  buffer_load_dwordx4 v12, s[4:7], s22 offen lds
  v_rcp_f32 v57, v57
  v_mul_f32 v128, v136, v56
  s_waitcnt lgkmcnt(6)
  v_mfma_f32_32x32x16_bf16 a[224:239], v[44:47], a[48:51], a[224:239]
  ds_read_b64_tr_b16 v[36:37], v20 offset:4608
  ds_read_b64_tr_b16 v[38:39], v20 offset:5760
  v_mul_f32 v129, v137, v57
  v_cvt_pk_bf16_f32 v48, v128, v129
  s_waitcnt lgkmcnt(6)
  v_mfma_f32_32x32x16_bf16 a[240:255], v[24:27], a[48:51], a[240:255]
  ds_read_b64_tr_b16 v[40:41], v20 offset:4640
  ds_read_b64_tr_b16 v[42:43], v20 offset:5792
  s_add_u32 m0, s24, 77312
  s_nop 0
  buffer_load_dwordx4 v13, s[4:7], s22 offen lds
  v_mul_f32 v58, 0xbfb8aa3b, v130
  v_mul_f32 v59, 0xbfb8aa3b, v131
  s_waitcnt lgkmcnt(6)
  v_mfma_f32_32x32x16_bf16 v[208:223], v[28:31], a[48:51], v[208:223]
  ds_read_b64_tr_b16 v[44:45], v20 offset:4672
  ds_read_b64_tr_b16 v[46:47], v20 offset:5824
  v_exp_f32 v58, v58
  v_exp_f32 v59, v59
  s_waitcnt lgkmcnt(6)
  v_mfma_f32_32x32x16_bf16 v[224:239], v[32:35], a[48:51], v[224:239]
  ds_read_b64_tr_b16 v[24:25], v20 offset:4704
  ds_read_b64_tr_b16 v[26:27], v20 offset:5856
  s_add_u32 m0, s24, 78336
  s_nop 0
  buffer_load_dwordx4 v14, s[4:7], s22 offen lds
  v_mul_f32 v138, v130, v138
  v_mul_f32 v139, v131, v139
  s_waitcnt lgkmcnt(6)
  v_mfma_f32_32x32x16_bf16 a[144:159], v[36:39], a[52:55], a[144:159]
  ds_read_b64_tr_b16 v[28:29], v20 offset:4736
  ds_read_b64_tr_b16 v[30:31], v20 offset:5888
  v_add_f32 v58, 1.0, v58
  v_add_f32 v59, 1.0, v59
  s_waitcnt lgkmcnt(6)
  v_mfma_f32_32x32x16_bf16 a[160:175], v[40:43], a[52:55], a[160:175]
  ds_read_b64_tr_b16 v[32:33], v20 offset:4768
  ds_read_b64_tr_b16 v[34:35], v20 offset:5920
  s_add_u32 m0, s24, 79360
  s_nop 0
  buffer_load_dwordx4 v15, s[4:7], s22 offen lds
  v_rcp_f32 v58, v58
  v_rcp_f32 v59, v59
  s_waitcnt lgkmcnt(6)
  v_mfma_f32_32x32x16_bf16 a[176:191], v[44:47], a[52:55], a[176:191]
  ds_read_b64_tr_b16 v[36:37], v20 offset:4800
  ds_read_b64_tr_b16 v[38:39], v20 offset:5952
  v_mul_f32 v130, v138, v58
  v_mul_f32 v131, v139, v59
  s_waitcnt lgkmcnt(6)
  v_mfma_f32_32x32x16_bf16 a[192:207], v[24:27], a[52:55], a[192:207]
  ds_read_b64_tr_b16 v[40:41], v20 offset:4832
  ds_read_b64_tr_b16 v[42:43], v20 offset:5984
  s_add_u32 m0, s24, 80384
  s_nop 0
  buffer_load_dwordx4 v16, s[4:7], s22 offen lds
  v_cvt_pk_bf16_f32 v49, v130, v131
  v_mul_f32 v56, 0xbfb8aa3b, v132
  s_waitcnt lgkmcnt(6)
  v_mfma_f32_32x32x16_bf16 a[208:223], v[28:31], a[52:55], a[208:223]
  ds_read_b64_tr_b16 v[44:45], v20 offset:4864
  ds_read_b64_tr_b16 v[46:47], v20 offset:6016
  v_mul_f32 v57, 0xbfb8aa3b, v133
  s_waitcnt lgkmcnt(6)
  v_mfma_f32_32x32x16_bf16 a[224:239], v[32:35], a[52:55], a[224:239]
  ds_read_b64_tr_b16 v[24:25], v20 offset:9216
  ds_read_b64_tr_b16 v[26:27], v20 offset:10368
  s_add_u32 m0, s24, 81408
  s_nop 0
  buffer_load_dwordx4 v17, s[4:7], s22 offen lds
  v_exp_f32 v56, v56
  v_exp_f32 v57, v57
  s_waitcnt lgkmcnt(6)
  v_mfma_f32_32x32x16_bf16 a[240:255], v[36:39], a[52:55], a[240:255]
  ds_read_b64_tr_b16 v[28:29], v20 offset:9248
  ds_read_b64_tr_b16 v[30:31], v20 offset:10400
  v_mul_f32 v140, v132, v140
  v_mul_f32 v141, v133, v141
  s_waitcnt lgkmcnt(6)
  v_mfma_f32_32x32x16_bf16 v[208:223], v[40:43], a[52:55], v[208:223]
  ds_read_b64_tr_b16 v[32:33], v20 offset:9280
  ds_read_b64_tr_b16 v[34:35], v20 offset:10432
  s_add_u32 m0, s24, 82432
  s_nop 0
  buffer_load_dwordx4 v18, s[4:7], s22 offen lds
  s_add_u32 s22, s22, 589824
  v_add_f32 v56, 1.0, v56
  v_add_f32 v57, 1.0, v57
  s_waitcnt lgkmcnt(6)
  v_mfma_f32_32x32x16_bf16 v[224:239], v[44:47], a[52:55], v[224:239]
  ds_read_b64_tr_b16 v[36:37], v20 offset:9312
  ds_read_b64_tr_b16 v[38:39], v20 offset:10464
  v_rcp_f32 v56, v56
  v_rcp_f32 v57, v57
  s_waitcnt lgkmcnt(6)
  v_mfma_f32_32x32x16_bf16 a[144:159], v[24:27], a[56:59], a[144:159]
  ds_read_b64_tr_b16 v[40:41], v20 offset:9344
  ds_read_b64_tr_b16 v[42:43], v20 offset:10496
  v_mul_f32 v132, v140, v56
  v_mul_f32 v133, v141, v57
  s_waitcnt lgkmcnt(6)
  v_mfma_f32_32x32x16_bf16 a[160:175], v[28:31], a[56:59], a[160:175]
  ds_read_b64_tr_b16 v[44:45], v20 offset:9376
  ds_read_b64_tr_b16 v[46:47], v20 offset:10528
  v_cvt_pk_bf16_f32 v50, v132, v133
  v_mul_f32 v58, 0xbfb8aa3b, v134
  s_waitcnt lgkmcnt(6)
  v_mfma_f32_32x32x16_bf16 a[176:191], v[32:35], a[56:59], a[176:191]
  ds_read_b64_tr_b16 v[24:25], v20 offset:9408
  ds_read_b64_tr_b16 v[26:27], v20 offset:10560
  v_mul_f32 v59, 0xbfb8aa3b, v135
  v_exp_f32 v58, v58
  s_waitcnt lgkmcnt(6)
  v_mfma_f32_32x32x16_bf16 a[192:207], v[36:39], a[56:59], a[192:207]
  ds_read_b64_tr_b16 v[28:29], v20 offset:9440
  ds_read_b64_tr_b16 v[30:31], v20 offset:10592
  v_exp_f32 v59, v59
  v_mul_f32 v142, v134, v142
  s_waitcnt lgkmcnt(6)
  v_mfma_f32_32x32x16_bf16 a[208:223], v[40:43], a[56:59], a[208:223]
  ds_read_b64_tr_b16 v[32:33], v20 offset:9472
  ds_read_b64_tr_b16 v[34:35], v20 offset:10624
  v_mul_f32 v143, v135, v143
  v_add_f32 v58, 1.0, v58
  s_waitcnt lgkmcnt(6)
  v_mfma_f32_32x32x16_bf16 a[224:239], v[44:47], a[56:59], a[224:239]
  ds_read_b64_tr_b16 v[36:37], v20 offset:13824
  ds_read_b64_tr_b16 v[38:39], v20 offset:14976
  v_add_f32 v59, 1.0, v59
  v_rcp_f32 v58, v58
  s_waitcnt lgkmcnt(6)
  v_mfma_f32_32x32x16_bf16 a[240:255], v[24:27], a[56:59], a[240:255]
  ds_read_b64_tr_b16 v[40:41], v20 offset:13856
  ds_read_b64_tr_b16 v[42:43], v20 offset:15008
  v_rcp_f32 v59, v59
  v_mul_f32 v134, v142, v58
  s_waitcnt lgkmcnt(6)
  v_mfma_f32_32x32x16_bf16 v[208:223], v[28:31], a[56:59], v[208:223]
  ds_read_b64_tr_b16 v[44:45], v20 offset:13888
  ds_read_b64_tr_b16 v[46:47], v20 offset:15040
  v_mul_f32 v135, v143, v59
  v_cvt_pk_bf16_f32 v51, v134, v135
  s_waitcnt lgkmcnt(6)
  v_mfma_f32_32x32x16_bf16 v[224:239], v[32:35], a[56:59], v[224:239]
  ds_read_b64_tr_b16 v[24:25], v20 offset:13920
  ds_read_b64_tr_b16 v[26:27], v20 offset:15072
  buffer_store_dwordx4 v[48:51], v1, s[12:15], s25 offen offset:0 sc0 sc1
  v_mul_f32 v56, 0xbfb8aa3b, v144
  s_waitcnt lgkmcnt(6)
  v_mfma_f32_32x32x16_bf16 a[144:159], v[36:39], a[60:63], a[144:159]
  ds_read_b64_tr_b16 v[28:29], v20 offset:13952
  ds_read_b64_tr_b16 v[30:31], v20 offset:15104
  v_mul_f32 v57, 0xbfb8aa3b, v145
  v_exp_f32 v56, v56
  s_waitcnt lgkmcnt(6)
  v_mfma_f32_32x32x16_bf16 a[160:175], v[40:43], a[60:63], a[160:175]
  ds_read_b64_tr_b16 v[32:33], v20 offset:13984
  ds_read_b64_tr_b16 v[34:35], v20 offset:15136
  v_exp_f32 v57, v57
  v_mul_f32 v152, v144, v152
  s_waitcnt lgkmcnt(6)
  v_mfma_f32_32x32x16_bf16 a[176:191], v[44:47], a[60:63], a[176:191]
  ds_read_b64_tr_b16 v[36:37], v20 offset:14016
  ds_read_b64_tr_b16 v[38:39], v20 offset:15168
  v_mul_f32 v153, v145, v153
  v_add_f32 v56, 1.0, v56
  s_waitcnt lgkmcnt(6)
  v_mfma_f32_32x32x16_bf16 a[192:207], v[24:27], a[60:63], a[192:207]
  ds_read_b64_tr_b16 v[40:41], v20 offset:14048
  ds_read_b64_tr_b16 v[42:43], v20 offset:15200
  v_add_f32 v57, 1.0, v57
  v_rcp_f32 v56, v56
  s_waitcnt lgkmcnt(6)
  v_mfma_f32_32x32x16_bf16 a[208:223], v[28:31], a[60:63], a[208:223]
  ds_read_b64_tr_b16 v[44:45], v20 offset:14080
  ds_read_b64_tr_b16 v[46:47], v20 offset:15232
  v_rcp_f32 v57, v57
  v_mul_f32 v144, v152, v56
  s_waitcnt lgkmcnt(6)
  v_mfma_f32_32x32x16_bf16 a[224:239], v[32:35], a[60:63], a[224:239]
  s_waitcnt vmcnt(11) lgkmcnt(0)
  s_barrier
  ds_read_b64_tr_b16 v[24:25], v20 offset:37120
  ds_read_b64_tr_b16 v[26:27], v20 offset:38272
  v_mul_f32 v145, v153, v57
  v_cvt_pk_bf16_f32 v52, v144, v145
  v_mfma_f32_32x32x16_bf16 a[240:255], v[36:39], a[60:63], a[240:255]
  ds_read_b64_tr_b16 v[28:29], v20 offset:37152
  ds_read_b64_tr_b16 v[30:31], v20 offset:38304
  v_mul_f32 v58, 0xbfb8aa3b, v146
  v_mul_f32 v59, 0xbfb8aa3b, v147
  v_mfma_f32_32x32x16_bf16 v[208:223], v[40:43], a[60:63], v[208:223]
  ds_read_b64_tr_b16 v[32:33], v20 offset:37184
  ds_read_b64_tr_b16 v[34:35], v20 offset:38336
  v_exp_f32 v58, v58
  v_exp_f32 v59, v59
  v_mfma_f32_32x32x16_bf16 v[224:239], v[44:47], a[60:63], v[224:239]
  ds_read_b64_tr_b16 v[36:37], v20 offset:37216
  ds_read_b64_tr_b16 v[38:39], v20 offset:38368
  v_mul_f32 v154, v146, v154
  v_mul_f32 v155, v147, v155
  s_waitcnt lgkmcnt(6)
  v_mfma_f32_32x32x16_bf16 a[144:159], v[24:27], a[64:67], a[144:159]
  ds_read_b64_tr_b16 v[40:41], v20 offset:37248
  ds_read_b64_tr_b16 v[42:43], v20 offset:38400
  s_add_u32 m0, s24, 111360
  s_nop 0
  buffer_load_dwordx4 v10, s[4:7], s22 offen lds
  v_add_f32 v58, 1.0, v58
  v_add_f32 v59, 1.0, v59
  s_waitcnt lgkmcnt(6)
  v_mfma_f32_32x32x16_bf16 a[160:175], v[28:31], a[64:67], a[160:175]
  ds_read_b64_tr_b16 v[44:45], v20 offset:37280
  ds_read_b64_tr_b16 v[46:47], v20 offset:38432
  v_rcp_f32 v58, v58
  v_rcp_f32 v59, v59
  s_waitcnt lgkmcnt(6)
  v_mfma_f32_32x32x16_bf16 a[176:191], v[32:35], a[64:67], a[176:191]
  ds_read_b64_tr_b16 v[24:25], v20 offset:37312
  ds_read_b64_tr_b16 v[26:27], v20 offset:38464
  s_add_u32 m0, s24, 112384
  s_nop 0
  buffer_load_dwordx4 v11, s[4:7], s22 offen lds
  v_mul_f32 v146, v154, v58
  v_mul_f32 v147, v155, v59
  s_waitcnt lgkmcnt(6)
  v_mfma_f32_32x32x16_bf16 a[192:207], v[36:39], a[64:67], a[192:207]
  ds_read_b64_tr_b16 v[28:29], v20 offset:37344
  ds_read_b64_tr_b16 v[30:31], v20 offset:38496
  v_cvt_pk_bf16_f32 v53, v146, v147
  v_mul_f32 v56, 0xbfb8aa3b, v148
  s_waitcnt lgkmcnt(6)
  v_mfma_f32_32x32x16_bf16 a[208:223], v[40:43], a[64:67], a[208:223]
  ds_read_b64_tr_b16 v[32:33], v20 offset:37376
  ds_read_b64_tr_b16 v[34:35], v20 offset:38528
  s_add_u32 m0, s24, 113408
  s_nop 0
  buffer_load_dwordx4 v12, s[4:7], s22 offen lds
  v_mul_f32 v57, 0xbfb8aa3b, v149
  v_exp_f32 v56, v56
  s_waitcnt lgkmcnt(6)
  v_mfma_f32_32x32x16_bf16 a[224:239], v[44:47], a[64:67], a[224:239]
  ds_read_b64_tr_b16 v[36:37], v20 offset:41728
  ds_read_b64_tr_b16 v[38:39], v20 offset:42880
  v_exp_f32 v57, v57
  v_mul_f32 v156, v148, v156
  s_waitcnt lgkmcnt(6)
  v_mfma_f32_32x32x16_bf16 a[240:255], v[24:27], a[64:67], a[240:255]
  ds_read_b64_tr_b16 v[40:41], v20 offset:41760
  ds_read_b64_tr_b16 v[42:43], v20 offset:42912
  s_add_u32 m0, s24, 114432
  s_nop 0
  buffer_load_dwordx4 v13, s[4:7], s22 offen lds
  v_mul_f32 v157, v149, v157
  v_add_f32 v56, 1.0, v56
  s_waitcnt lgkmcnt(6)
  v_mfma_f32_32x32x16_bf16 v[208:223], v[28:31], a[64:67], v[208:223]
  ds_read_b64_tr_b16 v[44:45], v20 offset:41792
  ds_read_b64_tr_b16 v[46:47], v20 offset:42944
  v_add_f32 v57, 1.0, v57
  v_rcp_f32 v56, v56
  s_waitcnt lgkmcnt(6)
  v_mfma_f32_32x32x16_bf16 v[224:239], v[32:35], a[64:67], v[224:239]
  ds_read_b64_tr_b16 v[24:25], v20 offset:41824
  ds_read_b64_tr_b16 v[26:27], v20 offset:42976
  s_add_u32 m0, s24, 115456
  s_nop 0
  buffer_load_dwordx4 v14, s[4:7], s22 offen lds
  v_rcp_f32 v57, v57
  v_mul_f32 v148, v156, v56
  s_waitcnt lgkmcnt(6)
  v_mfma_f32_32x32x16_bf16 a[144:159], v[36:39], a[68:71], a[144:159]
  ds_read_b64_tr_b16 v[28:29], v20 offset:41856
  ds_read_b64_tr_b16 v[30:31], v20 offset:43008
  v_mul_f32 v149, v157, v57
  v_cvt_pk_bf16_f32 v54, v148, v149
  s_waitcnt lgkmcnt(6)
  v_mfma_f32_32x32x16_bf16 a[160:175], v[40:43], a[68:71], a[160:175]
  ds_read_b64_tr_b16 v[32:33], v20 offset:41888
  ds_read_b64_tr_b16 v[34:35], v20 offset:43040
  s_add_u32 m0, s24, 116480
  s_nop 0
  buffer_load_dwordx4 v15, s[4:7], s22 offen lds
  v_mul_f32 v58, 0xbfb8aa3b, v150
  v_mul_f32 v59, 0xbfb8aa3b, v151
  s_waitcnt lgkmcnt(6)
  v_mfma_f32_32x32x16_bf16 a[176:191], v[44:47], a[68:71], a[176:191]
  ds_read_b64_tr_b16 v[36:37], v20 offset:41920
  ds_read_b64_tr_b16 v[38:39], v20 offset:43072
  v_exp_f32 v58, v58
  v_exp_f32 v59, v59
  s_waitcnt lgkmcnt(6)
  v_mfma_f32_32x32x16_bf16 a[192:207], v[24:27], a[68:71], a[192:207]
  ds_read_b64_tr_b16 v[40:41], v20 offset:41952
  ds_read_b64_tr_b16 v[42:43], v20 offset:43104
  s_add_u32 m0, s24, 117504
  s_nop 0
  buffer_load_dwordx4 v16, s[4:7], s22 offen lds
  v_mul_f32 v158, v150, v158
  v_mul_f32 v159, v151, v159
  s_waitcnt lgkmcnt(6)
  v_mfma_f32_32x32x16_bf16 a[208:223], v[28:31], a[68:71], a[208:223]
  ds_read_b64_tr_b16 v[44:45], v20 offset:41984
  ds_read_b64_tr_b16 v[46:47], v20 offset:43136
  v_add_f32 v58, 1.0, v58
  v_add_f32 v59, 1.0, v59
  s_waitcnt lgkmcnt(6)
  v_mfma_f32_32x32x16_bf16 a[224:239], v[32:35], a[68:71], a[224:239]
  ds_read_b64_tr_b16 v[24:25], v20 offset:46336
  ds_read_b64_tr_b16 v[26:27], v20 offset:47488
  s_add_u32 m0, s24, 118528
  s_nop 0
  buffer_load_dwordx4 v17, s[4:7], s22 offen lds
  v_rcp_f32 v58, v58
  v_rcp_f32 v59, v59
  s_waitcnt lgkmcnt(6)
  v_mfma_f32_32x32x16_bf16 a[240:255], v[36:39], a[68:71], a[240:255]
  ds_read_b64_tr_b16 v[28:29], v20 offset:46368
  ds_read_b64_tr_b16 v[30:31], v20 offset:47520
  v_mul_f32 v150, v158, v58
  v_mul_f32 v151, v159, v59
  s_waitcnt lgkmcnt(6)
  v_mfma_f32_32x32x16_bf16 v[208:223], v[40:43], a[68:71], v[208:223]
  ds_read_b64_tr_b16 v[32:33], v20 offset:46400
  ds_read_b64_tr_b16 v[34:35], v20 offset:47552
  s_add_u32 m0, s24, 119552
  s_nop 0
  buffer_load_dwordx4 v18, s[4:7], s22 offen lds
  s_add_u32 s22, s22, 589824
  v_cvt_pk_bf16_f32 v55, v150, v151
  buffer_store_dwordx4 v[52:55], v1, s[12:15], s25 offen offset:1024 sc0 sc1
  s_waitcnt lgkmcnt(6)
  v_mfma_f32_32x32x16_bf16 v[224:239], v[44:47], a[68:71], v[224:239]
  ds_read_b64_tr_b16 v[36:37], v20 offset:46432
  ds_read_b64_tr_b16 v[38:39], v20 offset:47584
  v_mul_f32 v56, 0xbfb8aa3b, v160
  s_waitcnt lgkmcnt(6)
  v_mfma_f32_32x32x16_bf16 a[144:159], v[24:27], a[72:75], a[144:159]
  ds_read_b64_tr_b16 v[40:41], v20 offset:46464
  ds_read_b64_tr_b16 v[42:43], v20 offset:47616
  v_mul_f32 v57, 0xbfb8aa3b, v161
  v_exp_f32 v56, v56
  s_waitcnt lgkmcnt(6)
  v_mfma_f32_32x32x16_bf16 a[160:175], v[28:31], a[72:75], a[160:175]
  ds_read_b64_tr_b16 v[44:45], v20 offset:46496
  ds_read_b64_tr_b16 v[46:47], v20 offset:47648
  v_exp_f32 v57, v57
  v_mul_f32 v168, v160, v168
  s_waitcnt lgkmcnt(6)
  v_mfma_f32_32x32x16_bf16 a[176:191], v[32:35], a[72:75], a[176:191]
  ds_read_b64_tr_b16 v[24:25], v20 offset:46528
  ds_read_b64_tr_b16 v[26:27], v20 offset:47680
  v_mul_f32 v169, v161, v169
  v_add_f32 v56, 1.0, v56
  s_waitcnt lgkmcnt(6)
  v_mfma_f32_32x32x16_bf16 a[192:207], v[36:39], a[72:75], a[192:207]
  ds_read_b64_tr_b16 v[28:29], v20 offset:46560
  ds_read_b64_tr_b16 v[30:31], v20 offset:47712
  v_add_f32 v57, 1.0, v57
  v_rcp_f32 v56, v56
  s_waitcnt lgkmcnt(6)
  v_mfma_f32_32x32x16_bf16 a[208:223], v[40:43], a[72:75], a[208:223]
  ds_read_b64_tr_b16 v[32:33], v20 offset:46592
  ds_read_b64_tr_b16 v[34:35], v20 offset:47744
  v_rcp_f32 v57, v57
  v_mul_f32 v160, v168, v56
  s_waitcnt lgkmcnt(6)
  v_mfma_f32_32x32x16_bf16 a[224:239], v[44:47], a[72:75], a[224:239]
  ds_read_b64_tr_b16 v[36:37], v20 offset:50944
  ds_read_b64_tr_b16 v[38:39], v20 offset:52096
  v_mul_f32 v161, v169, v57
  v_cvt_pk_bf16_f32 v48, v160, v161
  s_waitcnt lgkmcnt(6)
  v_mfma_f32_32x32x16_bf16 a[240:255], v[24:27], a[72:75], a[240:255]
  ds_read_b64_tr_b16 v[40:41], v20 offset:50976
  ds_read_b64_tr_b16 v[42:43], v20 offset:52128
  v_mul_f32 v58, 0xbfb8aa3b, v162
  v_mul_f32 v59, 0xbfb8aa3b, v163
  s_waitcnt lgkmcnt(6)
  v_mfma_f32_32x32x16_bf16 v[208:223], v[28:31], a[72:75], v[208:223]
  ds_read_b64_tr_b16 v[44:45], v20 offset:51008
  ds_read_b64_tr_b16 v[46:47], v20 offset:52160
  v_exp_f32 v58, v58
  v_exp_f32 v59, v59
  s_waitcnt lgkmcnt(6)
  v_mfma_f32_32x32x16_bf16 v[224:239], v[32:35], a[72:75], v[224:239]
  ds_read_b64_tr_b16 v[24:25], v20 offset:51040
  ds_read_b64_tr_b16 v[26:27], v20 offset:52192
  v_mul_f32 v170, v162, v170
  v_mul_f32 v171, v163, v171
  s_waitcnt lgkmcnt(6)
  v_mfma_f32_32x32x16_bf16 a[144:159], v[36:39], a[76:79], a[144:159]
  ds_read_b64_tr_b16 v[28:29], v20 offset:51072
  ds_read_b64_tr_b16 v[30:31], v20 offset:52224
  v_add_f32 v58, 1.0, v58
  v_add_f32 v59, 1.0, v59
  s_waitcnt lgkmcnt(6)
  v_mfma_f32_32x32x16_bf16 a[160:175], v[40:43], a[76:79], a[160:175]
  ds_read_b64_tr_b16 v[32:33], v20 offset:51104
  ds_read_b64_tr_b16 v[34:35], v20 offset:52256
  v_rcp_f32 v58, v58
  v_rcp_f32 v59, v59
  s_waitcnt lgkmcnt(6)
  v_mfma_f32_32x32x16_bf16 a[176:191], v[44:47], a[76:79], a[176:191]
  ds_read_b64_tr_b16 v[36:37], v20 offset:51136
  ds_read_b64_tr_b16 v[38:39], v20 offset:52288
  v_mul_f32 v162, v170, v58
  v_mul_f32 v163, v171, v59
  s_waitcnt lgkmcnt(6)
  v_mfma_f32_32x32x16_bf16 a[192:207], v[24:27], a[76:79], a[192:207]
  ds_read_b64_tr_b16 v[40:41], v20 offset:51168
  ds_read_b64_tr_b16 v[42:43], v20 offset:52320
  v_cvt_pk_bf16_f32 v49, v162, v163
  v_mul_f32 v56, 0xbfb8aa3b, v164
  s_waitcnt lgkmcnt(6)
  v_mfma_f32_32x32x16_bf16 a[208:223], v[28:31], a[76:79], a[208:223]
  ds_read_b64_tr_b16 v[44:45], v20 offset:51200
  ds_read_b64_tr_b16 v[46:47], v20 offset:52352
  v_mul_f32 v57, 0xbfb8aa3b, v165
  v_exp_f32 v56, v56
  s_waitcnt lgkmcnt(6)
  v_mfma_f32_32x32x16_bf16 a[224:239], v[32:35], a[76:79], a[224:239]
  s_waitcnt vmcnt(11) lgkmcnt(0)
  s_barrier
  ds_read_b64_tr_b16 v[24:25], v21 offset:0
  ds_read_b64_tr_b16 v[26:27], v21 offset:1152
  v_exp_f32 v57, v57
  v_mul_f32 v172, v164, v172
  v_mfma_f32_32x32x16_bf16 a[240:255], v[36:39], a[76:79], a[240:255]
  ds_read_b64_tr_b16 v[28:29], v21 offset:32
  ds_read_b64_tr_b16 v[30:31], v21 offset:1184
  v_mul_f32 v173, v165, v173
  v_add_f32 v56, 1.0, v56
  v_mfma_f32_32x32x16_bf16 v[208:223], v[40:43], a[76:79], v[208:223]
  ds_read_b64_tr_b16 v[32:33], v21 offset:64
  ds_read_b64_tr_b16 v[34:35], v21 offset:1216
  v_add_f32 v57, 1.0, v57
  v_rcp_f32 v56, v56
  v_mfma_f32_32x32x16_bf16 v[224:239], v[44:47], a[76:79], v[224:239]
  ds_read_b64_tr_b16 v[36:37], v21 offset:96
  ds_read_b64_tr_b16 v[38:39], v21 offset:1248
  v_rcp_f32 v57, v57
  v_mul_f32 v164, v172, v56
  s_waitcnt lgkmcnt(6)
  v_mfma_f32_32x32x16_bf16 a[144:159], v[24:27], a[80:83], a[144:159]
  ds_read_b64_tr_b16 v[40:41], v21 offset:128
  ds_read_b64_tr_b16 v[42:43], v21 offset:1280
  s_add_u32 m0, s24, 0
  s_nop 0
  buffer_load_dwordx4 v10, s[4:7], s22 offen lds
  v_mul_f32 v165, v173, v57
  v_cvt_pk_bf16_f32 v50, v164, v165
  s_waitcnt lgkmcnt(6)
  v_mfma_f32_32x32x16_bf16 a[160:175], v[28:31], a[80:83], a[160:175]
  ds_read_b64_tr_b16 v[44:45], v21 offset:160
  ds_read_b64_tr_b16 v[46:47], v21 offset:1312
  v_mul_f32 v58, 0xbfb8aa3b, v166
  v_mul_f32 v59, 0xbfb8aa3b, v167
  s_waitcnt lgkmcnt(6)
  v_mfma_f32_32x32x16_bf16 a[176:191], v[32:35], a[80:83], a[176:191]
  ds_read_b64_tr_b16 v[24:25], v21 offset:192
  ds_read_b64_tr_b16 v[26:27], v21 offset:1344
  s_add_u32 m0, s24, 1024
  s_nop 0
  buffer_load_dwordx4 v11, s[4:7], s22 offen lds
  v_exp_f32 v58, v58
  v_exp_f32 v59, v59
  s_waitcnt lgkmcnt(6)
  v_mfma_f32_32x32x16_bf16 a[192:207], v[36:39], a[80:83], a[192:207]
  ds_read_b64_tr_b16 v[28:29], v21 offset:224
  ds_read_b64_tr_b16 v[30:31], v21 offset:1376
  v_mul_f32 v174, v166, v174
  v_mul_f32 v175, v167, v175
  s_waitcnt lgkmcnt(6)
  v_mfma_f32_32x32x16_bf16 a[208:223], v[40:43], a[80:83], a[208:223]
  ds_read_b64_tr_b16 v[32:33], v21 offset:256
  ds_read_b64_tr_b16 v[34:35], v21 offset:1408
  s_add_u32 m0, s24, 2048
  s_nop 0
  buffer_load_dwordx4 v12, s[4:7], s22 offen lds
  v_add_f32 v58, 1.0, v58
  v_add_f32 v59, 1.0, v59
  s_waitcnt lgkmcnt(6)
  v_mfma_f32_32x32x16_bf16 a[224:239], v[44:47], a[80:83], a[224:239]
  ds_read_b64_tr_b16 v[36:37], v21 offset:4608
  ds_read_b64_tr_b16 v[38:39], v21 offset:5760
  v_rcp_f32 v58, v58
  v_rcp_f32 v59, v59
  s_waitcnt lgkmcnt(6)
  v_mfma_f32_32x32x16_bf16 a[240:255], v[24:27], a[80:83], a[240:255]
  ds_read_b64_tr_b16 v[40:41], v21 offset:4640
  ds_read_b64_tr_b16 v[42:43], v21 offset:5792
  s_add_u32 m0, s24, 3072
  s_nop 0
  buffer_load_dwordx4 v13, s[4:7], s22 offen lds
  v_mul_f32 v166, v174, v58
  v_mul_f32 v167, v175, v59
  s_waitcnt lgkmcnt(6)
  v_mfma_f32_32x32x16_bf16 v[208:223], v[28:31], a[80:83], v[208:223]
  ds_read_b64_tr_b16 v[44:45], v21 offset:4672
  ds_read_b64_tr_b16 v[46:47], v21 offset:5824
  v_cvt_pk_bf16_f32 v51, v166, v167
  buffer_store_dwordx4 v[48:51], v1, s[12:15], s25 offen offset:2048 sc0 sc1
  s_waitcnt lgkmcnt(6)
  v_mfma_f32_32x32x16_bf16 v[224:239], v[32:35], a[80:83], v[224:239]
  ds_read_b64_tr_b16 v[24:25], v21 offset:4704
  ds_read_b64_tr_b16 v[26:27], v21 offset:5856
  s_add_u32 m0, s24, 4096
  s_nop 0
  buffer_load_dwordx4 v14, s[4:7], s22 offen lds
  v_mul_f32 v56, 0xbfb8aa3b, v176
  v_mul_f32 v57, 0xbfb8aa3b, v177
  s_waitcnt lgkmcnt(6)
  v_mfma_f32_32x32x16_bf16 a[144:159], v[36:39], a[84:87], a[144:159]
  ds_read_b64_tr_b16 v[28:29], v21 offset:4736
  ds_read_b64_tr_b16 v[30:31], v21 offset:5888
  v_exp_f32 v56, v56
  v_exp_f32 v57, v57
  s_waitcnt lgkmcnt(6)
  v_mfma_f32_32x32x16_bf16 a[160:175], v[40:43], a[84:87], a[160:175]
  ds_read_b64_tr_b16 v[32:33], v21 offset:4768
  ds_read_b64_tr_b16 v[34:35], v21 offset:5920
  s_add_u32 m0, s24, 5120
  s_nop 0
  buffer_load_dwordx4 v15, s[4:7], s22 offen lds
  v_mul_f32 v184, v176, v184
  v_mul_f32 v185, v177, v185
  s_waitcnt lgkmcnt(6)
  v_mfma_f32_32x32x16_bf16 a[176:191], v[44:47], a[84:87], a[176:191]
  ds_read_b64_tr_b16 v[36:37], v21 offset:4800
  ds_read_b64_tr_b16 v[38:39], v21 offset:5952
  v_add_f32 v56, 1.0, v56
  v_add_f32 v57, 1.0, v57
  s_waitcnt lgkmcnt(6)
  v_mfma_f32_32x32x16_bf16 a[192:207], v[24:27], a[84:87], a[192:207]
  ds_read_b64_tr_b16 v[40:41], v21 offset:4832
  ds_read_b64_tr_b16 v[42:43], v21 offset:5984
  s_add_u32 m0, s24, 6144
  s_nop 0
  buffer_load_dwordx4 v16, s[4:7], s22 offen lds
  v_rcp_f32 v56, v56
  v_rcp_f32 v57, v57
  s_waitcnt lgkmcnt(6)
  v_mfma_f32_32x32x16_bf16 a[208:223], v[28:31], a[84:87], a[208:223]
  ds_read_b64_tr_b16 v[44:45], v21 offset:4864
  ds_read_b64_tr_b16 v[46:47], v21 offset:6016
  v_mul_f32 v176, v184, v56
  v_mul_f32 v177, v185, v57
  s_waitcnt lgkmcnt(6)
  v_mfma_f32_32x32x16_bf16 a[224:239], v[32:35], a[84:87], a[224:239]
  ds_read_b64_tr_b16 v[24:25], v21 offset:9216
  ds_read_b64_tr_b16 v[26:27], v21 offset:10368
  s_add_u32 m0, s24, 7168
  s_nop 0
  buffer_load_dwordx4 v17, s[4:7], s22 offen lds
  v_cvt_pk_bf16_f32 v52, v176, v177
  v_mul_f32 v58, 0xbfb8aa3b, v178
  s_waitcnt lgkmcnt(6)
  v_mfma_f32_32x32x16_bf16 a[240:255], v[36:39], a[84:87], a[240:255]
  ds_read_b64_tr_b16 v[28:29], v21 offset:9248
  ds_read_b64_tr_b16 v[30:31], v21 offset:10400
  v_mul_f32 v59, 0xbfb8aa3b, v179
  v_exp_f32 v58, v58
  s_waitcnt lgkmcnt(6)
  v_mfma_f32_32x32x16_bf16 v[208:223], v[40:43], a[84:87], v[208:223]
  ds_read_b64_tr_b16 v[32:33], v21 offset:9280
  ds_read_b64_tr_b16 v[34:35], v21 offset:10432
  s_add_u32 m0, s24, 8192
  s_nop 0
  buffer_load_dwordx4 v18, s[4:7], s22 offen lds
  s_add_u32 s22, s22, 589824
  v_exp_f32 v59, v59
  v_mul_f32 v186, v178, v186
  s_waitcnt lgkmcnt(6)
  v_mfma_f32_32x32x16_bf16 v[224:239], v[44:47], a[84:87], v[224:239]
  ds_read_b64_tr_b16 v[36:37], v21 offset:9312
  ds_read_b64_tr_b16 v[38:39], v21 offset:10464
  v_mul_f32 v187, v179, v187
  v_add_f32 v58, 1.0, v58
  s_waitcnt lgkmcnt(6)
  v_mfma_f32_32x32x16_bf16 a[144:159], v[24:27], a[88:91], a[144:159]
  ds_read_b64_tr_b16 v[40:41], v21 offset:9344
  ds_read_b64_tr_b16 v[42:43], v21 offset:10496
  v_add_f32 v59, 1.0, v59
  v_rcp_f32 v58, v58
  s_waitcnt lgkmcnt(6)
  v_mfma_f32_32x32x16_bf16 a[160:175], v[28:31], a[88:91], a[160:175]
  ds_read_b64_tr_b16 v[44:45], v21 offset:9376
  ds_read_b64_tr_b16 v[46:47], v21 offset:10528
  v_rcp_f32 v59, v59
  v_mul_f32 v178, v186, v58
  s_waitcnt lgkmcnt(6)
  v_mfma_f32_32x32x16_bf16 a[176:191], v[32:35], a[88:91], a[176:191]
  ds_read_b64_tr_b16 v[24:25], v21 offset:9408
  ds_read_b64_tr_b16 v[26:27], v21 offset:10560
  v_mul_f32 v179, v187, v59
  v_cvt_pk_bf16_f32 v53, v178, v179
  s_waitcnt lgkmcnt(6)
  v_mfma_f32_32x32x16_bf16 a[192:207], v[36:39], a[88:91], a[192:207]
  ds_read_b64_tr_b16 v[28:29], v21 offset:9440
  ds_read_b64_tr_b16 v[30:31], v21 offset:10592
  v_mul_f32 v56, 0xbfb8aa3b, v180
  v_mul_f32 v57, 0xbfb8aa3b, v181
  s_waitcnt lgkmcnt(6)
  v_mfma_f32_32x32x16_bf16 a[208:223], v[40:43], a[88:91], a[208:223]
  ds_read_b64_tr_b16 v[32:33], v21 offset:9472
  ds_read_b64_tr_b16 v[34:35], v21 offset:10624
  v_exp_f32 v56, v56
  s_waitcnt lgkmcnt(6)
  v_mfma_f32_32x32x16_bf16 a[224:239], v[44:47], a[88:91], a[224:239]
  ds_read_b64_tr_b16 v[36:37], v21 offset:13824
  ds_read_b64_tr_b16 v[38:39], v21 offset:14976
  v_exp_f32 v57, v57
  v_mul_f32 v188, v180, v188
  s_waitcnt lgkmcnt(6)
  v_mfma_f32_32x32x16_bf16 a[240:255], v[24:27], a[88:91], a[240:255]
  ds_read_b64_tr_b16 v[40:41], v21 offset:13856
  ds_read_b64_tr_b16 v[42:43], v21 offset:15008
  v_mul_f32 v189, v181, v189
  v_add_f32 v56, 1.0, v56
  s_waitcnt lgkmcnt(6)
  v_mfma_f32_32x32x16_bf16 v[208:223], v[28:31], a[88:91], v[208:223]
  ds_read_b64_tr_b16 v[44:45], v21 offset:13888
  ds_read_b64_tr_b16 v[46:47], v21 offset:15040
  v_add_f32 v57, 1.0, v57
  v_rcp_f32 v56, v56
  s_waitcnt lgkmcnt(6)
  v_mfma_f32_32x32x16_bf16 v[224:239], v[32:35], a[88:91], v[224:239]
  ds_read_b64_tr_b16 v[24:25], v21 offset:13920
  ds_read_b64_tr_b16 v[26:27], v21 offset:15072
  v_rcp_f32 v57, v57
  v_mul_f32 v180, v188, v56
  s_waitcnt lgkmcnt(6)
  v_mfma_f32_32x32x16_bf16 a[144:159], v[36:39], a[92:95], a[144:159]
  ds_read_b64_tr_b16 v[28:29], v21 offset:13952
  ds_read_b64_tr_b16 v[30:31], v21 offset:15104
  v_mul_f32 v181, v189, v57
  v_cvt_pk_bf16_f32 v54, v180, v181
  s_waitcnt lgkmcnt(6)
  v_mfma_f32_32x32x16_bf16 a[160:175], v[40:43], a[92:95], a[160:175]
  ds_read_b64_tr_b16 v[32:33], v21 offset:13984
  ds_read_b64_tr_b16 v[34:35], v21 offset:15136
  v_mul_f32 v58, 0xbfb8aa3b, v182
  v_mul_f32 v59, 0xbfb8aa3b, v183
  s_waitcnt lgkmcnt(6)
  v_mfma_f32_32x32x16_bf16 a[176:191], v[44:47], a[92:95], a[176:191]
  ds_read_b64_tr_b16 v[36:37], v21 offset:14016
  ds_read_b64_tr_b16 v[38:39], v21 offset:15168
  v_exp_f32 v58, v58
  v_exp_f32 v59, v59
  s_waitcnt lgkmcnt(6)
  v_mfma_f32_32x32x16_bf16 a[192:207], v[24:27], a[92:95], a[192:207]
  ds_read_b64_tr_b16 v[40:41], v21 offset:14048
  ds_read_b64_tr_b16 v[42:43], v21 offset:15200
  v_mul_f32 v190, v182, v190
  v_mul_f32 v191, v183, v191
  s_waitcnt lgkmcnt(6)
  v_mfma_f32_32x32x16_bf16 a[208:223], v[28:31], a[92:95], a[208:223]
  ds_read_b64_tr_b16 v[44:45], v21 offset:14080
  ds_read_b64_tr_b16 v[46:47], v21 offset:15232
  v_add_f32 v58, 1.0, v58
  v_add_f32 v59, 1.0, v59
  s_waitcnt lgkmcnt(6)
  v_mfma_f32_32x32x16_bf16 a[224:239], v[32:35], a[92:95], a[224:239]
  s_waitcnt vmcnt(11) lgkmcnt(0)
  s_barrier
  ds_read_b64_tr_b16 v[24:25], v21 offset:37120
  ds_read_b64_tr_b16 v[26:27], v21 offset:38272
  v_rcp_f32 v58, v58
  v_rcp_f32 v59, v59
  v_mfma_f32_32x32x16_bf16 a[240:255], v[36:39], a[92:95], a[240:255]
  ds_read_b64_tr_b16 v[28:29], v21 offset:37152
  ds_read_b64_tr_b16 v[30:31], v21 offset:38304
  v_mul_f32 v182, v190, v58
  v_mul_f32 v183, v191, v59
  v_mfma_f32_32x32x16_bf16 v[208:223], v[40:43], a[92:95], v[208:223]
  ds_read_b64_tr_b16 v[32:33], v21 offset:37184
  ds_read_b64_tr_b16 v[34:35], v21 offset:38336
  v_cvt_pk_bf16_f32 v55, v182, v183
  buffer_store_dwordx4 v[52:55], v1, s[12:15], s25 offen offset:3072 sc0 sc1
  v_mfma_f32_32x32x16_bf16 v[224:239], v[44:47], a[92:95], v[224:239]
  ds_read_b64_tr_b16 v[36:37], v21 offset:37216
  ds_read_b64_tr_b16 v[38:39], v21 offset:38368
  s_add_u32 s25, s25, 4096
  v_mul_f32 v56, 0xbfb8aa3b, v192
  s_waitcnt lgkmcnt(6)
  v_mfma_f32_32x32x16_bf16 a[144:159], v[24:27], a[96:99], a[144:159]
  ds_read_b64_tr_b16 v[40:41], v21 offset:37248
  ds_read_b64_tr_b16 v[42:43], v21 offset:38400
  s_add_u32 m0, s24, 37120
  s_nop 0
  buffer_load_dwordx4 v10, s[4:7], s22 offen lds
  v_mul_f32 v57, 0xbfb8aa3b, v193
  v_exp_f32 v56, v56
  s_waitcnt lgkmcnt(6)
  v_mfma_f32_32x32x16_bf16 a[160:175], v[28:31], a[96:99], a[160:175]
  ds_read_b64_tr_b16 v[44:45], v21 offset:37280
  ds_read_b64_tr_b16 v[46:47], v21 offset:38432
  v_exp_f32 v57, v57
  v_mul_f32 v200, v192, v200
  s_waitcnt lgkmcnt(6)
  v_mfma_f32_32x32x16_bf16 a[176:191], v[32:35], a[96:99], a[176:191]
  ds_read_b64_tr_b16 v[24:25], v21 offset:37312
  ds_read_b64_tr_b16 v[26:27], v21 offset:38464
  s_add_u32 m0, s24, 38144
  s_nop 0
  buffer_load_dwordx4 v11, s[4:7], s22 offen lds
  v_mul_f32 v201, v193, v201
  v_add_f32 v56, 1.0, v56
  s_waitcnt lgkmcnt(6)
  v_mfma_f32_32x32x16_bf16 a[192:207], v[36:39], a[96:99], a[192:207]
  ds_read_b64_tr_b16 v[28:29], v21 offset:37344
  ds_read_b64_tr_b16 v[30:31], v21 offset:38496
  v_add_f32 v57, 1.0, v57
  v_rcp_f32 v56, v56
  s_waitcnt lgkmcnt(6)
  v_mfma_f32_32x32x16_bf16 a[208:223], v[40:43], a[96:99], a[208:223]
  ds_read_b64_tr_b16 v[32:33], v21 offset:37376
  ds_read_b64_tr_b16 v[34:35], v21 offset:38528
  s_add_u32 m0, s24, 39168
  s_nop 0
  buffer_load_dwordx4 v12, s[4:7], s22 offen lds
  v_rcp_f32 v57, v57
  v_mul_f32 v192, v200, v56
  s_waitcnt lgkmcnt(6)
  v_mfma_f32_32x32x16_bf16 a[224:239], v[44:47], a[96:99], a[224:239]
  ds_read_b64_tr_b16 v[36:37], v21 offset:41728
  ds_read_b64_tr_b16 v[38:39], v21 offset:42880
  v_mul_f32 v193, v201, v57
  v_cvt_pk_bf16_f32 v48, v192, v193
  s_waitcnt lgkmcnt(6)
  v_mfma_f32_32x32x16_bf16 a[240:255], v[24:27], a[96:99], a[240:255]
  ds_read_b64_tr_b16 v[40:41], v21 offset:41760
  ds_read_b64_tr_b16 v[42:43], v21 offset:42912
  s_add_u32 m0, s24, 40192
  s_nop 0
  buffer_load_dwordx4 v13, s[4:7], s22 offen lds
  v_mul_f32 v58, 0xbfb8aa3b, v194
  v_mul_f32 v59, 0xbfb8aa3b, v195
  s_waitcnt lgkmcnt(6)
  v_mfma_f32_32x32x16_bf16 v[208:223], v[28:31], a[96:99], v[208:223]
  ds_read_b64_tr_b16 v[44:45], v21 offset:41792
  ds_read_b64_tr_b16 v[46:47], v21 offset:42944
  v_exp_f32 v58, v58
  v_exp_f32 v59, v59
  s_waitcnt lgkmcnt(6)
  v_mfma_f32_32x32x16_bf16 v[224:239], v[32:35], a[96:99], v[224:239]
  ds_read_b64_tr_b16 v[24:25], v21 offset:41824
  ds_read_b64_tr_b16 v[26:27], v21 offset:42976
  s_add_u32 m0, s24, 41216
  s_nop 0
  buffer_load_dwordx4 v14, s[4:7], s22 offen lds
  v_mul_f32 v202, v194, v202
  v_mul_f32 v203, v195, v203
  s_waitcnt lgkmcnt(6)
  v_mfma_f32_32x32x16_bf16 a[144:159], v[36:39], a[100:103], a[144:159]
  ds_read_b64_tr_b16 v[28:29], v21 offset:41856
  ds_read_b64_tr_b16 v[30:31], v21 offset:43008
  v_add_f32 v58, 1.0, v58
  v_add_f32 v59, 1.0, v59
  s_waitcnt lgkmcnt(6)
  v_mfma_f32_32x32x16_bf16 a[160:175], v[40:43], a[100:103], a[160:175]
  ds_read_b64_tr_b16 v[32:33], v21 offset:41888
  ds_read_b64_tr_b16 v[34:35], v21 offset:43040
  s_add_u32 m0, s24, 42240
  s_nop 0
  buffer_load_dwordx4 v15, s[4:7], s22 offen lds
  v_rcp_f32 v58, v58
  v_rcp_f32 v59, v59
  s_waitcnt lgkmcnt(6)
  v_mfma_f32_32x32x16_bf16 a[176:191], v[44:47], a[100:103], a[176:191]
  ds_read_b64_tr_b16 v[36:37], v21 offset:41920
  ds_read_b64_tr_b16 v[38:39], v21 offset:43072
  v_mul_f32 v194, v202, v58
  v_mul_f32 v195, v203, v59
  s_waitcnt lgkmcnt(6)
  v_mfma_f32_32x32x16_bf16 a[192:207], v[24:27], a[100:103], a[192:207]
  ds_read_b64_tr_b16 v[40:41], v21 offset:41952
  ds_read_b64_tr_b16 v[42:43], v21 offset:43104
  s_add_u32 m0, s24, 43264
  s_nop 0
  buffer_load_dwordx4 v16, s[4:7], s22 offen lds
  v_cvt_pk_bf16_f32 v49, v194, v195
  v_mul_f32 v56, 0xbfb8aa3b, v196
  s_waitcnt lgkmcnt(6)
  v_mfma_f32_32x32x16_bf16 a[208:223], v[28:31], a[100:103], a[208:223]
  ds_read_b64_tr_b16 v[44:45], v21 offset:41984
  ds_read_b64_tr_b16 v[46:47], v21 offset:43136
  v_mul_f32 v57, 0xbfb8aa3b, v197
  v_exp_f32 v56, v56
  s_waitcnt lgkmcnt(6)
  v_mfma_f32_32x32x16_bf16 a[224:239], v[32:35], a[100:103], a[224:239]
  ds_read_b64_tr_b16 v[24:25], v21 offset:46336
  ds_read_b64_tr_b16 v[26:27], v21 offset:47488
  s_add_u32 m0, s24, 44288
  s_nop 0
  buffer_load_dwordx4 v17, s[4:7], s22 offen lds
  v_exp_f32 v57, v57
  v_mul_f32 v204, v196, v204
  s_waitcnt lgkmcnt(6)
  v_mfma_f32_32x32x16_bf16 a[240:255], v[36:39], a[100:103], a[240:255]
  ds_read_b64_tr_b16 v[28:29], v21 offset:46368
  ds_read_b64_tr_b16 v[30:31], v21 offset:47520
  v_mul_f32 v205, v197, v205
  v_add_f32 v56, 1.0, v56
  s_waitcnt lgkmcnt(6)
  v_mfma_f32_32x32x16_bf16 v[208:223], v[40:43], a[100:103], v[208:223]
  ds_read_b64_tr_b16 v[32:33], v21 offset:46400
  ds_read_b64_tr_b16 v[34:35], v21 offset:47552
  s_add_u32 m0, s24, 45312
  s_nop 0
  buffer_load_dwordx4 v18, s[4:7], s22 offen lds
  s_add_u32 s22, s22, 589824
  s_sub_u32 s22, s22, 5308128
  v_add_f32 v57, 1.0, v57
  v_rcp_f32 v56, v56
  s_waitcnt lgkmcnt(6)
  v_mfma_f32_32x32x16_bf16 v[224:239], v[44:47], a[100:103], v[224:239]
  ds_read_b64_tr_b16 v[36:37], v21 offset:46432
  ds_read_b64_tr_b16 v[38:39], v21 offset:47584
  v_rcp_f32 v57, v57
  v_mul_f32 v196, v204, v56
  s_waitcnt lgkmcnt(6)
  v_mfma_f32_32x32x16_bf16 a[144:159], v[24:27], a[104:107], a[144:159]
  ds_read_b64_tr_b16 v[40:41], v21 offset:46464
  ds_read_b64_tr_b16 v[42:43], v21 offset:47616
  v_mul_f32 v197, v205, v57
  v_cvt_pk_bf16_f32 v50, v196, v197
  s_waitcnt lgkmcnt(6)
  v_mfma_f32_32x32x16_bf16 a[160:175], v[28:31], a[104:107], a[160:175]
  ds_read_b64_tr_b16 v[44:45], v21 offset:46496
  ds_read_b64_tr_b16 v[46:47], v21 offset:47648
  v_mul_f32 v58, 0xbfb8aa3b, v198
  v_mul_f32 v59, 0xbfb8aa3b, v199
  s_waitcnt lgkmcnt(6)
  v_mfma_f32_32x32x16_bf16 a[176:191], v[32:35], a[104:107], a[176:191]
  ds_read_b64_tr_b16 v[24:25], v21 offset:46528
  ds_read_b64_tr_b16 v[26:27], v21 offset:47680
  v_exp_f32 v58, v58
  v_exp_f32 v59, v59
  s_waitcnt lgkmcnt(6)
  v_mfma_f32_32x32x16_bf16 a[192:207], v[36:39], a[104:107], a[192:207]
  ds_read_b64_tr_b16 v[28:29], v21 offset:46560
  ds_read_b64_tr_b16 v[30:31], v21 offset:47712
  v_mul_f32 v206, v198, v206
  v_mul_f32 v207, v199, v207
  s_waitcnt lgkmcnt(6)
  v_mfma_f32_32x32x16_bf16 a[208:223], v[40:43], a[104:107], a[208:223]
  ds_read_b64_tr_b16 v[32:33], v21 offset:46592
  ds_read_b64_tr_b16 v[34:35], v21 offset:47744
  v_add_f32 v58, 1.0, v58
  v_add_f32 v59, 1.0, v59
  s_waitcnt lgkmcnt(6)
  v_mfma_f32_32x32x16_bf16 a[224:239], v[44:47], a[104:107], a[224:239]
  ds_read_b64_tr_b16 v[36:37], v21 offset:50944
  ds_read_b64_tr_b16 v[38:39], v21 offset:52096
  v_rcp_f32 v58, v58
  v_rcp_f32 v59, v59
  s_waitcnt lgkmcnt(6)
  v_mfma_f32_32x32x16_bf16 a[240:255], v[24:27], a[104:107], a[240:255]
  ds_read_b64_tr_b16 v[40:41], v21 offset:50976
  ds_read_b64_tr_b16 v[42:43], v21 offset:52128
  v_mul_f32 v198, v206, v58
  v_mul_f32 v199, v207, v59
  s_waitcnt lgkmcnt(6)
  v_mfma_f32_32x32x16_bf16 v[208:223], v[28:31], a[104:107], v[208:223]
  ds_read_b64_tr_b16 v[44:45], v21 offset:51008
  ds_read_b64_tr_b16 v[46:47], v21 offset:52160
  v_cvt_pk_bf16_f32 v51, v198, v199
  buffer_store_dwordx4 v[48:51], v1, s[12:15], s25 offen offset:0 sc0 sc1
  s_waitcnt lgkmcnt(6)
  v_mfma_f32_32x32x16_bf16 v[224:239], v[32:35], a[104:107], v[224:239]
  ds_read_b64_tr_b16 v[24:25], v21 offset:51040
  ds_read_b64_tr_b16 v[26:27], v21 offset:52192
  s_add_u32 s25, s25, 1024
  s_waitcnt lgkmcnt(6)
  v_mfma_f32_32x32x16_bf16 a[144:159], v[36:39], a[108:111], a[144:159]
  ds_read_b64_tr_b16 v[28:29], v21 offset:51072
  ds_read_b64_tr_b16 v[30:31], v21 offset:52224
  s_waitcnt lgkmcnt(6)
  v_mfma_f32_32x32x16_bf16 a[160:175], v[40:43], a[108:111], a[160:175]
  ds_read_b64_tr_b16 v[32:33], v21 offset:51104
  ds_read_b64_tr_b16 v[34:35], v21 offset:52256
  s_waitcnt lgkmcnt(6)
  v_mfma_f32_32x32x16_bf16 a[176:191], v[44:47], a[108:111], a[176:191]
  ds_read_b64_tr_b16 v[36:37], v21 offset:51136
  ds_read_b64_tr_b16 v[38:39], v21 offset:52288
  s_waitcnt lgkmcnt(6)
  v_mfma_f32_32x32x16_bf16 a[192:207], v[24:27], a[108:111], a[192:207]
  ds_read_b64_tr_b16 v[40:41], v21 offset:51168
  ds_read_b64_tr_b16 v[42:43], v21 offset:52320
  s_waitcnt lgkmcnt(6)
  v_mfma_f32_32x32x16_bf16 a[208:223], v[28:31], a[108:111], a[208:223]
  ds_read_b64_tr_b16 v[44:45], v21 offset:51200
  ds_read_b64_tr_b16 v[46:47], v21 offset:52352
  s_waitcnt lgkmcnt(6)
  v_mfma_f32_32x32x16_bf16 a[224:239], v[32:35], a[108:111], a[224:239]
  s_waitcnt vmcnt(11) lgkmcnt(0)
  s_barrier
  ds_read_b64_tr_b16 v[24:25], v20 offset:0
  ds_read_b64_tr_b16 v[26:27], v20 offset:1152
  v_mfma_f32_32x32x16_bf16 a[240:255], v[36:39], a[108:111], a[240:255]
  ds_read_b64_tr_b16 v[28:29], v20 offset:4608
  ds_read_b64_tr_b16 v[30:31], v20 offset:5760
  v_mfma_f32_32x32x16_bf16 v[208:223], v[40:43], a[108:111], v[208:223]
  ds_read_b64_tr_b16 v[32:33], v20 offset:9216
  ds_read_b64_tr_b16 v[34:35], v20 offset:10368
  v_mfma_f32_32x32x16_bf16 v[224:239], v[44:47], a[108:111], v[224:239]
  ds_read_b64_tr_b16 v[36:37], v20 offset:13824
  ds_read_b64_tr_b16 v[38:39], v20 offset:14976
  s_waitcnt lgkmcnt(6)
  v_mfma_f32_32x32x16_bf16 a[144:159], v[24:27], a[112:115], a[144:159]
  s_waitcnt vmcnt(1) lgkmcnt(0)
  s_barrier
  ds_read_b64_tr_b16 v[40:41], v20 offset:37120
  ds_read_b64_tr_b16 v[42:43], v20 offset:38272
  v_mfma_f32_32x32x16_bf16 a[144:159], v[28:31], a[116:119], a[144:159]
  ds_read_b64_tr_b16 v[44:45], v20 offset:41728
  ds_read_b64_tr_b16 v[46:47], v20 offset:42880
  v_mfma_f32_32x32x16_bf16 a[144:159], v[32:35], a[120:123], a[144:159]
  ds_read_b64_tr_b16 v[24:25], v20 offset:46336
  ds_read_b64_tr_b16 v[26:27], v20 offset:47488
  v_mfma_f32_32x32x16_bf16 a[144:159], v[36:39], a[124:127], a[144:159]
  ds_read_b64_tr_b16 v[28:29], v20 offset:50944
  ds_read_b64_tr_b16 v[30:31], v20 offset:52096
  s_waitcnt lgkmcnt(6)
  v_mfma_f32_32x32x16_bf16 a[144:159], v[40:43], a[128:131], a[144:159]
  ds_read_b64_tr_b16 v[32:33], v20 offset:32
  ds_read_b64_tr_b16 v[34:35], v20 offset:1184
  s_waitcnt lgkmcnt(6)
  v_mfma_f32_32x32x16_bf16 a[144:159], v[44:47], a[132:135], a[144:159]
  ds_read_b64_tr_b16 v[36:37], v20 offset:4640
  ds_read_b64_tr_b16 v[38:39], v20 offset:5792
  s_waitcnt lgkmcnt(6)
  v_mfma_f32_32x32x16_bf16 a[144:159], v[24:27], a[136:139], a[144:159]
  ds_read_b64_tr_b16 v[40:41], v20 offset:9248
  ds_read_b64_tr_b16 v[42:43], v20 offset:10400
  s_waitcnt lgkmcnt(6)
  v_mfma_f32_32x32x16_bf16 a[144:159], v[28:31], a[140:143], a[144:159]
  ds_read_b64_tr_b16 v[44:45], v20 offset:13856
  ds_read_b64_tr_b16 v[46:47], v20 offset:15008
  s_waitcnt lgkmcnt(6)
  v_mfma_f32_32x32x16_bf16 a[160:175], v[32:35], a[112:115], a[160:175]
  ds_read_b64_tr_b16 v[24:25], v20 offset:37152
  ds_read_b64_tr_b16 v[26:27], v20 offset:38304
  s_waitcnt lgkmcnt(6)
  v_mfma_f32_32x32x16_bf16 a[160:175], v[36:39], a[116:119], a[160:175]
  ds_read_b64_tr_b16 v[28:29], v20 offset:41760
  ds_read_b64_tr_b16 v[30:31], v20 offset:42912
  s_waitcnt lgkmcnt(6)
  v_mfma_f32_32x32x16_bf16 a[160:175], v[40:43], a[120:123], a[160:175]
  ds_read_b64_tr_b16 v[32:33], v20 offset:46368
  ds_read_b64_tr_b16 v[34:35], v20 offset:47520
  v_accvgpr_read_b32 v64, a144
  v_accvgpr_read_b32 v65, a145
  v_accvgpr_read_b32 v66, a146
  v_accvgpr_read_b32 v67, a147
  v_accvgpr_read_b32 v68, a148
  v_accvgpr_read_b32 v69, a149
  v_accvgpr_read_b32 v70, a150
  v_accvgpr_read_b32 v71, a151
  s_waitcnt lgkmcnt(6)
  v_mfma_f32_32x32x16_bf16 a[160:175], v[44:47], a[124:127], a[160:175]
  ds_read_b64_tr_b16 v[36:37], v20 offset:50976
  ds_read_b64_tr_b16 v[38:39], v20 offset:52128
  v_accvgpr_read_b32 v72, a152
  v_accvgpr_read_b32 v73, a153
  v_accvgpr_read_b32 v74, a154
  v_accvgpr_read_b32 v75, a155
  v_accvgpr_read_b32 v76, a156
  v_accvgpr_read_b32 v77, a157
  v_accvgpr_read_b32 v78, a158
  v_accvgpr_read_b32 v79, a159
  s_waitcnt lgkmcnt(6)
  v_mfma_f32_32x32x16_bf16 a[160:175], v[24:27], a[128:131], a[160:175]
  ds_read_b64_tr_b16 v[40:41], v20 offset:64
  ds_read_b64_tr_b16 v[42:43], v20 offset:1216
  v_mul_f32 v56, 0xbfb8aa3b, v64
  v_mul_f32 v57, 0xbfb8aa3b, v65
  v_exp_f32 v56, v56
  v_exp_f32 v57, v57
  v_mul_f32 v72, v64, v72
  v_mul_f32 v73, v65, v73
  v_add_f32 v56, 1.0, v56
  v_add_f32 v57, 1.0, v57
  s_waitcnt lgkmcnt(6)
  v_mfma_f32_32x32x16_bf16 a[160:175], v[28:31], a[132:135], a[160:175]
  ds_read_b64_tr_b16 v[44:45], v20 offset:4672
  ds_read_b64_tr_b16 v[46:47], v20 offset:5824
  v_rcp_f32 v56, v56
  v_rcp_f32 v57, v57
  v_mul_f32 v64, v72, v56
  v_mul_f32 v65, v73, v57
  v_cvt_pk_bf16_f32 v48, v64, v65
  v_mul_f32 v58, 0xbfb8aa3b, v66
  v_mul_f32 v59, 0xbfb8aa3b, v67
  v_exp_f32 v58, v58
  s_waitcnt lgkmcnt(6)
  v_mfma_f32_32x32x16_bf16 a[160:175], v[32:35], a[136:139], a[160:175]
  ds_read_b64_tr_b16 v[24:25], v20 offset:9280
  ds_read_b64_tr_b16 v[26:27], v20 offset:10432
  v_exp_f32 v59, v59
  v_mul_f32 v74, v66, v74
  v_mul_f32 v75, v67, v75
  v_add_f32 v58, 1.0, v58
  v_add_f32 v59, 1.0, v59
  v_rcp_f32 v58, v58
  v_rcp_f32 v59, v59
  v_mul_f32 v66, v74, v58
  s_waitcnt lgkmcnt(6)
  v_mfma_f32_32x32x16_bf16 a[160:175], v[36:39], a[140:143], a[160:175]
  ds_read_b64_tr_b16 v[28:29], v20 offset:13888
  ds_read_b64_tr_b16 v[30:31], v20 offset:15040
  v_mul_f32 v67, v75, v59
  v_cvt_pk_bf16_f32 v49, v66, v67
  v_mul_f32 v56, 0xbfb8aa3b, v68
  v_mul_f32 v57, 0xbfb8aa3b, v69
  v_exp_f32 v56, v56
  v_exp_f32 v57, v57
  v_mul_f32 v76, v68, v76
  v_mul_f32 v77, v69, v77
  s_waitcnt lgkmcnt(6)
  v_mfma_f32_32x32x16_bf16 a[176:191], v[40:43], a[112:115], a[176:191]
  ds_read_b64_tr_b16 v[32:33], v20 offset:37184
  ds_read_b64_tr_b16 v[34:35], v20 offset:38336
  v_add_f32 v56, 1.0, v56
  v_add_f32 v57, 1.0, v57
  v_rcp_f32 v56, v56
  v_rcp_f32 v57, v57
  v_mul_f32 v68, v76, v56
  v_mul_f32 v69, v77, v57
  v_cvt_pk_bf16_f32 v50, v68, v69
  v_mul_f32 v58, 0xbfb8aa3b, v70
  s_waitcnt lgkmcnt(6)
  v_mfma_f32_32x32x16_bf16 a[176:191], v[44:47], a[116:119], a[176:191]
  ds_read_b64_tr_b16 v[36:37], v20 offset:41792
  ds_read_b64_tr_b16 v[38:39], v20 offset:42944
  v_mul_f32 v59, 0xbfb8aa3b, v71
  v_exp_f32 v58, v58
  v_exp_f32 v59, v59
  v_mul_f32 v78, v70, v78
  v_mul_f32 v79, v71, v79
  v_add_f32 v58, 1.0, v58
  v_add_f32 v59, 1.0, v59
  v_rcp_f32 v58, v58
  s_waitcnt lgkmcnt(6)
  v_mfma_f32_32x32x16_bf16 a[176:191], v[24:27], a[120:123], a[176:191]
  ds_read_b64_tr_b16 v[40:41], v20 offset:46400
  ds_read_b64_tr_b16 v[42:43], v20 offset:47552
  v_rcp_f32 v59, v59
  v_mul_f32 v70, v78, v58
  v_mul_f32 v71, v79, v59
  v_cvt_pk_bf16_f32 v51, v70, v71
  buffer_store_dwordx4 v[48:51], v1, s[12:15], s25 offen offset:0 sc0 sc1
  v_accvgpr_read_b32 v80, a160
  v_accvgpr_read_b32 v81, a161
  v_accvgpr_read_b32 v82, a162
  s_waitcnt lgkmcnt(6)
  v_mfma_f32_32x32x16_bf16 a[176:191], v[28:31], a[124:127], a[176:191]
  ds_read_b64_tr_b16 v[44:45], v20 offset:51008
  ds_read_b64_tr_b16 v[46:47], v20 offset:52160
  v_accvgpr_read_b32 v83, a163
  v_accvgpr_read_b32 v84, a164
  v_accvgpr_read_b32 v85, a165
  v_accvgpr_read_b32 v86, a166
  v_accvgpr_read_b32 v87, a167
  v_accvgpr_read_b32 v88, a168
  v_accvgpr_read_b32 v89, a169
  v_accvgpr_read_b32 v90, a170
  s_waitcnt lgkmcnt(6)
  v_mfma_f32_32x32x16_bf16 a[176:191], v[32:35], a[128:131], a[176:191]
  ds_read_b64_tr_b16 v[24:25], v20 offset:96
  ds_read_b64_tr_b16 v[26:27], v20 offset:1248
  v_accvgpr_read_b32 v91, a171
  v_accvgpr_read_b32 v92, a172
  v_accvgpr_read_b32 v93, a173
  v_accvgpr_read_b32 v94, a174
  v_accvgpr_read_b32 v95, a175
  v_mul_f32 v56, 0xbfb8aa3b, v80
  v_mul_f32 v57, 0xbfb8aa3b, v81
  v_exp_f32 v56, v56
  s_waitcnt lgkmcnt(6)
  v_mfma_f32_32x32x16_bf16 a[176:191], v[36:39], a[132:135], a[176:191]
  ds_read_b64_tr_b16 v[28:29], v20 offset:4704
  ds_read_b64_tr_b16 v[30:31], v20 offset:5856
  v_exp_f32 v57, v57
  v_mul_f32 v88, v80, v88
  v_mul_f32 v89, v81, v89
  v_add_f32 v56, 1.0, v56
  v_add_f32 v57, 1.0, v57
  v_rcp_f32 v56, v56
  v_rcp_f32 v57, v57
  v_mul_f32 v80, v88, v56
  s_waitcnt lgkmcnt(6)
  v_mfma_f32_32x32x16_bf16 a[176:191], v[40:43], a[136:139], a[176:191]
  ds_read_b64_tr_b16 v[32:33], v20 offset:9312
  ds_read_b64_tr_b16 v[34:35], v20 offset:10464
  v_mul_f32 v81, v89, v57
  v_cvt_pk_bf16_f32 v52, v80, v81
  v_mul_f32 v58, 0xbfb8aa3b, v82
  v_mul_f32 v59, 0xbfb8aa3b, v83
  v_exp_f32 v58, v58
  v_exp_f32 v59, v59
  v_mul_f32 v90, v82, v90
  v_mul_f32 v91, v83, v91
  s_waitcnt lgkmcnt(6)
  v_mfma_f32_32x32x16_bf16 a[176:191], v[44:47], a[140:143], a[176:191]
  ds_read_b64_tr_b16 v[36:37], v20 offset:13920
  ds_read_b64_tr_b16 v[38:39], v20 offset:15072
  v_add_f32 v58, 1.0, v58
  v_add_f32 v59, 1.0, v59
  v_rcp_f32 v58, v58
  v_rcp_f32 v59, v59
  v_mul_f32 v82, v90, v58
  v_mul_f32 v83, v91, v59
  v_cvt_pk_bf16_f32 v53, v82, v83
  v_mul_f32 v56, 0xbfb8aa3b, v84
  s_waitcnt lgkmcnt(6)
  v_mfma_f32_32x32x16_bf16 a[192:207], v[24:27], a[112:115], a[192:207]
  ds_read_b64_tr_b16 v[40:41], v20 offset:37216
  ds_read_b64_tr_b16 v[42:43], v20 offset:38368
  v_mul_f32 v57, 0xbfb8aa3b, v85
  v_exp_f32 v56, v56
  v_exp_f32 v57, v57
  v_mul_f32 v92, v84, v92
  v_mul_f32 v93, v85, v93
  v_add_f32 v56, 1.0, v56
  v_add_f32 v57, 1.0, v57
  v_rcp_f32 v56, v56
  s_waitcnt lgkmcnt(6)
  v_mfma_f32_32x32x16_bf16 a[192:207], v[28:31], a[116:119], a[192:207]
  ds_read_b64_tr_b16 v[44:45], v20 offset:41824
  ds_read_b64_tr_b16 v[46:47], v20 offset:42976
  v_rcp_f32 v57, v57
  v_mul_f32 v84, v92, v56
  v_mul_f32 v85, v93, v57
  v_cvt_pk_bf16_f32 v54, v84, v85
  v_mul_f32 v58, 0xbfb8aa3b, v86
  v_mul_f32 v59, 0xbfb8aa3b, v87
  v_exp_f32 v58, v58
  v_exp_f32 v59, v59
  s_waitcnt lgkmcnt(6)
  v_mfma_f32_32x32x16_bf16 a[192:207], v[32:35], a[120:123], a[192:207]
  ds_read_b64_tr_b16 v[24:25], v20 offset:46432
  ds_read_b64_tr_b16 v[26:27], v20 offset:47584
  v_mul_f32 v94, v86, v94
  v_mul_f32 v95, v87, v95
  v_add_f32 v58, 1.0, v58
  v_add_f32 v59, 1.0, v59
  v_rcp_f32 v58, v58
  v_rcp_f32 v59, v59
  v_mul_f32 v86, v94, v58
  v_mul_f32 v87, v95, v59
  s_waitcnt lgkmcnt(6)
  v_mfma_f32_32x32x16_bf16 a[192:207], v[36:39], a[124:127], a[192:207]
  ds_read_b64_tr_b16 v[28:29], v20 offset:51040
  ds_read_b64_tr_b16 v[30:31], v20 offset:52192
  v_cvt_pk_bf16_f32 v55, v86, v87
  buffer_store_dwordx4 v[52:55], v1, s[12:15], s25 offen offset:1024 sc0 sc1
  v_accvgpr_read_b32 v64, a176
  v_accvgpr_read_b32 v65, a177
  v_accvgpr_read_b32 v66, a178
  v_accvgpr_read_b32 v67, a179
  v_accvgpr_read_b32 v68, a180
  v_accvgpr_read_b32 v69, a181
  s_waitcnt lgkmcnt(6)
  v_mfma_f32_32x32x16_bf16 a[192:207], v[40:43], a[128:131], a[192:207]
  ds_read_b64_tr_b16 v[32:33], v20 offset:128
  ds_read_b64_tr_b16 v[34:35], v20 offset:1280
  v_accvgpr_read_b32 v70, a182
  v_accvgpr_read_b32 v71, a183
  v_accvgpr_read_b32 v72, a184
  v_accvgpr_read_b32 v73, a185
  v_accvgpr_read_b32 v74, a186
  v_accvgpr_read_b32 v75, a187
  v_accvgpr_read_b32 v76, a188
  v_accvgpr_read_b32 v77, a189
  s_waitcnt lgkmcnt(6)
  v_mfma_f32_32x32x16_bf16 a[192:207], v[44:47], a[132:135], a[192:207]
  ds_read_b64_tr_b16 v[36:37], v20 offset:4736
  ds_read_b64_tr_b16 v[38:39], v20 offset:5888
  v_accvgpr_read_b32 v78, a190
  v_accvgpr_read_b32 v79, a191
  v_mul_f32 v56, 0xbfb8aa3b, v64
  v_mul_f32 v57, 0xbfb8aa3b, v65
  v_exp_f32 v56, v56
  v_exp_f32 v57, v57
  v_mul_f32 v72, v64, v72
  v_mul_f32 v73, v65, v73
  s_waitcnt lgkmcnt(6)
  v_mfma_f32_32x32x16_bf16 a[192:207], v[24:27], a[136:139], a[192:207]
  ds_read_b64_tr_b16 v[40:41], v20 offset:9344
  ds_read_b64_tr_b16 v[42:43], v20 offset:10496
  v_add_f32 v56, 1.0, v56
  v_add_f32 v57, 1.0, v57
  v_rcp_f32 v56, v56
  v_rcp_f32 v57, v57
  v_mul_f32 v64, v72, v56
  v_mul_f32 v65, v73, v57
  v_cvt_pk_bf16_f32 v48, v64, v65
  v_mul_f32 v58, 0xbfb8aa3b, v66
  s_waitcnt lgkmcnt(6)
  v_mfma_f32_32x32x16_bf16 a[192:207], v[28:31], a[140:143], a[192:207]
  ds_read_b64_tr_b16 v[44:45], v20 offset:13952
  ds_read_b64_tr_b16 v[46:47], v20 offset:15104
  v_mul_f32 v59, 0xbfb8aa3b, v67
  v_exp_f32 v58, v58
  v_exp_f32 v59, v59
  v_mul_f32 v74, v66, v74
  v_mul_f32 v75, v67, v75
  v_add_f32 v58, 1.0, v58
  v_add_f32 v59, 1.0, v59
  v_rcp_f32 v58, v58
  s_waitcnt lgkmcnt(6)
  v_mfma_f32_32x32x16_bf16 a[208:223], v[32:35], a[112:115], a[208:223]
  ds_read_b64_tr_b16 v[24:25], v20 offset:37248
  ds_read_b64_tr_b16 v[26:27], v20 offset:38400
  v_rcp_f32 v59, v59
  v_mul_f32 v66, v74, v58
  v_mul_f32 v67, v75, v59
  v_cvt_pk_bf16_f32 v49, v66, v67
  v_mul_f32 v56, 0xbfb8aa3b, v68
  v_mul_f32 v57, 0xbfb8aa3b, v69
  v_exp_f32 v56, v56
  v_exp_f32 v57, v57
  s_waitcnt lgkmcnt(6)
  v_mfma_f32_32x32x16_bf16 a[208:223], v[36:39], a[116:119], a[208:223]
  ds_read_b64_tr_b16 v[28:29], v20 offset:41856
  ds_read_b64_tr_b16 v[30:31], v20 offset:43008
  v_mul_f32 v76, v68, v76
  v_mul_f32 v77, v69, v77
  v_add_f32 v56, 1.0, v56
  v_add_f32 v57, 1.0, v57
  v_rcp_f32 v56, v56
  v_rcp_f32 v57, v57
  v_mul_f32 v68, v76, v56
  v_mul_f32 v69, v77, v57
  s_waitcnt lgkmcnt(6)
  v_mfma_f32_32x32x16_bf16 a[208:223], v[40:43], a[120:123], a[208:223]
  ds_read_b64_tr_b16 v[32:33], v20 offset:46464
  ds_read_b64_tr_b16 v[34:35], v20 offset:47616
  v_cvt_pk_bf16_f32 v50, v68, v69
  v_mul_f32 v58, 0xbfb8aa3b, v70
  v_mul_f32 v59, 0xbfb8aa3b, v71
  v_exp_f32 v58, v58
  v_exp_f32 v59, v59
  v_mul_f32 v78, v70, v78
  v_mul_f32 v79, v71, v79
  v_add_f32 v58, 1.0, v58
  s_waitcnt lgkmcnt(6)
  v_mfma_f32_32x32x16_bf16 a[208:223], v[44:47], a[124:127], a[208:223]
  ds_read_b64_tr_b16 v[36:37], v20 offset:51072
  ds_read_b64_tr_b16 v[38:39], v20 offset:52224
  v_add_f32 v59, 1.0, v59
  v_rcp_f32 v58, v58
  v_rcp_f32 v59, v59
  v_mul_f32 v70, v78, v58
  v_mul_f32 v71, v79, v59
  v_cvt_pk_bf16_f32 v51, v70, v71
  buffer_store_dwordx4 v[48:51], v1, s[12:15], s25 offen offset:2048 sc0 sc1
  v_accvgpr_read_b32 v80, a192
  s_waitcnt lgkmcnt(6)
  v_mfma_f32_32x32x16_bf16 a[208:223], v[24:27], a[128:131], a[208:223]
  ds_read_b64_tr_b16 v[40:41], v20 offset:160
  ds_read_b64_tr_b16 v[42:43], v20 offset:1312
  v_accvgpr_read_b32 v81, a193
  v_accvgpr_read_b32 v82, a194
  v_accvgpr_read_b32 v83, a195
  v_accvgpr_read_b32 v84, a196
  v_accvgpr_read_b32 v85, a197
  v_accvgpr_read_b32 v86, a198
  v_accvgpr_read_b32 v87, a199
  v_accvgpr_read_b32 v88, a200
  s_waitcnt lgkmcnt(6)
  v_mfma_f32_32x32x16_bf16 a[208:223], v[28:31], a[132:135], a[208:223]
  ds_read_b64_tr_b16 v[44:45], v20 offset:4768
  ds_read_b64_tr_b16 v[46:47], v20 offset:5920
  v_accvgpr_read_b32 v89, a201
  v_accvgpr_read_b32 v90, a202
  v_accvgpr_read_b32 v91, a203
  v_accvgpr_read_b32 v92, a204
  v_accvgpr_read_b32 v93, a205
  v_accvgpr_read_b32 v94, a206
  v_accvgpr_read_b32 v95, a207
  v_mul_f32 v56, 0xbfb8aa3b, v80
  s_waitcnt lgkmcnt(6)
  v_mfma_f32_32x32x16_bf16 a[208:223], v[32:35], a[136:139], a[208:223]
  ds_read_b64_tr_b16 v[24:25], v20 offset:9376
  ds_read_b64_tr_b16 v[26:27], v20 offset:10528
  v_mul_f32 v57, 0xbfb8aa3b, v81
  v_exp_f32 v56, v56
  v_exp_f32 v57, v57
  v_mul_f32 v88, v80, v88
  v_mul_f32 v89, v81, v89
  v_add_f32 v56, 1.0, v56
  v_add_f32 v57, 1.0, v57
  v_rcp_f32 v56, v56
  s_waitcnt lgkmcnt(6)
  v_mfma_f32_32x32x16_bf16 a[208:223], v[36:39], a[140:143], a[208:223]
  ds_read_b64_tr_b16 v[28:29], v20 offset:13984
  ds_read_b64_tr_b16 v[30:31], v20 offset:15136
  v_rcp_f32 v57, v57
  v_mul_f32 v80, v88, v56
  v_mul_f32 v81, v89, v57
  v_cvt_pk_bf16_f32 v52, v80, v81
  v_mul_f32 v58, 0xbfb8aa3b, v82
  v_mul_f32 v59, 0xbfb8aa3b, v83
  v_exp_f32 v58, v58
  v_exp_f32 v59, v59
  s_waitcnt lgkmcnt(6)
  v_mfma_f32_32x32x16_bf16 a[224:239], v[40:43], a[112:115], a[224:239]
  ds_read_b64_tr_b16 v[32:33], v20 offset:37280
  ds_read_b64_tr_b16 v[34:35], v20 offset:38432
  v_mul_f32 v90, v82, v90
  v_mul_f32 v91, v83, v91
  v_add_f32 v58, 1.0, v58
  v_add_f32 v59, 1.0, v59
  v_rcp_f32 v58, v58
  v_rcp_f32 v59, v59
  v_mul_f32 v82, v90, v58
  v_mul_f32 v83, v91, v59
  s_waitcnt lgkmcnt(6)
  v_mfma_f32_32x32x16_bf16 a[224:239], v[44:47], a[116:119], a[224:239]
  ds_read_b64_tr_b16 v[36:37], v20 offset:41888
  ds_read_b64_tr_b16 v[38:39], v20 offset:43040
  v_cvt_pk_bf16_f32 v53, v82, v83
  v_mul_f32 v56, 0xbfb8aa3b, v84
  v_mul_f32 v57, 0xbfb8aa3b, v85
  v_exp_f32 v56, v56
  v_exp_f32 v57, v57
  v_mul_f32 v92, v84, v92
  v_mul_f32 v93, v85, v93
  v_add_f32 v56, 1.0, v56
  s_waitcnt lgkmcnt(6)
  v_mfma_f32_32x32x16_bf16 a[224:239], v[24:27], a[120:123], a[224:239]
  ds_read_b64_tr_b16 v[40:41], v20 offset:46496
  ds_read_b64_tr_b16 v[42:43], v20 offset:47648
  v_add_f32 v57, 1.0, v57
  v_rcp_f32 v56, v56
  v_rcp_f32 v57, v57
  v_mul_f32 v84, v92, v56
  v_mul_f32 v85, v93, v57
  v_cvt_pk_bf16_f32 v54, v84, v85
  v_mul_f32 v58, 0xbfb8aa3b, v86
  v_mul_f32 v59, 0xbfb8aa3b, v87
  s_waitcnt lgkmcnt(6)
  v_mfma_f32_32x32x16_bf16 a[224:239], v[28:31], a[124:127], a[224:239]
  ds_read_b64_tr_b16 v[44:45], v20 offset:51104
  ds_read_b64_tr_b16 v[46:47], v20 offset:52256
  v_exp_f32 v58, v58
  v_exp_f32 v59, v59
  v_mul_f32 v94, v86, v94
  v_mul_f32 v95, v87, v95
  v_add_f32 v58, 1.0, v58
  v_add_f32 v59, 1.0, v59
  v_rcp_f32 v58, v58
  v_rcp_f32 v59, v59
  s_waitcnt lgkmcnt(6)
  v_mfma_f32_32x32x16_bf16 a[224:239], v[32:35], a[128:131], a[224:239]
  ds_read_b64_tr_b16 v[24:25], v20 offset:192
  ds_read_b64_tr_b16 v[26:27], v20 offset:1344
  v_mul_f32 v86, v94, v58
  v_mul_f32 v87, v95, v59
  v_cvt_pk_bf16_f32 v55, v86, v87
  buffer_store_dwordx4 v[52:55], v1, s[12:15], s25 offen offset:3072 sc0 sc1
  s_add_u32 s25, s25, 4096
  v_accvgpr_read_b32 v64, a208
  v_accvgpr_read_b32 v65, a209
  v_accvgpr_read_b32 v66, a210
  s_waitcnt lgkmcnt(6)
  v_mfma_f32_32x32x16_bf16 a[224:239], v[36:39], a[132:135], a[224:239]
  ds_read_b64_tr_b16 v[28:29], v20 offset:4800
  ds_read_b64_tr_b16 v[30:31], v20 offset:5952
  v_accvgpr_read_b32 v67, a211
  v_accvgpr_read_b32 v68, a212
  v_accvgpr_read_b32 v69, a213
  v_accvgpr_read_b32 v70, a214
  v_accvgpr_read_b32 v71, a215
  v_accvgpr_read_b32 v72, a216
  v_accvgpr_read_b32 v73, a217
  v_accvgpr_read_b32 v74, a218
  s_waitcnt lgkmcnt(6)
  v_mfma_f32_32x32x16_bf16 a[224:239], v[40:43], a[136:139], a[224:239]
  ds_read_b64_tr_b16 v[32:33], v20 offset:9408
  ds_read_b64_tr_b16 v[34:35], v20 offset:10560
  v_accvgpr_read_b32 v75, a219
  v_accvgpr_read_b32 v76, a220
  v_accvgpr_read_b32 v77, a221
  v_accvgpr_read_b32 v78, a222
  v_accvgpr_read_b32 v79, a223
  v_mul_f32 v56, 0xbfb8aa3b, v64
  v_mul_f32 v57, 0xbfb8aa3b, v65
  v_exp_f32 v56, v56
  s_waitcnt lgkmcnt(6)
  v_mfma_f32_32x32x16_bf16 a[224:239], v[44:47], a[140:143], a[224:239]
  ds_read_b64_tr_b16 v[36:37], v20 offset:14016
  ds_read_b64_tr_b16 v[38:39], v20 offset:15168
  v_exp_f32 v57, v57
  v_mul_f32 v72, v64, v72
  v_mul_f32 v73, v65, v73
  v_add_f32 v56, 1.0, v56
  v_add_f32 v57, 1.0, v57
  v_rcp_f32 v56, v56
  v_rcp_f32 v57, v57
  v_mul_f32 v64, v72, v56
  s_waitcnt lgkmcnt(6)
  v_mfma_f32_32x32x16_bf16 a[240:255], v[24:27], a[112:115], a[240:255]
  ds_read_b64_tr_b16 v[40:41], v20 offset:37312
  ds_read_b64_tr_b16 v[42:43], v20 offset:38464
  v_mul_f32 v65, v73, v57
  v_cvt_pk_bf16_f32 v48, v64, v65
  v_mul_f32 v58, 0xbfb8aa3b, v66
  v_mul_f32 v59, 0xbfb8aa3b, v67
  v_exp_f32 v58, v58
  v_exp_f32 v59, v59
  v_mul_f32 v74, v66, v74
  v_mul_f32 v75, v67, v75
  s_waitcnt lgkmcnt(6)
  v_mfma_f32_32x32x16_bf16 a[240:255], v[28:31], a[116:119], a[240:255]
  ds_read_b64_tr_b16 v[44:45], v20 offset:41920
  ds_read_b64_tr_b16 v[46:47], v20 offset:43072
  v_add_f32 v58, 1.0, v58
  v_add_f32 v59, 1.0, v59
  v_rcp_f32 v58, v58
  v_rcp_f32 v59, v59
  v_mul_f32 v66, v74, v58
  v_mul_f32 v67, v75, v59
  v_cvt_pk_bf16_f32 v49, v66, v67
  v_mul_f32 v56, 0xbfb8aa3b, v68
  s_waitcnt lgkmcnt(6)
  v_mfma_f32_32x32x16_bf16 a[240:255], v[32:35], a[120:123], a[240:255]
  ds_read_b64_tr_b16 v[24:25], v20 offset:46528
  ds_read_b64_tr_b16 v[26:27], v20 offset:47680
  v_mul_f32 v57, 0xbfb8aa3b, v69
  v_exp_f32 v56, v56
  v_exp_f32 v57, v57
  v_mul_f32 v76, v68, v76
  v_mul_f32 v77, v69, v77
  v_add_f32 v56, 1.0, v56
  v_add_f32 v57, 1.0, v57
  v_rcp_f32 v56, v56
  s_waitcnt lgkmcnt(6)
  v_mfma_f32_32x32x16_bf16 a[240:255], v[36:39], a[124:127], a[240:255]
  ds_read_b64_tr_b16 v[28:29], v20 offset:51136
  ds_read_b64_tr_b16 v[30:31], v20 offset:52288
  v_rcp_f32 v57, v57
  v_mul_f32 v68, v76, v56
  v_mul_f32 v69, v77, v57
  v_cvt_pk_bf16_f32 v50, v68, v69
  v_mul_f32 v58, 0xbfb8aa3b, v70
  v_mul_f32 v59, 0xbfb8aa3b, v71
  v_exp_f32 v58, v58
  v_exp_f32 v59, v59
  s_waitcnt lgkmcnt(6)
  v_mfma_f32_32x32x16_bf16 a[240:255], v[40:43], a[128:131], a[240:255]
  ds_read_b64_tr_b16 v[32:33], v20 offset:224
  ds_read_b64_tr_b16 v[34:35], v20 offset:1376
  v_mul_f32 v78, v70, v78
  v_mul_f32 v79, v71, v79
  v_add_f32 v58, 1.0, v58
  v_add_f32 v59, 1.0, v59
  v_rcp_f32 v58, v58
  v_rcp_f32 v59, v59
  v_mul_f32 v70, v78, v58
  v_mul_f32 v71, v79, v59
  s_waitcnt lgkmcnt(6)
  v_mfma_f32_32x32x16_bf16 a[240:255], v[44:47], a[132:135], a[240:255]
  ds_read_b64_tr_b16 v[36:37], v20 offset:4832
  ds_read_b64_tr_b16 v[38:39], v20 offset:5984
  v_cvt_pk_bf16_f32 v51, v70, v71
  buffer_store_dwordx4 v[48:51], v1, s[12:15], s25 offen offset:0 sc0 sc1
  v_accvgpr_read_b32 v80, a224
  v_accvgpr_read_b32 v81, a225
  v_accvgpr_read_b32 v82, a226
  v_accvgpr_read_b32 v83, a227
  v_accvgpr_read_b32 v84, a228
  v_accvgpr_read_b32 v85, a229
  s_waitcnt lgkmcnt(6)
  v_mfma_f32_32x32x16_bf16 a[240:255], v[24:27], a[136:139], a[240:255]
  ds_read_b64_tr_b16 v[40:41], v20 offset:9440
  ds_read_b64_tr_b16 v[42:43], v20 offset:10592
  v_accvgpr_read_b32 v86, a230
  v_accvgpr_read_b32 v87, a231
  v_accvgpr_read_b32 v88, a232
  v_accvgpr_read_b32 v89, a233
  v_accvgpr_read_b32 v90, a234
  v_accvgpr_read_b32 v91, a235
  v_accvgpr_read_b32 v92, a236
  v_accvgpr_read_b32 v93, a237
  s_waitcnt lgkmcnt(6)
  v_mfma_f32_32x32x16_bf16 a[240:255], v[28:31], a[140:143], a[240:255]
  ds_read_b64_tr_b16 v[44:45], v20 offset:14048
  ds_read_b64_tr_b16 v[46:47], v20 offset:15200
  v_accvgpr_read_b32 v94, a238
  v_accvgpr_read_b32 v95, a239
  v_mul_f32 v56, 0xbfb8aa3b, v80
  v_mul_f32 v57, 0xbfb8aa3b, v81
  v_exp_f32 v56, v56
  v_exp_f32 v57, v57
  v_mul_f32 v88, v80, v88
  v_mul_f32 v89, v81, v89
  s_waitcnt lgkmcnt(6)
  v_mfma_f32_32x32x16_bf16 v[208:223], v[32:35], a[112:115], v[208:223]
  ds_read_b64_tr_b16 v[24:25], v20 offset:37344
  ds_read_b64_tr_b16 v[26:27], v20 offset:38496
  v_add_f32 v56, 1.0, v56
  v_add_f32 v57, 1.0, v57
  v_rcp_f32 v56, v56
  v_rcp_f32 v57, v57
  v_mul_f32 v80, v88, v56
  v_mul_f32 v81, v89, v57
  v_cvt_pk_bf16_f32 v52, v80, v81
  v_mul_f32 v58, 0xbfb8aa3b, v82
  s_waitcnt lgkmcnt(6)
  v_mfma_f32_32x32x16_bf16 v[208:223], v[36:39], a[116:119], v[208:223]
  ds_read_b64_tr_b16 v[28:29], v20 offset:41952
  ds_read_b64_tr_b16 v[30:31], v20 offset:43104
  v_mul_f32 v59, 0xbfb8aa3b, v83
  v_exp_f32 v58, v58
  v_exp_f32 v59, v59
  v_mul_f32 v90, v82, v90
  v_mul_f32 v91, v83, v91
  v_add_f32 v58, 1.0, v58
  v_add_f32 v59, 1.0, v59
  v_rcp_f32 v58, v58
  s_waitcnt lgkmcnt(6)
  v_mfma_f32_32x32x16_bf16 v[208:223], v[40:43], a[120:123], v[208:223]
  ds_read_b64_tr_b16 v[32:33], v20 offset:46560
  ds_read_b64_tr_b16 v[34:35], v20 offset:47712
  v_rcp_f32 v59, v59
  v_mul_f32 v82, v90, v58
  v_mul_f32 v83, v91, v59
  v_cvt_pk_bf16_f32 v53, v82, v83
  v_mul_f32 v56, 0xbfb8aa3b, v84
  v_mul_f32 v57, 0xbfb8aa3b, v85
  v_exp_f32 v56, v56
  v_exp_f32 v57, v57
  s_waitcnt lgkmcnt(6)
  v_mfma_f32_32x32x16_bf16 v[208:223], v[44:47], a[124:127], v[208:223]
  ds_read_b64_tr_b16 v[36:37], v20 offset:51168
  ds_read_b64_tr_b16 v[38:39], v20 offset:52320
  v_mul_f32 v92, v84, v92
  v_mul_f32 v93, v85, v93
  v_add_f32 v56, 1.0, v56
  v_add_f32 v57, 1.0, v57
  v_rcp_f32 v56, v56
  v_rcp_f32 v57, v57
  v_mul_f32 v84, v92, v56
  v_mul_f32 v85, v93, v57
  s_waitcnt lgkmcnt(6)
  v_mfma_f32_32x32x16_bf16 v[208:223], v[24:27], a[128:131], v[208:223]
  ds_read_b64_tr_b16 v[40:41], v20 offset:256
  ds_read_b64_tr_b16 v[42:43], v20 offset:1408
  v_cvt_pk_bf16_f32 v54, v84, v85
  v_mul_f32 v58, 0xbfb8aa3b, v86
  v_mul_f32 v59, 0xbfb8aa3b, v87
  v_exp_f32 v58, v58
  v_exp_f32 v59, v59
  v_mul_f32 v94, v86, v94
  v_mul_f32 v95, v87, v95
  v_add_f32 v58, 1.0, v58
  s_waitcnt lgkmcnt(6)
  v_mfma_f32_32x32x16_bf16 v[208:223], v[28:31], a[132:135], v[208:223]
  ds_read_b64_tr_b16 v[44:45], v20 offset:4864
  ds_read_b64_tr_b16 v[46:47], v20 offset:6016
  v_add_f32 v59, 1.0, v59
  v_rcp_f32 v58, v58
  v_rcp_f32 v59, v59
  v_mul_f32 v86, v94, v58
  v_mul_f32 v87, v95, v59
  v_cvt_pk_bf16_f32 v55, v86, v87
  buffer_store_dwordx4 v[52:55], v1, s[12:15], s25 offen offset:1024 sc0 sc1
  v_accvgpr_read_b32 v64, a240
  s_waitcnt lgkmcnt(6)
  v_mfma_f32_32x32x16_bf16 v[208:223], v[32:35], a[136:139], v[208:223]
  ds_read_b64_tr_b16 v[24:25], v20 offset:9472
  ds_read_b64_tr_b16 v[26:27], v20 offset:10624
  v_accvgpr_read_b32 v65, a241
  v_accvgpr_read_b32 v66, a242
  v_accvgpr_read_b32 v67, a243
  v_accvgpr_read_b32 v68, a244
  v_accvgpr_read_b32 v69, a245
  v_accvgpr_read_b32 v70, a246
  v_accvgpr_read_b32 v71, a247
  v_accvgpr_read_b32 v72, a248
  s_waitcnt lgkmcnt(6)
  v_mfma_f32_32x32x16_bf16 v[208:223], v[36:39], a[140:143], v[208:223]
  ds_read_b64_tr_b16 v[28:29], v20 offset:14080
  ds_read_b64_tr_b16 v[30:31], v20 offset:15232
  v_accvgpr_read_b32 v73, a249
  v_accvgpr_read_b32 v74, a250
  v_accvgpr_read_b32 v75, a251
  v_accvgpr_read_b32 v76, a252
  v_accvgpr_read_b32 v77, a253
  v_accvgpr_read_b32 v78, a254
  v_accvgpr_read_b32 v79, a255
  v_mul_f32 v56, 0xbfb8aa3b, v64
  s_waitcnt lgkmcnt(6)
  v_mfma_f32_32x32x16_bf16 v[224:239], v[40:43], a[112:115], v[224:239]
  ds_read_b64_tr_b16 v[32:33], v20 offset:37376
  ds_read_b64_tr_b16 v[34:35], v20 offset:38528
  v_mul_f32 v57, 0xbfb8aa3b, v65
  v_exp_f32 v56, v56
  v_exp_f32 v57, v57
  v_mul_f32 v72, v64, v72
  v_mul_f32 v73, v65, v73
  v_add_f32 v56, 1.0, v56
  v_add_f32 v57, 1.0, v57
  v_rcp_f32 v56, v56
  s_waitcnt lgkmcnt(6)
  v_mfma_f32_32x32x16_bf16 v[224:239], v[44:47], a[116:119], v[224:239]
  ds_read_b64_tr_b16 v[36:37], v20 offset:41984
  ds_read_b64_tr_b16 v[38:39], v20 offset:43136
  v_rcp_f32 v57, v57
  v_mul_f32 v64, v72, v56
  v_mul_f32 v65, v73, v57
  v_cvt_pk_bf16_f32 v48, v64, v65
  v_mul_f32 v58, 0xbfb8aa3b, v66
  v_mul_f32 v59, 0xbfb8aa3b, v67
  v_exp_f32 v58, v58
  v_exp_f32 v59, v59
  s_waitcnt lgkmcnt(6)
  v_mfma_f32_32x32x16_bf16 v[224:239], v[24:27], a[120:123], v[224:239]
  ds_read_b64_tr_b16 v[40:41], v20 offset:46592
  ds_read_b64_tr_b16 v[42:43], v20 offset:47744
  v_mul_f32 v74, v66, v74
  v_mul_f32 v75, v67, v75
  v_add_f32 v58, 1.0, v58
  v_add_f32 v59, 1.0, v59
  v_rcp_f32 v58, v58
  v_rcp_f32 v59, v59
  v_mul_f32 v66, v74, v58
  v_mul_f32 v67, v75, v59
  s_waitcnt lgkmcnt(6)
  v_mfma_f32_32x32x16_bf16 v[224:239], v[28:31], a[124:127], v[224:239]
  ds_read_b64_tr_b16 v[44:45], v20 offset:51200
  ds_read_b64_tr_b16 v[46:47], v20 offset:52352
  v_cvt_pk_bf16_f32 v49, v66, v67
  v_mul_f32 v56, 0xbfb8aa3b, v68
  v_mul_f32 v57, 0xbfb8aa3b, v69
  v_exp_f32 v56, v56
  v_exp_f32 v57, v57
  v_mul_f32 v76, v68, v76
  v_mul_f32 v77, v69, v77
  v_add_f32 v56, 1.0, v56
  s_waitcnt lgkmcnt(6)
  v_mfma_f32_32x32x16_bf16 v[224:239], v[32:35], a[128:131], v[224:239]
  v_add_f32 v57, 1.0, v57
  v_rcp_f32 v56, v56
  v_rcp_f32 v57, v57
  v_mul_f32 v68, v76, v56
  v_mul_f32 v69, v77, v57
  v_cvt_pk_bf16_f32 v50, v68, v69
  v_mul_f32 v58, 0xbfb8aa3b, v70
  v_mul_f32 v59, 0xbfb8aa3b, v71
  s_waitcnt lgkmcnt(4)
  v_mfma_f32_32x32x16_bf16 v[224:239], v[36:39], a[132:135], v[224:239]
  v_exp_f32 v58, v58
  v_exp_f32 v59, v59
  v_mul_f32 v78, v70, v78
  v_mul_f32 v79, v71, v79
  v_add_f32 v58, 1.0, v58
  v_add_f32 v59, 1.0, v59
  v_rcp_f32 v58, v58
  v_rcp_f32 v59, v59
  s_waitcnt lgkmcnt(2)
  v_mfma_f32_32x32x16_bf16 v[224:239], v[40:43], a[136:139], v[224:239]
  v_mul_f32 v70, v78, v58
  v_mul_f32 v71, v79, v59
  v_cvt_pk_bf16_f32 v51, v70, v71
  buffer_store_dwordx4 v[48:51], v1, s[12:15], s25 offen offset:2048 sc0 sc1
  v_mul_f32 v56, 0xbfb8aa3b, v208
  v_mul_f32 v57, 0xbfb8aa3b, v209
  v_exp_f32 v56, v56
  v_exp_f32 v57, v57
  s_waitcnt lgkmcnt(0)
  v_mfma_f32_32x32x16_bf16 v[224:239], v[44:47], a[140:143], v[224:239]
  v_mul_f32 v216, v208, v216
  v_mul_f32 v217, v209, v217
  v_add_f32 v56, 1.0, v56
  v_add_f32 v57, 1.0, v57
  v_rcp_f32 v56, v56
  v_rcp_f32 v57, v57
  v_mul_f32 v208, v216, v56
  v_mul_f32 v209, v217, v57
  v_cvt_pk_bf16_f32 v52, v208, v209
  v_mul_f32 v58, 0xbfb8aa3b, v210
  v_mul_f32 v59, 0xbfb8aa3b, v211
  v_exp_f32 v58, v58
  v_exp_f32 v59, v59
  v_mul_f32 v218, v210, v218
  v_mul_f32 v219, v211, v219
  v_add_f32 v58, 1.0, v58
  v_add_f32 v59, 1.0, v59
  v_rcp_f32 v58, v58
  v_rcp_f32 v59, v59
  v_mul_f32 v210, v218, v58
  v_mul_f32 v211, v219, v59
  v_cvt_pk_bf16_f32 v53, v210, v211
  v_mul_f32 v56, 0xbfb8aa3b, v212
  v_mul_f32 v57, 0xbfb8aa3b, v213
  v_exp_f32 v56, v56
  v_exp_f32 v57, v57
  v_mul_f32 v220, v212, v220
  v_mul_f32 v221, v213, v221
  v_add_f32 v56, 1.0, v56
  v_add_f32 v57, 1.0, v57
  v_rcp_f32 v56, v56
  v_rcp_f32 v57, v57
  v_mul_f32 v212, v220, v56
  v_mul_f32 v213, v221, v57
  v_cvt_pk_bf16_f32 v54, v212, v213
  v_mul_f32 v58, 0xbfb8aa3b, v214
  v_mul_f32 v59, 0xbfb8aa3b, v215
  v_exp_f32 v58, v58
  v_exp_f32 v59, v59
  v_mul_f32 v222, v214, v222
  v_mul_f32 v223, v215, v223
  v_add_f32 v58, 1.0, v58
  v_add_f32 v59, 1.0, v59
  v_rcp_f32 v58, v58
  v_rcp_f32 v59, v59
  v_mul_f32 v214, v222, v58
  v_mul_f32 v215, v223, v59
  v_cvt_pk_bf16_f32 v55, v214, v215
  buffer_store_dwordx4 v[52:55], v1, s[12:15], s25 offen offset:3072 sc0 sc1
  s_add_u32 s25, s25, 4096
  v_mul_f32 v56, 0xbfb8aa3b, v224
  v_mul_f32 v57, 0xbfb8aa3b, v225
  v_exp_f32 v56, v56
  v_exp_f32 v57, v57
  v_mul_f32 v232, v224, v232
  v_mul_f32 v233, v225, v233
  v_add_f32 v56, 1.0, v56
  v_add_f32 v57, 1.0, v57
  v_rcp_f32 v56, v56
  v_rcp_f32 v57, v57
  v_mul_f32 v224, v232, v56
  v_mul_f32 v225, v233, v57
  v_cvt_pk_bf16_f32 v48, v224, v225
  v_mul_f32 v58, 0xbfb8aa3b, v226
  v_mul_f32 v59, 0xbfb8aa3b, v227
  v_exp_f32 v58, v58
  v_exp_f32 v59, v59
  v_mul_f32 v234, v226, v234
  v_mul_f32 v235, v227, v235
  v_add_f32 v58, 1.0, v58
  v_add_f32 v59, 1.0, v59
  v_rcp_f32 v58, v58
  v_rcp_f32 v59, v59
  v_mul_f32 v226, v234, v58
  v_mul_f32 v227, v235, v59
  v_cvt_pk_bf16_f32 v49, v226, v227
  v_mul_f32 v56, 0xbfb8aa3b, v228
  v_mul_f32 v57, 0xbfb8aa3b, v229
  v_exp_f32 v56, v56
  v_exp_f32 v57, v57
  v_mul_f32 v236, v228, v236
  v_mul_f32 v237, v229, v237
  v_add_f32 v56, 1.0, v56
  v_add_f32 v57, 1.0, v57
  v_rcp_f32 v56, v56
  v_rcp_f32 v57, v57
  v_mul_f32 v228, v236, v56
  v_mul_f32 v229, v237, v57
  v_cvt_pk_bf16_f32 v50, v228, v229
  v_mul_f32 v58, 0xbfb8aa3b, v230
  v_mul_f32 v59, 0xbfb8aa3b, v231
  v_exp_f32 v58, v58
  v_exp_f32 v59, v59
  v_mul_f32 v238, v230, v238
  v_mul_f32 v239, v231, v239
  v_add_f32 v58, 1.0, v58
  v_add_f32 v59, 1.0, v59
  v_rcp_f32 v58, v58
  v_rcp_f32 v59, v59
  v_mul_f32 v230, v238, v58
  v_mul_f32 v231, v239, v59
  v_cvt_pk_bf16_f32 v51, v230, v231
  buffer_store_dwordx4 v[48:51], v1, s[12:15], s25 offen offset:0 sc0 sc1
  s_add_u32 s25, s25, 1024
L_k5_gateup_kernel_end:
  s_endpgm
.globl k6_down_kernel
.p2align 8
.type k6_down_kernel,@function
k6_down_kernel:
  s_cmp_ge_u32 s2, 256
  s_cbranch_scc1 L_k6_down_kernel_end
  s_load_dwordx2 s[4:5], s[0:1], 64
  s_mov_b32 s6, 5308416
  s_mov_b32 s7, 0x00020000
  s_load_dwordx2 s[8:9], s[0:1], 104
  s_mov_b32 s10, 18874368
  s_mov_b32 s11, 0x00020000
  s_load_dwordx2 s[12:13], s[0:1], 104
  s_mov_b32 s14, 18874368
  s_mov_b32 s15, 0x00020000
  v_lshrrev_b32 v1, 6, v0
  s_nop 0
  v_readfirstlane_b32 s16, v1
  v_and_b32 v0, 63, v0
  s_nop 3
  s_and_b32 s17, s2, 7
  s_bfe_u32 s18, s2, 0x10003
  s_lshr_b32 s19, s2, 4
  s_lshl_b32 s20, s19, 2
  s_add_u32 s20, s20, s16
  s_mul_i32 s21, s20, 294912
  s_mul_i32 s22, s17, 36864
  s_add_u32 s21, s21, s22
  s_mul_i32 s22, s17, 663552
  s_mul_i32 s23, s18, 576
  s_add_u32 s22, s22, s23
  s_mul_i32 s24, s16, 9216
  s_mul_i32 s25, s17, 2359296
  s_mul_i32 s26, s20, 36864
  s_add_u32 s25, s25, s26
  s_mul_i32 s26, s18, 18432
  s_add_u32 s25, s25, s26
  v_lshlrev_b32 v1, 4, v0
  s_waitcnt lgkmcnt(0)
  s_add_u32 s8, s8, 14680064
  s_addc_u32 s9, s9, 0
  s_add_u32 s12, s12, 33554432
  s_addc_u32 s13, s13, 0
  buffer_load_dwordx4 a[0:3], v1, s[8:11], s21 offen offset:0
  buffer_load_dwordx4 a[4:7], v1, s[8:11], s21 offen offset:1024
  buffer_load_dwordx4 a[8:11], v1, s[8:11], s21 offen offset:2048
  buffer_load_dwordx4 a[12:15], v1, s[8:11], s21 offen offset:3072
  s_add_u32 s21, s21, 4096
  buffer_load_dwordx4 a[16:19], v1, s[8:11], s21 offen offset:0
  buffer_load_dwordx4 a[20:23], v1, s[8:11], s21 offen offset:1024
  buffer_load_dwordx4 a[24:27], v1, s[8:11], s21 offen offset:2048
  buffer_load_dwordx4 a[28:31], v1, s[8:11], s21 offen offset:3072
  s_add_u32 s21, s21, 4096
  s_mul_i32 s26, s16, 576
  s_add_u32 s26, s26, 0
  v_add_u32 v2, s26, v0
  v_mul_u32_u24 v3, 1821, v2
  v_lshrrev_b32 v3, 16, v3
  v_mul_u32_u24 v5, 36, v3
  v_sub_u32 v4, v2, v5
  v_mul_u32_u24 v10, 1152, v3
  v_lshl_add_u32 v10, v4, 4, v10
  s_add_u32 m0, s24, 0
  s_nop 0
  buffer_load_dwordx4 v10, s[4:7], s22 offen lds
  s_mul_i32 s26, s16, 576
  s_add_u32 s26, s26, 64
  v_add_u32 v2, s26, v0
  v_mul_u32_u24 v3, 1821, v2
  v_lshrrev_b32 v3, 16, v3
  v_mul_u32_u24 v5, 36, v3
  v_sub_u32 v4, v2, v5
  v_mul_u32_u24 v11, 1152, v3
  v_lshl_add_u32 v11, v4, 4, v11
  s_add_u32 m0, s24, 1024
  s_nop 0
  buffer_load_dwordx4 v11, s[4:7], s22 offen lds
  s_mul_i32 s26, s16, 576
  s_add_u32 s26, s26, 128
  v_add_u32 v2, s26, v0
  v_mul_u32_u24 v3, 1821, v2
  v_lshrrev_b32 v3, 16, v3
  v_mul_u32_u24 v5, 36, v3
  v_sub_u32 v4, v2, v5
  v_mul_u32_u24 v12, 1152, v3
  v_lshl_add_u32 v12, v4, 4, v12
  s_add_u32 m0, s24, 2048
  s_nop 0
  buffer_load_dwordx4 v12, s[4:7], s22 offen lds
  s_mul_i32 s26, s16, 576
  s_add_u32 s26, s26, 192
  v_add_u32 v2, s26, v0
  v_mul_u32_u24 v3, 1821, v2
  v_lshrrev_b32 v3, 16, v3
  v_mul_u32_u24 v5, 36, v3
  v_sub_u32 v4, v2, v5
  v_mul_u32_u24 v13, 1152, v3
  v_lshl_add_u32 v13, v4, 4, v13
  s_add_u32 m0, s24, 3072
  s_nop 0
  buffer_load_dwordx4 v13, s[4:7], s22 offen lds
  s_mul_i32 s26, s16, 576
  s_add_u32 s26, s26, 256
  v_add_u32 v2, s26, v0
  v_mul_u32_u24 v3, 1821, v2
  v_lshrrev_b32 v3, 16, v3
  v_mul_u32_u24 v5, 36, v3
  v_sub_u32 v4, v2, v5
  v_mul_u32_u24 v14, 1152, v3
  v_lshl_add_u32 v14, v4, 4, v14
  s_add_u32 m0, s24, 4096
  s_nop 0
  buffer_load_dwordx4 v14, s[4:7], s22 offen lds
  s_mul_i32 s26, s16, 576
  s_add_u32 s26, s26, 320
  v_add_u32 v2, s26, v0
  v_mul_u32_u24 v3, 1821, v2
  v_lshrrev_b32 v3, 16, v3
  v_mul_u32_u24 v5, 36, v3
  v_sub_u32 v4, v2, v5
  v_mul_u32_u24 v15, 1152, v3
  v_lshl_add_u32 v15, v4, 4, v15
  s_add_u32 m0, s24, 5120
  s_nop 0
  buffer_load_dwordx4 v15, s[4:7], s22 offen lds
  s_mul_i32 s26, s16, 576
  s_add_u32 s26, s26, 384
  v_add_u32 v2, s26, v0
  v_mul_u32_u24 v3, 1821, v2
  v_lshrrev_b32 v3, 16, v3
  v_mul_u32_u24 v5, 36, v3
  v_sub_u32 v4, v2, v5
  v_mul_u32_u24 v16, 1152, v3
  v_lshl_add_u32 v16, v4, 4, v16
  s_add_u32 m0, s24, 6144
  s_nop 0
  buffer_load_dwordx4 v16, s[4:7], s22 offen lds
  s_mul_i32 s26, s16, 576
  s_add_u32 s26, s26, 448
  v_add_u32 v2, s26, v0
  v_mul_u32_u24 v3, 1821, v2
  v_lshrrev_b32 v3, 16, v3
  v_mul_u32_u24 v5, 36, v3
  v_sub_u32 v4, v2, v5
  v_mul_u32_u24 v17, 1152, v3
  v_lshl_add_u32 v17, v4, 4, v17
  s_add_u32 m0, s24, 7168
  s_nop 0
  buffer_load_dwordx4 v17, s[4:7], s22 offen lds
  s_mul_i32 s26, s16, 576
  s_add_u32 s26, s26, 512
  v_add_u32 v2, s26, v0
  v_mul_u32_u24 v3, 1821, v2
  v_lshrrev_b32 v3, 16, v3
  v_mul_u32_u24 v5, 36, v3
  v_sub_u32 v4, v2, v5
  v_mul_u32_u24 v18, 1152, v3
  v_lshl_add_u32 v18, v4, 4, v18
  s_add_u32 m0, s24, 8192
  s_nop 0
  buffer_load_dwordx4 v18, s[4:7], s22 offen lds
  s_add_u32 s22, s22, 73728
  v_lshrrev_b32 v2, 5, v0
  v_lshlrev_b32 v2, 3, v2
  v_bfe_u32 v3, v0, 2, 2
  v_add_u32 v2, v2, v3
  v_mul_u32_u24 v20, 576, v2
  v_bfe_u32 v3, v0, 4, 1
  v_mul_u32_u24 v3, 32, v3
  v_add_u32 v20, v20, v3
  v_and_b32 v3, 1, v0
  v_lshl_add_u32 v20, v3, 4, v20
  v_bfe_u32 v3, v0, 1, 1
  v_lshl_add_u32 v20, v3, 3, v20
  v_add_u32 v21, 36864, v20
  v_add_u32 v22, 73728, v20
  v_add_u32 v23, 110592, v20
  s_add_u32 m0, s24, 36864
  s_nop 0
  buffer_load_dwordx4 v10, s[4:7], s22 offen lds
  s_add_u32 m0, s24, 37888
  s_nop 0
  buffer_load_dwordx4 v11, s[4:7], s22 offen lds
  s_add_u32 m0, s24, 38912
  s_nop 0
  buffer_load_dwordx4 v12, s[4:7], s22 offen lds
  s_add_u32 m0, s24, 39936
  s_nop 0
  buffer_load_dwordx4 v13, s[4:7], s22 offen lds
  s_add_u32 m0, s24, 40960
  s_nop 0
  buffer_load_dwordx4 v14, s[4:7], s22 offen lds
  s_add_u32 m0, s24, 41984
  s_nop 0
  buffer_load_dwordx4 v15, s[4:7], s22 offen lds
  s_add_u32 m0, s24, 43008
  s_nop 0
  buffer_load_dwordx4 v16, s[4:7], s22 offen lds
  s_add_u32 m0, s24, 44032
  s_nop 0
  buffer_load_dwordx4 v17, s[4:7], s22 offen lds
  s_add_u32 m0, s24, 45056
  s_nop 0
  buffer_load_dwordx4 v18, s[4:7], s22 offen lds
  s_add_u32 s22, s22, 73728
  s_waitcnt vmcnt(9) lgkmcnt(0)
  s_barrier
  ds_read_b64_tr_b16 v[24:25], v20 offset:0
  ds_read_b64_tr_b16 v[26:27], v20 offset:2304
  ds_read_b64_tr_b16 v[28:29], v20 offset:64
  ds_read_b64_tr_b16 v[30:31], v20 offset:2368
  ds_read_b64_tr_b16 v[32:33], v20 offset:128
  ds_read_b64_tr_b16 v[34:35], v20 offset:2432
  ds_read_b64_tr_b16 v[36:37], v20 offset:192
  ds_read_b64_tr_b16 v[38:39], v20 offset:2496
  s_waitcnt lgkmcnt(6)
  v_mfma_f32_32x32x16_bf16 v[64:79], v[24:27], a[0:3], 0
  ds_read_b64_tr_b16 v[40:41], v20 offset:256
  ds_read_b64_tr_b16 v[42:43], v20 offset:2560
  buffer_load_dwordx4 a[32:35], v1, s[8:11], s21 offen offset:0
  s_waitcnt lgkmcnt(6)
  v_mfma_f32_32x32x16_bf16 v[80:95], v[28:31], a[0:3], 0
  ds_read_b64_tr_b16 v[44:45], v20 offset:320
  ds_read_b64_tr_b16 v[46:47], v20 offset:2624
  s_waitcnt lgkmcnt(6)
  v_mfma_f32_32x32x16_bf16 v[96:111], v[32:35], a[0:3], 0
  ds_read_b64_tr_b16 v[24:25], v20 offset:384
  ds_read_b64_tr_b16 v[26:27], v20 offset:2688
  buffer_load_dwordx4 a[36:39], v1, s[8:11], s21 offen offset:1024
  s_waitcnt lgkmcnt(6)
  v_mfma_f32_32x32x16_bf16 v[112:127], v[36:39], a[0:3], 0
  ds_read_b64_tr_b16 v[28:29], v20 offset:448
  ds_read_b64_tr_b16 v[30:31], v20 offset:2752
  s_waitcnt lgkmcnt(6)
  v_mfma_f32_32x32x16_bf16 v[128:143], v[40:43], a[0:3], 0
  ds_read_b64_tr_b16 v[32:33], v20 offset:512
  ds_read_b64_tr_b16 v[34:35], v20 offset:2816
  buffer_load_dwordx4 a[40:43], v1, s[8:11], s21 offen offset:2048
  s_waitcnt lgkmcnt(6)
  v_mfma_f32_32x32x16_bf16 v[144:159], v[44:47], a[0:3], 0
  ds_read_b64_tr_b16 v[36:37], v20 offset:9216
  ds_read_b64_tr_b16 v[38:39], v20 offset:11520
  s_waitcnt lgkmcnt(6)
  v_mfma_f32_32x32x16_bf16 v[160:175], v[24:27], a[0:3], 0
  ds_read_b64_tr_b16 v[40:41], v20 offset:9280
  ds_read_b64_tr_b16 v[42:43], v20 offset:11584
  buffer_load_dwordx4 a[44:47], v1, s[8:11], s21 offen offset:3072
  s_add_u32 s21, s21, 4096
  s_waitcnt lgkmcnt(6)
  v_mfma_f32_32x32x16_bf16 v[176:191], v[28:31], a[0:3], 0
  ds_read_b64_tr_b16 v[44:45], v20 offset:9344
  ds_read_b64_tr_b16 v[46:47], v20 offset:11648
  s_waitcnt lgkmcnt(6)
  v_mfma_f32_32x32x16_bf16 v[192:207], v[32:35], a[0:3], 0
  ds_read_b64_tr_b16 v[24:25], v20 offset:9408
  ds_read_b64_tr_b16 v[26:27], v20 offset:11712
  s_add_u32 m0, s24, 73728
  s_nop 0
  buffer_load_dwordx4 v10, s[4:7], s22 offen lds
  s_waitcnt lgkmcnt(6)
  v_mfma_f32_32x32x16_bf16 v[64:79], v[36:39], a[4:7], v[64:79]
  ds_read_b64_tr_b16 v[28:29], v20 offset:9472
  ds_read_b64_tr_b16 v[30:31], v20 offset:11776
  s_waitcnt lgkmcnt(6)
  v_mfma_f32_32x32x16_bf16 v[80:95], v[40:43], a[4:7], v[80:95]
  ds_read_b64_tr_b16 v[32:33], v20 offset:9536
  ds_read_b64_tr_b16 v[34:35], v20 offset:11840
  s_add_u32 m0, s24, 74752
  s_nop 0
  buffer_load_dwordx4 v11, s[4:7], s22 offen lds
  s_waitcnt lgkmcnt(6)
  v_mfma_f32_32x32x16_bf16 v[96:111], v[44:47], a[4:7], v[96:111]
  ds_read_b64_tr_b16 v[36:37], v20 offset:9600
  ds_read_b64_tr_b16 v[38:39], v20 offset:11904
  s_waitcnt lgkmcnt(6)
  v_mfma_f32_32x32x16_bf16 v[112:127], v[24:27], a[4:7], v[112:127]
  ds_read_b64_tr_b16 v[40:41], v20 offset:9664
  ds_read_b64_tr_b16 v[42:43], v20 offset:11968
  s_add_u32 m0, s24, 75776
  s_nop 0
  buffer_load_dwordx4 v12, s[4:7], s22 offen lds
  s_waitcnt lgkmcnt(6)
  v_mfma_f32_32x32x16_bf16 v[128:143], v[28:31], a[4:7], v[128:143]
  ds_read_b64_tr_b16 v[44:45], v20 offset:9728
  ds_read_b64_tr_b16 v[46:47], v20 offset:12032
  s_waitcnt lgkmcnt(6)
  v_mfma_f32_32x32x16_bf16 v[144:159], v[32:35], a[4:7], v[144:159]
  ds_read_b64_tr_b16 v[24:25], v20 offset:18432
  ds_read_b64_tr_b16 v[26:27], v20 offset:20736
  s_add_u32 m0, s24, 76800
  s_nop 0
  buffer_load_dwordx4 v13, s[4:7], s22 offen lds
  s_waitcnt lgkmcnt(6)
  v_mfma_f32_32x32x16_bf16 v[160:175], v[36:39], a[4:7], v[160:175]
  ds_read_b64_tr_b16 v[28:29], v20 offset:18496
  ds_read_b64_tr_b16 v[30:31], v20 offset:20800
  s_waitcnt lgkmcnt(6)
  v_mfma_f32_32x32x16_bf16 v[176:191], v[40:43], a[4:7], v[176:191]
  ds_read_b64_tr_b16 v[32:33], v20 offset:18560
  ds_read_b64_tr_b16 v[34:35], v20 offset:20864
  s_add_u32 m0, s24, 77824
  s_nop 0
  buffer_load_dwordx4 v14, s[4:7], s22 offen lds
  s_waitcnt lgkmcnt(6)
  v_mfma_f32_32x32x16_bf16 v[192:207], v[44:47], a[4:7], v[192:207]
  ds_read_b64_tr_b16 v[36:37], v20 offset:18624
  ds_read_b64_tr_b16 v[38:39], v20 offset:20928
  s_waitcnt lgkmcnt(6)
  v_mfma_f32_32x32x16_bf16 v[64:79], v[24:27], a[8:11], v[64:79]
  ds_read_b64_tr_b16 v[40:41], v20 offset:18688
  ds_read_b64_tr_b16 v[42:43], v20 offset:20992
  s_add_u32 m0, s24, 78848
  s_nop 0
  buffer_load_dwordx4 v15, s[4:7], s22 offen lds
  s_waitcnt lgkmcnt(6)
  v_mfma_f32_32x32x16_bf16 v[80:95], v[28:31], a[8:11], v[80:95]
  ds_read_b64_tr_b16 v[44:45], v20 offset:18752
  ds_read_b64_tr_b16 v[46:47], v20 offset:21056
  s_waitcnt lgkmcnt(6)
  v_mfma_f32_32x32x16_bf16 v[96:111], v[32:35], a[8:11], v[96:111]
  ds_read_b64_tr_b16 v[24:25], v20 offset:18816
  ds_read_b64_tr_b16 v[26:27], v20 offset:21120
  s_add_u32 m0, s24, 79872
  s_nop 0
  buffer_load_dwordx4 v16, s[4:7], s22 offen lds
  s_waitcnt lgkmcnt(6)
  v_mfma_f32_32x32x16_bf16 v[112:127], v[36:39], a[8:11], v[112:127]
  ds_read_b64_tr_b16 v[28:29], v20 offset:18880
  ds_read_b64_tr_b16 v[30:31], v20 offset:21184
  s_waitcnt lgkmcnt(6)
  v_mfma_f32_32x32x16_bf16 v[128:143], v[40:43], a[8:11], v[128:143]
  ds_read_b64_tr_b16 v[32:33], v20 offset:18944
  ds_read_b64_tr_b16 v[34:35], v20 offset:21248
  s_add_u32 m0, s24, 80896
  s_nop 0
  buffer_load_dwordx4 v17, s[4:7], s22 offen lds
  s_waitcnt lgkmcnt(6)
  v_mfma_f32_32x32x16_bf16 v[144:159], v[44:47], a[8:11], v[144:159]
  ds_read_b64_tr_b16 v[36:37], v20 offset:27648
  ds_read_b64_tr_b16 v[38:39], v20 offset:29952
  s_waitcnt lgkmcnt(6)
  v_mfma_f32_32x32x16_bf16 v[160:175], v[24:27], a[8:11], v[160:175]
  ds_read_b64_tr_b16 v[40:41], v20 offset:27712
  ds_read_b64_tr_b16 v[42:43], v20 offset:30016
  s_add_u32 m0, s24, 81920
  s_nop 0
  buffer_load_dwordx4 v18, s[4:7], s22 offen lds
  s_add_u32 s22, s22, 73728
  s_waitcnt lgkmcnt(6)
  v_mfma_f32_32x32x16_bf16 v[176:191], v[28:31], a[8:11], v[176:191]
  ds_read_b64_tr_b16 v[44:45], v20 offset:27776
  ds_read_b64_tr_b16 v[46:47], v20 offset:30080
  s_waitcnt lgkmcnt(6)
  v_mfma_f32_32x32x16_bf16 v[192:207], v[32:35], a[8:11], v[192:207]
  ds_read_b64_tr_b16 v[24:25], v20 offset:27840
  ds_read_b64_tr_b16 v[26:27], v20 offset:30144
  s_waitcnt lgkmcnt(6)
  v_mfma_f32_32x32x16_bf16 v[64:79], v[36:39], a[12:15], v[64:79]
  ds_read_b64_tr_b16 v[28:29], v20 offset:27904
  ds_read_b64_tr_b16 v[30:31], v20 offset:30208
  s_waitcnt lgkmcnt(6)
  v_mfma_f32_32x32x16_bf16 v[80:95], v[40:43], a[12:15], v[80:95]
  ds_read_b64_tr_b16 v[32:33], v20 offset:27968
  ds_read_b64_tr_b16 v[34:35], v20 offset:30272
  s_waitcnt lgkmcnt(6)
  v_mfma_f32_32x32x16_bf16 v[96:111], v[44:47], a[12:15], v[96:111]
  ds_read_b64_tr_b16 v[36:37], v20 offset:28032
  ds_read_b64_tr_b16 v[38:39], v20 offset:30336
  s_waitcnt lgkmcnt(6)
  v_mfma_f32_32x32x16_bf16 v[112:127], v[24:27], a[12:15], v[112:127]
  ds_read_b64_tr_b16 v[40:41], v20 offset:28096
  ds_read_b64_tr_b16 v[42:43], v20 offset:30400
  s_waitcnt lgkmcnt(6)
  v_mfma_f32_32x32x16_bf16 v[128:143], v[28:31], a[12:15], v[128:143]
  ds_read_b64_tr_b16 v[44:45], v20 offset:28160
  ds_read_b64_tr_b16 v[46:47], v20 offset:30464
  s_waitcnt lgkmcnt(6)
  v_mfma_f32_32x32x16_bf16 v[144:159], v[32:35], a[12:15], v[144:159]
  s_waitcnt vmcnt(13) lgkmcnt(0)
  s_barrier
  ds_read_b64_tr_b16 v[24:25], v21 offset:0
  ds_read_b64_tr_b16 v[26:27], v21 offset:2304
  v_mfma_f32_32x32x16_bf16 v[160:175], v[36:39], a[12:15], v[160:175]
  ds_read_b64_tr_b16 v[28:29], v21 offset:64
  ds_read_b64_tr_b16 v[30:31], v21 offset:2368
  v_mfma_f32_32x32x16_bf16 v[176:191], v[40:43], a[12:15], v[176:191]
  ds_read_b64_tr_b16 v[32:33], v21 offset:128
  ds_read_b64_tr_b16 v[34:35], v21 offset:2432
  v_mfma_f32_32x32x16_bf16 v[192:207], v[44:47], a[12:15], v[192:207]
  ds_read_b64_tr_b16 v[36:37], v21 offset:192
  ds_read_b64_tr_b16 v[38:39], v21 offset:2496
  s_waitcnt lgkmcnt(6)
  v_mfma_f32_32x32x16_bf16 v[64:79], v[24:27], a[16:19], v[64:79]
  ds_read_b64_tr_b16 v[40:41], v21 offset:256
  ds_read_b64_tr_b16 v[42:43], v21 offset:2560
  buffer_load_dwordx4 a[48:51], v1, s[8:11], s21 offen offset:0
  s_waitcnt lgkmcnt(6)
  v_mfma_f32_32x32x16_bf16 v[80:95], v[28:31], a[16:19], v[80:95]
  ds_read_b64_tr_b16 v[44:45], v21 offset:320
  ds_read_b64_tr_b16 v[46:47], v21 offset:2624
  s_waitcnt lgkmcnt(6)
  v_mfma_f32_32x32x16_bf16 v[96:111], v[32:35], a[16:19], v[96:111]
  ds_read_b64_tr_b16 v[24:25], v21 offset:384
  ds_read_b64_tr_b16 v[26:27], v21 offset:2688
  buffer_load_dwordx4 a[52:55], v1, s[8:11], s21 offen offset:1024
  s_waitcnt lgkmcnt(6)
  v_mfma_f32_32x32x16_bf16 v[112:127], v[36:39], a[16:19], v[112:127]
  ds_read_b64_tr_b16 v[28:29], v21 offset:448
  ds_read_b64_tr_b16 v[30:31], v21 offset:2752
  s_waitcnt lgkmcnt(6)
  v_mfma_f32_32x32x16_bf16 v[128:143], v[40:43], a[16:19], v[128:143]
  ds_read_b64_tr_b16 v[32:33], v21 offset:512
  ds_read_b64_tr_b16 v[34:35], v21 offset:2816
  buffer_load_dwordx4 a[56:59], v1, s[8:11], s21 offen offset:2048
  s_waitcnt lgkmcnt(6)
  v_mfma_f32_32x32x16_bf16 v[144:159], v[44:47], a[16:19], v[144:159]
  ds_read_b64_tr_b16 v[36:37], v21 offset:9216
  ds_read_b64_tr_b16 v[38:39], v21 offset:11520
  s_waitcnt lgkmcnt(6)
  v_mfma_f32_32x32x16_bf16 v[160:175], v[24:27], a[16:19], v[160:175]
  ds_read_b64_tr_b16 v[40:41], v21 offset:9280
  ds_read_b64_tr_b16 v[42:43], v21 offset:11584
  buffer_load_dwordx4 a[60:63], v1, s[8:11], s21 offen offset:3072
  s_add_u32 s21, s21, 4096
  s_waitcnt lgkmcnt(6)
  v_mfma_f32_32x32x16_bf16 v[176:191], v[28:31], a[16:19], v[176:191]
  ds_read_b64_tr_b16 v[44:45], v21 offset:9344
  ds_read_b64_tr_b16 v[46:47], v21 offset:11648
  s_waitcnt lgkmcnt(6)
  v_mfma_f32_32x32x16_bf16 v[192:207], v[32:35], a[16:19], v[192:207]
  ds_read_b64_tr_b16 v[24:25], v21 offset:9408
  ds_read_b64_tr_b16 v[26:27], v21 offset:11712
  s_add_u32 m0, s24, 110592
  s_nop 0
  buffer_load_dwordx4 v10, s[4:7], s22 offen lds
  s_waitcnt lgkmcnt(6)
  v_mfma_f32_32x32x16_bf16 v[64:79], v[36:39], a[20:23], v[64:79]
  ds_read_b64_tr_b16 v[28:29], v21 offset:9472
  ds_read_b64_tr_b16 v[30:31], v21 offset:11776
  s_waitcnt lgkmcnt(6)
  v_mfma_f32_32x32x16_bf16 v[80:95], v[40:43], a[20:23], v[80:95]
  ds_read_b64_tr_b16 v[32:33], v21 offset:9536
  ds_read_b64_tr_b16 v[34:35], v21 offset:11840
  s_add_u32 m0, s24, 111616
  s_nop 0
  buffer_load_dwordx4 v11, s[4:7], s22 offen lds
  s_waitcnt lgkmcnt(6)
  v_mfma_f32_32x32x16_bf16 v[96:111], v[44:47], a[20:23], v[96:111]
  ds_read_b64_tr_b16 v[36:37], v21 offset:9600
  ds_read_b64_tr_b16 v[38:39], v21 offset:11904
  s_waitcnt lgkmcnt(6)
  v_mfma_f32_32x32x16_bf16 v[112:127], v[24:27], a[20:23], v[112:127]
  ds_read_b64_tr_b16 v[40:41], v21 offset:9664
  ds_read_b64_tr_b16 v[42:43], v21 offset:11968
  s_add_u32 m0, s24, 112640
  s_nop 0
  buffer_load_dwordx4 v12, s[4:7], s22 offen lds
  s_waitcnt lgkmcnt(6)
  v_mfma_f32_32x32x16_bf16 v[128:143], v[28:31], a[20:23], v[128:143]
  ds_read_b64_tr_b16 v[44:45], v21 offset:9728
  ds_read_b64_tr_b16 v[46:47], v21 offset:12032
  s_waitcnt lgkmcnt(6)
  v_mfma_f32_32x32x16_bf16 v[144:159], v[32:35], a[20:23], v[144:159]
  ds_read_b64_tr_b16 v[24:25], v21 offset:18432
  ds_read_b64_tr_b16 v[26:27], v21 offset:20736
  s_add_u32 m0, s24, 113664
  s_nop 0
  buffer_load_dwordx4 v13, s[4:7], s22 offen lds
  s_waitcnt lgkmcnt(6)
  v_mfma_f32_32x32x16_bf16 v[160:175], v[36:39], a[20:23], v[160:175]
  ds_read_b64_tr_b16 v[28:29], v21 offset:18496
  ds_read_b64_tr_b16 v[30:31], v21 offset:20800
  s_waitcnt lgkmcnt(6)
  v_mfma_f32_32x32x16_bf16 v[176:191], v[40:43], a[20:23], v[176:191]
  ds_read_b64_tr_b16 v[32:33], v21 offset:18560
  ds_read_b64_tr_b16 v[34:35], v21 offset:20864
  s_add_u32 m0, s24, 114688
  s_nop 0
  buffer_load_dwordx4 v14, s[4:7], s22 offen lds
  s_waitcnt lgkmcnt(6)
  v_mfma_f32_32x32x16_bf16 v[192:207], v[44:47], a[20:23], v[192:207]
  ds_read_b64_tr_b16 v[36:37], v21 offset:18624
  ds_read_b64_tr_b16 v[38:39], v21 offset:20928
  s_waitcnt lgkmcnt(6)
  v_mfma_f32_32x32x16_bf16 v[64:79], v[24:27], a[24:27], v[64:79]
  ds_read_b64_tr_b16 v[40:41], v21 offset:18688
  ds_read_b64_tr_b16 v[42:43], v21 offset:20992
  s_add_u32 m0, s24, 115712
  s_nop 0
  buffer_load_dwordx4 v15, s[4:7], s22 offen lds
  s_waitcnt lgkmcnt(6)
  v_mfma_f32_32x32x16_bf16 v[80:95], v[28:31], a[24:27], v[80:95]
  ds_read_b64_tr_b16 v[44:45], v21 offset:18752
  ds_read_b64_tr_b16 v[46:47], v21 offset:21056
  s_waitcnt lgkmcnt(6)
  v_mfma_f32_32x32x16_bf16 v[96:111], v[32:35], a[24:27], v[96:111]
  ds_read_b64_tr_b16 v[24:25], v21 offset:18816
  ds_read_b64_tr_b16 v[26:27], v21 offset:21120
  s_add_u32 m0, s24, 116736
  s_nop 0
  buffer_load_dwordx4 v16, s[4:7], s22 offen lds
  s_waitcnt lgkmcnt(6)
  v_mfma_f32_32x32x16_bf16 v[112:127], v[36:39], a[24:27], v[112:127]
  ds_read_b64_tr_b16 v[28:29], v21 offset:18880
  ds_read_b64_tr_b16 v[30:31], v21 offset:21184
  s_waitcnt lgkmcnt(6)
  v_mfma_f32_32x32x16_bf16 v[128:143], v[40:43], a[24:27], v[128:143]
  ds_read_b64_tr_b16 v[32:33], v21 offset:18944
  ds_read_b64_tr_b16 v[34:35], v21 offset:21248
  s_add_u32 m0, s24, 117760
  s_nop 0
  buffer_load_dwordx4 v17, s[4:7], s22 offen lds
  s_waitcnt lgkmcnt(6)
  v_mfma_f32_32x32x16_bf16 v[144:159], v[44:47], a[24:27], v[144:159]
  ds_read_b64_tr_b16 v[36:37], v21 offset:27648
  ds_read_b64_tr_b16 v[38:39], v21 offset:29952
  s_waitcnt lgkmcnt(6)
  v_mfma_f32_32x32x16_bf16 v[160:175], v[24:27], a[24:27], v[160:175]
  ds_read_b64_tr_b16 v[40:41], v21 offset:27712
  ds_read_b64_tr_b16 v[42:43], v21 offset:30016
  s_add_u32 m0, s24, 118784
  s_nop 0
  buffer_load_dwordx4 v18, s[4:7], s22 offen lds
  s_add_u32 s22, s22, 73728
  s_waitcnt lgkmcnt(6)
  v_mfma_f32_32x32x16_bf16 v[176:191], v[28:31], a[24:27], v[176:191]
  ds_read_b64_tr_b16 v[44:45], v21 offset:27776
  ds_read_b64_tr_b16 v[46:47], v21 offset:30080
  s_waitcnt lgkmcnt(6)
  v_mfma_f32_32x32x16_bf16 v[192:207], v[32:35], a[24:27], v[192:207]
  ds_read_b64_tr_b16 v[24:25], v21 offset:27840
  ds_read_b64_tr_b16 v[26:27], v21 offset:30144
  s_waitcnt lgkmcnt(6)
  v_mfma_f32_32x32x16_bf16 v[64:79], v[36:39], a[28:31], v[64:79]
  ds_read_b64_tr_b16 v[28:29], v21 offset:27904
  ds_read_b64_tr_b16 v[30:31], v21 offset:30208
  s_waitcnt lgkmcnt(6)
  v_mfma_f32_32x32x16_bf16 v[80:95], v[40:43], a[28:31], v[80:95]
  ds_read_b64_tr_b16 v[32:33], v21 offset:27968
  ds_read_b64_tr_b16 v[34:35], v21 offset:30272
  s_waitcnt lgkmcnt(6)
  v_mfma_f32_32x32x16_bf16 v[96:111], v[44:47], a[28:31], v[96:111]
  ds_read_b64_tr_b16 v[36:37], v21 offset:28032
  ds_read_b64_tr_b16 v[38:39], v21 offset:30336
  s_waitcnt lgkmcnt(6)
  v_mfma_f32_32x32x16_bf16 v[112:127], v[24:27], a[28:31], v[112:127]
  ds_read_b64_tr_b16 v[40:41], v21 offset:28096
  ds_read_b64_tr_b16 v[42:43], v21 offset:30400
  s_waitcnt lgkmcnt(6)
  v_mfma_f32_32x32x16_bf16 v[128:143], v[28:31], a[28:31], v[128:143]
  ds_read_b64_tr_b16 v[44:45], v21 offset:28160
  ds_read_b64_tr_b16 v[46:47], v21 offset:30464
  s_waitcnt lgkmcnt(6)
  v_mfma_f32_32x32x16_bf16 v[144:159], v[32:35], a[28:31], v[144:159]
  s_waitcnt vmcnt(13) lgkmcnt(0)
  s_barrier
  ds_read_b64_tr_b16 v[24:25], v22 offset:0
  ds_read_b64_tr_b16 v[26:27], v22 offset:2304
  v_mfma_f32_32x32x16_bf16 v[160:175], v[36:39], a[28:31], v[160:175]
  ds_read_b64_tr_b16 v[28:29], v22 offset:64
  ds_read_b64_tr_b16 v[30:31], v22 offset:2368
  v_mfma_f32_32x32x16_bf16 v[176:191], v[40:43], a[28:31], v[176:191]
  ds_read_b64_tr_b16 v[32:33], v22 offset:128
  ds_read_b64_tr_b16 v[34:35], v22 offset:2432
  v_mfma_f32_32x32x16_bf16 v[192:207], v[44:47], a[28:31], v[192:207]
  ds_read_b64_tr_b16 v[36:37], v22 offset:192
  ds_read_b64_tr_b16 v[38:39], v22 offset:2496
  s_waitcnt lgkmcnt(6)
  v_mfma_f32_32x32x16_bf16 v[64:79], v[24:27], a[32:35], v[64:79]
  ds_read_b64_tr_b16 v[40:41], v22 offset:256
  ds_read_b64_tr_b16 v[42:43], v22 offset:2560
  buffer_load_dwordx4 a[64:67], v1, s[8:11], s21 offen offset:0
  s_waitcnt lgkmcnt(6)
  v_mfma_f32_32x32x16_bf16 v[80:95], v[28:31], a[32:35], v[80:95]
  ds_read_b64_tr_b16 v[44:45], v22 offset:320
  ds_read_b64_tr_b16 v[46:47], v22 offset:2624
  s_waitcnt lgkmcnt(6)
  v_mfma_f32_32x32x16_bf16 v[96:111], v[32:35], a[32:35], v[96:111]
  ds_read_b64_tr_b16 v[24:25], v22 offset:384
  ds_read_b64_tr_b16 v[26:27], v22 offset:2688
  buffer_load_dwordx4 a[68:71], v1, s[8:11], s21 offen offset:1024
  s_waitcnt lgkmcnt(6)
  v_mfma_f32_32x32x16_bf16 v[112:127], v[36:39], a[32:35], v[112:127]
  ds_read_b64_tr_b16 v[28:29], v22 offset:448
  ds_read_b64_tr_b16 v[30:31], v22 offset:2752
  s_waitcnt lgkmcnt(6)
  v_mfma_f32_32x32x16_bf16 v[128:143], v[40:43], a[32:35], v[128:143]
  ds_read_b64_tr_b16 v[32:33], v22 offset:512
  ds_read_b64_tr_b16 v[34:35], v22 offset:2816
  buffer_load_dwordx4 a[72:75], v1, s[8:11], s21 offen offset:2048
  s_waitcnt lgkmcnt(6)
  v_mfma_f32_32x32x16_bf16 v[144:159], v[44:47], a[32:35], v[144:159]
  ds_read_b64_tr_b16 v[36:37], v22 offset:9216
  ds_read_b64_tr_b16 v[38:39], v22 offset:11520
  s_waitcnt lgkmcnt(6)
  v_mfma_f32_32x32x16_bf16 v[160:175], v[24:27], a[32:35], v[160:175]
  ds_read_b64_tr_b16 v[40:41], v22 offset:9280
  ds_read_b64_tr_b16 v[42:43], v22 offset:11584
  buffer_load_dwordx4 a[76:79], v1, s[8:11], s21 offen offset:3072
  s_add_u32 s21, s21, 4096
  s_waitcnt lgkmcnt(6)
  v_mfma_f32_32x32x16_bf16 v[176:191], v[28:31], a[32:35], v[176:191]
  ds_read_b64_tr_b16 v[44:45], v22 offset:9344
  ds_read_b64_tr_b16 v[46:47], v22 offset:11648
  s_waitcnt lgkmcnt(6)
  v_mfma_f32_32x32x16_bf16 v[192:207], v[32:35], a[32:35], v[192:207]
  ds_read_b64_tr_b16 v[24:25], v22 offset:9408
  ds_read_b64_tr_b16 v[26:27], v22 offset:11712
  s_add_u32 m0, s24, 0
  s_nop 0
  buffer_load_dwordx4 v10, s[4:7], s22 offen lds
  s_waitcnt lgkmcnt(6)
  v_mfma_f32_32x32x16_bf16 v[64:79], v[36:39], a[36:39], v[64:79]
  ds_read_b64_tr_b16 v[28:29], v22 offset:9472
  ds_read_b64_tr_b16 v[30:31], v22 offset:11776
  s_waitcnt lgkmcnt(6)
  v_mfma_f32_32x32x16_bf16 v[80:95], v[40:43], a[36:39], v[80:95]
  ds_read_b64_tr_b16 v[32:33], v22 offset:9536
  ds_read_b64_tr_b16 v[34:35], v22 offset:11840
  s_add_u32 m0, s24, 1024
  s_nop 0
  buffer_load_dwordx4 v11, s[4:7], s22 offen lds
  s_waitcnt lgkmcnt(6)
  v_mfma_f32_32x32x16_bf16 v[96:111], v[44:47], a[36:39], v[96:111]
  ds_read_b64_tr_b16 v[36:37], v22 offset:9600
  ds_read_b64_tr_b16 v[38:39], v22 offset:11904
  s_waitcnt lgkmcnt(6)
  v_mfma_f32_32x32x16_bf16 v[112:127], v[24:27], a[36:39], v[112:127]
  ds_read_b64_tr_b16 v[40:41], v22 offset:9664
  ds_read_b64_tr_b16 v[42:43], v22 offset:11968
  s_add_u32 m0, s24, 2048
  s_nop 0
  buffer_load_dwordx4 v12, s[4:7], s22 offen lds
  s_waitcnt lgkmcnt(6)
  v_mfma_f32_32x32x16_bf16 v[128:143], v[28:31], a[36:39], v[128:143]
  ds_read_b64_tr_b16 v[44:45], v22 offset:9728
  ds_read_b64_tr_b16 v[46:47], v22 offset:12032
  s_waitcnt lgkmcnt(6)
  v_mfma_f32_32x32x16_bf16 v[144:159], v[32:35], a[36:39], v[144:159]
  ds_read_b64_tr_b16 v[24:25], v22 offset:18432
  ds_read_b64_tr_b16 v[26:27], v22 offset:20736
  s_add_u32 m0, s24, 3072
  s_nop 0
  buffer_load_dwordx4 v13, s[4:7], s22 offen lds
  s_waitcnt lgkmcnt(6)
  v_mfma_f32_32x32x16_bf16 v[160:175], v[36:39], a[36:39], v[160:175]
  ds_read_b64_tr_b16 v[28:29], v22 offset:18496
  ds_read_b64_tr_b16 v[30:31], v22 offset:20800
  s_waitcnt lgkmcnt(6)
  v_mfma_f32_32x32x16_bf16 v[176:191], v[40:43], a[36:39], v[176:191]
  ds_read_b64_tr_b16 v[32:33], v22 offset:18560
  ds_read_b64_tr_b16 v[34:35], v22 offset:20864
  s_add_u32 m0, s24, 4096
  s_nop 0
  buffer_load_dwordx4 v14, s[4:7], s22 offen lds
  s_waitcnt lgkmcnt(6)
  v_mfma_f32_32x32x16_bf16 v[192:207], v[44:47], a[36:39], v[192:207]
  ds_read_b64_tr_b16 v[36:37], v22 offset:18624
  ds_read_b64_tr_b16 v[38:39], v22 offset:20928
  s_waitcnt lgkmcnt(6)
  v_mfma_f32_32x32x16_bf16 v[64:79], v[24:27], a[40:43], v[64:79]
  ds_read_b64_tr_b16 v[40:41], v22 offset:18688
  ds_read_b64_tr_b16 v[42:43], v22 offset:20992
  s_add_u32 m0, s24, 5120
  s_nop 0
  buffer_load_dwordx4 v15, s[4:7], s22 offen lds
  s_waitcnt lgkmcnt(6)
  v_mfma_f32_32x32x16_bf16 v[80:95], v[28:31], a[40:43], v[80:95]
  ds_read_b64_tr_b16 v[44:45], v22 offset:18752
  ds_read_b64_tr_b16 v[46:47], v22 offset:21056
  s_waitcnt lgkmcnt(6)
  v_mfma_f32_32x32x16_bf16 v[96:111], v[32:35], a[40:43], v[96:111]
  ds_read_b64_tr_b16 v[24:25], v22 offset:18816
  ds_read_b64_tr_b16 v[26:27], v22 offset:21120
  s_add_u32 m0, s24, 6144
  s_nop 0
  buffer_load_dwordx4 v16, s[4:7], s22 offen lds
  s_waitcnt lgkmcnt(6)
  v_mfma_f32_32x32x16_bf16 v[112:127], v[36:39], a[40:43], v[112:127]
  ds_read_b64_tr_b16 v[28:29], v22 offset:18880
  ds_read_b64_tr_b16 v[30:31], v22 offset:21184
  s_waitcnt lgkmcnt(6)
  v_mfma_f32_32x32x16_bf16 v[128:143], v[40:43], a[40:43], v[128:143]
  ds_read_b64_tr_b16 v[32:33], v22 offset:18944
  ds_read_b64_tr_b16 v[34:35], v22 offset:21248
  s_add_u32 m0, s24, 7168
  s_nop 0
  buffer_load_dwordx4 v17, s[4:7], s22 offen lds
  s_waitcnt lgkmcnt(6)
  v_mfma_f32_32x32x16_bf16 v[144:159], v[44:47], a[40:43], v[144:159]
  ds_read_b64_tr_b16 v[36:37], v22 offset:27648
  ds_read_b64_tr_b16 v[38:39], v22 offset:29952
  s_waitcnt lgkmcnt(6)
  v_mfma_f32_32x32x16_bf16 v[160:175], v[24:27], a[40:43], v[160:175]
  ds_read_b64_tr_b16 v[40:41], v22 offset:27712
  ds_read_b64_tr_b16 v[42:43], v22 offset:30016
  s_add_u32 m0, s24, 8192
  s_nop 0
  buffer_load_dwordx4 v18, s[4:7], s22 offen lds
  s_add_u32 s22, s22, 73728
  s_waitcnt lgkmcnt(6)
  v_mfma_f32_32x32x16_bf16 v[176:191], v[28:31], a[40:43], v[176:191]
  ds_read_b64_tr_b16 v[44:45], v22 offset:27776
  ds_read_b64_tr_b16 v[46:47], v22 offset:30080
  s_waitcnt lgkmcnt(6)
  v_mfma_f32_32x32x16_bf16 v[192:207], v[32:35], a[40:43], v[192:207]
  ds_read_b64_tr_b16 v[24:25], v22 offset:27840
  ds_read_b64_tr_b16 v[26:27], v22 offset:30144
  s_waitcnt lgkmcnt(6)
  v_mfma_f32_32x32x16_bf16 v[64:79], v[36:39], a[44:47], v[64:79]
  ds_read_b64_tr_b16 v[28:29], v22 offset:27904
  ds_read_b64_tr_b16 v[30:31], v22 offset:30208
  s_waitcnt lgkmcnt(6)
  v_mfma_f32_32x32x16_bf16 v[80:95], v[40:43], a[44:47], v[80:95]
  ds_read_b64_tr_b16 v[32:33], v22 offset:27968
  ds_read_b64_tr_b16 v[34:35], v22 offset:30272
  s_waitcnt lgkmcnt(6)
  v_mfma_f32_32x32x16_bf16 v[96:111], v[44:47], a[44:47], v[96:111]
  ds_read_b64_tr_b16 v[36:37], v22 offset:28032
  ds_read_b64_tr_b16 v[38:39], v22 offset:30336
  s_waitcnt lgkmcnt(6)
  v_mfma_f32_32x32x16_bf16 v[112:127], v[24:27], a[44:47], v[112:127]
  ds_read_b64_tr_b16 v[40:41], v22 offset:28096
  ds_read_b64_tr_b16 v[42:43], v22 offset:30400
  s_waitcnt lgkmcnt(6)
  v_mfma_f32_32x32x16_bf16 v[128:143], v[28:31], a[44:47], v[128:143]
  ds_read_b64_tr_b16 v[44:45], v22 offset:28160
  ds_read_b64_tr_b16 v[46:47], v22 offset:30464
  s_waitcnt lgkmcnt(6)
  v_mfma_f32_32x32x16_bf16 v[144:159], v[32:35], a[44:47], v[144:159]
  s_waitcnt vmcnt(13) lgkmcnt(0)
  s_barrier
  ds_read_b64_tr_b16 v[24:25], v23 offset:0
  ds_read_b64_tr_b16 v[26:27], v23 offset:2304
  v_mfma_f32_32x32x16_bf16 v[160:175], v[36:39], a[44:47], v[160:175]
  ds_read_b64_tr_b16 v[28:29], v23 offset:64
  ds_read_b64_tr_b16 v[30:31], v23 offset:2368
  v_mfma_f32_32x32x16_bf16 v[176:191], v[40:43], a[44:47], v[176:191]
  ds_read_b64_tr_b16 v[32:33], v23 offset:128
  ds_read_b64_tr_b16 v[34:35], v23 offset:2432
  v_mfma_f32_32x32x16_bf16 v[192:207], v[44:47], a[44:47], v[192:207]
  ds_read_b64_tr_b16 v[36:37], v23 offset:192
  ds_read_b64_tr_b16 v[38:39], v23 offset:2496
  s_waitcnt lgkmcnt(6)
  v_mfma_f32_32x32x16_bf16 v[64:79], v[24:27], a[48:51], v[64:79]
  ds_read_b64_tr_b16 v[40:41], v23 offset:256
  ds_read_b64_tr_b16 v[42:43], v23 offset:2560
  buffer_load_dwordx4 a[80:83], v1, s[8:11], s21 offen offset:0
  s_waitcnt lgkmcnt(6)
  v_mfma_f32_32x32x16_bf16 v[80:95], v[28:31], a[48:51], v[80:95]
  ds_read_b64_tr_b16 v[44:45], v23 offset:320
  ds_read_b64_tr_b16 v[46:47], v23 offset:2624
  s_waitcnt lgkmcnt(6)
  v_mfma_f32_32x32x16_bf16 v[96:111], v[32:35], a[48:51], v[96:111]
  ds_read_b64_tr_b16 v[24:25], v23 offset:384
  ds_read_b64_tr_b16 v[26:27], v23 offset:2688
  buffer_load_dwordx4 a[84:87], v1, s[8:11], s21 offen offset:1024
  s_waitcnt lgkmcnt(6)
  v_mfma_f32_32x32x16_bf16 v[112:127], v[36:39], a[48:51], v[112:127]
  ds_read_b64_tr_b16 v[28:29], v23 offset:448
  ds_read_b64_tr_b16 v[30:31], v23 offset:2752
  s_waitcnt lgkmcnt(6)
  v_mfma_f32_32x32x16_bf16 v[128:143], v[40:43], a[48:51], v[128:143]
  ds_read_b64_tr_b16 v[32:33], v23 offset:512
  ds_read_b64_tr_b16 v[34:35], v23 offset:2816
  buffer_load_dwordx4 a[88:91], v1, s[8:11], s21 offen offset:2048
  s_waitcnt lgkmcnt(6)
  v_mfma_f32_32x32x16_bf16 v[144:159], v[44:47], a[48:51], v[144:159]
  ds_read_b64_tr_b16 v[36:37], v23 offset:9216
  ds_read_b64_tr_b16 v[38:39], v23 offset:11520
  s_waitcnt lgkmcnt(6)
  v_mfma_f32_32x32x16_bf16 v[160:175], v[24:27], a[48:51], v[160:175]
  ds_read_b64_tr_b16 v[40:41], v23 offset:9280
  ds_read_b64_tr_b16 v[42:43], v23 offset:11584
  buffer_load_dwordx4 a[92:95], v1, s[8:11], s21 offen offset:3072
  s_add_u32 s21, s21, 4096
  s_waitcnt lgkmcnt(6)
  v_mfma_f32_32x32x16_bf16 v[176:191], v[28:31], a[48:51], v[176:191]
  ds_read_b64_tr_b16 v[44:45], v23 offset:9344
  ds_read_b64_tr_b16 v[46:47], v23 offset:11648
  s_waitcnt lgkmcnt(6)
  v_mfma_f32_32x32x16_bf16 v[192:207], v[32:35], a[48:51], v[192:207]
  ds_read_b64_tr_b16 v[24:25], v23 offset:9408
  ds_read_b64_tr_b16 v[26:27], v23 offset:11712
  s_add_u32 m0, s24, 36864
  s_nop 0
  buffer_load_dwordx4 v10, s[4:7], s22 offen lds
  s_waitcnt lgkmcnt(6)
  v_mfma_f32_32x32x16_bf16 v[64:79], v[36:39], a[52:55], v[64:79]
  ds_read_b64_tr_b16 v[28:29], v23 offset:9472
  ds_read_b64_tr_b16 v[30:31], v23 offset:11776
  s_waitcnt lgkmcnt(6)
  v_mfma_f32_32x32x16_bf16 v[80:95], v[40:43], a[52:55], v[80:95]
  ds_read_b64_tr_b16 v[32:33], v23 offset:9536
  ds_read_b64_tr_b16 v[34:35], v23 offset:11840
  s_add_u32 m0, s24, 37888
  s_nop 0
  buffer_load_dwordx4 v11, s[4:7], s22 offen lds
  s_waitcnt lgkmcnt(6)
  v_mfma_f32_32x32x16_bf16 v[96:111], v[44:47], a[52:55], v[96:111]
  ds_read_b64_tr_b16 v[36:37], v23 offset:9600
  ds_read_b64_tr_b16 v[38:39], v23 offset:11904
  s_waitcnt lgkmcnt(6)
  v_mfma_f32_32x32x16_bf16 v[112:127], v[24:27], a[52:55], v[112:127]
  ds_read_b64_tr_b16 v[40:41], v23 offset:9664
  ds_read_b64_tr_b16 v[42:43], v23 offset:11968
  s_add_u32 m0, s24, 38912
  s_nop 0
  buffer_load_dwordx4 v12, s[4:7], s22 offen lds
  s_waitcnt lgkmcnt(6)
  v_mfma_f32_32x32x16_bf16 v[128:143], v[28:31], a[52:55], v[128:143]
  ds_read_b64_tr_b16 v[44:45], v23 offset:9728
  ds_read_b64_tr_b16 v[46:47], v23 offset:12032
  s_waitcnt lgkmcnt(6)
  v_mfma_f32_32x32x16_bf16 v[144:159], v[32:35], a[52:55], v[144:159]
  ds_read_b64_tr_b16 v[24:25], v23 offset:18432
  ds_read_b64_tr_b16 v[26:27], v23 offset:20736
  s_add_u32 m0, s24, 39936
  s_nop 0
  buffer_load_dwordx4 v13, s[4:7], s22 offen lds
  s_waitcnt lgkmcnt(6)
  v_mfma_f32_32x32x16_bf16 v[160:175], v[36:39], a[52:55], v[160:175]
  ds_read_b64_tr_b16 v[28:29], v23 offset:18496
  ds_read_b64_tr_b16 v[30:31], v23 offset:20800
  s_waitcnt lgkmcnt(6)
  v_mfma_f32_32x32x16_bf16 v[176:191], v[40:43], a[52:55], v[176:191]
  ds_read_b64_tr_b16 v[32:33], v23 offset:18560
  ds_read_b64_tr_b16 v[34:35], v23 offset:20864
  s_add_u32 m0, s24, 40960
  s_nop 0
  buffer_load_dwordx4 v14, s[4:7], s22 offen lds
  s_waitcnt lgkmcnt(6)
  v_mfma_f32_32x32x16_bf16 v[192:207], v[44:47], a[52:55], v[192:207]
  ds_read_b64_tr_b16 v[36:37], v23 offset:18624
  ds_read_b64_tr_b16 v[38:39], v23 offset:20928
  s_waitcnt lgkmcnt(6)
  v_mfma_f32_32x32x16_bf16 v[64:79], v[24:27], a[56:59], v[64:79]
  ds_read_b64_tr_b16 v[40:41], v23 offset:18688
  ds_read_b64_tr_b16 v[42:43], v23 offset:20992
  s_add_u32 m0, s24, 41984
  s_nop 0
  buffer_load_dwordx4 v15, s[4:7], s22 offen lds
  s_waitcnt lgkmcnt(6)
  v_mfma_f32_32x32x16_bf16 v[80:95], v[28:31], a[56:59], v[80:95]
  ds_read_b64_tr_b16 v[44:45], v23 offset:18752
  ds_read_b64_tr_b16 v[46:47], v23 offset:21056
  s_waitcnt lgkmcnt(6)
  v_mfma_f32_32x32x16_bf16 v[96:111], v[32:35], a[56:59], v[96:111]
  ds_read_b64_tr_b16 v[24:25], v23 offset:18816
  ds_read_b64_tr_b16 v[26:27], v23 offset:21120
  s_add_u32 m0, s24, 43008
  s_nop 0
  buffer_load_dwordx4 v16, s[4:7], s22 offen lds
  s_waitcnt lgkmcnt(6)
  v_mfma_f32_32x32x16_bf16 v[112:127], v[36:39], a[56:59], v[112:127]
  ds_read_b64_tr_b16 v[28:29], v23 offset:18880
  ds_read_b64_tr_b16 v[30:31], v23 offset:21184
  s_waitcnt lgkmcnt(6)
  v_mfma_f32_32x32x16_bf16 v[128:143], v[40:43], a[56:59], v[128:143]
  ds_read_b64_tr_b16 v[32:33], v23 offset:18944
  ds_read_b64_tr_b16 v[34:35], v23 offset:21248
  s_add_u32 m0, s24, 44032
  s_nop 0
  buffer_load_dwordx4 v17, s[4:7], s22 offen lds
  s_waitcnt lgkmcnt(6)
  v_mfma_f32_32x32x16_bf16 v[144:159], v[44:47], a[56:59], v[144:159]
  ds_read_b64_tr_b16 v[36:37], v23 offset:27648
  ds_read_b64_tr_b16 v[38:39], v23 offset:29952
  s_waitcnt lgkmcnt(6)
  v_mfma_f32_32x32x16_bf16 v[160:175], v[24:27], a[56:59], v[160:175]
  ds_read_b64_tr_b16 v[40:41], v23 offset:27712
  ds_read_b64_tr_b16 v[42:43], v23 offset:30016
  s_add_u32 m0, s24, 45056
  s_nop 0
  buffer_load_dwordx4 v18, s[4:7], s22 offen lds
  s_add_u32 s22, s22, 73728
  s_waitcnt lgkmcnt(6)
  v_mfma_f32_32x32x16_bf16 v[176:191], v[28:31], a[56:59], v[176:191]
  ds_read_b64_tr_b16 v[44:45], v23 offset:27776
  ds_read_b64_tr_b16 v[46:47], v23 offset:30080
  s_waitcnt lgkmcnt(6)
  v_mfma_f32_32x32x16_bf16 v[192:207], v[32:35], a[56:59], v[192:207]
  ds_read_b64_tr_b16 v[24:25], v23 offset:27840
  ds_read_b64_tr_b16 v[26:27], v23 offset:30144
  s_waitcnt lgkmcnt(6)
  v_mfma_f32_32x32x16_bf16 v[64:79], v[36:39], a[60:63], v[64:79]
  ds_read_b64_tr_b16 v[28:29], v23 offset:27904
  ds_read_b64_tr_b16 v[30:31], v23 offset:30208
  s_waitcnt lgkmcnt(6)
  v_mfma_f32_32x32x16_bf16 v[80:95], v[40:43], a[60:63], v[80:95]
  ds_read_b64_tr_b16 v[32:33], v23 offset:27968
  ds_read_b64_tr_b16 v[34:35], v23 offset:30272
  s_waitcnt lgkmcnt(6)
  v_mfma_f32_32x32x16_bf16 v[96:111], v[44:47], a[60:63], v[96:111]
  ds_read_b64_tr_b16 v[36:37], v23 offset:28032
  ds_read_b64_tr_b16 v[38:39], v23 offset:30336
  s_waitcnt lgkmcnt(6)
  v_mfma_f32_32x32x16_bf16 v[112:127], v[24:27], a[60:63], v[112:127]
  ds_read_b64_tr_b16 v[40:41], v23 offset:28096
  ds_read_b64_tr_b16 v[42:43], v23 offset:30400
  s_waitcnt lgkmcnt(6)
  v_mfma_f32_32x32x16_bf16 v[128:143], v[28:31], a[60:63], v[128:143]
  ds_read_b64_tr_b16 v[44:45], v23 offset:28160
  ds_read_b64_tr_b16 v[46:47], v23 offset:30464
  s_waitcnt lgkmcnt(6)
  v_mfma_f32_32x32x16_bf16 v[144:159], v[32:35], a[60:63], v[144:159]
  s_waitcnt vmcnt(13) lgkmcnt(0)
  s_barrier
  ds_read_b64_tr_b16 v[24:25], v20 offset:0
  ds_read_b64_tr_b16 v[26:27], v20 offset:2304
  v_mfma_f32_32x32x16_bf16 v[160:175], v[36:39], a[60:63], v[160:175]
  ds_read_b64_tr_b16 v[28:29], v20 offset:64
  ds_read_b64_tr_b16 v[30:31], v20 offset:2368
  v_mfma_f32_32x32x16_bf16 v[176:191], v[40:43], a[60:63], v[176:191]
  ds_read_b64_tr_b16 v[32:33], v20 offset:128
  ds_read_b64_tr_b16 v[34:35], v20 offset:2432
  v_mfma_f32_32x32x16_bf16 v[192:207], v[44:47], a[60:63], v[192:207]
  ds_read_b64_tr_b16 v[36:37], v20 offset:192
  ds_read_b64_tr_b16 v[38:39], v20 offset:2496
  s_waitcnt lgkmcnt(6)
  v_mfma_f32_32x32x16_bf16 v[64:79], v[24:27], a[64:67], v[64:79]
  ds_read_b64_tr_b16 v[40:41], v20 offset:256
  ds_read_b64_tr_b16 v[42:43], v20 offset:2560
  buffer_load_dwordx4 a[96:99], v1, s[8:11], s21 offen offset:0
  s_waitcnt lgkmcnt(6)
  v_mfma_f32_32x32x16_bf16 v[80:95], v[28:31], a[64:67], v[80:95]
  ds_read_b64_tr_b16 v[44:45], v20 offset:320
  ds_read_b64_tr_b16 v[46:47], v20 offset:2624
  s_waitcnt lgkmcnt(6)
  v_mfma_f32_32x32x16_bf16 v[96:111], v[32:35], a[64:67], v[96:111]
  ds_read_b64_tr_b16 v[24:25], v20 offset:384
  ds_read_b64_tr_b16 v[26:27], v20 offset:2688
  buffer_load_dwordx4 a[100:103], v1, s[8:11], s21 offen offset:1024
  s_waitcnt lgkmcnt(6)
  v_mfma_f32_32x32x16_bf16 v[112:127], v[36:39], a[64:67], v[112:127]
  ds_read_b64_tr_b16 v[28:29], v20 offset:448
  ds_read_b64_tr_b16 v[30:31], v20 offset:2752
  s_waitcnt lgkmcnt(6)
  v_mfma_f32_32x32x16_bf16 v[128:143], v[40:43], a[64:67], v[128:143]
  ds_read_b64_tr_b16 v[32:33], v20 offset:512
  ds_read_b64_tr_b16 v[34:35], v20 offset:2816
  buffer_load_dwordx4 a[104:107], v1, s[8:11], s21 offen offset:2048
  s_waitcnt lgkmcnt(6)
  v_mfma_f32_32x32x16_bf16 v[144:159], v[44:47], a[64:67], v[144:159]
  ds_read_b64_tr_b16 v[36:37], v20 offset:9216
  ds_read_b64_tr_b16 v[38:39], v20 offset:11520
  s_waitcnt lgkmcnt(6)
  v_mfma_f32_32x32x16_bf16 v[160:175], v[24:27], a[64:67], v[160:175]
  ds_read_b64_tr_b16 v[40:41], v20 offset:9280
  ds_read_b64_tr_b16 v[42:43], v20 offset:11584
  buffer_load_dwordx4 a[108:111], v1, s[8:11], s21 offen offset:3072
  s_add_u32 s21, s21, 4096
  s_waitcnt lgkmcnt(6)
  v_mfma_f32_32x32x16_bf16 v[176:191], v[28:31], a[64:67], v[176:191]
  ds_read_b64_tr_b16 v[44:45], v20 offset:9344
  ds_read_b64_tr_b16 v[46:47], v20 offset:11648
  s_waitcnt lgkmcnt(6)
  v_mfma_f32_32x32x16_bf16 v[192:207], v[32:35], a[64:67], v[192:207]
  ds_read_b64_tr_b16 v[24:25], v20 offset:9408
  ds_read_b64_tr_b16 v[26:27], v20 offset:11712
  s_add_u32 m0, s24, 73728
  s_nop 0
  buffer_load_dwordx4 v10, s[4:7], s22 offen lds
  s_waitcnt lgkmcnt(6)
  v_mfma_f32_32x32x16_bf16 v[64:79], v[36:39], a[68:71], v[64:79]
  ds_read_b64_tr_b16 v[28:29], v20 offset:9472
  ds_read_b64_tr_b16 v[30:31], v20 offset:11776
  s_waitcnt lgkmcnt(6)
  v_mfma_f32_32x32x16_bf16 v[80:95], v[40:43], a[68:71], v[80:95]
  ds_read_b64_tr_b16 v[32:33], v20 offset:9536
  ds_read_b64_tr_b16 v[34:35], v20 offset:11840
  s_add_u32 m0, s24, 74752
  s_nop 0
  buffer_load_dwordx4 v11, s[4:7], s22 offen lds
  s_waitcnt lgkmcnt(6)
  v_mfma_f32_32x32x16_bf16 v[96:111], v[44:47], a[68:71], v[96:111]
  ds_read_b64_tr_b16 v[36:37], v20 offset:9600
  ds_read_b64_tr_b16 v[38:39], v20 offset:11904
  s_waitcnt lgkmcnt(6)
  v_mfma_f32_32x32x16_bf16 v[112:127], v[24:27], a[68:71], v[112:127]
  ds_read_b64_tr_b16 v[40:41], v20 offset:9664
  ds_read_b64_tr_b16 v[42:43], v20 offset:11968
  s_add_u32 m0, s24, 75776
  s_nop 0
  buffer_load_dwordx4 v12, s[4:7], s22 offen lds
  s_waitcnt lgkmcnt(6)
  v_mfma_f32_32x32x16_bf16 v[128:143], v[28:31], a[68:71], v[128:143]
  ds_read_b64_tr_b16 v[44:45], v20 offset:9728
  ds_read_b64_tr_b16 v[46:47], v20 offset:12032
  s_waitcnt lgkmcnt(6)
  v_mfma_f32_32x32x16_bf16 v[144:159], v[32:35], a[68:71], v[144:159]
  ds_read_b64_tr_b16 v[24:25], v20 offset:18432
  ds_read_b64_tr_b16 v[26:27], v20 offset:20736
  s_add_u32 m0, s24, 76800
  s_nop 0
  buffer_load_dwordx4 v13, s[4:7], s22 offen lds
  s_waitcnt lgkmcnt(6)
  v_mfma_f32_32x32x16_bf16 v[160:175], v[36:39], a[68:71], v[160:175]
  ds_read_b64_tr_b16 v[28:29], v20 offset:18496
  ds_read_b64_tr_b16 v[30:31], v20 offset:20800
  s_waitcnt lgkmcnt(6)
  v_mfma_f32_32x32x16_bf16 v[176:191], v[40:43], a[68:71], v[176:191]
  ds_read_b64_tr_b16 v[32:33], v20 offset:18560
  ds_read_b64_tr_b16 v[34:35], v20 offset:20864
  s_add_u32 m0, s24, 77824
  s_nop 0
  buffer_load_dwordx4 v14, s[4:7], s22 offen lds
  s_waitcnt lgkmcnt(6)
  v_mfma_f32_32x32x16_bf16 v[192:207], v[44:47], a[68:71], v[192:207]
  ds_read_b64_tr_b16 v[36:37], v20 offset:18624
  ds_read_b64_tr_b16 v[38:39], v20 offset:20928
  s_waitcnt lgkmcnt(6)
  v_mfma_f32_32x32x16_bf16 v[64:79], v[24:27], a[72:75], v[64:79]
  ds_read_b64_tr_b16 v[40:41], v20 offset:18688
  ds_read_b64_tr_b16 v[42:43], v20 offset:20992
  s_add_u32 m0, s24, 78848
  s_nop 0
  buffer_load_dwordx4 v15, s[4:7], s22 offen lds
  s_waitcnt lgkmcnt(6)
  v_mfma_f32_32x32x16_bf16 v[80:95], v[28:31], a[72:75], v[80:95]
  ds_read_b64_tr_b16 v[44:45], v20 offset:18752
  ds_read_b64_tr_b16 v[46:47], v20 offset:21056
  s_waitcnt lgkmcnt(6)
  v_mfma_f32_32x32x16_bf16 v[96:111], v[32:35], a[72:75], v[96:111]
  ds_read_b64_tr_b16 v[24:25], v20 offset:18816
  ds_read_b64_tr_b16 v[26:27], v20 offset:21120
  s_add_u32 m0, s24, 79872
  s_nop 0
  buffer_load_dwordx4 v16, s[4:7], s22 offen lds
  s_waitcnt lgkmcnt(6)
  v_mfma_f32_32x32x16_bf16 v[112:127], v[36:39], a[72:75], v[112:127]
  ds_read_b64_tr_b16 v[28:29], v20 offset:18880
  ds_read_b64_tr_b16 v[30:31], v20 offset:21184
  s_waitcnt lgkmcnt(6)
  v_mfma_f32_32x32x16_bf16 v[128:143], v[40:43], a[72:75], v[128:143]
  ds_read_b64_tr_b16 v[32:33], v20 offset:18944
  ds_read_b64_tr_b16 v[34:35], v20 offset:21248
  s_add_u32 m0, s24, 80896
  s_nop 0
  buffer_load_dwordx4 v17, s[4:7], s22 offen lds
  s_waitcnt lgkmcnt(6)
  v_mfma_f32_32x32x16_bf16 v[144:159], v[44:47], a[72:75], v[144:159]
  ds_read_b64_tr_b16 v[36:37], v20 offset:27648
  ds_read_b64_tr_b16 v[38:39], v20 offset:29952
  s_waitcnt lgkmcnt(6)
  v_mfma_f32_32x32x16_bf16 v[160:175], v[24:27], a[72:75], v[160:175]
  ds_read_b64_tr_b16 v[40:41], v20 offset:27712
  ds_read_b64_tr_b16 v[42:43], v20 offset:30016
  s_add_u32 m0, s24, 81920
  s_nop 0
  buffer_load_dwordx4 v18, s[4:7], s22 offen lds
  s_add_u32 s22, s22, 73728
  s_waitcnt lgkmcnt(6)
  v_mfma_f32_32x32x16_bf16 v[176:191], v[28:31], a[72:75], v[176:191]
  ds_read_b64_tr_b16 v[44:45], v20 offset:27776
  ds_read_b64_tr_b16 v[46:47], v20 offset:30080
  s_waitcnt lgkmcnt(6)
  v_mfma_f32_32x32x16_bf16 v[192:207], v[32:35], a[72:75], v[192:207]
  ds_read_b64_tr_b16 v[24:25], v20 offset:27840
  ds_read_b64_tr_b16 v[26:27], v20 offset:30144
  s_waitcnt lgkmcnt(6)
  v_mfma_f32_32x32x16_bf16 v[64:79], v[36:39], a[76:79], v[64:79]
  ds_read_b64_tr_b16 v[28:29], v20 offset:27904
  ds_read_b64_tr_b16 v[30:31], v20 offset:30208
  s_waitcnt lgkmcnt(6)
  v_mfma_f32_32x32x16_bf16 v[80:95], v[40:43], a[76:79], v[80:95]
  ds_read_b64_tr_b16 v[32:33], v20 offset:27968
  ds_read_b64_tr_b16 v[34:35], v20 offset:30272
  s_waitcnt lgkmcnt(6)
  v_mfma_f32_32x32x16_bf16 v[96:111], v[44:47], a[76:79], v[96:111]
  ds_read_b64_tr_b16 v[36:37], v20 offset:28032
  ds_read_b64_tr_b16 v[38:39], v20 offset:30336
  s_waitcnt lgkmcnt(6)
  v_mfma_f32_32x32x16_bf16 v[112:127], v[24:27], a[76:79], v[112:127]
  ds_read_b64_tr_b16 v[40:41], v20 offset:28096
  ds_read_b64_tr_b16 v[42:43], v20 offset:30400
  s_waitcnt lgkmcnt(6)
  v_mfma_f32_32x32x16_bf16 v[128:143], v[28:31], a[76:79], v[128:143]
  ds_read_b64_tr_b16 v[44:45], v20 offset:28160
  ds_read_b64_tr_b16 v[46:47], v20 offset:30464
  s_waitcnt lgkmcnt(6)
  v_mfma_f32_32x32x16_bf16 v[144:159], v[32:35], a[76:79], v[144:159]
  s_waitcnt vmcnt(13) lgkmcnt(0)
  s_barrier
  ds_read_b64_tr_b16 v[24:25], v21 offset:0
  ds_read_b64_tr_b16 v[26:27], v21 offset:2304
  v_mfma_f32_32x32x16_bf16 v[160:175], v[36:39], a[76:79], v[160:175]
  ds_read_b64_tr_b16 v[28:29], v21 offset:64
  ds_read_b64_tr_b16 v[30:31], v21 offset:2368
  v_mfma_f32_32x32x16_bf16 v[176:191], v[40:43], a[76:79], v[176:191]
  ds_read_b64_tr_b16 v[32:33], v21 offset:128
  ds_read_b64_tr_b16 v[34:35], v21 offset:2432
  v_mfma_f32_32x32x16_bf16 v[192:207], v[44:47], a[76:79], v[192:207]
  ds_read_b64_tr_b16 v[36:37], v21 offset:192
  ds_read_b64_tr_b16 v[38:39], v21 offset:2496
  s_waitcnt lgkmcnt(6)
  v_mfma_f32_32x32x16_bf16 v[64:79], v[24:27], a[80:83], v[64:79]
  ds_read_b64_tr_b16 v[40:41], v21 offset:256
  ds_read_b64_tr_b16 v[42:43], v21 offset:2560
  buffer_load_dwordx4 a[112:115], v1, s[8:11], s21 offen offset:0
  s_waitcnt lgkmcnt(6)
  v_mfma_f32_32x32x16_bf16 v[80:95], v[28:31], a[80:83], v[80:95]
  ds_read_b64_tr_b16 v[44:45], v21 offset:320
  ds_read_b64_tr_b16 v[46:47], v21 offset:2624
  s_waitcnt lgkmcnt(6)
  v_mfma_f32_32x32x16_bf16 v[96:111], v[32:35], a[80:83], v[96:111]
  ds_read_b64_tr_b16 v[24:25], v21 offset:384
  ds_read_b64_tr_b16 v[26:27], v21 offset:2688
  buffer_load_dwordx4 a[116:119], v1, s[8:11], s21 offen offset:1024
  s_waitcnt lgkmcnt(6)
  v_mfma_f32_32x32x16_bf16 v[112:127], v[36:39], a[80:83], v[112:127]
  ds_read_b64_tr_b16 v[28:29], v21 offset:448
  ds_read_b64_tr_b16 v[30:31], v21 offset:2752
  s_waitcnt lgkmcnt(6)
  v_mfma_f32_32x32x16_bf16 v[128:143], v[40:43], a[80:83], v[128:143]
  ds_read_b64_tr_b16 v[32:33], v21 offset:512
  ds_read_b64_tr_b16 v[34:35], v21 offset:2816
  buffer_load_dwordx4 a[120:123], v1, s[8:11], s21 offen offset:2048
  s_waitcnt lgkmcnt(6)
  v_mfma_f32_32x32x16_bf16 v[144:159], v[44:47], a[80:83], v[144:159]
  ds_read_b64_tr_b16 v[36:37], v21 offset:9216
  ds_read_b64_tr_b16 v[38:39], v21 offset:11520
  s_waitcnt lgkmcnt(6)
  v_mfma_f32_32x32x16_bf16 v[160:175], v[24:27], a[80:83], v[160:175]
  ds_read_b64_tr_b16 v[40:41], v21 offset:9280
  ds_read_b64_tr_b16 v[42:43], v21 offset:11584
  buffer_load_dwordx4 a[124:127], v1, s[8:11], s21 offen offset:3072
  s_add_u32 s21, s21, 4096
  s_waitcnt lgkmcnt(6)
  v_mfma_f32_32x32x16_bf16 v[176:191], v[28:31], a[80:83], v[176:191]
  ds_read_b64_tr_b16 v[44:45], v21 offset:9344
  ds_read_b64_tr_b16 v[46:47], v21 offset:11648
  s_waitcnt lgkmcnt(6)
  v_mfma_f32_32x32x16_bf16 v[192:207], v[32:35], a[80:83], v[192:207]
  ds_read_b64_tr_b16 v[24:25], v21 offset:9408
  ds_read_b64_tr_b16 v[26:27], v21 offset:11712
  s_add_u32 m0, s24, 110592
  s_nop 0
  buffer_load_dwordx4 v10, s[4:7], s22 offen lds
  s_waitcnt lgkmcnt(6)
  v_mfma_f32_32x32x16_bf16 v[64:79], v[36:39], a[84:87], v[64:79]
  ds_read_b64_tr_b16 v[28:29], v21 offset:9472
  ds_read_b64_tr_b16 v[30:31], v21 offset:11776
  s_waitcnt lgkmcnt(6)
  v_mfma_f32_32x32x16_bf16 v[80:95], v[40:43], a[84:87], v[80:95]
  ds_read_b64_tr_b16 v[32:33], v21 offset:9536
  ds_read_b64_tr_b16 v[34:35], v21 offset:11840
  s_add_u32 m0, s24, 111616
  s_nop 0
  buffer_load_dwordx4 v11, s[4:7], s22 offen lds
  s_waitcnt lgkmcnt(6)
  v_mfma_f32_32x32x16_bf16 v[96:111], v[44:47], a[84:87], v[96:111]
  ds_read_b64_tr_b16 v[36:37], v21 offset:9600
  ds_read_b64_tr_b16 v[38:39], v21 offset:11904
  s_waitcnt lgkmcnt(6)
  v_mfma_f32_32x32x16_bf16 v[112:127], v[24:27], a[84:87], v[112:127]
  ds_read_b64_tr_b16 v[40:41], v21 offset:9664
  ds_read_b64_tr_b16 v[42:43], v21 offset:11968
  s_add_u32 m0, s24, 112640
  s_nop 0
  buffer_load_dwordx4 v12, s[4:7], s22 offen lds
  s_waitcnt lgkmcnt(6)
  v_mfma_f32_32x32x16_bf16 v[128:143], v[28:31], a[84:87], v[128:143]
  ds_read_b64_tr_b16 v[44:45], v21 offset:9728
  ds_read_b64_tr_b16 v[46:47], v21 offset:12032
  s_waitcnt lgkmcnt(6)
  v_mfma_f32_32x32x16_bf16 v[144:159], v[32:35], a[84:87], v[144:159]
  ds_read_b64_tr_b16 v[24:25], v21 offset:18432
  ds_read_b64_tr_b16 v[26:27], v21 offset:20736
  s_add_u32 m0, s24, 113664
  s_nop 0
  buffer_load_dwordx4 v13, s[4:7], s22 offen lds
  s_waitcnt lgkmcnt(6)
  v_mfma_f32_32x32x16_bf16 v[160:175], v[36:39], a[84:87], v[160:175]
  ds_read_b64_tr_b16 v[28:29], v21 offset:18496
  ds_read_b64_tr_b16 v[30:31], v21 offset:20800
  s_waitcnt lgkmcnt(6)
  v_mfma_f32_32x32x16_bf16 v[176:191], v[40:43], a[84:87], v[176:191]
  ds_read_b64_tr_b16 v[32:33], v21 offset:18560
  ds_read_b64_tr_b16 v[34:35], v21 offset:20864
  s_add_u32 m0, s24, 114688
  s_nop 0
  buffer_load_dwordx4 v14, s[4:7], s22 offen lds
  s_waitcnt lgkmcnt(6)
  v_mfma_f32_32x32x16_bf16 v[192:207], v[44:47], a[84:87], v[192:207]
  ds_read_b64_tr_b16 v[36:37], v21 offset:18624
  ds_read_b64_tr_b16 v[38:39], v21 offset:20928
  s_waitcnt lgkmcnt(6)
  v_mfma_f32_32x32x16_bf16 v[64:79], v[24:27], a[88:91], v[64:79]
  ds_read_b64_tr_b16 v[40:41], v21 offset:18688
  ds_read_b64_tr_b16 v[42:43], v21 offset:20992
  s_add_u32 m0, s24, 115712
  s_nop 0
  buffer_load_dwordx4 v15, s[4:7], s22 offen lds
  s_waitcnt lgkmcnt(6)
  v_mfma_f32_32x32x16_bf16 v[80:95], v[28:31], a[88:91], v[80:95]
  ds_read_b64_tr_b16 v[44:45], v21 offset:18752
  ds_read_b64_tr_b16 v[46:47], v21 offset:21056
  s_waitcnt lgkmcnt(6)
  v_mfma_f32_32x32x16_bf16 v[96:111], v[32:35], a[88:91], v[96:111]
  ds_read_b64_tr_b16 v[24:25], v21 offset:18816
  ds_read_b64_tr_b16 v[26:27], v21 offset:21120
  s_add_u32 m0, s24, 116736
  s_nop 0
  buffer_load_dwordx4 v16, s[4:7], s22 offen lds
  s_waitcnt lgkmcnt(6)
  v_mfma_f32_32x32x16_bf16 v[112:127], v[36:39], a[88:91], v[112:127]
  ds_read_b64_tr_b16 v[28:29], v21 offset:18880
  ds_read_b64_tr_b16 v[30:31], v21 offset:21184
  s_waitcnt lgkmcnt(6)
  v_mfma_f32_32x32x16_bf16 v[128:143], v[40:43], a[88:91], v[128:143]
  ds_read_b64_tr_b16 v[32:33], v21 offset:18944
  ds_read_b64_tr_b16 v[34:35], v21 offset:21248
  s_add_u32 m0, s24, 117760
  s_nop 0
  buffer_load_dwordx4 v17, s[4:7], s22 offen lds
  s_waitcnt lgkmcnt(6)
  v_mfma_f32_32x32x16_bf16 v[144:159], v[44:47], a[88:91], v[144:159]
  ds_read_b64_tr_b16 v[36:37], v21 offset:27648
  ds_read_b64_tr_b16 v[38:39], v21 offset:29952
  s_waitcnt lgkmcnt(6)
  v_mfma_f32_32x32x16_bf16 v[160:175], v[24:27], a[88:91], v[160:175]
  ds_read_b64_tr_b16 v[40:41], v21 offset:27712
  ds_read_b64_tr_b16 v[42:43], v21 offset:30016
  s_add_u32 m0, s24, 118784
  s_nop 0
  buffer_load_dwordx4 v18, s[4:7], s22 offen lds
  s_add_u32 s22, s22, 73728
  s_waitcnt lgkmcnt(6)
  v_mfma_f32_32x32x16_bf16 v[176:191], v[28:31], a[88:91], v[176:191]
  ds_read_b64_tr_b16 v[44:45], v21 offset:27776
  ds_read_b64_tr_b16 v[46:47], v21 offset:30080
  s_waitcnt lgkmcnt(6)
  v_mfma_f32_32x32x16_bf16 v[192:207], v[32:35], a[88:91], v[192:207]
  ds_read_b64_tr_b16 v[24:25], v21 offset:27840
  ds_read_b64_tr_b16 v[26:27], v21 offset:30144
  s_waitcnt lgkmcnt(6)
  v_mfma_f32_32x32x16_bf16 v[64:79], v[36:39], a[92:95], v[64:79]
  ds_read_b64_tr_b16 v[28:29], v21 offset:27904
  ds_read_b64_tr_b16 v[30:31], v21 offset:30208
  s_waitcnt lgkmcnt(6)
  v_mfma_f32_32x32x16_bf16 v[80:95], v[40:43], a[92:95], v[80:95]
  ds_read_b64_tr_b16 v[32:33], v21 offset:27968
  ds_read_b64_tr_b16 v[34:35], v21 offset:30272
  s_waitcnt lgkmcnt(6)
  v_mfma_f32_32x32x16_bf16 v[96:111], v[44:47], a[92:95], v[96:111]
  ds_read_b64_tr_b16 v[36:37], v21 offset:28032
  ds_read_b64_tr_b16 v[38:39], v21 offset:30336
  s_waitcnt lgkmcnt(6)
  v_mfma_f32_32x32x16_bf16 v[112:127], v[24:27], a[92:95], v[112:127]
  ds_read_b64_tr_b16 v[40:41], v21 offset:28096
  ds_read_b64_tr_b16 v[42:43], v21 offset:30400
  s_waitcnt lgkmcnt(6)
  v_mfma_f32_32x32x16_bf16 v[128:143], v[28:31], a[92:95], v[128:143]
  ds_read_b64_tr_b16 v[44:45], v21 offset:28160
  ds_read_b64_tr_b16 v[46:47], v21 offset:30464
  s_waitcnt lgkmcnt(6)
  v_mfma_f32_32x32x16_bf16 v[144:159], v[32:35], a[92:95], v[144:159]
  s_waitcnt vmcnt(13) lgkmcnt(0)
  s_barrier
  ds_read_b64_tr_b16 v[24:25], v22 offset:0
  ds_read_b64_tr_b16 v[26:27], v22 offset:2304
  v_mfma_f32_32x32x16_bf16 v[160:175], v[36:39], a[92:95], v[160:175]
  ds_read_b64_tr_b16 v[28:29], v22 offset:64
  ds_read_b64_tr_b16 v[30:31], v22 offset:2368
  v_mfma_f32_32x32x16_bf16 v[176:191], v[40:43], a[92:95], v[176:191]
  ds_read_b64_tr_b16 v[32:33], v22 offset:128
  ds_read_b64_tr_b16 v[34:35], v22 offset:2432
  v_mfma_f32_32x32x16_bf16 v[192:207], v[44:47], a[92:95], v[192:207]
  ds_read_b64_tr_b16 v[36:37], v22 offset:192
  ds_read_b64_tr_b16 v[38:39], v22 offset:2496
  s_waitcnt lgkmcnt(6)
  v_mfma_f32_32x32x16_bf16 v[64:79], v[24:27], a[96:99], v[64:79]
  ds_read_b64_tr_b16 v[40:41], v22 offset:256
  ds_read_b64_tr_b16 v[42:43], v22 offset:2560
  buffer_load_dwordx4 a[128:131], v1, s[8:11], s21 offen offset:0
  s_waitcnt lgkmcnt(6)
  v_mfma_f32_32x32x16_bf16 v[80:95], v[28:31], a[96:99], v[80:95]
  ds_read_b64_tr_b16 v[44:45], v22 offset:320
  ds_read_b64_tr_b16 v[46:47], v22 offset:2624
  s_waitcnt lgkmcnt(6)
  v_mfma_f32_32x32x16_bf16 v[96:111], v[32:35], a[96:99], v[96:111]
  ds_read_b64_tr_b16 v[24:25], v22 offset:384
  ds_read_b64_tr_b16 v[26:27], v22 offset:2688
  buffer_load_dwordx4 a[132:135], v1, s[8:11], s21 offen offset:1024
  s_waitcnt lgkmcnt(6)
  v_mfma_f32_32x32x16_bf16 v[112:127], v[36:39], a[96:99], v[112:127]
  ds_read_b64_tr_b16 v[28:29], v22 offset:448
  ds_read_b64_tr_b16 v[30:31], v22 offset:2752
  s_waitcnt lgkmcnt(6)
  v_mfma_f32_32x32x16_bf16 v[128:143], v[40:43], a[96:99], v[128:143]
  ds_read_b64_tr_b16 v[32:33], v22 offset:512
  ds_read_b64_tr_b16 v[34:35], v22 offset:2816
  buffer_load_dwordx4 a[136:139], v1, s[8:11], s21 offen offset:2048
  s_waitcnt lgkmcnt(6)
  v_mfma_f32_32x32x16_bf16 v[144:159], v[44:47], a[96:99], v[144:159]
  ds_read_b64_tr_b16 v[36:37], v22 offset:9216
  ds_read_b64_tr_b16 v[38:39], v22 offset:11520
  s_waitcnt lgkmcnt(6)
  v_mfma_f32_32x32x16_bf16 v[160:175], v[24:27], a[96:99], v[160:175]
  ds_read_b64_tr_b16 v[40:41], v22 offset:9280
  ds_read_b64_tr_b16 v[42:43], v22 offset:11584
  buffer_load_dwordx4 a[140:143], v1, s[8:11], s21 offen offset:3072
  s_add_u32 s21, s21, 4096
  s_waitcnt lgkmcnt(6)
  v_mfma_f32_32x32x16_bf16 v[176:191], v[28:31], a[96:99], v[176:191]
  ds_read_b64_tr_b16 v[44:45], v22 offset:9344
  ds_read_b64_tr_b16 v[46:47], v22 offset:11648
  s_waitcnt lgkmcnt(6)
  v_mfma_f32_32x32x16_bf16 v[192:207], v[32:35], a[96:99], v[192:207]
  ds_read_b64_tr_b16 v[24:25], v22 offset:9408
  ds_read_b64_tr_b16 v[26:27], v22 offset:11712
  s_add_u32 m0, s24, 0
  s_nop 0
  buffer_load_dwordx4 v10, s[4:7], s22 offen lds
  s_waitcnt lgkmcnt(6)
  v_mfma_f32_32x32x16_bf16 v[64:79], v[36:39], a[100:103], v[64:79]
  ds_read_b64_tr_b16 v[28:29], v22 offset:9472
  ds_read_b64_tr_b16 v[30:31], v22 offset:11776
  s_waitcnt lgkmcnt(6)
  v_mfma_f32_32x32x16_bf16 v[80:95], v[40:43], a[100:103], v[80:95]
  ds_read_b64_tr_b16 v[32:33], v22 offset:9536
  ds_read_b64_tr_b16 v[34:35], v22 offset:11840
  s_add_u32 m0, s24, 1024
  s_nop 0
  buffer_load_dwordx4 v11, s[4:7], s22 offen lds
  s_waitcnt lgkmcnt(6)
  v_mfma_f32_32x32x16_bf16 v[96:111], v[44:47], a[100:103], v[96:111]
  ds_read_b64_tr_b16 v[36:37], v22 offset:9600
  ds_read_b64_tr_b16 v[38:39], v22 offset:11904
  s_waitcnt lgkmcnt(6)
  v_mfma_f32_32x32x16_bf16 v[112:127], v[24:27], a[100:103], v[112:127]
  ds_read_b64_tr_b16 v[40:41], v22 offset:9664
  ds_read_b64_tr_b16 v[42:43], v22 offset:11968
  s_add_u32 m0, s24, 2048
  s_nop 0
  buffer_load_dwordx4 v12, s[4:7], s22 offen lds
  s_waitcnt lgkmcnt(6)
  v_mfma_f32_32x32x16_bf16 v[128:143], v[28:31], a[100:103], v[128:143]
  ds_read_b64_tr_b16 v[44:45], v22 offset:9728
  ds_read_b64_tr_b16 v[46:47], v22 offset:12032
  s_waitcnt lgkmcnt(6)
  v_mfma_f32_32x32x16_bf16 v[144:159], v[32:35], a[100:103], v[144:159]
  ds_read_b64_tr_b16 v[24:25], v22 offset:18432
  ds_read_b64_tr_b16 v[26:27], v22 offset:20736
  s_add_u32 m0, s24, 3072
  s_nop 0
  buffer_load_dwordx4 v13, s[4:7], s22 offen lds
  s_waitcnt lgkmcnt(6)
  v_mfma_f32_32x32x16_bf16 v[160:175], v[36:39], a[100:103], v[160:175]
  ds_read_b64_tr_b16 v[28:29], v22 offset:18496
  ds_read_b64_tr_b16 v[30:31], v22 offset:20800
  s_waitcnt lgkmcnt(6)
  v_mfma_f32_32x32x16_bf16 v[176:191], v[40:43], a[100:103], v[176:191]
  ds_read_b64_tr_b16 v[32:33], v22 offset:18560
  ds_read_b64_tr_b16 v[34:35], v22 offset:20864
  s_add_u32 m0, s24, 4096
  s_nop 0
  buffer_load_dwordx4 v14, s[4:7], s22 offen lds
  s_waitcnt lgkmcnt(6)
  v_mfma_f32_32x32x16_bf16 v[192:207], v[44:47], a[100:103], v[192:207]
  ds_read_b64_tr_b16 v[36:37], v22 offset:18624
  ds_read_b64_tr_b16 v[38:39], v22 offset:20928
  s_waitcnt lgkmcnt(6)
  v_mfma_f32_32x32x16_bf16 v[64:79], v[24:27], a[104:107], v[64:79]
  ds_read_b64_tr_b16 v[40:41], v22 offset:18688
  ds_read_b64_tr_b16 v[42:43], v22 offset:20992
  s_add_u32 m0, s24, 5120
  s_nop 0
  buffer_load_dwordx4 v15, s[4:7], s22 offen lds
  s_waitcnt lgkmcnt(6)
  v_mfma_f32_32x32x16_bf16 v[80:95], v[28:31], a[104:107], v[80:95]
  ds_read_b64_tr_b16 v[44:45], v22 offset:18752
  ds_read_b64_tr_b16 v[46:47], v22 offset:21056
  s_waitcnt lgkmcnt(6)
  v_mfma_f32_32x32x16_bf16 v[96:111], v[32:35], a[104:107], v[96:111]
  ds_read_b64_tr_b16 v[24:25], v22 offset:18816
  ds_read_b64_tr_b16 v[26:27], v22 offset:21120
  s_add_u32 m0, s24, 6144
  s_nop 0
  buffer_load_dwordx4 v16, s[4:7], s22 offen lds
  s_waitcnt lgkmcnt(6)
  v_mfma_f32_32x32x16_bf16 v[112:127], v[36:39], a[104:107], v[112:127]
  ds_read_b64_tr_b16 v[28:29], v22 offset:18880
  ds_read_b64_tr_b16 v[30:31], v22 offset:21184
  s_waitcnt lgkmcnt(6)
  v_mfma_f32_32x32x16_bf16 v[128:143], v[40:43], a[104:107], v[128:143]
  ds_read_b64_tr_b16 v[32:33], v22 offset:18944
  ds_read_b64_tr_b16 v[34:35], v22 offset:21248
  s_add_u32 m0, s24, 7168
  s_nop 0
  buffer_load_dwordx4 v17, s[4:7], s22 offen lds
  s_waitcnt lgkmcnt(6)
  v_mfma_f32_32x32x16_bf16 v[144:159], v[44:47], a[104:107], v[144:159]
  ds_read_b64_tr_b16 v[36:37], v22 offset:27648
  ds_read_b64_tr_b16 v[38:39], v22 offset:29952
  s_waitcnt lgkmcnt(6)
  v_mfma_f32_32x32x16_bf16 v[160:175], v[24:27], a[104:107], v[160:175]
  ds_read_b64_tr_b16 v[40:41], v22 offset:27712
  ds_read_b64_tr_b16 v[42:43], v22 offset:30016
  s_add_u32 m0, s24, 8192
  s_nop 0
  buffer_load_dwordx4 v18, s[4:7], s22 offen lds
  s_add_u32 s22, s22, 73728
  s_sub_u32 s22, s22, 662976
  s_waitcnt lgkmcnt(6)
  v_mfma_f32_32x32x16_bf16 v[176:191], v[28:31], a[104:107], v[176:191]
  ds_read_b64_tr_b16 v[44:45], v22 offset:27776
  ds_read_b64_tr_b16 v[46:47], v22 offset:30080
  s_waitcnt lgkmcnt(6)
  v_mfma_f32_32x32x16_bf16 v[192:207], v[32:35], a[104:107], v[192:207]
  ds_read_b64_tr_b16 v[24:25], v22 offset:27840
  ds_read_b64_tr_b16 v[26:27], v22 offset:30144
  s_waitcnt lgkmcnt(6)
  v_mfma_f32_32x32x16_bf16 v[64:79], v[36:39], a[108:111], v[64:79]
  ds_read_b64_tr_b16 v[28:29], v22 offset:27904
  ds_read_b64_tr_b16 v[30:31], v22 offset:30208
  s_waitcnt lgkmcnt(6)
  v_mfma_f32_32x32x16_bf16 v[80:95], v[40:43], a[108:111], v[80:95]
  ds_read_b64_tr_b16 v[32:33], v22 offset:27968
  ds_read_b64_tr_b16 v[34:35], v22 offset:30272
  s_waitcnt lgkmcnt(6)
  v_mfma_f32_32x32x16_bf16 v[96:111], v[44:47], a[108:111], v[96:111]
  ds_read_b64_tr_b16 v[36:37], v22 offset:28032
  ds_read_b64_tr_b16 v[38:39], v22 offset:30336
  s_waitcnt lgkmcnt(6)
  v_mfma_f32_32x32x16_bf16 v[112:127], v[24:27], a[108:111], v[112:127]
  ds_read_b64_tr_b16 v[40:41], v22 offset:28096
  ds_read_b64_tr_b16 v[42:43], v22 offset:30400
  s_waitcnt lgkmcnt(6)
  v_mfma_f32_32x32x16_bf16 v[128:143], v[28:31], a[108:111], v[128:143]
  ds_read_b64_tr_b16 v[44:45], v22 offset:28160
  ds_read_b64_tr_b16 v[46:47], v22 offset:30464
  s_waitcnt lgkmcnt(6)
  v_mfma_f32_32x32x16_bf16 v[144:159], v[32:35], a[108:111], v[144:159]
  s_waitcnt vmcnt(13) lgkmcnt(0)
  s_barrier
  ds_read_b64_tr_b16 v[24:25], v23 offset:0
  ds_read_b64_tr_b16 v[26:27], v23 offset:2304
  v_mfma_f32_32x32x16_bf16 v[160:175], v[36:39], a[108:111], v[160:175]
  ds_read_b64_tr_b16 v[28:29], v23 offset:9216
  ds_read_b64_tr_b16 v[30:31], v23 offset:11520
  v_mfma_f32_32x32x16_bf16 v[176:191], v[40:43], a[108:111], v[176:191]
  ds_read_b64_tr_b16 v[32:33], v23 offset:18432
  ds_read_b64_tr_b16 v[34:35], v23 offset:20736
  v_mfma_f32_32x32x16_bf16 v[192:207], v[44:47], a[108:111], v[192:207]
  ds_read_b64_tr_b16 v[36:37], v23 offset:27648
  ds_read_b64_tr_b16 v[38:39], v23 offset:29952
  s_waitcnt lgkmcnt(6)
  v_mfma_f32_32x32x16_bf16 v[64:79], v[24:27], a[112:115], v[64:79]
  s_waitcnt vmcnt(0) lgkmcnt(0)
  s_barrier
  ds_read_b64_tr_b16 v[40:41], v20 offset:0
  ds_read_b64_tr_b16 v[42:43], v20 offset:2304
  v_mfma_f32_32x32x16_bf16 v[64:79], v[28:31], a[116:119], v[64:79]
  ds_read_b64_tr_b16 v[44:45], v20 offset:9216
  ds_read_b64_tr_b16 v[46:47], v20 offset:11520
  v_mfma_f32_32x32x16_bf16 v[64:79], v[32:35], a[120:123], v[64:79]
  ds_read_b64_tr_b16 v[24:25], v20 offset:18432
  ds_read_b64_tr_b16 v[26:27], v20 offset:20736
  v_mfma_f32_32x32x16_bf16 v[64:79], v[36:39], a[124:127], v[64:79]
  ds_read_b64_tr_b16 v[28:29], v20 offset:27648
  ds_read_b64_tr_b16 v[30:31], v20 offset:29952
  s_waitcnt lgkmcnt(6)
  v_mfma_f32_32x32x16_bf16 v[64:79], v[40:43], a[128:131], v[64:79]
  ds_read_b64_tr_b16 v[32:33], v23 offset:64
  ds_read_b64_tr_b16 v[34:35], v23 offset:2368
  s_waitcnt lgkmcnt(6)
  v_mfma_f32_32x32x16_bf16 v[64:79], v[44:47], a[132:135], v[64:79]
  ds_read_b64_tr_b16 v[36:37], v23 offset:9280
  ds_read_b64_tr_b16 v[38:39], v23 offset:11584
  s_waitcnt lgkmcnt(6)
  v_mfma_f32_32x32x16_bf16 v[64:79], v[24:27], a[136:139], v[64:79]
  ds_read_b64_tr_b16 v[40:41], v23 offset:18496
  ds_read_b64_tr_b16 v[42:43], v23 offset:20800
  s_waitcnt lgkmcnt(6)
  v_mfma_f32_32x32x16_bf16 v[64:79], v[28:31], a[140:143], v[64:79]
  ds_read_b64_tr_b16 v[44:45], v23 offset:27712
  ds_read_b64_tr_b16 v[46:47], v23 offset:30016
  s_waitcnt lgkmcnt(6)
  v_mfma_f32_32x32x16_bf16 v[80:95], v[32:35], a[112:115], v[80:95]
  ds_read_b64_tr_b16 v[24:25], v20 offset:64
  ds_read_b64_tr_b16 v[26:27], v20 offset:2368
  s_waitcnt lgkmcnt(6)
  v_mfma_f32_32x32x16_bf16 v[80:95], v[36:39], a[116:119], v[80:95]
  ds_read_b64_tr_b16 v[28:29], v20 offset:9280
  ds_read_b64_tr_b16 v[30:31], v20 offset:11584
  s_waitcnt lgkmcnt(6)
  v_mfma_f32_32x32x16_bf16 v[80:95], v[40:43], a[120:123], v[80:95]
  ds_read_b64_tr_b16 v[32:33], v20 offset:18496
  ds_read_b64_tr_b16 v[34:35], v20 offset:20800
  v_cvt_pk_bf16_f32 v48, v64, v65
  v_cvt_pk_bf16_f32 v49, v66, v67
  s_waitcnt lgkmcnt(6)
  v_mfma_f32_32x32x16_bf16 v[80:95], v[44:47], a[124:127], v[80:95]
  ds_read_b64_tr_b16 v[36:37], v20 offset:27712
  ds_read_b64_tr_b16 v[38:39], v20 offset:30016
  v_cvt_pk_bf16_f32 v50, v68, v69
  v_cvt_pk_bf16_f32 v51, v70, v71
  s_waitcnt lgkmcnt(6)
  v_mfma_f32_32x32x16_bf16 v[80:95], v[24:27], a[128:131], v[80:95]
  ds_read_b64_tr_b16 v[40:41], v23 offset:128
  ds_read_b64_tr_b16 v[42:43], v23 offset:2432
  buffer_store_dwordx4 v[48:51], v1, s[12:15], s25 offen offset:0 sc0 sc1
  v_cvt_pk_bf16_f32 v52, v72, v73
  s_waitcnt lgkmcnt(6)
  v_mfma_f32_32x32x16_bf16 v[80:95], v[28:31], a[132:135], v[80:95]
  ds_read_b64_tr_b16 v[44:45], v23 offset:9344
  ds_read_b64_tr_b16 v[46:47], v23 offset:11648
  v_cvt_pk_bf16_f32 v53, v74, v75
  v_cvt_pk_bf16_f32 v54, v76, v77
  s_waitcnt lgkmcnt(6)
  v_mfma_f32_32x32x16_bf16 v[80:95], v[32:35], a[136:139], v[80:95]
  ds_read_b64_tr_b16 v[24:25], v23 offset:18560
  ds_read_b64_tr_b16 v[26:27], v23 offset:20864
  v_cvt_pk_bf16_f32 v55, v78, v79
  buffer_store_dwordx4 v[52:55], v1, s[12:15], s25 offen offset:1024 sc0 sc1
  s_waitcnt lgkmcnt(6)
  v_mfma_f32_32x32x16_bf16 v[80:95], v[36:39], a[140:143], v[80:95]
  ds_read_b64_tr_b16 v[28:29], v23 offset:27776
  ds_read_b64_tr_b16 v[30:31], v23 offset:30080
  s_waitcnt lgkmcnt(6)
  v_mfma_f32_32x32x16_bf16 v[96:111], v[40:43], a[112:115], v[96:111]
  ds_read_b64_tr_b16 v[32:33], v20 offset:128
  ds_read_b64_tr_b16 v[34:35], v20 offset:2432
  s_waitcnt lgkmcnt(6)
  v_mfma_f32_32x32x16_bf16 v[96:111], v[44:47], a[116:119], v[96:111]
  ds_read_b64_tr_b16 v[36:37], v20 offset:9344
  ds_read_b64_tr_b16 v[38:39], v20 offset:11648
  s_waitcnt lgkmcnt(6)
  v_mfma_f32_32x32x16_bf16 v[96:111], v[24:27], a[120:123], v[96:111]
  ds_read_b64_tr_b16 v[40:41], v20 offset:18560
  ds_read_b64_tr_b16 v[42:43], v20 offset:20864
  v_cvt_pk_bf16_f32 v56, v80, v81
  v_cvt_pk_bf16_f32 v57, v82, v83
  s_waitcnt lgkmcnt(6)
  v_mfma_f32_32x32x16_bf16 v[96:111], v[28:31], a[124:127], v[96:111]
  ds_read_b64_tr_b16 v[44:45], v20 offset:27776
  ds_read_b64_tr_b16 v[46:47], v20 offset:30080
  v_cvt_pk_bf16_f32 v58, v84, v85
  v_cvt_pk_bf16_f32 v59, v86, v87
  s_waitcnt lgkmcnt(6)
  v_mfma_f32_32x32x16_bf16 v[96:111], v[32:35], a[128:131], v[96:111]
  ds_read_b64_tr_b16 v[24:25], v23 offset:192
  ds_read_b64_tr_b16 v[26:27], v23 offset:2496
  buffer_store_dwordx4 v[56:59], v1, s[12:15], s25 offen offset:2048 sc0 sc1
  v_cvt_pk_bf16_f32 v60, v88, v89
  s_waitcnt lgkmcnt(6)
  v_mfma_f32_32x32x16_bf16 v[96:111], v[36:39], a[132:135], v[96:111]
  ds_read_b64_tr_b16 v[28:29], v23 offset:9408
  ds_read_b64_tr_b16 v[30:31], v23 offset:11712
  v_cvt_pk_bf16_f32 v61, v90, v91
  v_cvt_pk_bf16_f32 v62, v92, v93
  s_waitcnt lgkmcnt(6)
  v_mfma_f32_32x32x16_bf16 v[96:111], v[40:43], a[136:139], v[96:111]
  ds_read_b64_tr_b16 v[32:33], v23 offset:18624
  ds_read_b64_tr_b16 v[34:35], v23 offset:20928
  v_cvt_pk_bf16_f32 v63, v94, v95
  buffer_store_dwordx4 v[60:63], v1, s[12:15], s25 offen offset:3072 sc0 sc1
  s_waitcnt lgkmcnt(6)
  v_mfma_f32_32x32x16_bf16 v[96:111], v[44:47], a[140:143], v[96:111]
  ds_read_b64_tr_b16 v[36:37], v23 offset:27840
  ds_read_b64_tr_b16 v[38:39], v23 offset:30144
  s_waitcnt lgkmcnt(6)
  v_mfma_f32_32x32x16_bf16 v[112:127], v[24:27], a[112:115], v[112:127]
  ds_read_b64_tr_b16 v[40:41], v20 offset:192
  ds_read_b64_tr_b16 v[42:43], v20 offset:2496
  s_waitcnt lgkmcnt(6)
  v_mfma_f32_32x32x16_bf16 v[112:127], v[28:31], a[116:119], v[112:127]
  ds_read_b64_tr_b16 v[44:45], v20 offset:9408
  ds_read_b64_tr_b16 v[46:47], v20 offset:11712
  s_waitcnt lgkmcnt(6)
  v_mfma_f32_32x32x16_bf16 v[112:127], v[32:35], a[120:123], v[112:127]
  ds_read_b64_tr_b16 v[24:25], v20 offset:18624
  ds_read_b64_tr_b16 v[26:27], v20 offset:20928
  v_cvt_pk_bf16_f32 v48, v96, v97
  v_cvt_pk_bf16_f32 v49, v98, v99
  s_waitcnt lgkmcnt(6)
  v_mfma_f32_32x32x16_bf16 v[112:127], v[36:39], a[124:127], v[112:127]
  ds_read_b64_tr_b16 v[28:29], v20 offset:27840
  ds_read_b64_tr_b16 v[30:31], v20 offset:30144
  v_cvt_pk_bf16_f32 v50, v100, v101
  v_cvt_pk_bf16_f32 v51, v102, v103
  s_waitcnt lgkmcnt(6)
  v_mfma_f32_32x32x16_bf16 v[112:127], v[40:43], a[128:131], v[112:127]
  ds_read_b64_tr_b16 v[32:33], v23 offset:256
  ds_read_b64_tr_b16 v[34:35], v23 offset:2560
  s_add_u32 s25, s25, 4096
  buffer_store_dwordx4 v[48:51], v1, s[12:15], s25 offen offset:0 sc0 sc1
  s_waitcnt lgkmcnt(6)
  v_mfma_f32_32x32x16_bf16 v[112:127], v[44:47], a[132:135], v[112:127]
  ds_read_b64_tr_b16 v[36:37], v23 offset:9472
  ds_read_b64_tr_b16 v[38:39], v23 offset:11776
  v_cvt_pk_bf16_f32 v52, v104, v105
  v_cvt_pk_bf16_f32 v53, v106, v107
  s_waitcnt lgkmcnt(6)
  v_mfma_f32_32x32x16_bf16 v[112:127], v[24:27], a[136:139], v[112:127]
  ds_read_b64_tr_b16 v[40:41], v23 offset:18688
  ds_read_b64_tr_b16 v[42:43], v23 offset:20992
  v_cvt_pk_bf16_f32 v54, v108, v109
  v_cvt_pk_bf16_f32 v55, v110, v111
  s_waitcnt lgkmcnt(6)
  v_mfma_f32_32x32x16_bf16 v[112:127], v[28:31], a[140:143], v[112:127]
  ds_read_b64_tr_b16 v[44:45], v23 offset:27904
  ds_read_b64_tr_b16 v[46:47], v23 offset:30208
  buffer_store_dwordx4 v[52:55], v1, s[12:15], s25 offen offset:1024 sc0 sc1
  s_waitcnt lgkmcnt(6)
  v_mfma_f32_32x32x16_bf16 v[128:143], v[32:35], a[112:115], v[128:143]
  ds_read_b64_tr_b16 v[24:25], v20 offset:256
  ds_read_b64_tr_b16 v[26:27], v20 offset:2560
  s_waitcnt lgkmcnt(6)
  v_mfma_f32_32x32x16_bf16 v[128:143], v[36:39], a[116:119], v[128:143]
  ds_read_b64_tr_b16 v[28:29], v20 offset:9472
  ds_read_b64_tr_b16 v[30:31], v20 offset:11776
  s_waitcnt lgkmcnt(6)
  v_mfma_f32_32x32x16_bf16 v[128:143], v[40:43], a[120:123], v[128:143]
  ds_read_b64_tr_b16 v[32:33], v20 offset:18688
  ds_read_b64_tr_b16 v[34:35], v20 offset:20992
  v_cvt_pk_bf16_f32 v56, v112, v113
  v_cvt_pk_bf16_f32 v57, v114, v115
  s_waitcnt lgkmcnt(6)
  v_mfma_f32_32x32x16_bf16 v[128:143], v[44:47], a[124:127], v[128:143]
  ds_read_b64_tr_b16 v[36:37], v20 offset:27904
  ds_read_b64_tr_b16 v[38:39], v20 offset:30208
  v_cvt_pk_bf16_f32 v58, v116, v117
  v_cvt_pk_bf16_f32 v59, v118, v119
  s_waitcnt lgkmcnt(6)
  v_mfma_f32_32x32x16_bf16 v[128:143], v[24:27], a[128:131], v[128:143]
  ds_read_b64_tr_b16 v[40:41], v23 offset:320
  ds_read_b64_tr_b16 v[42:43], v23 offset:2624
  buffer_store_dwordx4 v[56:59], v1, s[12:15], s25 offen offset:2048 sc0 sc1
  v_cvt_pk_bf16_f32 v60, v120, v121
  s_waitcnt lgkmcnt(6)
  v_mfma_f32_32x32x16_bf16 v[128:143], v[28:31], a[132:135], v[128:143]
  ds_read_b64_tr_b16 v[44:45], v23 offset:9536
  ds_read_b64_tr_b16 v[46:47], v23 offset:11840
  v_cvt_pk_bf16_f32 v61, v122, v123
  v_cvt_pk_bf16_f32 v62, v124, v125
  s_waitcnt lgkmcnt(6)
  v_mfma_f32_32x32x16_bf16 v[128:143], v[32:35], a[136:139], v[128:143]
  ds_read_b64_tr_b16 v[24:25], v23 offset:18752
  ds_read_b64_tr_b16 v[26:27], v23 offset:21056
  v_cvt_pk_bf16_f32 v63, v126, v127
  buffer_store_dwordx4 v[60:63], v1, s[12:15], s25 offen offset:3072 sc0 sc1
  s_waitcnt lgkmcnt(6)
  v_mfma_f32_32x32x16_bf16 v[128:143], v[36:39], a[140:143], v[128:143]
  ds_read_b64_tr_b16 v[28:29], v23 offset:27968
  ds_read_b64_tr_b16 v[30:31], v23 offset:30272
  s_waitcnt lgkmcnt(6)
  v_mfma_f32_32x32x16_bf16 v[144:159], v[40:43], a[112:115], v[144:159]
  ds_read_b64_tr_b16 v[32:33], v20 offset:320
  ds_read_b64_tr_b16 v[34:35], v20 offset:2624
  s_waitcnt lgkmcnt(6)
  v_mfma_f32_32x32x16_bf16 v[144:159], v[44:47], a[116:119], v[144:159]
  ds_read_b64_tr_b16 v[36:37], v20 offset:9536
  ds_read_b64_tr_b16 v[38:39], v20 offset:11840
  s_waitcnt lgkmcnt(6)
  v_mfma_f32_32x32x16_bf16 v[144:159], v[24:27], a[120:123], v[144:159]
  ds_read_b64_tr_b16 v[40:41], v20 offset:18752
  ds_read_b64_tr_b16 v[42:43], v20 offset:21056
  v_cvt_pk_bf16_f32 v48, v128, v129
  v_cvt_pk_bf16_f32 v49, v130, v131
  s_waitcnt lgkmcnt(6)
  v_mfma_f32_32x32x16_bf16 v[144:159], v[28:31], a[124:127], v[144:159]
  ds_read_b64_tr_b16 v[44:45], v20 offset:27968
  ds_read_b64_tr_b16 v[46:47], v20 offset:30272
  v_cvt_pk_bf16_f32 v50, v132, v133
  v_cvt_pk_bf16_f32 v51, v134, v135
  s_waitcnt lgkmcnt(6)
  v_mfma_f32_32x32x16_bf16 v[144:159], v[32:35], a[128:131], v[144:159]
  ds_read_b64_tr_b16 v[24:25], v23 offset:384
  ds_read_b64_tr_b16 v[26:27], v23 offset:2688
  s_add_u32 s25, s25, 4096
  buffer_store_dwordx4 v[48:51], v1, s[12:15], s25 offen offset:0 sc0 sc1
  s_waitcnt lgkmcnt(6)
  v_mfma_f32_32x32x16_bf16 v[144:159], v[36:39], a[132:135], v[144:159]
  ds_read_b64_tr_b16 v[28:29], v23 offset:9600
  ds_read_b64_tr_b16 v[30:31], v23 offset:11904
  v_cvt_pk_bf16_f32 v52, v136, v137
  v_cvt_pk_bf16_f32 v53, v138, v139
  s_waitcnt lgkmcnt(6)
  v_mfma_f32_32x32x16_bf16 v[144:159], v[40:43], a[136:139], v[144:159]
  ds_read_b64_tr_b16 v[32:33], v23 offset:18816
  ds_read_b64_tr_b16 v[34:35], v23 offset:21120
  v_cvt_pk_bf16_f32 v54, v140, v141
  v_cvt_pk_bf16_f32 v55, v142, v143
  s_waitcnt lgkmcnt(6)
  v_mfma_f32_32x32x16_bf16 v[144:159], v[44:47], a[140:143], v[144:159]
  ds_read_b64_tr_b16 v[36:37], v23 offset:28032
  ds_read_b64_tr_b16 v[38:39], v23 offset:30336
  buffer_store_dwordx4 v[52:55], v1, s[12:15], s25 offen offset:1024 sc0 sc1
  s_waitcnt lgkmcnt(6)
  v_mfma_f32_32x32x16_bf16 v[160:175], v[24:27], a[112:115], v[160:175]
  ds_read_b64_tr_b16 v[40:41], v20 offset:384
  ds_read_b64_tr_b16 v[42:43], v20 offset:2688
  s_waitcnt lgkmcnt(6)
  v_mfma_f32_32x32x16_bf16 v[160:175], v[28:31], a[116:119], v[160:175]
  ds_read_b64_tr_b16 v[44:45], v20 offset:9600
  ds_read_b64_tr_b16 v[46:47], v20 offset:11904
  s_waitcnt lgkmcnt(6)
  v_mfma_f32_32x32x16_bf16 v[160:175], v[32:35], a[120:123], v[160:175]
  ds_read_b64_tr_b16 v[24:25], v20 offset:18816
  ds_read_b64_tr_b16 v[26:27], v20 offset:21120
  v_cvt_pk_bf16_f32 v56, v144, v145
  v_cvt_pk_bf16_f32 v57, v146, v147
  s_waitcnt lgkmcnt(6)
  v_mfma_f32_32x32x16_bf16 v[160:175], v[36:39], a[124:127], v[160:175]
  ds_read_b64_tr_b16 v[28:29], v20 offset:28032
  ds_read_b64_tr_b16 v[30:31], v20 offset:30336
  v_cvt_pk_bf16_f32 v58, v148, v149
  v_cvt_pk_bf16_f32 v59, v150, v151
  s_waitcnt lgkmcnt(6)
  v_mfma_f32_32x32x16_bf16 v[160:175], v[40:43], a[128:131], v[160:175]
  ds_read_b64_tr_b16 v[32:33], v23 offset:448
  ds_read_b64_tr_b16 v[34:35], v23 offset:2752
  buffer_store_dwordx4 v[56:59], v1, s[12:15], s25 offen offset:2048 sc0 sc1
  v_cvt_pk_bf16_f32 v60, v152, v153
  s_waitcnt lgkmcnt(6)
  v_mfma_f32_32x32x16_bf16 v[160:175], v[44:47], a[132:135], v[160:175]
  ds_read_b64_tr_b16 v[36:37], v23 offset:9664
  ds_read_b64_tr_b16 v[38:39], v23 offset:11968
  v_cvt_pk_bf16_f32 v61, v154, v155
  v_cvt_pk_bf16_f32 v62, v156, v157
  s_waitcnt lgkmcnt(6)
  v_mfma_f32_32x32x16_bf16 v[160:175], v[24:27], a[136:139], v[160:175]
  ds_read_b64_tr_b16 v[40:41], v23 offset:18880
  ds_read_b64_tr_b16 v[42:43], v23 offset:21184
  v_cvt_pk_bf16_f32 v63, v158, v159
  buffer_store_dwordx4 v[60:63], v1, s[12:15], s25 offen offset:3072 sc0 sc1
  s_waitcnt lgkmcnt(6)
  v_mfma_f32_32x32x16_bf16 v[160:175], v[28:31], a[140:143], v[160:175]
  ds_read_b64_tr_b16 v[44:45], v23 offset:28096
  ds_read_b64_tr_b16 v[46:47], v23 offset:30400
  s_waitcnt lgkmcnt(6)
  v_mfma_f32_32x32x16_bf16 v[176:191], v[32:35], a[112:115], v[176:191]
  ds_read_b64_tr_b16 v[24:25], v20 offset:448
  ds_read_b64_tr_b16 v[26:27], v20 offset:2752
  s_waitcnt lgkmcnt(6)
  v_mfma_f32_32x32x16_bf16 v[176:191], v[36:39], a[116:119], v[176:191]
  ds_read_b64_tr_b16 v[28:29], v20 offset:9664
  ds_read_b64_tr_b16 v[30:31], v20 offset:11968
  s_waitcnt lgkmcnt(6)
  v_mfma_f32_32x32x16_bf16 v[176:191], v[40:43], a[120:123], v[176:191]
  ds_read_b64_tr_b16 v[32:33], v20 offset:18880
  ds_read_b64_tr_b16 v[34:35], v20 offset:21184
  v_cvt_pk_bf16_f32 v48, v160, v161
  v_cvt_pk_bf16_f32 v49, v162, v163
  s_waitcnt lgkmcnt(6)
  v_mfma_f32_32x32x16_bf16 v[176:191], v[44:47], a[124:127], v[176:191]
  ds_read_b64_tr_b16 v[36:37], v20 offset:28096
  ds_read_b64_tr_b16 v[38:39], v20 offset:30400
  v_cvt_pk_bf16_f32 v50, v164, v165
  v_cvt_pk_bf16_f32 v51, v166, v167
  s_waitcnt lgkmcnt(6)
  v_mfma_f32_32x32x16_bf16 v[176:191], v[24:27], a[128:131], v[176:191]
  ds_read_b64_tr_b16 v[40:41], v23 offset:512
  ds_read_b64_tr_b16 v[42:43], v23 offset:2816
  s_add_u32 s25, s25, 4096
  buffer_store_dwordx4 v[48:51], v1, s[12:15], s25 offen offset:0 sc0 sc1
  s_waitcnt lgkmcnt(6)
  v_mfma_f32_32x32x16_bf16 v[176:191], v[28:31], a[132:135], v[176:191]
  ds_read_b64_tr_b16 v[44:45], v23 offset:9728
  ds_read_b64_tr_b16 v[46:47], v23 offset:12032
  v_cvt_pk_bf16_f32 v52, v168, v169
  v_cvt_pk_bf16_f32 v53, v170, v171
  s_waitcnt lgkmcnt(6)
  v_mfma_f32_32x32x16_bf16 v[176:191], v[32:35], a[136:139], v[176:191]
  ds_read_b64_tr_b16 v[24:25], v23 offset:18944
  ds_read_b64_tr_b16 v[26:27], v23 offset:21248
  v_cvt_pk_bf16_f32 v54, v172, v173
  v_cvt_pk_bf16_f32 v55, v174, v175
  s_waitcnt lgkmcnt(6)
  v_mfma_f32_32x32x16_bf16 v[176:191], v[36:39], a[140:143], v[176:191]
  ds_read_b64_tr_b16 v[28:29], v23 offset:28160
  ds_read_b64_tr_b16 v[30:31], v23 offset:30464
  buffer_store_dwordx4 v[52:55], v1, s[12:15], s25 offen offset:1024 sc0 sc1
  s_waitcnt lgkmcnt(6)
  v_mfma_f32_32x32x16_bf16 v[192:207], v[40:43], a[112:115], v[192:207]
  ds_read_b64_tr_b16 v[32:33], v20 offset:512
  ds_read_b64_tr_b16 v[34:35], v20 offset:2816
  s_waitcnt lgkmcnt(6)
  v_mfma_f32_32x32x16_bf16 v[192:207], v[44:47], a[116:119], v[192:207]
  ds_read_b64_tr_b16 v[36:37], v20 offset:9728
  ds_read_b64_tr_b16 v[38:39], v20 offset:12032
  s_waitcnt lgkmcnt(6)
  v_mfma_f32_32x32x16_bf16 v[192:207], v[24:27], a[120:123], v[192:207]
  ds_read_b64_tr_b16 v[40:41], v20 offset:18944
  ds_read_b64_tr_b16 v[42:43], v20 offset:21248
  v_cvt_pk_bf16_f32 v56, v176, v177
  v_cvt_pk_bf16_f32 v57, v178, v179
  s_waitcnt lgkmcnt(6)
  v_mfma_f32_32x32x16_bf16 v[192:207], v[28:31], a[124:127], v[192:207]
  ds_read_b64_tr_b16 v[44:45], v20 offset:28160
  ds_read_b64_tr_b16 v[46:47], v20 offset:30464
  v_cvt_pk_bf16_f32 v58, v180, v181
  v_cvt_pk_bf16_f32 v59, v182, v183
  s_waitcnt lgkmcnt(6)
  v_mfma_f32_32x32x16_bf16 v[192:207], v[32:35], a[128:131], v[192:207]
  buffer_store_dwordx4 v[56:59], v1, s[12:15], s25 offen offset:2048 sc0 sc1
  v_cvt_pk_bf16_f32 v60, v184, v185
  s_waitcnt lgkmcnt(4)
  v_mfma_f32_32x32x16_bf16 v[192:207], v[36:39], a[132:135], v[192:207]
  v_cvt_pk_bf16_f32 v61, v186, v187
  v_cvt_pk_bf16_f32 v62, v188, v189
  s_waitcnt lgkmcnt(2)
  v_mfma_f32_32x32x16_bf16 v[192:207], v[40:43], a[136:139], v[192:207]
  v_cvt_pk_bf16_f32 v63, v190, v191
  buffer_store_dwordx4 v[60:63], v1, s[12:15], s25 offen offset:3072 sc0 sc1
  s_waitcnt lgkmcnt(0)
  v_mfma_f32_32x32x16_bf16 v[192:207], v[44:47], a[140:143], v[192:207]
  s_nop 11
  v_cvt_pk_bf16_f32 v48, v192, v193
  v_cvt_pk_bf16_f32 v49, v194, v195
  v_cvt_pk_bf16_f32 v50, v196, v197
  v_cvt_pk_bf16_f32 v51, v198, v199
  s_add_u32 s25, s25, 4096
  buffer_store_dwordx4 v[48:51], v1, s[12:15], s25 offen offset:0 sc0 sc1
  v_cvt_pk_bf16_f32 v52, v200, v201
  v_cvt_pk_bf16_f32 v53, v202, v203
  v_cvt_pk_bf16_f32 v54, v204, v205
  v_cvt_pk_bf16_f32 v55, v206, v207
  buffer_store_dwordx4 v[52:55], v1, s[12:15], s25 offen offset:1024 sc0 sc1
L_k6_down_kernel_end:
  s_endpgm
.globl k7_red_kernel
.p2align 8
.type k7_red_kernel,@function
k7_red_kernel:
  s_cmp_ge_u32 s2, 256
  s_cbranch_scc1 L_k7_red_kernel_end
  s_load_dwordx2 s[4:5], s[0:1], 104
  s_mov_b32 s6, 2359296
  s_mov_b32 s7, 0x00020000
  s_load_dwordx2 s[8:9], s[0:1], 104
  s_mov_b32 s10, 13824
  s_mov_b32 s11, 0x00020000
  s_load_dwordx2 s[12:13], s[0:1], 104
  s_mov_b32 s14, 18874368
  s_mov_b32 s15, 0x00020000
  s_load_dwordx2 s[16:17], s[0:1], 88
  s_mov_b32 s18, 2359296
  s_mov_b32 s19, 0x00020000
  s_load_dwordx2 s[20:21], s[0:1], 104
  s_mov_b32 s22, 2359296
  s_mov_b32 s23, 0x00020000
  s_mov_b32 s24, 0xffff0000
  v_and_b32 v1, 7, v0
  v_bfe_u32 v2, v0, 3, 1
  v_lshrrev_b32 v3, 4, v0
  s_lshl_b32 s25, s2, 3
  v_add_u32 v4, s25, v1
  v_mul_u32_u24 v4, 1152, v4
  v_lshl_add_u32 v4, v3, 5, v4
  v_lshl_add_u32 v4, v2, 4, v4
  s_lshr_b32 s26, s2, 2
  s_mul_i32 s26, s26, 36864
  s_and_b32 s27, s2, 3
  s_lshl_b32 s27, s27, 7
  s_add_u32 s26, s26, s27
  v_lshlrev_b32 v5, 10, v3
  v_lshl_add_u32 v5, v2, 9, v5
  v_lshl_add_u32 v5, v1, 4, v5
  v_add_u32 v5, s26, v5
  v_lshlrev_b32 v6, 6, v3
  v_lshl_add_u32 v6, v2, 5, v6
  v_lshlrev_b32 v7, 2, v0
  v_lshlrev_b32 v8, 2, v1
  s_waitcnt lgkmcnt(0)
  s_add_u32 s4, s4, 4194304
  s_addc_u32 s5, s5, 0
  s_add_u32 s12, s12, 33554432
  s_addc_u32 s13, s13, 0
  s_add_u32 s20, s20, 4194304
  s_addc_u32 s21, s21, 0
  buffer_load_dwordx4 v[10:13], v4, s[4:7], 0 offen
  s_mov_b32 s28, 0
  buffer_load_dwordx4 v[80:83], v5, s[12:15], s28 offen
  s_mov_b32 s28, 2359296
  buffer_load_dwordx4 v[84:87], v5, s[12:15], s28 offen
  s_mov_b32 s28, 4718592
  buffer_load_dwordx4 v[88:91], v5, s[12:15], s28 offen
  s_mov_b32 s28, 7077888
  buffer_load_dwordx4 v[92:95], v5, s[12:15], s28 offen
  s_mov_b32 s28, 9437184
  buffer_load_dwordx4 v[96:99], v5, s[12:15], s28 offen
  s_mov_b32 s28, 11796480
  buffer_load_dwordx4 v[100:103], v5, s[12:15], s28 offen
  s_mov_b32 s28, 14155776
  buffer_load_dwordx4 v[104:107], v5, s[12:15], s28 offen
  s_mov_b32 s28, 16515072
  buffer_load_dwordx4 v[108:111], v5, s[12:15], s28 offen
  s_mov_b32 s28, 11520
  buffer_load_dwordx4 v[40:43], v6, s[8:11], s28 offen
  buffer_load_dwordx4 v[44:47], v6, s[8:11], s28 offen offset:16
  s_waitcnt vmcnt(10)
  v_lshlrev_b32 v20, 16, v10
  v_and_b32 v21, s24, v10
  v_lshlrev_b32 v22, 16, v11
  v_and_b32 v23, s24, v11
  v_lshlrev_b32 v24, 16, v12
  v_and_b32 v25, s24, v12
  v_lshlrev_b32 v26, 16, v13
  v_and_b32 v27, s24, v13
  s_waitcnt vmcnt(9)
  v_lshlrev_b32 v30, 16, v80
  v_and_b32 v31, s24, v80
  v_lshlrev_b32 v32, 16, v81
  v_and_b32 v33, s24, v81
  v_lshlrev_b32 v34, 16, v82
  v_and_b32 v35, s24, v82
  v_lshlrev_b32 v36, 16, v83
  v_and_b32 v37, s24, v83
  s_waitcnt vmcnt(8)
  v_lshlrev_b32 v64, 16, v84
  v_and_b32 v65, s24, v84
  v_lshlrev_b32 v66, 16, v85
  v_and_b32 v67, s24, v85
  v_lshlrev_b32 v68, 16, v86
  v_and_b32 v69, s24, v86
  v_lshlrev_b32 v70, 16, v87
  v_and_b32 v71, s24, v87
  v_add_f32 v30, v30, v64
  v_add_f32 v31, v31, v65
  v_add_f32 v32, v32, v66
  v_add_f32 v33, v33, v67
  v_add_f32 v34, v34, v68
  v_add_f32 v35, v35, v69
  v_add_f32 v36, v36, v70
  v_add_f32 v37, v37, v71
  s_waitcnt vmcnt(7)
  v_lshlrev_b32 v64, 16, v88
  v_and_b32 v65, s24, v88
  v_lshlrev_b32 v66, 16, v89
  v_and_b32 v67, s24, v89
  v_lshlrev_b32 v68, 16, v90
  v_and_b32 v69, s24, v90
  v_lshlrev_b32 v70, 16, v91
  v_and_b32 v71, s24, v91
  v_add_f32 v30, v30, v64
  v_add_f32 v31, v31, v65
  v_add_f32 v32, v32, v66
  v_add_f32 v33, v33, v67
  v_add_f32 v34, v34, v68
  v_add_f32 v35, v35, v69
  v_add_f32 v36, v36, v70
  v_add_f32 v37, v37, v71
  s_waitcnt vmcnt(6)
  v_lshlrev_b32 v64, 16, v92
  v_and_b32 v65, s24, v92
  v_lshlrev_b32 v66, 16, v93
  v_and_b32 v67, s24, v93
  v_lshlrev_b32 v68, 16, v94
  v_and_b32 v69, s24, v94
  v_lshlrev_b32 v70, 16, v95
  v_and_b32 v71, s24, v95
  v_add_f32 v30, v30, v64
  v_add_f32 v31, v31, v65
  v_add_f32 v32, v32, v66
  v_add_f32 v33, v33, v67
  v_add_f32 v34, v34, v68
  v_add_f32 v35, v35, v69
  v_add_f32 v36, v36, v70
  v_add_f32 v37, v37, v71
  s_waitcnt vmcnt(5)
  v_lshlrev_b32 v64, 16, v96
  v_and_b32 v65, s24, v96
  v_lshlrev_b32 v66, 16, v97
  v_and_b32 v67, s24, v97
  v_lshlrev_b32 v68, 16, v98
  v_and_b32 v69, s24, v98
  v_lshlrev_b32 v70, 16, v99
  v_and_b32 v71, s24, v99
  v_add_f32 v30, v30, v64
  v_add_f32 v31, v31, v65
  v_add_f32 v32, v32, v66
  v_add_f32 v33, v33, v67
  v_add_f32 v34, v34, v68
  v_add_f32 v35, v35, v69
  v_add_f32 v36, v36, v70
  v_add_f32 v37, v37, v71
  s_waitcnt vmcnt(4)
  v_lshlrev_b32 v64, 16, v100
  v_and_b32 v65, s24, v100
  v_lshlrev_b32 v66, 16, v101
  v_and_b32 v67, s24, v101
  v_lshlrev_b32 v68, 16, v102
  v_and_b32 v69, s24, v102
  v_lshlrev_b32 v70, 16, v103
  v_and_b32 v71, s24, v103
  v_add_f32 v30, v30, v64
  v_add_f32 v31, v31, v65
  v_add_f32 v32, v32, v66
  v_add_f32 v33, v33, v67
  v_add_f32 v34, v34, v68
  v_add_f32 v35, v35, v69
  v_add_f32 v36, v36, v70
  v_add_f32 v37, v37, v71
  s_waitcnt vmcnt(3)
  v_lshlrev_b32 v64, 16, v104
  v_and_b32 v65, s24, v104
  v_lshlrev_b32 v66, 16, v105
  v_and_b32 v67, s24, v105
  v_lshlrev_b32 v68, 16, v106
  v_and_b32 v69, s24, v106
  v_lshlrev_b32 v70, 16, v107
  v_and_b32 v71, s24, v107
  v_add_f32 v30, v30, v64
  v_add_f32 v31, v31, v65
  v_add_f32 v32, v32, v66
  v_add_f32 v33, v33, v67
  v_add_f32 v34, v34, v68
  v_add_f32 v35, v35, v69
  v_add_f32 v36, v36, v70
  v_add_f32 v37, v37, v71
  s_waitcnt vmcnt(2)
  v_lshlrev_b32 v64, 16, v108
  v_and_b32 v65, s24, v108
  v_lshlrev_b32 v66, 16, v109
  v_and_b32 v67, s24, v109
  v_lshlrev_b32 v68, 16, v110
  v_and_b32 v69, s24, v110
  v_lshlrev_b32 v70, 16, v111
  v_and_b32 v71, s24, v111
  v_add_f32 v30, v30, v64
  v_add_f32 v31, v31, v65
  v_add_f32 v32, v32, v66
  v_add_f32 v33, v33, v67
  v_add_f32 v34, v34, v68
  v_add_f32 v35, v35, v69
  v_add_f32 v36, v36, v70
  v_add_f32 v37, v37, v71
  s_waitcnt vmcnt(0)
  v_cvt_pk_bf16_f32 v64, v30, v31
  v_cvt_pk_bf16_f32 v65, v32, v33
  v_cvt_pk_bf16_f32 v66, v34, v35
  v_cvt_pk_bf16_f32 v67, v36, v37
  v_lshlrev_b32 v30, 16, v64
  v_and_b32 v31, s24, v64
  v_lshlrev_b32 v32, 16, v65
  v_and_b32 v33, s24, v65
  v_lshlrev_b32 v34, 16, v66
  v_and_b32 v35, s24, v66
  v_lshlrev_b32 v36, 16, v67
  v_and_b32 v37, s24, v67
  v_mul_f32 v30, v30, v40
  v_mul_f32 v31, v31, v41
  v_mul_f32 v32, v32, v42
  v_mul_f32 v33, v33, v43
  v_mul_f32 v34, v34, v44
  v_mul_f32 v35, v35, v45
  v_mul_f32 v36, v36, v46
  v_mul_f32 v37, v37, v47
  v_cvt_pk_bf16_f32 v64, v30, v31
  v_cvt_pk_bf16_f32 v65, v32, v33
  v_cvt_pk_bf16_f32 v66, v34, v35
  v_cvt_pk_bf16_f32 v67, v36, v37
  v_lshlrev_b32 v30, 16, v64
  v_and_b32 v31, s24, v64
  v_lshlrev_b32 v32, 16, v65
  v_and_b32 v33, s24, v65
  v_lshlrev_b32 v34, 16, v66
  v_and_b32 v35, s24, v66
  v_lshlrev_b32 v36, 16, v67
  v_and_b32 v37, s24, v67
  v_add_f32 v20, v20, v30
  v_add_f32 v21, v21, v31
  v_add_f32 v22, v22, v32
  v_add_f32 v23, v23, v33
  v_add_f32 v24, v24, v34
  v_add_f32 v25, v25, v35
  v_add_f32 v26, v26, v36
  v_add_f32 v27, v27, v37
  v_cvt_pk_bf16_f32 v64, v20, v21
  v_cvt_pk_bf16_f32 v65, v22, v23
  v_cvt_pk_bf16_f32 v66, v24, v25
  v_cvt_pk_bf16_f32 v67, v26, v27
  buffer_store_dwordx4 v[64:67], v4, s[16:19], 0 offen sc0 sc1
L_k7_red_kernel_end:
  s_endpgm
.section .rodata,"a"
.p2align 6
.amdhsa_kernel k0_mod_kernel
  .amdhsa_next_free_vgpr 80
  .amdhsa_next_free_sgpr 102
  .amdhsa_accum_offset 80
  .amdhsa_group_segment_fixed_size 0
  .amdhsa_kernarg_size 112
  .amdhsa_user_sgpr_count 2
  .amdhsa_user_sgpr_kernarg_segment_ptr 1
  .amdhsa_system_sgpr_workgroup_id_x 1
.end_amdhsa_kernel
.p2align 6
.amdhsa_kernel k1_ln_kernel
  .amdhsa_next_free_vgpr 112
  .amdhsa_next_free_sgpr 102
  .amdhsa_accum_offset 112
  .amdhsa_group_segment_fixed_size 0
  .amdhsa_kernarg_size 112
  .amdhsa_user_sgpr_count 2
  .amdhsa_user_sgpr_kernarg_segment_ptr 1
  .amdhsa_system_sgpr_workgroup_id_x 1
.end_amdhsa_kernel
.p2align 6
.amdhsa_kernel k2_attn_kernel
  .amdhsa_next_free_vgpr 400
  .amdhsa_next_free_sgpr 102
  .amdhsa_accum_offset 256
  .amdhsa_group_segment_fixed_size 0
  .amdhsa_kernarg_size 112
  .amdhsa_user_sgpr_count 2
  .amdhsa_user_sgpr_kernarg_segment_ptr 1
  .amdhsa_system_sgpr_workgroup_id_x 1
.end_amdhsa_kernel
.p2align 6
.amdhsa_kernel k3_oproj_kernel
  .amdhsa_next_free_vgpr 400
  .amdhsa_next_free_sgpr 102
  .amdhsa_accum_offset 256
  .amdhsa_group_segment_fixed_size 0
  .amdhsa_kernarg_size 112
  .amdhsa_user_sgpr_count 2
  .amdhsa_user_sgpr_kernarg_segment_ptr 1
  .amdhsa_system_sgpr_workgroup_id_x 1
.end_amdhsa_kernel
.p2align 6
.amdhsa_kernel k4_red_kernel
  .amdhsa_next_free_vgpr 112
  .amdhsa_next_free_sgpr 102
  .amdhsa_accum_offset 112
  .amdhsa_group_segment_fixed_size 0
  .amdhsa_kernarg_size 112
  .amdhsa_user_sgpr_count 2
  .amdhsa_user_sgpr_kernarg_segment_ptr 1
  .amdhsa_system_sgpr_workgroup_id_x 1
.end_amdhsa_kernel
.p2align 6
.amdhsa_kernel k5_gateup_kernel
  .amdhsa_next_free_vgpr 512
  .amdhsa_next_free_sgpr 102
  .amdhsa_accum_offset 256
  .amdhsa_group_segment_fixed_size 0
  .amdhsa_kernarg_size 112
  .amdhsa_user_sgpr_count 2
  .amdhsa_user_sgpr_kernarg_segment_ptr 1
  .amdhsa_system_sgpr_workgroup_id_x 1
.end_amdhsa_kernel
.p2align 6
.amdhsa_kernel k6_down_kernel
  .amdhsa_next_free_vgpr 400
  .amdhsa_next_free_sgpr 102
  .amdhsa_accum_offset 256
  .amdhsa_group_segment_fixed_size 0
  .amdhsa_kernarg_size 112
  .amdhsa_user_sgpr_count 2
  .amdhsa_user_sgpr_kernarg_segment_ptr 1
  .amdhsa_system_sgpr_workgroup_id_x 1
.end_amdhsa_kernel
.p2align 6
.amdhsa_kernel k7_red_kernel
  .amdhsa_next_free_vgpr 112
  .amdhsa_next_free_sgpr 102
  .amdhsa_accum_offset 112
  .amdhsa_group_segment_fixed_size 0
  .amdhsa_kernarg_size 112
  .amdhsa_user_sgpr_count 2
  .amdhsa_user_sgpr_kernarg_segment_ptr 1
  .amdhsa_system_sgpr_workgroup_id_x 1
.end_amdhsa_kernel
```
